```python
import torch

def _softmax(x, axis=-1):
    return torch.softmax(x, dim=axis)

def _gelu(x):
    return torch.nn.functional.gelu(x, approximate='tanh')

def _silu(x):
    return torch.nn.functional.silu(x)

def _sigmoid(x):
    return torch.sigmoid(x)

def _layernorm(x, axis=-1, eps=1e-05):
    m = x.mean(dim=axis, keepdim=True)
    v = x.var(dim=axis, keepdim=True, unbiased=False)
    return (x - m) / torch.sqrt(v + eps)

def _scatter_add(tgt, idx, src, axis=0):
    return tgt.clone().index_add_(axis, idx, src)

def _segment_sum(src, seg, n):
    out = torch.zeros((n,) + src.shape[1:], dtype=src.dtype)
    return out.index_add_(0, seg, src)

def _pad(x, pw):
    flat = tuple((v for pair in reversed(pw) for v in pair))
    return torch.nn.functional.pad(x, flat)
kernel_name = 'recurrent_scan__memory_aug_recurrent_mem_tr__glu_gated_reglu__prompt'

def setup_inputs():

    _w = lambda a: (lambda t: t.to(torch.bfloat16) if t.is_floating_point() else t)(torch.as_tensor(a))

    def _A_setup():
        B, S, Dm = (1, 2048, 448)
        H, Dh = (16, 256)
        M, seg = (8, 32)
        seg = min(seg, S)
        S = S // seg * seg
        return {'x': _w((lambda *s: torch.randn(*s, dtype=torch.bfloat16) * 0.1)(B, S, Dm)), 'mem0': _w((lambda *s: torch.randn(*s, dtype=torch.bfloat16) * 1.6)(B, M, Dm)), 'Wq': _w((lambda *s: torch.randn(*s, dtype=torch.bfloat16) * 0.8)(Dm, H, Dh) * Dm ** (-0.5)), 'Wk': _w((lambda *s: torch.randn(*s, dtype=torch.bfloat16) * 0.8)(Dm, H, Dh) * Dm ** (-0.5)), 'Wv': _w((lambda *s: torch.randn(*s, dtype=torch.bfloat16) * 1.6)(Dm, H, Dh) * Dm ** (-0.5)), 'Wo': _w((lambda *s: torch.randn(*s, dtype=torch.bfloat16) * 1.6)(H, Dh, Dm) * (H * Dh) ** (-0.5)), 'seg_len': seg}
    _A_in = _A_setup()

    def _B_setup():
        B, S, D, F = (1, 2048, 448, 1792)
        return {'x': _w((lambda *s: torch.randn(*s, dtype=torch.bfloat16) * 0.1)(B, S, D)), 'W_gate': _w((lambda *s: torch.randn(*s, dtype=torch.bfloat16) * 0.4)(D, F) * (2.0 / D) ** 0.5), 'W_up': _w((lambda *s: torch.randn(*s, dtype=torch.bfloat16) * 0.4)(D, F) * (2.0 / D) ** 0.5), 'W_down': _w((lambda *s: torch.randn(*s, dtype=torch.bfloat16) * 0.4)(F, D) * (1.0 / F) ** 0.5)}
    _B_in = _B_setup()
    return {'A_x': _A_in['x'], 'A_mem0': _A_in['mem0'], 'A_Wq': _A_in['Wq'], 'A_Wk': _A_in['Wk'], 'A_Wv': _A_in['Wv'], 'A_Wo': _A_in['Wo'], 'A_seg_len': _A_in['seg_len'], 'B_x': _B_in['x'], 'B_W_gate': _B_in['W_gate'], 'B_W_up': _B_in['W_up'], 'B_W_down': _B_in['W_down']}

def reference(A_x, A_mem0, A_Wq, A_Wk, A_Wv, A_Wo, A_seg_len, B_x, B_W_gate, B_W_up, B_W_down):

    def _A_ref(x, mem0, Wq, Wk, Wv, Wo, seg_len):
        B, S, Dm = x.shape
        H, Dh = (Wq.shape[1], Wq.shape[2])
        M = mem0.shape[1]
        scale = Dh ** (-0.5)
        n_seg = S // seg_len
        L = M + seg_len
        idx = torch.arange(L)
        mask = (idx[:, None] < M) | (idx[:, None] >= idx[None, :])
        mem = mem0
        outs = []
        for s in range(n_seg):
            xs = x[:, s * seg_len:(s + 1) * seg_len, :].clone()
            h = torch.concatenate([mem, xs], axis=1)
            q = torch.einsum('btd,dhe->bhte', h, Wq)
            k = torch.einsum('btd,dhe->bhte', h, Wk)
            v = torch.einsum('btd,dhe->bhte', h, Wv)
            scores = torch.einsum('bhqe,bhke->bhqk', q, k) * scale
            scores = torch.where(mask[None, None], scores, -1000000000.0)
            p = _softmax(scores, axis=-1)
            o = torch.einsum('bhqk,bhke->bhqe', p, v)
            o = torch.einsum('bhte,hed->btd', o, Wo)
            mem = o[:, :M, :].clone()
            outs.append(o[:, M:, :])
        return torch.concatenate(outs, axis=1)

    def _B_ref(x, W_gate, W_up, W_down):
        gate = torch.einsum('bsd,df->bsf', x, W_gate)
        up = torch.einsum('bsd,df->bsf', x, W_up)
        gate = gate * (lambda x, dt: x.to(dt))(gate > 0, gate.dtype)
        h = gate * up
        return torch.einsum('bsf,fd->bsd', h, W_down)
    x = A_x
    xn = _layernorm(x, axis=-1)
    s = _A_ref(xn, A_mem0, A_Wq, A_Wk, A_Wv, A_Wo, A_seg_len)
    g = _silu(_B_ref(xn, B_W_gate, B_W_up, B_W_down))
    return x + s * g
```

```asm
; @launch kernel=rs_prep_kernel grid=(256,1,1) block=(256,1,1) lds=163840
; @launch kernel=recurrent_scan__memory_aug_recurrent_mem_tr__glu_gated_reglu__prompt_kernel grid=(256,1,1) block=(256,1,1) lds=163840
.amdgcn_target "amdgcn-amd-amdhsa--gfx950"
.text
.globl rs_prep_kernel
.p2align 8
.type rs_prep_kernel,@function
rs_prep_kernel:
 s_cmp_ge_u32 s2, 256
 s_cbranch_scc1 P_exit
 s_load_dwordx2 s[4:5], s[0:1], 104
 v_lshrrev_b32 v4, 6, v0
 v_and_b32 v0, 63, v0
 s_nop 0
 v_readfirstlane_b32 s8, v4
 v_lshlrev_b32 v1, 4, v0
 s_waitcnt lgkmcnt(0)
 s_and_b32 s5, s5, 0xffff
 s_mov_b32 s6, 0x10000000
 s_mov_b32 s7, 0x00020000
 s_and_b32 s20, s2, 7
 s_lshr_b32 s21, s2, 3
 s_cmp_ge_u32 s21, 28
 s_cbranch_scc1 P_ln
 s_load_dwordx2 s[24:25], s[0:1], 16
 s_load_dwordx2 s[28:29], s[0:1], 24
 s_load_dwordx2 s[32:33], s[0:1], 32
 s_load_dwordx2 s[36:37], s[0:1], 40
 s_mul_i32 s11, s21, 37
 s_lshr_b32 s11, s11, 8
 s_mul_i32 s48, s11, 7
 s_sub_u32 s48, s21, s48
 s_lshl_b32 s9, s20, 2
 s_add_u32 s9, s9, s11
 s_lshr_b32 s49, s9, 1
 v_and_b32 v2, 15, v0
 v_lshrrev_b32 v3, 4, v0
 v_lshrrev_b32 v4, 3, v0
 v_and_b32 v5, 7, v0
 v_xor_b32 v5, v5, v4
 v_lshlrev_b32 v4, 13, v4
 v_lshl_add_u32 v4, v5, 4, v4
 v_and_b32 v8, 7, v2
 v_xor_b32 v6, v3, v8
 v_lshlrev_b32 v6, 4, v6
 v_xor_b32 v7, 64, v6
 v_lshlrev_b32 v9, 7, v8
 v_lshrrev_b32 v8, 3, v2
 v_lshl_add_u32 v9, v8, 10, v9
 v_add_u32 v6, v6, v9
 v_add_u32 v7, v7, v9
 s_waitcnt lgkmcnt(0)
 s_and_b32 s25, s25, 0xffff
 s_mov_b32 s26, 3670016
 s_mov_b32 s27, 0x00020000
 s_and_b32 s29, s29, 0xffff
 s_mov_b32 s30, 3670016
 s_mov_b32 s31, 0x00020000
 s_and_b32 s33, s33, 0xffff
 s_mov_b32 s34, 3670016
 s_mov_b32 s35, 0x00020000
 s_and_b32 s37, s37, 0xffff
 s_mov_b32 s38, 3670016
 s_mov_b32 s39, 0x00020000
 s_lshl_b32 s50, s49, 9
 s_lshl_b32 s11, s48, 19
 s_add_u32 s51, s11, s50
 s_lshl_b32 s11, s8, 17
 s_add_u32 s51, s51, s11
 s_mul_i32 s11, s49, 28
 s_mul_i32 s56, s8, 7
 s_add_u32 s11, s11, s56
 s_mul_i32 s11, s11, 14
 s_lshl_b32 s57, s48, 1
 s_add_u32 s11, s11, s57
 s_lshl_b32 s58, s11, 10
 s_and_b32 s12, s8, 1
 s_lshl_b32 s12, s12, 6
 v_add_u32 v14, s12, v0
 s_lshl_b32 s11, s48, 7
 v_add_u32 v10, s11, v14
 s_lshl_b32 s11, s48, 19
 s_add_u32 s52, s11, s50
 v_lshrrev_b32 v11, 1, v14
 v_lshlrev_b32 v11, 13, v11
 v_and_b32 v14, 1, v14
 v_lshl_add_u32 v14, v14, 7, v11
 v_add_u32 v14, 256, v14
 s_and_b32 s11, s9, 1
 s_cmp_eq_u32 s11, 1
 s_cbranch_scc1 P_B_1
 v_lshrrev_b32 v11, 1, v10
 v_lshlrev_b32 v11, 13, v11
 v_and_b32 v10, 1, v10
 v_lshl_add_u32 v10, v10, 7, v11
 v_add_u32 v15, 256, v10
 s_mul_i32 s11, s8, 917504
 s_add_u32 s59, s11, s50
 s_mul_i32 s60, s8, 14336
 v_add_u32 v12, s60, v6
 v_add_u32 v13, s60, v7
 v_add_u32 v10, 0x10000, v12
 v_add_u32 v11, 0x10000, v13
 v_add_u32 v8, 0x10000, v6
 v_add_u32 v9, 0x10000, v7
 s_lshl_b32 s11, s8, 11
 s_add_u32 s11, s11, 0
 s_mov_b32 m0, s11
 s_add_u32 s12, s51, 0
 buffer_load_dwordx4 v4, s[24:27], s12 offen lds
 s_lshl_b32 s11, s8, 11
 s_add_u32 s11, s11, 1024
 s_mov_b32 m0, s11
 s_add_u32 s12, s51, 65536
 buffer_load_dwordx4 v4, s[24:27], s12 offen lds
 s_add_u32 s11, s60, 8192
 s_mov_b32 m0, s11
 s_add_u32 s12, s59, 0
 buffer_load_dwordx4 v4, s[28:31], s12 offen lds
 s_add_u32 s11, s60, 9216
 s_mov_b32 m0, s11
 s_add_u32 s12, s59, 65536
 buffer_load_dwordx4 v4, s[28:31], s12 offen lds
 s_add_u32 s11, s60, 10240
 s_mov_b32 m0, s11
 s_add_u32 s12, s59, 131072
 buffer_load_dwordx4 v4, s[28:31], s12 offen lds
 s_add_u32 s11, s60, 11264
 s_mov_b32 m0, s11
 s_add_u32 s12, s59, 196608
 buffer_load_dwordx4 v4, s[28:31], s12 offen lds
 s_add_u32 s11, s60, 12288
 s_mov_b32 m0, s11
 s_add_u32 s12, s59, 262144
 buffer_load_dwordx4 v4, s[28:31], s12 offen lds
 s_add_u32 s11, s60, 13312
 s_mov_b32 m0, s11
 s_add_u32 s12, s59, 327680
 buffer_load_dwordx4 v4, s[28:31], s12 offen lds
 s_add_u32 s11, s60, 14336
 s_mov_b32 m0, s11
 s_add_u32 s12, s59, 393216
 buffer_load_dwordx4 v4, s[28:31], s12 offen lds
 s_add_u32 s11, s60, 15360
 s_mov_b32 m0, s11
 s_add_u32 s12, s59, 458752
 buffer_load_dwordx4 v4, s[28:31], s12 offen lds
 s_add_u32 s11, s60, 16384
 s_mov_b32 m0, s11
 s_add_u32 s12, s59, 524288
 buffer_load_dwordx4 v4, s[28:31], s12 offen lds
 s_add_u32 s11, s60, 17408
 s_mov_b32 m0, s11
 s_add_u32 s12, s59, 589824
 buffer_load_dwordx4 v4, s[28:31], s12 offen lds
 s_add_u32 s11, s60, 18432
 s_mov_b32 m0, s11
 s_add_u32 s12, s59, 655360
 buffer_load_dwordx4 v4, s[28:31], s12 offen lds
 s_add_u32 s11, s60, 19456
 s_mov_b32 m0, s11
 s_add_u32 s12, s59, 720896
 buffer_load_dwordx4 v4, s[28:31], s12 offen lds
 s_add_u32 s11, s60, 20480
 s_mov_b32 m0, s11
 s_add_u32 s12, s59, 786432
 buffer_load_dwordx4 v4, s[28:31], s12 offen lds
 s_add_u32 s11, s60, 21504
 s_mov_b32 m0, s11
 s_add_u32 s12, s59, 851968
 buffer_load_dwordx4 v4, s[28:31], s12 offen lds
 s_lshl_b32 s11, s8, 11
 s_add_u32 s11, s11, 65536
 s_mov_b32 m0, s11
 s_add_u32 s12, s51, 128
 buffer_load_dwordx4 v4, s[24:27], s12 offen lds
 s_lshl_b32 s11, s8, 11
 s_add_u32 s11, s11, 66560
 s_mov_b32 m0, s11
 s_add_u32 s12, s51, 65664
 buffer_load_dwordx4 v4, s[24:27], s12 offen lds
 s_add_u32 s11, s60, 73728
 s_mov_b32 m0, s11
 s_add_u32 s12, s59, 128
 buffer_load_dwordx4 v4, s[28:31], s12 offen lds
 s_add_u32 s11, s60, 74752
 s_mov_b32 m0, s11
 s_add_u32 s12, s59, 65664
 buffer_load_dwordx4 v4, s[28:31], s12 offen lds
 s_add_u32 s11, s60, 75776
 s_mov_b32 m0, s11
 s_add_u32 s12, s59, 131200
 buffer_load_dwordx4 v4, s[28:31], s12 offen lds
 s_add_u32 s11, s60, 76800
 s_mov_b32 m0, s11
 s_add_u32 s12, s59, 196736
 buffer_load_dwordx4 v4, s[28:31], s12 offen lds
 s_add_u32 s11, s60, 77824
 s_mov_b32 m0, s11
 s_add_u32 s12, s59, 262272
 buffer_load_dwordx4 v4, s[28:31], s12 offen lds
 s_add_u32 s11, s60, 78848
 s_mov_b32 m0, s11
 s_add_u32 s12, s59, 327808
 buffer_load_dwordx4 v4, s[28:31], s12 offen lds
 s_add_u32 s11, s60, 79872
 s_mov_b32 m0, s11
 s_add_u32 s12, s59, 393344
 buffer_load_dwordx4 v4, s[28:31], s12 offen lds
 s_add_u32 s11, s60, 80896
 s_mov_b32 m0, s11
 s_add_u32 s12, s59, 458880
 buffer_load_dwordx4 v4, s[28:31], s12 offen lds
 s_add_u32 s11, s60, 81920
 s_mov_b32 m0, s11
 s_add_u32 s12, s59, 524416
 buffer_load_dwordx4 v4, s[28:31], s12 offen lds
 s_add_u32 s11, s60, 82944
 s_mov_b32 m0, s11
 s_add_u32 s12, s59, 589952
 buffer_load_dwordx4 v4, s[28:31], s12 offen lds
 s_add_u32 s11, s60, 83968
 s_mov_b32 m0, s11
 s_add_u32 s12, s59, 655488
 buffer_load_dwordx4 v4, s[28:31], s12 offen lds
 s_add_u32 s11, s60, 84992
 s_mov_b32 m0, s11
 s_add_u32 s12, s59, 721024
 buffer_load_dwordx4 v4, s[28:31], s12 offen lds
 s_add_u32 s11, s60, 86016
 s_mov_b32 m0, s11
 s_add_u32 s12, s59, 786560
 buffer_load_dwordx4 v4, s[28:31], s12 offen lds
 s_add_u32 s11, s60, 87040
 s_mov_b32 m0, s11
 s_add_u32 s12, s59, 852096
 buffer_load_dwordx4 v4, s[28:31], s12 offen lds
 s_cmp_ge_u32 s8, 2
 s_cbranch_scc1 P_t_2_l
 buffer_load_dword v219, v15, s[28:31], s50 offen
 s_branch P_t_2_e
P_t_2_l:
 buffer_load_dword v219, v14, s[24:27], s52 offen
P_t_2_e:
 s_waitcnt vmcnt(17)
 s_barrier
 ds_read_b128 v[128:131], v6 offset:0
 ds_read_b128 v[132:135], v6 offset:2048
 ds_read_b128 v[136:139], v6 offset:4096
 ds_read_b128 v[140:143], v6 offset:6144
 ds_read_b128 v[160:163], v12 offset:8192
 ds_read_b128 v[164:167], v12 offset:10240
 ds_read_b128 v[168:171], v12 offset:12288
 ds_read_b128 v[172:175], v12 offset:14336
 ds_read_b128 v[176:179], v12 offset:16384
 ds_read_b128 v[180:183], v12 offset:18432
 ds_read_b128 v[184:187], v12 offset:20480
 ds_read_b128 v[144:147], v7 offset:0
 ds_read_b128 v[148:151], v7 offset:2048
 ds_read_b128 v[152:155], v7 offset:4096
 ds_read_b128 v[156:159], v7 offset:6144
 ds_read_b128 v[188:191], v13 offset:8192
 ds_read_b128 v[192:195], v13 offset:10240
 ds_read_b128 v[196:199], v13 offset:12288
 ds_read_b128 v[200:203], v13 offset:14336
 ds_read_b128 v[204:207], v13 offset:16384
 ds_read_b128 v[208:211], v13 offset:18432
 ds_read_b128 v[212:215], v13 offset:20480
 s_waitcnt lgkmcnt(11)
 v_mfma_f32_16x16x32_bf16 v[16:19], v[128:131], v[160:163], 0
 v_mfma_f32_16x16x32_bf16 v[20:23], v[128:131], v[164:167], 0
 v_mfma_f32_16x16x32_bf16 v[24:27], v[128:131], v[168:171], 0
 v_mfma_f32_16x16x32_bf16 v[28:31], v[128:131], v[172:175], 0
 v_mfma_f32_16x16x32_bf16 v[32:35], v[128:131], v[176:179], 0
 v_mfma_f32_16x16x32_bf16 v[36:39], v[128:131], v[180:183], 0
 v_mfma_f32_16x16x32_bf16 v[40:43], v[128:131], v[184:187], 0
 v_mfma_f32_16x16x32_bf16 v[44:47], v[132:135], v[160:163], 0
 v_mfma_f32_16x16x32_bf16 v[48:51], v[132:135], v[164:167], 0
 v_mfma_f32_16x16x32_bf16 v[52:55], v[132:135], v[168:171], 0
 v_mfma_f32_16x16x32_bf16 v[56:59], v[132:135], v[172:175], 0
 v_mfma_f32_16x16x32_bf16 v[60:63], v[132:135], v[176:179], 0
 v_mfma_f32_16x16x32_bf16 v[64:67], v[132:135], v[180:183], 0
 v_mfma_f32_16x16x32_bf16 v[68:71], v[132:135], v[184:187], 0
 v_mfma_f32_16x16x32_bf16 v[72:75], v[136:139], v[160:163], 0
 v_mfma_f32_16x16x32_bf16 v[76:79], v[136:139], v[164:167], 0
 v_mfma_f32_16x16x32_bf16 v[80:83], v[136:139], v[168:171], 0
 v_mfma_f32_16x16x32_bf16 v[84:87], v[136:139], v[172:175], 0
 v_mfma_f32_16x16x32_bf16 v[88:91], v[136:139], v[176:179], 0
 v_mfma_f32_16x16x32_bf16 v[92:95], v[136:139], v[180:183], 0
 v_mfma_f32_16x16x32_bf16 v[96:99], v[136:139], v[184:187], 0
 v_mfma_f32_16x16x32_bf16 v[100:103], v[140:143], v[160:163], 0
 v_mfma_f32_16x16x32_bf16 v[104:107], v[140:143], v[164:167], 0
 v_mfma_f32_16x16x32_bf16 v[108:111], v[140:143], v[168:171], 0
 v_mfma_f32_16x16x32_bf16 v[112:115], v[140:143], v[172:175], 0
 v_mfma_f32_16x16x32_bf16 v[116:119], v[140:143], v[176:179], 0
 v_mfma_f32_16x16x32_bf16 v[120:123], v[140:143], v[180:183], 0
 v_mfma_f32_16x16x32_bf16 v[124:127], v[140:143], v[184:187], 0
 s_waitcnt lgkmcnt(0)
 s_barrier
 s_lshl_b32 s11, s8, 11
 s_add_u32 s11, s11, 0
 s_mov_b32 m0, s11
 s_add_u32 s12, s51, 256
 buffer_load_dwordx4 v4, s[24:27], s12 offen lds
 s_lshl_b32 s11, s8, 11
 s_add_u32 s11, s11, 1024
 s_mov_b32 m0, s11
 s_add_u32 s12, s51, 65792
 buffer_load_dwordx4 v4, s[24:27], s12 offen lds
 s_add_u32 s11, s60, 8192
 s_mov_b32 m0, s11
 s_add_u32 s12, s59, 256
 buffer_load_dwordx4 v4, s[28:31], s12 offen lds
 s_add_u32 s11, s60, 9216
 s_mov_b32 m0, s11
 s_add_u32 s12, s59, 65792
 buffer_load_dwordx4 v4, s[28:31], s12 offen lds
 s_add_u32 s11, s60, 10240
 s_mov_b32 m0, s11
 s_add_u32 s12, s59, 131328
 buffer_load_dwordx4 v4, s[28:31], s12 offen lds
 s_add_u32 s11, s60, 11264
 s_mov_b32 m0, s11
 s_add_u32 s12, s59, 196864
 buffer_load_dwordx4 v4, s[28:31], s12 offen lds
 s_add_u32 s11, s60, 12288
 s_mov_b32 m0, s11
 s_add_u32 s12, s59, 262400
 buffer_load_dwordx4 v4, s[28:31], s12 offen lds
 s_add_u32 s11, s60, 13312
 s_mov_b32 m0, s11
 s_add_u32 s12, s59, 327936
 buffer_load_dwordx4 v4, s[28:31], s12 offen lds
 s_add_u32 s11, s60, 14336
 s_mov_b32 m0, s11
 s_add_u32 s12, s59, 393472
 buffer_load_dwordx4 v4, s[28:31], s12 offen lds
 s_add_u32 s11, s60, 15360
 s_mov_b32 m0, s11
 s_add_u32 s12, s59, 459008
 buffer_load_dwordx4 v4, s[28:31], s12 offen lds
 s_add_u32 s11, s60, 16384
 s_mov_b32 m0, s11
 s_add_u32 s12, s59, 524544
 buffer_load_dwordx4 v4, s[28:31], s12 offen lds
 s_add_u32 s11, s60, 17408
 s_mov_b32 m0, s11
 s_add_u32 s12, s59, 590080
 buffer_load_dwordx4 v4, s[28:31], s12 offen lds
 s_add_u32 s11, s60, 18432
 s_mov_b32 m0, s11
 s_add_u32 s12, s59, 655616
 buffer_load_dwordx4 v4, s[28:31], s12 offen lds
 s_add_u32 s11, s60, 19456
 s_mov_b32 m0, s11
 s_add_u32 s12, s59, 721152
 buffer_load_dwordx4 v4, s[28:31], s12 offen lds
 s_add_u32 s11, s60, 20480
 s_mov_b32 m0, s11
 s_add_u32 s12, s59, 786688
 buffer_load_dwordx4 v4, s[28:31], s12 offen lds
 s_add_u32 s11, s60, 21504
 s_mov_b32 m0, s11
 s_add_u32 s12, s59, 852224
 buffer_load_dwordx4 v4, s[28:31], s12 offen lds
 v_mfma_f32_16x16x32_bf16 v[16:19], v[144:147], v[188:191], v[16:19]
 v_mfma_f32_16x16x32_bf16 v[20:23], v[144:147], v[192:195], v[20:23]
 v_mfma_f32_16x16x32_bf16 v[24:27], v[144:147], v[196:199], v[24:27]
 v_mfma_f32_16x16x32_bf16 v[28:31], v[144:147], v[200:203], v[28:31]
 v_mfma_f32_16x16x32_bf16 v[32:35], v[144:147], v[204:207], v[32:35]
 v_mfma_f32_16x16x32_bf16 v[36:39], v[144:147], v[208:211], v[36:39]
 v_mfma_f32_16x16x32_bf16 v[40:43], v[144:147], v[212:215], v[40:43]
 v_mfma_f32_16x16x32_bf16 v[44:47], v[148:151], v[188:191], v[44:47]
 v_mfma_f32_16x16x32_bf16 v[48:51], v[148:151], v[192:195], v[48:51]
 v_mfma_f32_16x16x32_bf16 v[52:55], v[148:151], v[196:199], v[52:55]
 v_mfma_f32_16x16x32_bf16 v[56:59], v[148:151], v[200:203], v[56:59]
 v_mfma_f32_16x16x32_bf16 v[60:63], v[148:151], v[204:207], v[60:63]
 v_mfma_f32_16x16x32_bf16 v[64:67], v[148:151], v[208:211], v[64:67]
 v_mfma_f32_16x16x32_bf16 v[68:71], v[148:151], v[212:215], v[68:71]
 v_mfma_f32_16x16x32_bf16 v[72:75], v[152:155], v[188:191], v[72:75]
 v_mfma_f32_16x16x32_bf16 v[76:79], v[152:155], v[192:195], v[76:79]
 v_mfma_f32_16x16x32_bf16 v[80:83], v[152:155], v[196:199], v[80:83]
 v_mfma_f32_16x16x32_bf16 v[84:87], v[152:155], v[200:203], v[84:87]
 v_mfma_f32_16x16x32_bf16 v[88:91], v[152:155], v[204:207], v[88:91]
 v_mfma_f32_16x16x32_bf16 v[92:95], v[152:155], v[208:211], v[92:95]
 v_mfma_f32_16x16x32_bf16 v[96:99], v[152:155], v[212:215], v[96:99]
 v_mfma_f32_16x16x32_bf16 v[100:103], v[156:159], v[188:191], v[100:103]
 v_mfma_f32_16x16x32_bf16 v[104:107], v[156:159], v[192:195], v[104:107]
 v_mfma_f32_16x16x32_bf16 v[108:111], v[156:159], v[196:199], v[108:111]
 v_mfma_f32_16x16x32_bf16 v[112:115], v[156:159], v[200:203], v[112:115]
 v_mfma_f32_16x16x32_bf16 v[116:119], v[156:159], v[204:207], v[116:119]
 v_mfma_f32_16x16x32_bf16 v[120:123], v[156:159], v[208:211], v[120:123]
 v_mfma_f32_16x16x32_bf16 v[124:127], v[156:159], v[212:215], v[124:127]
 s_waitcnt vmcnt(17)
 s_barrier
 ds_read_b128 v[128:131], v8 offset:0
 ds_read_b128 v[132:135], v8 offset:2048
 ds_read_b128 v[136:139], v8 offset:4096
 ds_read_b128 v[140:143], v8 offset:6144
 ds_read_b128 v[160:163], v10 offset:8192
 ds_read_b128 v[164:167], v10 offset:10240
 ds_read_b128 v[168:171], v10 offset:12288
 ds_read_b128 v[172:175], v10 offset:14336
 ds_read_b128 v[176:179], v10 offset:16384
 ds_read_b128 v[180:183], v10 offset:18432
 ds_read_b128 v[184:187], v10 offset:20480
 ds_read_b128 v[144:147], v9 offset:0
 ds_read_b128 v[148:151], v9 offset:2048
 ds_read_b128 v[152:155], v9 offset:4096
 ds_read_b128 v[156:159], v9 offset:6144
 ds_read_b128 v[188:191], v11 offset:8192
 ds_read_b128 v[192:195], v11 offset:10240
 ds_read_b128 v[196:199], v11 offset:12288
 ds_read_b128 v[200:203], v11 offset:14336
 ds_read_b128 v[204:207], v11 offset:16384
 ds_read_b128 v[208:211], v11 offset:18432
 ds_read_b128 v[212:215], v11 offset:20480
 s_waitcnt lgkmcnt(11)
 v_mfma_f32_16x16x32_bf16 v[16:19], v[128:131], v[160:163], v[16:19]
 v_mfma_f32_16x16x32_bf16 v[20:23], v[128:131], v[164:167], v[20:23]
 v_mfma_f32_16x16x32_bf16 v[24:27], v[128:131], v[168:171], v[24:27]
 v_mfma_f32_16x16x32_bf16 v[28:31], v[128:131], v[172:175], v[28:31]
 v_mfma_f32_16x16x32_bf16 v[32:35], v[128:131], v[176:179], v[32:35]
 v_mfma_f32_16x16x32_bf16 v[36:39], v[128:131], v[180:183], v[36:39]
 v_mfma_f32_16x16x32_bf16 v[40:43], v[128:131], v[184:187], v[40:43]
 v_mfma_f32_16x16x32_bf16 v[44:47], v[132:135], v[160:163], v[44:47]
 v_mfma_f32_16x16x32_bf16 v[48:51], v[132:135], v[164:167], v[48:51]
 v_mfma_f32_16x16x32_bf16 v[52:55], v[132:135], v[168:171], v[52:55]
 v_mfma_f32_16x16x32_bf16 v[56:59], v[132:135], v[172:175], v[56:59]
 v_mfma_f32_16x16x32_bf16 v[60:63], v[132:135], v[176:179], v[60:63]
 v_mfma_f32_16x16x32_bf16 v[64:67], v[132:135], v[180:183], v[64:67]
 v_mfma_f32_16x16x32_bf16 v[68:71], v[132:135], v[184:187], v[68:71]
 v_mfma_f32_16x16x32_bf16 v[72:75], v[136:139], v[160:163], v[72:75]
 v_mfma_f32_16x16x32_bf16 v[76:79], v[136:139], v[164:167], v[76:79]
 v_mfma_f32_16x16x32_bf16 v[80:83], v[136:139], v[168:171], v[80:83]
 v_mfma_f32_16x16x32_bf16 v[84:87], v[136:139], v[172:175], v[84:87]
 v_mfma_f32_16x16x32_bf16 v[88:91], v[136:139], v[176:179], v[88:91]
 v_mfma_f32_16x16x32_bf16 v[92:95], v[136:139], v[180:183], v[92:95]
 v_mfma_f32_16x16x32_bf16 v[96:99], v[136:139], v[184:187], v[96:99]
 v_mfma_f32_16x16x32_bf16 v[100:103], v[140:143], v[160:163], v[100:103]
 v_mfma_f32_16x16x32_bf16 v[104:107], v[140:143], v[164:167], v[104:107]
 v_mfma_f32_16x16x32_bf16 v[108:111], v[140:143], v[168:171], v[108:111]
 v_mfma_f32_16x16x32_bf16 v[112:115], v[140:143], v[172:175], v[112:115]
 v_mfma_f32_16x16x32_bf16 v[116:119], v[140:143], v[176:179], v[116:119]
 v_mfma_f32_16x16x32_bf16 v[120:123], v[140:143], v[180:183], v[120:123]
 v_mfma_f32_16x16x32_bf16 v[124:127], v[140:143], v[184:187], v[124:127]
 s_waitcnt lgkmcnt(0)
 s_barrier
 s_lshl_b32 s11, s8, 11
 s_add_u32 s11, s11, 65536
 s_mov_b32 m0, s11
 s_add_u32 s12, s51, 384
 buffer_load_dwordx4 v4, s[24:27], s12 offen lds
 s_lshl_b32 s11, s8, 11
 s_add_u32 s11, s11, 66560
 s_mov_b32 m0, s11
 s_add_u32 s12, s51, 65920
 buffer_load_dwordx4 v4, s[24:27], s12 offen lds
 s_add_u32 s11, s60, 73728
 s_mov_b32 m0, s11
 s_add_u32 s12, s59, 384
 buffer_load_dwordx4 v4, s[28:31], s12 offen lds
 s_add_u32 s11, s60, 74752
 s_mov_b32 m0, s11
 s_add_u32 s12, s59, 65920
 buffer_load_dwordx4 v4, s[28:31], s12 offen lds
 s_add_u32 s11, s60, 75776
 s_mov_b32 m0, s11
 s_add_u32 s12, s59, 131456
 buffer_load_dwordx4 v4, s[28:31], s12 offen lds
 s_add_u32 s11, s60, 76800
 s_mov_b32 m0, s11
 s_add_u32 s12, s59, 196992
 buffer_load_dwordx4 v4, s[28:31], s12 offen lds
 s_add_u32 s11, s60, 77824
 s_mov_b32 m0, s11
 s_add_u32 s12, s59, 262528
 buffer_load_dwordx4 v4, s[28:31], s12 offen lds
 s_add_u32 s11, s60, 78848
 s_mov_b32 m0, s11
 s_add_u32 s12, s59, 328064
 buffer_load_dwordx4 v4, s[28:31], s12 offen lds
 s_add_u32 s11, s60, 79872
 s_mov_b32 m0, s11
 s_add_u32 s12, s59, 393600
 buffer_load_dwordx4 v4, s[28:31], s12 offen lds
 s_add_u32 s11, s60, 80896
 s_mov_b32 m0, s11
 s_add_u32 s12, s59, 459136
 buffer_load_dwordx4 v4, s[28:31], s12 offen lds
 s_add_u32 s11, s60, 81920
 s_mov_b32 m0, s11
 s_add_u32 s12, s59, 524672
 buffer_load_dwordx4 v4, s[28:31], s12 offen lds
 s_add_u32 s11, s60, 82944
 s_mov_b32 m0, s11
 s_add_u32 s12, s59, 590208
 buffer_load_dwordx4 v4, s[28:31], s12 offen lds
 s_add_u32 s11, s60, 83968
 s_mov_b32 m0, s11
 s_add_u32 s12, s59, 655744
 buffer_load_dwordx4 v4, s[28:31], s12 offen lds
 s_add_u32 s11, s60, 84992
 s_mov_b32 m0, s11
 s_add_u32 s12, s59, 721280
 buffer_load_dwordx4 v4, s[28:31], s12 offen lds
 s_add_u32 s11, s60, 86016
 s_mov_b32 m0, s11
 s_add_u32 s12, s59, 786816
 buffer_load_dwordx4 v4, s[28:31], s12 offen lds
 s_add_u32 s11, s60, 87040
 s_mov_b32 m0, s11
 s_add_u32 s12, s59, 852352
 buffer_load_dwordx4 v4, s[28:31], s12 offen lds
 v_mfma_f32_16x16x32_bf16 v[16:19], v[144:147], v[188:191], v[16:19]
 v_mfma_f32_16x16x32_bf16 v[20:23], v[144:147], v[192:195], v[20:23]
 v_mfma_f32_16x16x32_bf16 v[24:27], v[144:147], v[196:199], v[24:27]
 v_mfma_f32_16x16x32_bf16 v[28:31], v[144:147], v[200:203], v[28:31]
 v_mfma_f32_16x16x32_bf16 v[32:35], v[144:147], v[204:207], v[32:35]
 v_mfma_f32_16x16x32_bf16 v[36:39], v[144:147], v[208:211], v[36:39]
 v_mfma_f32_16x16x32_bf16 v[40:43], v[144:147], v[212:215], v[40:43]
 v_mfma_f32_16x16x32_bf16 v[44:47], v[148:151], v[188:191], v[44:47]
 v_mfma_f32_16x16x32_bf16 v[48:51], v[148:151], v[192:195], v[48:51]
 v_mfma_f32_16x16x32_bf16 v[52:55], v[148:151], v[196:199], v[52:55]
 v_mfma_f32_16x16x32_bf16 v[56:59], v[148:151], v[200:203], v[56:59]
 v_mfma_f32_16x16x32_bf16 v[60:63], v[148:151], v[204:207], v[60:63]
 v_mfma_f32_16x16x32_bf16 v[64:67], v[148:151], v[208:211], v[64:67]
 v_mfma_f32_16x16x32_bf16 v[68:71], v[148:151], v[212:215], v[68:71]
 v_mfma_f32_16x16x32_bf16 v[72:75], v[152:155], v[188:191], v[72:75]
 v_mfma_f32_16x16x32_bf16 v[76:79], v[152:155], v[192:195], v[76:79]
 v_mfma_f32_16x16x32_bf16 v[80:83], v[152:155], v[196:199], v[80:83]
 v_mfma_f32_16x16x32_bf16 v[84:87], v[152:155], v[200:203], v[84:87]
 v_mfma_f32_16x16x32_bf16 v[88:91], v[152:155], v[204:207], v[88:91]
 v_mfma_f32_16x16x32_bf16 v[92:95], v[152:155], v[208:211], v[92:95]
 v_mfma_f32_16x16x32_bf16 v[96:99], v[152:155], v[212:215], v[96:99]
 v_mfma_f32_16x16x32_bf16 v[100:103], v[156:159], v[188:191], v[100:103]
 v_mfma_f32_16x16x32_bf16 v[104:107], v[156:159], v[192:195], v[104:107]
 v_mfma_f32_16x16x32_bf16 v[108:111], v[156:159], v[196:199], v[108:111]
 v_mfma_f32_16x16x32_bf16 v[112:115], v[156:159], v[200:203], v[112:115]
 v_mfma_f32_16x16x32_bf16 v[116:119], v[156:159], v[204:207], v[116:119]
 v_mfma_f32_16x16x32_bf16 v[120:123], v[156:159], v[208:211], v[120:123]
 v_mfma_f32_16x16x32_bf16 v[124:127], v[156:159], v[212:215], v[124:127]
 s_waitcnt vmcnt(16)
 s_barrier
 ds_read_b128 v[128:131], v6 offset:0
 ds_read_b128 v[132:135], v6 offset:2048
 ds_read_b128 v[136:139], v6 offset:4096
 ds_read_b128 v[140:143], v6 offset:6144
 ds_read_b128 v[160:163], v12 offset:8192
 ds_read_b128 v[164:167], v12 offset:10240
 ds_read_b128 v[168:171], v12 offset:12288
 ds_read_b128 v[172:175], v12 offset:14336
 ds_read_b128 v[176:179], v12 offset:16384
 ds_read_b128 v[180:183], v12 offset:18432
 ds_read_b128 v[184:187], v12 offset:20480
 ds_read_b128 v[144:147], v7 offset:0
 ds_read_b128 v[148:151], v7 offset:2048
 ds_read_b128 v[152:155], v7 offset:4096
 ds_read_b128 v[156:159], v7 offset:6144
 ds_read_b128 v[188:191], v13 offset:8192
 ds_read_b128 v[192:195], v13 offset:10240
 ds_read_b128 v[196:199], v13 offset:12288
 ds_read_b128 v[200:203], v13 offset:14336
 ds_read_b128 v[204:207], v13 offset:16384
 ds_read_b128 v[208:211], v13 offset:18432
 ds_read_b128 v[212:215], v13 offset:20480
 s_waitcnt lgkmcnt(11)
 v_mfma_f32_16x16x32_bf16 v[16:19], v[128:131], v[160:163], v[16:19]
 v_mfma_f32_16x16x32_bf16 v[20:23], v[128:131], v[164:167], v[20:23]
 v_mfma_f32_16x16x32_bf16 v[24:27], v[128:131], v[168:171], v[24:27]
 v_mfma_f32_16x16x32_bf16 v[28:31], v[128:131], v[172:175], v[28:31]
 v_mfma_f32_16x16x32_bf16 v[32:35], v[128:131], v[176:179], v[32:35]
 v_mfma_f32_16x16x32_bf16 v[36:39], v[128:131], v[180:183], v[36:39]
 v_mfma_f32_16x16x32_bf16 v[40:43], v[128:131], v[184:187], v[40:43]
 v_mfma_f32_16x16x32_bf16 v[44:47], v[132:135], v[160:163], v[44:47]
 v_mfma_f32_16x16x32_bf16 v[48:51], v[132:135], v[164:167], v[48:51]
 v_mfma_f32_16x16x32_bf16 v[52:55], v[132:135], v[168:171], v[52:55]
 v_mfma_f32_16x16x32_bf16 v[56:59], v[132:135], v[172:175], v[56:59]
 v_mfma_f32_16x16x32_bf16 v[60:63], v[132:135], v[176:179], v[60:63]
 v_mfma_f32_16x16x32_bf16 v[64:67], v[132:135], v[180:183], v[64:67]
 v_mfma_f32_16x16x32_bf16 v[68:71], v[132:135], v[184:187], v[68:71]
 v_mfma_f32_16x16x32_bf16 v[72:75], v[136:139], v[160:163], v[72:75]
 v_mfma_f32_16x16x32_bf16 v[76:79], v[136:139], v[164:167], v[76:79]
 v_mfma_f32_16x16x32_bf16 v[80:83], v[136:139], v[168:171], v[80:83]
 v_mfma_f32_16x16x32_bf16 v[84:87], v[136:139], v[172:175], v[84:87]
 v_mfma_f32_16x16x32_bf16 v[88:91], v[136:139], v[176:179], v[88:91]
 v_mfma_f32_16x16x32_bf16 v[92:95], v[136:139], v[180:183], v[92:95]
 v_mfma_f32_16x16x32_bf16 v[96:99], v[136:139], v[184:187], v[96:99]
 v_mfma_f32_16x16x32_bf16 v[100:103], v[140:143], v[160:163], v[100:103]
 v_mfma_f32_16x16x32_bf16 v[104:107], v[140:143], v[164:167], v[104:107]
 v_mfma_f32_16x16x32_bf16 v[108:111], v[140:143], v[168:171], v[108:111]
 v_mfma_f32_16x16x32_bf16 v[112:115], v[140:143], v[172:175], v[112:115]
 v_mfma_f32_16x16x32_bf16 v[116:119], v[140:143], v[176:179], v[116:119]
 v_mfma_f32_16x16x32_bf16 v[120:123], v[140:143], v[180:183], v[120:123]
 v_mfma_f32_16x16x32_bf16 v[124:127], v[140:143], v[184:187], v[124:127]
 s_waitcnt lgkmcnt(0)
 v_mfma_f32_16x16x32_bf16 v[16:19], v[144:147], v[188:191], v[16:19]
 v_mfma_f32_16x16x32_bf16 v[20:23], v[144:147], v[192:195], v[20:23]
 v_mfma_f32_16x16x32_bf16 v[24:27], v[144:147], v[196:199], v[24:27]
 v_mfma_f32_16x16x32_bf16 v[28:31], v[144:147], v[200:203], v[28:31]
 v_mfma_f32_16x16x32_bf16 v[32:35], v[144:147], v[204:207], v[32:35]
 v_mfma_f32_16x16x32_bf16 v[36:39], v[144:147], v[208:211], v[36:39]
 v_mfma_f32_16x16x32_bf16 v[40:43], v[144:147], v[212:215], v[40:43]
 v_mfma_f32_16x16x32_bf16 v[44:47], v[148:151], v[188:191], v[44:47]
 v_mfma_f32_16x16x32_bf16 v[48:51], v[148:151], v[192:195], v[48:51]
 v_mfma_f32_16x16x32_bf16 v[52:55], v[148:151], v[196:199], v[52:55]
 v_mfma_f32_16x16x32_bf16 v[56:59], v[148:151], v[200:203], v[56:59]
 v_mfma_f32_16x16x32_bf16 v[60:63], v[148:151], v[204:207], v[60:63]
 v_mfma_f32_16x16x32_bf16 v[64:67], v[148:151], v[208:211], v[64:67]
 v_mfma_f32_16x16x32_bf16 v[68:71], v[148:151], v[212:215], v[68:71]
 v_mfma_f32_16x16x32_bf16 v[72:75], v[152:155], v[188:191], v[72:75]
 v_mfma_f32_16x16x32_bf16 v[76:79], v[152:155], v[192:195], v[76:79]
 v_mfma_f32_16x16x32_bf16 v[80:83], v[152:155], v[196:199], v[80:83]
 v_mfma_f32_16x16x32_bf16 v[84:87], v[152:155], v[200:203], v[84:87]
 v_mfma_f32_16x16x32_bf16 v[88:91], v[152:155], v[204:207], v[88:91]
 v_mfma_f32_16x16x32_bf16 v[92:95], v[152:155], v[208:211], v[92:95]
 v_mfma_f32_16x16x32_bf16 v[96:99], v[152:155], v[212:215], v[96:99]
 v_mfma_f32_16x16x32_bf16 v[100:103], v[156:159], v[188:191], v[100:103]
 v_mfma_f32_16x16x32_bf16 v[104:107], v[156:159], v[192:195], v[104:107]
 v_mfma_f32_16x16x32_bf16 v[108:111], v[156:159], v[196:199], v[108:111]
 v_mfma_f32_16x16x32_bf16 v[112:115], v[156:159], v[200:203], v[112:115]
 v_mfma_f32_16x16x32_bf16 v[116:119], v[156:159], v[204:207], v[116:119]
 v_mfma_f32_16x16x32_bf16 v[120:123], v[156:159], v[208:211], v[120:123]
 v_mfma_f32_16x16x32_bf16 v[124:127], v[156:159], v[212:215], v[124:127]
 s_waitcnt vmcnt(0)
 s_barrier
 ds_read_b128 v[128:131], v8 offset:0
 ds_read_b128 v[132:135], v8 offset:2048
 ds_read_b128 v[136:139], v8 offset:4096
 ds_read_b128 v[140:143], v8 offset:6144
 ds_read_b128 v[160:163], v10 offset:8192
 ds_read_b128 v[164:167], v10 offset:10240
 ds_read_b128 v[168:171], v10 offset:12288
 ds_read_b128 v[172:175], v10 offset:14336
 ds_read_b128 v[176:179], v10 offset:16384
 ds_read_b128 v[180:183], v10 offset:18432
 ds_read_b128 v[184:187], v10 offset:20480
 ds_read_b128 v[144:147], v9 offset:0
 ds_read_b128 v[148:151], v9 offset:2048
 ds_read_b128 v[152:155], v9 offset:4096
 ds_read_b128 v[156:159], v9 offset:6144
 ds_read_b128 v[188:191], v11 offset:8192
 ds_read_b128 v[192:195], v11 offset:10240
 ds_read_b128 v[196:199], v11 offset:12288
 ds_read_b128 v[200:203], v11 offset:14336
 ds_read_b128 v[204:207], v11 offset:16384
 ds_read_b128 v[208:211], v11 offset:18432
 ds_read_b128 v[212:215], v11 offset:20480
 s_waitcnt lgkmcnt(11)
 v_mfma_f32_16x16x32_bf16 v[16:19], v[128:131], v[160:163], v[16:19]
 v_mfma_f32_16x16x32_bf16 v[20:23], v[128:131], v[164:167], v[20:23]
 v_mfma_f32_16x16x32_bf16 v[24:27], v[128:131], v[168:171], v[24:27]
 v_mfma_f32_16x16x32_bf16 v[28:31], v[128:131], v[172:175], v[28:31]
 v_mfma_f32_16x16x32_bf16 v[32:35], v[128:131], v[176:179], v[32:35]
 v_mfma_f32_16x16x32_bf16 v[36:39], v[128:131], v[180:183], v[36:39]
 v_mfma_f32_16x16x32_bf16 v[40:43], v[128:131], v[184:187], v[40:43]
 v_mfma_f32_16x16x32_bf16 v[44:47], v[132:135], v[160:163], v[44:47]
 v_mfma_f32_16x16x32_bf16 v[48:51], v[132:135], v[164:167], v[48:51]
 v_mfma_f32_16x16x32_bf16 v[52:55], v[132:135], v[168:171], v[52:55]
 v_mfma_f32_16x16x32_bf16 v[56:59], v[132:135], v[172:175], v[56:59]
 v_mfma_f32_16x16x32_bf16 v[60:63], v[132:135], v[176:179], v[60:63]
 v_mfma_f32_16x16x32_bf16 v[64:67], v[132:135], v[180:183], v[64:67]
 v_mfma_f32_16x16x32_bf16 v[68:71], v[132:135], v[184:187], v[68:71]
 v_mfma_f32_16x16x32_bf16 v[72:75], v[136:139], v[160:163], v[72:75]
 v_mfma_f32_16x16x32_bf16 v[76:79], v[136:139], v[164:167], v[76:79]
 v_mfma_f32_16x16x32_bf16 v[80:83], v[136:139], v[168:171], v[80:83]
 v_mfma_f32_16x16x32_bf16 v[84:87], v[136:139], v[172:175], v[84:87]
 v_mfma_f32_16x16x32_bf16 v[88:91], v[136:139], v[176:179], v[88:91]
 v_mfma_f32_16x16x32_bf16 v[92:95], v[136:139], v[180:183], v[92:95]
 v_mfma_f32_16x16x32_bf16 v[96:99], v[136:139], v[184:187], v[96:99]
 v_mfma_f32_16x16x32_bf16 v[100:103], v[140:143], v[160:163], v[100:103]
 v_mfma_f32_16x16x32_bf16 v[104:107], v[140:143], v[164:167], v[104:107]
 v_mfma_f32_16x16x32_bf16 v[108:111], v[140:143], v[168:171], v[108:111]
 v_mfma_f32_16x16x32_bf16 v[112:115], v[140:143], v[172:175], v[112:115]
 v_mfma_f32_16x16x32_bf16 v[116:119], v[140:143], v[176:179], v[116:119]
 v_mfma_f32_16x16x32_bf16 v[120:123], v[140:143], v[180:183], v[120:123]
 v_mfma_f32_16x16x32_bf16 v[124:127], v[140:143], v[184:187], v[124:127]
 s_waitcnt lgkmcnt(0)
 v_mfma_f32_16x16x32_bf16 v[16:19], v[144:147], v[188:191], v[16:19]
 v_mfma_f32_16x16x32_bf16 v[20:23], v[144:147], v[192:195], v[20:23]
 v_mfma_f32_16x16x32_bf16 v[24:27], v[144:147], v[196:199], v[24:27]
 v_mfma_f32_16x16x32_bf16 v[28:31], v[144:147], v[200:203], v[28:31]
 v_mfma_f32_16x16x32_bf16 v[32:35], v[144:147], v[204:207], v[32:35]
 v_mfma_f32_16x16x32_bf16 v[36:39], v[144:147], v[208:211], v[36:39]
 v_mfma_f32_16x16x32_bf16 v[40:43], v[144:147], v[212:215], v[40:43]
 v_mfma_f32_16x16x32_bf16 v[44:47], v[148:151], v[188:191], v[44:47]
 v_mfma_f32_16x16x32_bf16 v[48:51], v[148:151], v[192:195], v[48:51]
 v_mfma_f32_16x16x32_bf16 v[52:55], v[148:151], v[196:199], v[52:55]
 v_mfma_f32_16x16x32_bf16 v[56:59], v[148:151], v[200:203], v[56:59]
 v_mfma_f32_16x16x32_bf16 v[60:63], v[148:151], v[204:207], v[60:63]
 v_mfma_f32_16x16x32_bf16 v[64:67], v[148:151], v[208:211], v[64:67]
 v_mfma_f32_16x16x32_bf16 v[68:71], v[148:151], v[212:215], v[68:71]
 v_mfma_f32_16x16x32_bf16 v[72:75], v[152:155], v[188:191], v[72:75]
 v_mfma_f32_16x16x32_bf16 v[76:79], v[152:155], v[192:195], v[76:79]
 v_mfma_f32_16x16x32_bf16 v[80:83], v[152:155], v[196:199], v[80:83]
 v_mfma_f32_16x16x32_bf16 v[84:87], v[152:155], v[200:203], v[84:87]
 v_mfma_f32_16x16x32_bf16 v[88:91], v[152:155], v[204:207], v[88:91]
 v_mfma_f32_16x16x32_bf16 v[92:95], v[152:155], v[208:211], v[92:95]
 v_mfma_f32_16x16x32_bf16 v[96:99], v[152:155], v[212:215], v[96:99]
 v_mfma_f32_16x16x32_bf16 v[100:103], v[156:159], v[188:191], v[100:103]
 v_mfma_f32_16x16x32_bf16 v[104:107], v[156:159], v[192:195], v[104:107]
 v_mfma_f32_16x16x32_bf16 v[108:111], v[156:159], v[196:199], v[108:111]
 v_mfma_f32_16x16x32_bf16 v[112:115], v[156:159], v[200:203], v[112:115]
 v_mfma_f32_16x16x32_bf16 v[116:119], v[156:159], v[204:207], v[116:119]
 v_mfma_f32_16x16x32_bf16 v[120:123], v[156:159], v[208:211], v[120:123]
 v_mfma_f32_16x16x32_bf16 v[124:127], v[156:159], v[212:215], v[124:127]
 s_nop 7
 v_mov_b32 v12, 0x3db8aa3b
 v_mov_b32 v13, v12
 v_pk_mul_f32 v[16:17], v[16:17], v[12:13]
 v_pk_mul_f32 v[18:19], v[18:19], v[12:13]
 v_pk_mul_f32 v[20:21], v[20:21], v[12:13]
 v_pk_mul_f32 v[22:23], v[22:23], v[12:13]
 v_pk_mul_f32 v[24:25], v[24:25], v[12:13]
 v_pk_mul_f32 v[26:27], v[26:27], v[12:13]
 v_pk_mul_f32 v[28:29], v[28:29], v[12:13]
 v_pk_mul_f32 v[30:31], v[30:31], v[12:13]
 v_pk_mul_f32 v[32:33], v[32:33], v[12:13]
 v_pk_mul_f32 v[34:35], v[34:35], v[12:13]
 v_pk_mul_f32 v[36:37], v[36:37], v[12:13]
 v_pk_mul_f32 v[38:39], v[38:39], v[12:13]
 v_pk_mul_f32 v[40:41], v[40:41], v[12:13]
 v_pk_mul_f32 v[42:43], v[42:43], v[12:13]
 v_pk_mul_f32 v[44:45], v[44:45], v[12:13]
 v_pk_mul_f32 v[46:47], v[46:47], v[12:13]
 v_pk_mul_f32 v[48:49], v[48:49], v[12:13]
 v_pk_mul_f32 v[50:51], v[50:51], v[12:13]
 v_pk_mul_f32 v[52:53], v[52:53], v[12:13]
 v_pk_mul_f32 v[54:55], v[54:55], v[12:13]
 v_pk_mul_f32 v[56:57], v[56:57], v[12:13]
 v_pk_mul_f32 v[58:59], v[58:59], v[12:13]
 v_pk_mul_f32 v[60:61], v[60:61], v[12:13]
 v_pk_mul_f32 v[62:63], v[62:63], v[12:13]
 v_pk_mul_f32 v[64:65], v[64:65], v[12:13]
 v_pk_mul_f32 v[66:67], v[66:67], v[12:13]
 v_pk_mul_f32 v[68:69], v[68:69], v[12:13]
 v_pk_mul_f32 v[70:71], v[70:71], v[12:13]
 v_pk_mul_f32 v[72:73], v[72:73], v[12:13]
 v_pk_mul_f32 v[74:75], v[74:75], v[12:13]
 v_pk_mul_f32 v[76:77], v[76:77], v[12:13]
 v_pk_mul_f32 v[78:79], v[78:79], v[12:13]
 v_pk_mul_f32 v[80:81], v[80:81], v[12:13]
 v_pk_mul_f32 v[82:83], v[82:83], v[12:13]
 v_pk_mul_f32 v[84:85], v[84:85], v[12:13]
 v_pk_mul_f32 v[86:87], v[86:87], v[12:13]
 v_pk_mul_f32 v[88:89], v[88:89], v[12:13]
 v_pk_mul_f32 v[90:91], v[90:91], v[12:13]
 v_pk_mul_f32 v[92:93], v[92:93], v[12:13]
 v_pk_mul_f32 v[94:95], v[94:95], v[12:13]
 v_pk_mul_f32 v[96:97], v[96:97], v[12:13]
 v_pk_mul_f32 v[98:99], v[98:99], v[12:13]
 v_pk_mul_f32 v[100:101], v[100:101], v[12:13]
 v_pk_mul_f32 v[102:103], v[102:103], v[12:13]
 v_pk_mul_f32 v[104:105], v[104:105], v[12:13]
 v_pk_mul_f32 v[106:107], v[106:107], v[12:13]
 v_pk_mul_f32 v[108:109], v[108:109], v[12:13]
 v_pk_mul_f32 v[110:111], v[110:111], v[12:13]
 v_pk_mul_f32 v[112:113], v[112:113], v[12:13]
 v_pk_mul_f32 v[114:115], v[114:115], v[12:13]
 v_pk_mul_f32 v[116:117], v[116:117], v[12:13]
 v_pk_mul_f32 v[118:119], v[118:119], v[12:13]
 v_pk_mul_f32 v[120:121], v[120:121], v[12:13]
 v_pk_mul_f32 v[122:123], v[122:123], v[12:13]
 v_pk_mul_f32 v[124:125], v[124:125], v[12:13]
 v_pk_mul_f32 v[126:127], v[126:127], v[12:13]
 v_cvt_pk_bf16_f32 v128, v16, v17
 v_cvt_pk_bf16_f32 v129, v44, v45
 v_cvt_pk_bf16_f32 v130, v18, v19
 v_cvt_pk_bf16_f32 v131, v46, v47
 s_add_u32 s11, s58, 2097152
 buffer_store_dwordx4 v[128:131], v1, s[4:7], s11 offen
 v_cvt_pk_bf16_f32 v132, v20, v21
 v_cvt_pk_bf16_f32 v133, v48, v49
 v_cvt_pk_bf16_f32 v134, v22, v23
 v_cvt_pk_bf16_f32 v135, v50, v51
 s_add_u32 s11, s58, 2111488
 buffer_store_dwordx4 v[132:135], v1, s[4:7], s11 offen
 v_cvt_pk_bf16_f32 v136, v24, v25
 v_cvt_pk_bf16_f32 v137, v52, v53
 v_cvt_pk_bf16_f32 v138, v26, v27
 v_cvt_pk_bf16_f32 v139, v54, v55
 s_add_u32 s11, s58, 2125824
 buffer_store_dwordx4 v[136:139], v1, s[4:7], s11 offen
 v_cvt_pk_bf16_f32 v140, v28, v29
 v_cvt_pk_bf16_f32 v141, v56, v57
 v_cvt_pk_bf16_f32 v142, v30, v31
 v_cvt_pk_bf16_f32 v143, v58, v59
 s_add_u32 s11, s58, 2140160
 buffer_store_dwordx4 v[140:143], v1, s[4:7], s11 offen
 v_cvt_pk_bf16_f32 v128, v32, v33
 v_cvt_pk_bf16_f32 v129, v60, v61
 v_cvt_pk_bf16_f32 v130, v34, v35
 v_cvt_pk_bf16_f32 v131, v62, v63
 s_add_u32 s11, s58, 2154496
 buffer_store_dwordx4 v[128:131], v1, s[4:7], s11 offen
 v_cvt_pk_bf16_f32 v132, v36, v37
 v_cvt_pk_bf16_f32 v133, v64, v65
 v_cvt_pk_bf16_f32 v134, v38, v39
 v_cvt_pk_bf16_f32 v135, v66, v67
 s_add_u32 s11, s58, 2168832
 buffer_store_dwordx4 v[132:135], v1, s[4:7], s11 offen
 v_cvt_pk_bf16_f32 v136, v40, v41
 v_cvt_pk_bf16_f32 v137, v68, v69
 v_cvt_pk_bf16_f32 v138, v42, v43
 v_cvt_pk_bf16_f32 v139, v70, v71
 s_add_u32 s11, s58, 2183168
 buffer_store_dwordx4 v[136:139], v1, s[4:7], s11 offen
 v_cvt_pk_bf16_f32 v140, v72, v73
 v_cvt_pk_bf16_f32 v141, v100, v101
 v_cvt_pk_bf16_f32 v142, v74, v75
 v_cvt_pk_bf16_f32 v143, v102, v103
 s_add_u32 s11, s58, 2098176
 buffer_store_dwordx4 v[140:143], v1, s[4:7], s11 offen
 v_cvt_pk_bf16_f32 v128, v76, v77
 v_cvt_pk_bf16_f32 v129, v104, v105
 v_cvt_pk_bf16_f32 v130, v78, v79
 v_cvt_pk_bf16_f32 v131, v106, v107
 s_add_u32 s11, s58, 2112512
 buffer_store_dwordx4 v[128:131], v1, s[4:7], s11 offen
 v_cvt_pk_bf16_f32 v132, v80, v81
 v_cvt_pk_bf16_f32 v133, v108, v109
 v_cvt_pk_bf16_f32 v134, v82, v83
 v_cvt_pk_bf16_f32 v135, v110, v111
 s_add_u32 s11, s58, 2126848
 buffer_store_dwordx4 v[132:135], v1, s[4:7], s11 offen
 v_cvt_pk_bf16_f32 v136, v84, v85
 v_cvt_pk_bf16_f32 v137, v112, v113
 v_cvt_pk_bf16_f32 v138, v86, v87
 v_cvt_pk_bf16_f32 v139, v114, v115
 s_add_u32 s11, s58, 2141184
 buffer_store_dwordx4 v[136:139], v1, s[4:7], s11 offen
 v_cvt_pk_bf16_f32 v140, v88, v89
 v_cvt_pk_bf16_f32 v141, v116, v117
 v_cvt_pk_bf16_f32 v142, v90, v91
 v_cvt_pk_bf16_f32 v143, v118, v119
 s_add_u32 s11, s58, 2155520
 buffer_store_dwordx4 v[140:143], v1, s[4:7], s11 offen
 v_cvt_pk_bf16_f32 v128, v92, v93
 v_cvt_pk_bf16_f32 v129, v120, v121
 v_cvt_pk_bf16_f32 v130, v94, v95
 v_cvt_pk_bf16_f32 v131, v122, v123
 s_add_u32 s11, s58, 2169856
 buffer_store_dwordx4 v[128:131], v1, s[4:7], s11 offen
 v_cvt_pk_bf16_f32 v132, v96, v97
 v_cvt_pk_bf16_f32 v133, v124, v125
 v_cvt_pk_bf16_f32 v134, v98, v99
 v_cvt_pk_bf16_f32 v135, v126, v127
 s_add_u32 s11, s58, 2184192
 buffer_store_dwordx4 v[132:135], v1, s[4:7], s11 offen
 s_branch P_done
P_B_1:
 v_lshlrev_b32 v15, 7, v10
 v_add_u32 v15, 114688, v15
 s_mul_i32 s53, s49, 229376
 v_mul_u32_u24 v10, 74, v0
 v_lshrrev_b32 v10, 10, v10
 v_mul_u32_u24 v11, 14, v10
 v_sub_u32 v11, v0, v11
 v_mul_u32_u24 v10, 896, v10
 v_lshl_add_u32 v10, v11, 4, v10
 s_mul_i32 s59, s49, 229376
 s_mul_i32 s11, s8, 224
 s_add_u32 s59, s59, s11
 s_mul_i32 s60, s8, 34816
 v_mul_u32_u24 v11, 2176, v3
 v_bfe_u32 v12, v0, 2, 2
 v_mul_u32_u24 v12, 224, v12
 v_add_u32 v11, v11, v12
 v_and_b32 v12, 3, v0
 v_lshl_add_u32 v11, v12, 3, v11
 v_add_u32 v11, s60, v11
 v_add_u32 v8, 139264, v6
 v_add_u32 v9, 139264, v7
 s_lshl_b32 s11, s8, 11
 s_add_u32 s11, s11, 139264
 s_mov_b32 m0, s11
 s_add_u32 s12, s51, 0
 buffer_load_dwordx4 v4, s[32:35], s12 offen lds
 s_lshl_b32 s11, s8, 11
 s_add_u32 s11, s11, 140288
 s_mov_b32 m0, s11
 s_add_u32 s12, s51, 65536
 buffer_load_dwordx4 v4, s[32:35], s12 offen lds
 s_add_u32 s11, s60, 0
 s_mov_b32 m0, s11
 s_add_u32 s61, s59, 0
 buffer_load_dwordx4 v10, s[36:39], s61 offen lds
 s_add_u32 s11, s60, 1088
 s_mov_b32 m0, s11
 s_add_u32 s61, s59, 3584
 buffer_load_dwordx4 v10, s[36:39], s61 offen lds
 s_add_u32 s11, s60, 2176
 s_mov_b32 m0, s11
 s_add_u32 s61, s59, 7168
 buffer_load_dwordx4 v10, s[36:39], s61 offen lds
 s_add_u32 s11, s60, 3264
 s_mov_b32 m0, s11
 s_add_u32 s61, s59, 10752
 buffer_load_dwordx4 v10, s[36:39], s61 offen lds
 s_add_u32 s11, s60, 4352
 s_mov_b32 m0, s11
 s_add_u32 s61, s59, 14336
 buffer_load_dwordx4 v10, s[36:39], s61 offen lds
 s_add_u32 s11, s60, 5440
 s_mov_b32 m0, s11
 s_add_u32 s61, s59, 17920
 buffer_load_dwordx4 v10, s[36:39], s61 offen lds
 s_add_u32 s11, s60, 6528
 s_mov_b32 m0, s11
 s_add_u32 s61, s59, 21504
 buffer_load_dwordx4 v10, s[36:39], s61 offen lds
 s_add_u32 s11, s60, 7616
 s_mov_b32 m0, s11
 s_add_u32 s61, s59, 25088
 buffer_load_dwordx4 v10, s[36:39], s61 offen lds
 s_add_u32 s11, s60, 8704
 s_mov_b32 m0, s11
 s_add_u32 s61, s59, 28672
 buffer_load_dwordx4 v10, s[36:39], s61 offen lds
 s_add_u32 s11, s60, 9792
 s_mov_b32 m0, s11
 s_add_u32 s61, s59, 32256
 buffer_load_dwordx4 v10, s[36:39], s61 offen lds
 s_add_u32 s11, s60, 10880
 s_mov_b32 m0, s11
 s_add_u32 s61, s59, 35840
 buffer_load_dwordx4 v10, s[36:39], s61 offen lds
 s_add_u32 s11, s60, 11968
 s_mov_b32 m0, s11
 s_add_u32 s61, s59, 39424
 buffer_load_dwordx4 v10, s[36:39], s61 offen lds
 s_add_u32 s11, s60, 13056
 s_mov_b32 m0, s11
 s_add_u32 s61, s59, 43008
 buffer_load_dwordx4 v10, s[36:39], s61 offen lds
 s_add_u32 s11, s60, 14144
 s_mov_b32 m0, s11
 s_add_u32 s61, s59, 46592
 buffer_load_dwordx4 v10, s[36:39], s61 offen lds
 s_add_u32 s11, s60, 15232
 s_mov_b32 m0, s11
 s_add_u32 s61, s59, 50176
 buffer_load_dwordx4 v10, s[36:39], s61 offen lds
 s_add_u32 s11, s60, 16320
 s_mov_b32 m0, s11
 s_add_u32 s61, s59, 53760
 buffer_load_dwordx4 v10, s[36:39], s61 offen lds
 s_lshl_b32 s11, s8, 11
 s_add_u32 s11, s11, 147456
 s_mov_b32 m0, s11
 s_add_u32 s12, s51, 128
 buffer_load_dwordx4 v4, s[32:35], s12 offen lds
 s_lshl_b32 s11, s8, 11
 s_add_u32 s11, s11, 148480
 s_mov_b32 m0, s11
 s_add_u32 s12, s51, 65664
 buffer_load_dwordx4 v4, s[32:35], s12 offen lds
 s_add_u32 s11, s60, 17408
 s_mov_b32 m0, s11
 s_add_u32 s61, s59, 57344
 buffer_load_dwordx4 v10, s[36:39], s61 offen lds
 s_add_u32 s11, s60, 18496
 s_mov_b32 m0, s11
 s_add_u32 s61, s59, 60928
 buffer_load_dwordx4 v10, s[36:39], s61 offen lds
 s_add_u32 s11, s60, 19584
 s_mov_b32 m0, s11
 s_add_u32 s61, s59, 64512
 buffer_load_dwordx4 v10, s[36:39], s61 offen lds
 s_add_u32 s11, s60, 20672
 s_mov_b32 m0, s11
 s_add_u32 s61, s59, 68096
 buffer_load_dwordx4 v10, s[36:39], s61 offen lds
 s_add_u32 s11, s60, 21760
 s_mov_b32 m0, s11
 s_add_u32 s61, s59, 71680
 buffer_load_dwordx4 v10, s[36:39], s61 offen lds
 s_add_u32 s11, s60, 22848
 s_mov_b32 m0, s11
 s_add_u32 s61, s59, 75264
 buffer_load_dwordx4 v10, s[36:39], s61 offen lds
 s_add_u32 s11, s60, 23936
 s_mov_b32 m0, s11
 s_add_u32 s61, s59, 78848
 buffer_load_dwordx4 v10, s[36:39], s61 offen lds
 s_add_u32 s11, s60, 25024
 s_mov_b32 m0, s11
 s_add_u32 s61, s59, 82432
 buffer_load_dwordx4 v10, s[36:39], s61 offen lds
 s_add_u32 s11, s60, 26112
 s_mov_b32 m0, s11
 s_add_u32 s61, s59, 86016
 buffer_load_dwordx4 v10, s[36:39], s61 offen lds
 s_add_u32 s11, s60, 27200
 s_mov_b32 m0, s11
 s_add_u32 s61, s59, 89600
 buffer_load_dwordx4 v10, s[36:39], s61 offen lds
 s_add_u32 s11, s60, 28288
 s_mov_b32 m0, s11
 s_add_u32 s61, s59, 93184
 buffer_load_dwordx4 v10, s[36:39], s61 offen lds
 s_add_u32 s11, s60, 29376
 s_mov_b32 m0, s11
 s_add_u32 s61, s59, 96768
 buffer_load_dwordx4 v10, s[36:39], s61 offen lds
 s_add_u32 s11, s60, 30464
 s_mov_b32 m0, s11
 s_add_u32 s61, s59, 100352
 buffer_load_dwordx4 v10, s[36:39], s61 offen lds
 s_add_u32 s11, s60, 31552
 s_mov_b32 m0, s11
 s_add_u32 s61, s59, 103936
 buffer_load_dwordx4 v10, s[36:39], s61 offen lds
 s_add_u32 s11, s60, 32640
 s_mov_b32 m0, s11
 s_add_u32 s61, s59, 107520
 buffer_load_dwordx4 v10, s[36:39], s61 offen lds
 s_add_u32 s11, s60, 33728
 s_mov_b32 m0, s11
 s_add_u32 s61, s59, 111104
 buffer_load_dwordx4 v10, s[36:39], s61 offen lds
 s_cmp_ge_u32 s8, 2
 s_cbranch_scc1 P_t_3_l
 buffer_load_dword v219, v15, s[36:39], s53 offen
 s_branch P_t_3_e
P_t_3_l:
 buffer_load_dword v219, v14, s[32:35], s52 offen
P_t_3_e:
 s_waitcnt vmcnt(19)
 s_barrier
 ds_read_b128 v[128:131], v8 offset:0
 ds_read_b128 v[132:135], v8 offset:2048
 ds_read_b128 v[136:139], v8 offset:4096
 ds_read_b128 v[140:143], v8 offset:6144
 ds_read_b64_tr_b16 v[160:161], v11 offset:0
 ds_read_b64_tr_b16 v[162:163], v11 offset:1088
 ds_read_b64_tr_b16 v[164:165], v11 offset:32
 ds_read_b64_tr_b16 v[166:167], v11 offset:1120
 ds_read_b64_tr_b16 v[168:169], v11 offset:64
 ds_read_b64_tr_b16 v[170:171], v11 offset:1152
 ds_read_b64_tr_b16 v[172:173], v11 offset:96
 ds_read_b64_tr_b16 v[174:175], v11 offset:1184
 ds_read_b64_tr_b16 v[176:177], v11 offset:128
 ds_read_b64_tr_b16 v[178:179], v11 offset:1216
 ds_read_b64_tr_b16 v[180:181], v11 offset:160
 ds_read_b64_tr_b16 v[182:183], v11 offset:1248
 ds_read_b64_tr_b16 v[184:185], v11 offset:192
 ds_read_b64_tr_b16 v[186:187], v11 offset:1280
 ds_read_b128 v[144:147], v9 offset:0
 ds_read_b128 v[148:151], v9 offset:2048
 ds_read_b128 v[152:155], v9 offset:4096
 ds_read_b128 v[156:159], v9 offset:6144
 ds_read_b64_tr_b16 v[188:189], v11 offset:8704
 ds_read_b64_tr_b16 v[190:191], v11 offset:9792
 ds_read_b64_tr_b16 v[192:193], v11 offset:8736
 ds_read_b64_tr_b16 v[194:195], v11 offset:9824
 ds_read_b64_tr_b16 v[196:197], v11 offset:8768
 ds_read_b64_tr_b16 v[198:199], v11 offset:9856
 ds_read_b64_tr_b16 v[200:201], v11 offset:8800
 ds_read_b64_tr_b16 v[202:203], v11 offset:9888
 ds_read_b64_tr_b16 v[204:205], v11 offset:8832
 ds_read_b64_tr_b16 v[206:207], v11 offset:9920
 ds_read_b64_tr_b16 v[208:209], v11 offset:8864
 ds_read_b64_tr_b16 v[210:211], v11 offset:9952
 ds_read_b64_tr_b16 v[212:213], v11 offset:8896
 ds_read_b64_tr_b16 v[214:215], v11 offset:9984
 s_waitcnt lgkmcnt(15)
 v_mfma_f32_16x16x32_bf16 v[16:19], v[128:131], v[160:163], 0
 v_mfma_f32_16x16x32_bf16 v[20:23], v[128:131], v[164:167], 0
 v_mfma_f32_16x16x32_bf16 v[24:27], v[128:131], v[168:171], 0
 v_mfma_f32_16x16x32_bf16 v[28:31], v[128:131], v[172:175], 0
 v_mfma_f32_16x16x32_bf16 v[32:35], v[128:131], v[176:179], 0
 v_mfma_f32_16x16x32_bf16 v[36:39], v[128:131], v[180:183], 0
 v_mfma_f32_16x16x32_bf16 v[40:43], v[128:131], v[184:187], 0
 v_mfma_f32_16x16x32_bf16 v[44:47], v[132:135], v[160:163], 0
 v_mfma_f32_16x16x32_bf16 v[48:51], v[132:135], v[164:167], 0
 v_mfma_f32_16x16x32_bf16 v[52:55], v[132:135], v[168:171], 0
 v_mfma_f32_16x16x32_bf16 v[56:59], v[132:135], v[172:175], 0
 v_mfma_f32_16x16x32_bf16 v[60:63], v[132:135], v[176:179], 0
 v_mfma_f32_16x16x32_bf16 v[64:67], v[132:135], v[180:183], 0
 v_mfma_f32_16x16x32_bf16 v[68:71], v[132:135], v[184:187], 0
 v_mfma_f32_16x16x32_bf16 v[72:75], v[136:139], v[160:163], 0
 v_mfma_f32_16x16x32_bf16 v[76:79], v[136:139], v[164:167], 0
 v_mfma_f32_16x16x32_bf16 v[80:83], v[136:139], v[168:171], 0
 v_mfma_f32_16x16x32_bf16 v[84:87], v[136:139], v[172:175], 0
 v_mfma_f32_16x16x32_bf16 v[88:91], v[136:139], v[176:179], 0
 v_mfma_f32_16x16x32_bf16 v[92:95], v[136:139], v[180:183], 0
 v_mfma_f32_16x16x32_bf16 v[96:99], v[136:139], v[184:187], 0
 v_mfma_f32_16x16x32_bf16 v[100:103], v[140:143], v[160:163], 0
 v_mfma_f32_16x16x32_bf16 v[104:107], v[140:143], v[164:167], 0
 v_mfma_f32_16x16x32_bf16 v[108:111], v[140:143], v[168:171], 0
 v_mfma_f32_16x16x32_bf16 v[112:115], v[140:143], v[172:175], 0
 v_mfma_f32_16x16x32_bf16 v[116:119], v[140:143], v[176:179], 0
 v_mfma_f32_16x16x32_bf16 v[120:123], v[140:143], v[180:183], 0
 v_mfma_f32_16x16x32_bf16 v[124:127], v[140:143], v[184:187], 0
 s_waitcnt lgkmcnt(0)
 s_barrier
 s_lshl_b32 s11, s8, 11
 s_add_u32 s11, s11, 139264
 s_mov_b32 m0, s11
 s_add_u32 s12, s51, 256
 buffer_load_dwordx4 v4, s[32:35], s12 offen lds
 s_lshl_b32 s11, s8, 11
 s_add_u32 s11, s11, 140288
 s_mov_b32 m0, s11
 s_add_u32 s12, s51, 65792
 buffer_load_dwordx4 v4, s[32:35], s12 offen lds
 s_add_u32 s11, s60, 0
 s_mov_b32 m0, s11
 s_add_u32 s61, s59, 114688
 buffer_load_dwordx4 v10, s[36:39], s61 offen lds
 s_add_u32 s11, s60, 1088
 s_mov_b32 m0, s11
 s_add_u32 s61, s59, 118272
 buffer_load_dwordx4 v10, s[36:39], s61 offen lds
 s_add_u32 s11, s60, 2176
 s_mov_b32 m0, s11
 s_add_u32 s61, s59, 121856
 buffer_load_dwordx4 v10, s[36:39], s61 offen lds
 s_add_u32 s11, s60, 3264
 s_mov_b32 m0, s11
 s_add_u32 s61, s59, 125440
 buffer_load_dwordx4 v10, s[36:39], s61 offen lds
 s_add_u32 s11, s60, 4352
 s_mov_b32 m0, s11
 s_add_u32 s61, s59, 129024
 buffer_load_dwordx4 v10, s[36:39], s61 offen lds
 s_add_u32 s11, s60, 5440
 s_mov_b32 m0, s11
 s_add_u32 s61, s59, 132608
 buffer_load_dwordx4 v10, s[36:39], s61 offen lds
 s_add_u32 s11, s60, 6528
 s_mov_b32 m0, s11
 s_add_u32 s61, s59, 136192
 buffer_load_dwordx4 v10, s[36:39], s61 offen lds
 s_add_u32 s11, s60, 7616
 s_mov_b32 m0, s11
 s_add_u32 s61, s59, 139776
 buffer_load_dwordx4 v10, s[36:39], s61 offen lds
 s_add_u32 s11, s60, 8704
 s_mov_b32 m0, s11
 s_add_u32 s61, s59, 143360
 buffer_load_dwordx4 v10, s[36:39], s61 offen lds
 s_add_u32 s11, s60, 9792
 s_mov_b32 m0, s11
 s_add_u32 s61, s59, 146944
 buffer_load_dwordx4 v10, s[36:39], s61 offen lds
 s_add_u32 s11, s60, 10880
 s_mov_b32 m0, s11
 s_add_u32 s61, s59, 150528
 buffer_load_dwordx4 v10, s[36:39], s61 offen lds
 s_add_u32 s11, s60, 11968
 s_mov_b32 m0, s11
 s_add_u32 s61, s59, 154112
 buffer_load_dwordx4 v10, s[36:39], s61 offen lds
 s_add_u32 s11, s60, 13056
 s_mov_b32 m0, s11
 s_add_u32 s61, s59, 157696
 buffer_load_dwordx4 v10, s[36:39], s61 offen lds
 s_add_u32 s11, s60, 14144
 s_mov_b32 m0, s11
 s_add_u32 s61, s59, 161280
 buffer_load_dwordx4 v10, s[36:39], s61 offen lds
 s_add_u32 s11, s60, 15232
 s_mov_b32 m0, s11
 s_add_u32 s61, s59, 164864
 buffer_load_dwordx4 v10, s[36:39], s61 offen lds
 s_add_u32 s11, s60, 16320
 s_mov_b32 m0, s11
 s_add_u32 s61, s59, 168448
 buffer_load_dwordx4 v10, s[36:39], s61 offen lds
 v_mfma_f32_16x16x32_bf16 v[16:19], v[144:147], v[188:191], v[16:19]
 v_mfma_f32_16x16x32_bf16 v[20:23], v[144:147], v[192:195], v[20:23]
 v_mfma_f32_16x16x32_bf16 v[24:27], v[144:147], v[196:199], v[24:27]
 v_mfma_f32_16x16x32_bf16 v[28:31], v[144:147], v[200:203], v[28:31]
 v_mfma_f32_16x16x32_bf16 v[32:35], v[144:147], v[204:207], v[32:35]
 v_mfma_f32_16x16x32_bf16 v[36:39], v[144:147], v[208:211], v[36:39]
 v_mfma_f32_16x16x32_bf16 v[40:43], v[144:147], v[212:215], v[40:43]
 v_mfma_f32_16x16x32_bf16 v[44:47], v[148:151], v[188:191], v[44:47]
 v_mfma_f32_16x16x32_bf16 v[48:51], v[148:151], v[192:195], v[48:51]
 v_mfma_f32_16x16x32_bf16 v[52:55], v[148:151], v[196:199], v[52:55]
 v_mfma_f32_16x16x32_bf16 v[56:59], v[148:151], v[200:203], v[56:59]
 v_mfma_f32_16x16x32_bf16 v[60:63], v[148:151], v[204:207], v[60:63]
 v_mfma_f32_16x16x32_bf16 v[64:67], v[148:151], v[208:211], v[64:67]
 v_mfma_f32_16x16x32_bf16 v[68:71], v[148:151], v[212:215], v[68:71]
 v_mfma_f32_16x16x32_bf16 v[72:75], v[152:155], v[188:191], v[72:75]
 v_mfma_f32_16x16x32_bf16 v[76:79], v[152:155], v[192:195], v[76:79]
 v_mfma_f32_16x16x32_bf16 v[80:83], v[152:155], v[196:199], v[80:83]
 v_mfma_f32_16x16x32_bf16 v[84:87], v[152:155], v[200:203], v[84:87]
 v_mfma_f32_16x16x32_bf16 v[88:91], v[152:155], v[204:207], v[88:91]
 v_mfma_f32_16x16x32_bf16 v[92:95], v[152:155], v[208:211], v[92:95]
 v_mfma_f32_16x16x32_bf16 v[96:99], v[152:155], v[212:215], v[96:99]
 v_mfma_f32_16x16x32_bf16 v[100:103], v[156:159], v[188:191], v[100:103]
 v_mfma_f32_16x16x32_bf16 v[104:107], v[156:159], v[192:195], v[104:107]
 v_mfma_f32_16x16x32_bf16 v[108:111], v[156:159], v[196:199], v[108:111]
 v_mfma_f32_16x16x32_bf16 v[112:115], v[156:159], v[200:203], v[112:115]
 v_mfma_f32_16x16x32_bf16 v[116:119], v[156:159], v[204:207], v[116:119]
 v_mfma_f32_16x16x32_bf16 v[120:123], v[156:159], v[208:211], v[120:123]
 v_mfma_f32_16x16x32_bf16 v[124:127], v[156:159], v[212:215], v[124:127]
 s_waitcnt vmcnt(19)
 s_barrier
 ds_read_b128 v[128:131], v8 offset:8192
 ds_read_b128 v[132:135], v8 offset:10240
 ds_read_b128 v[136:139], v8 offset:12288
 ds_read_b128 v[140:143], v8 offset:14336
 ds_read_b64_tr_b16 v[160:161], v11 offset:17408
 ds_read_b64_tr_b16 v[162:163], v11 offset:18496
 ds_read_b64_tr_b16 v[164:165], v11 offset:17440
 ds_read_b64_tr_b16 v[166:167], v11 offset:18528
 ds_read_b64_tr_b16 v[168:169], v11 offset:17472
 ds_read_b64_tr_b16 v[170:171], v11 offset:18560
 ds_read_b64_tr_b16 v[172:173], v11 offset:17504
 ds_read_b64_tr_b16 v[174:175], v11 offset:18592
 ds_read_b64_tr_b16 v[176:177], v11 offset:17536
 ds_read_b64_tr_b16 v[178:179], v11 offset:18624
 ds_read_b64_tr_b16 v[180:181], v11 offset:17568
 ds_read_b64_tr_b16 v[182:183], v11 offset:18656
 ds_read_b64_tr_b16 v[184:185], v11 offset:17600
 ds_read_b64_tr_b16 v[186:187], v11 offset:18688
 ds_read_b128 v[144:147], v9 offset:8192
 ds_read_b128 v[148:151], v9 offset:10240
 ds_read_b128 v[152:155], v9 offset:12288
 ds_read_b128 v[156:159], v9 offset:14336
 ds_read_b64_tr_b16 v[188:189], v11 offset:26112
 ds_read_b64_tr_b16 v[190:191], v11 offset:27200
 ds_read_b64_tr_b16 v[192:193], v11 offset:26144
 ds_read_b64_tr_b16 v[194:195], v11 offset:27232
 ds_read_b64_tr_b16 v[196:197], v11 offset:26176
 ds_read_b64_tr_b16 v[198:199], v11 offset:27264
 ds_read_b64_tr_b16 v[200:201], v11 offset:26208
 ds_read_b64_tr_b16 v[202:203], v11 offset:27296
 ds_read_b64_tr_b16 v[204:205], v11 offset:26240
 ds_read_b64_tr_b16 v[206:207], v11 offset:27328
 ds_read_b64_tr_b16 v[208:209], v11 offset:26272
 ds_read_b64_tr_b16 v[210:211], v11 offset:27360
 ds_read_b64_tr_b16 v[212:213], v11 offset:26304
 ds_read_b64_tr_b16 v[214:215], v11 offset:27392
 s_waitcnt lgkmcnt(15)
 v_mfma_f32_16x16x32_bf16 v[16:19], v[128:131], v[160:163], v[16:19]
 v_mfma_f32_16x16x32_bf16 v[20:23], v[128:131], v[164:167], v[20:23]
 v_mfma_f32_16x16x32_bf16 v[24:27], v[128:131], v[168:171], v[24:27]
 v_mfma_f32_16x16x32_bf16 v[28:31], v[128:131], v[172:175], v[28:31]
 v_mfma_f32_16x16x32_bf16 v[32:35], v[128:131], v[176:179], v[32:35]
 v_mfma_f32_16x16x32_bf16 v[36:39], v[128:131], v[180:183], v[36:39]
 v_mfma_f32_16x16x32_bf16 v[40:43], v[128:131], v[184:187], v[40:43]
 v_mfma_f32_16x16x32_bf16 v[44:47], v[132:135], v[160:163], v[44:47]
 v_mfma_f32_16x16x32_bf16 v[48:51], v[132:135], v[164:167], v[48:51]
 v_mfma_f32_16x16x32_bf16 v[52:55], v[132:135], v[168:171], v[52:55]
 v_mfma_f32_16x16x32_bf16 v[56:59], v[132:135], v[172:175], v[56:59]
 v_mfma_f32_16x16x32_bf16 v[60:63], v[132:135], v[176:179], v[60:63]
 v_mfma_f32_16x16x32_bf16 v[64:67], v[132:135], v[180:183], v[64:67]
 v_mfma_f32_16x16x32_bf16 v[68:71], v[132:135], v[184:187], v[68:71]
 v_mfma_f32_16x16x32_bf16 v[72:75], v[136:139], v[160:163], v[72:75]
 v_mfma_f32_16x16x32_bf16 v[76:79], v[136:139], v[164:167], v[76:79]
 v_mfma_f32_16x16x32_bf16 v[80:83], v[136:139], v[168:171], v[80:83]
 v_mfma_f32_16x16x32_bf16 v[84:87], v[136:139], v[172:175], v[84:87]
 v_mfma_f32_16x16x32_bf16 v[88:91], v[136:139], v[176:179], v[88:91]
 v_mfma_f32_16x16x32_bf16 v[92:95], v[136:139], v[180:183], v[92:95]
 v_mfma_f32_16x16x32_bf16 v[96:99], v[136:139], v[184:187], v[96:99]
 v_mfma_f32_16x16x32_bf16 v[100:103], v[140:143], v[160:163], v[100:103]
 v_mfma_f32_16x16x32_bf16 v[104:107], v[140:143], v[164:167], v[104:107]
 v_mfma_f32_16x16x32_bf16 v[108:111], v[140:143], v[168:171], v[108:111]
 v_mfma_f32_16x16x32_bf16 v[112:115], v[140:143], v[172:175], v[112:115]
 v_mfma_f32_16x16x32_bf16 v[116:119], v[140:143], v[176:179], v[116:119]
 v_mfma_f32_16x16x32_bf16 v[120:123], v[140:143], v[180:183], v[120:123]
 v_mfma_f32_16x16x32_bf16 v[124:127], v[140:143], v[184:187], v[124:127]
 s_waitcnt lgkmcnt(0)
 s_barrier
 s_lshl_b32 s11, s8, 11
 s_add_u32 s11, s11, 147456
 s_mov_b32 m0, s11
 s_add_u32 s12, s51, 384
 buffer_load_dwordx4 v4, s[32:35], s12 offen lds
 s_lshl_b32 s11, s8, 11
 s_add_u32 s11, s11, 148480
 s_mov_b32 m0, s11
 s_add_u32 s12, s51, 65920
 buffer_load_dwordx4 v4, s[32:35], s12 offen lds
 s_add_u32 s11, s60, 17408
 s_mov_b32 m0, s11
 s_add_u32 s61, s59, 172032
 buffer_load_dwordx4 v10, s[36:39], s61 offen lds
 s_add_u32 s11, s60, 18496
 s_mov_b32 m0, s11
 s_add_u32 s61, s59, 175616
 buffer_load_dwordx4 v10, s[36:39], s61 offen lds
 s_add_u32 s11, s60, 19584
 s_mov_b32 m0, s11
 s_add_u32 s61, s59, 179200
 buffer_load_dwordx4 v10, s[36:39], s61 offen lds
 s_add_u32 s11, s60, 20672
 s_mov_b32 m0, s11
 s_add_u32 s61, s59, 182784
 buffer_load_dwordx4 v10, s[36:39], s61 offen lds
 s_add_u32 s11, s60, 21760
 s_mov_b32 m0, s11
 s_add_u32 s61, s59, 186368
 buffer_load_dwordx4 v10, s[36:39], s61 offen lds
 s_add_u32 s11, s60, 22848
 s_mov_b32 m0, s11
 s_add_u32 s61, s59, 189952
 buffer_load_dwordx4 v10, s[36:39], s61 offen lds
 s_add_u32 s11, s60, 23936
 s_mov_b32 m0, s11
 s_add_u32 s61, s59, 193536
 buffer_load_dwordx4 v10, s[36:39], s61 offen lds
 s_add_u32 s11, s60, 25024
 s_mov_b32 m0, s11
 s_add_u32 s61, s59, 197120
 buffer_load_dwordx4 v10, s[36:39], s61 offen lds
 s_add_u32 s11, s60, 26112
 s_mov_b32 m0, s11
 s_add_u32 s61, s59, 200704
 buffer_load_dwordx4 v10, s[36:39], s61 offen lds
 s_add_u32 s11, s60, 27200
 s_mov_b32 m0, s11
 s_add_u32 s61, s59, 204288
 buffer_load_dwordx4 v10, s[36:39], s61 offen lds
 s_add_u32 s11, s60, 28288
 s_mov_b32 m0, s11
 s_add_u32 s61, s59, 207872
 buffer_load_dwordx4 v10, s[36:39], s61 offen lds
 s_add_u32 s11, s60, 29376
 s_mov_b32 m0, s11
 s_add_u32 s61, s59, 211456
 buffer_load_dwordx4 v10, s[36:39], s61 offen lds
 s_add_u32 s11, s60, 30464
 s_mov_b32 m0, s11
 s_add_u32 s61, s59, 215040
 buffer_load_dwordx4 v10, s[36:39], s61 offen lds
 s_add_u32 s11, s60, 31552
 s_mov_b32 m0, s11
 s_add_u32 s61, s59, 218624
 buffer_load_dwordx4 v10, s[36:39], s61 offen lds
 s_add_u32 s11, s60, 32640
 s_mov_b32 m0, s11
 s_add_u32 s61, s59, 222208
 buffer_load_dwordx4 v10, s[36:39], s61 offen lds
 s_add_u32 s11, s60, 33728
 s_mov_b32 m0, s11
 s_add_u32 s61, s59, 225792
 buffer_load_dwordx4 v10, s[36:39], s61 offen lds
 v_mfma_f32_16x16x32_bf16 v[16:19], v[144:147], v[188:191], v[16:19]
 v_mfma_f32_16x16x32_bf16 v[20:23], v[144:147], v[192:195], v[20:23]
 v_mfma_f32_16x16x32_bf16 v[24:27], v[144:147], v[196:199], v[24:27]
 v_mfma_f32_16x16x32_bf16 v[28:31], v[144:147], v[200:203], v[28:31]
 v_mfma_f32_16x16x32_bf16 v[32:35], v[144:147], v[204:207], v[32:35]
 v_mfma_f32_16x16x32_bf16 v[36:39], v[144:147], v[208:211], v[36:39]
 v_mfma_f32_16x16x32_bf16 v[40:43], v[144:147], v[212:215], v[40:43]
 v_mfma_f32_16x16x32_bf16 v[44:47], v[148:151], v[188:191], v[44:47]
 v_mfma_f32_16x16x32_bf16 v[48:51], v[148:151], v[192:195], v[48:51]
 v_mfma_f32_16x16x32_bf16 v[52:55], v[148:151], v[196:199], v[52:55]
 v_mfma_f32_16x16x32_bf16 v[56:59], v[148:151], v[200:203], v[56:59]
 v_mfma_f32_16x16x32_bf16 v[60:63], v[148:151], v[204:207], v[60:63]
 v_mfma_f32_16x16x32_bf16 v[64:67], v[148:151], v[208:211], v[64:67]
 v_mfma_f32_16x16x32_bf16 v[68:71], v[148:151], v[212:215], v[68:71]
 v_mfma_f32_16x16x32_bf16 v[72:75], v[152:155], v[188:191], v[72:75]
 v_mfma_f32_16x16x32_bf16 v[76:79], v[152:155], v[192:195], v[76:79]
 v_mfma_f32_16x16x32_bf16 v[80:83], v[152:155], v[196:199], v[80:83]
 v_mfma_f32_16x16x32_bf16 v[84:87], v[152:155], v[200:203], v[84:87]
 v_mfma_f32_16x16x32_bf16 v[88:91], v[152:155], v[204:207], v[88:91]
 v_mfma_f32_16x16x32_bf16 v[92:95], v[152:155], v[208:211], v[92:95]
 v_mfma_f32_16x16x32_bf16 v[96:99], v[152:155], v[212:215], v[96:99]
 v_mfma_f32_16x16x32_bf16 v[100:103], v[156:159], v[188:191], v[100:103]
 v_mfma_f32_16x16x32_bf16 v[104:107], v[156:159], v[192:195], v[104:107]
 v_mfma_f32_16x16x32_bf16 v[108:111], v[156:159], v[196:199], v[108:111]
 v_mfma_f32_16x16x32_bf16 v[112:115], v[156:159], v[200:203], v[112:115]
 v_mfma_f32_16x16x32_bf16 v[116:119], v[156:159], v[204:207], v[116:119]
 v_mfma_f32_16x16x32_bf16 v[120:123], v[156:159], v[208:211], v[120:123]
 v_mfma_f32_16x16x32_bf16 v[124:127], v[156:159], v[212:215], v[124:127]
 s_waitcnt vmcnt(18)
 s_barrier
 ds_read_b128 v[128:131], v8 offset:0
 ds_read_b128 v[132:135], v8 offset:2048
 ds_read_b128 v[136:139], v8 offset:4096
 ds_read_b128 v[140:143], v8 offset:6144
 ds_read_b64_tr_b16 v[160:161], v11 offset:0
 ds_read_b64_tr_b16 v[162:163], v11 offset:1088
 ds_read_b64_tr_b16 v[164:165], v11 offset:32
 ds_read_b64_tr_b16 v[166:167], v11 offset:1120
 ds_read_b64_tr_b16 v[168:169], v11 offset:64
 ds_read_b64_tr_b16 v[170:171], v11 offset:1152
 ds_read_b64_tr_b16 v[172:173], v11 offset:96
 ds_read_b64_tr_b16 v[174:175], v11 offset:1184
 ds_read_b64_tr_b16 v[176:177], v11 offset:128
 ds_read_b64_tr_b16 v[178:179], v11 offset:1216
 ds_read_b64_tr_b16 v[180:181], v11 offset:160
 ds_read_b64_tr_b16 v[182:183], v11 offset:1248
 ds_read_b64_tr_b16 v[184:185], v11 offset:192
 ds_read_b64_tr_b16 v[186:187], v11 offset:1280
 ds_read_b128 v[144:147], v9 offset:0
 ds_read_b128 v[148:151], v9 offset:2048
 ds_read_b128 v[152:155], v9 offset:4096
 ds_read_b128 v[156:159], v9 offset:6144
 ds_read_b64_tr_b16 v[188:189], v11 offset:8704
 ds_read_b64_tr_b16 v[190:191], v11 offset:9792
 ds_read_b64_tr_b16 v[192:193], v11 offset:8736
 ds_read_b64_tr_b16 v[194:195], v11 offset:9824
 ds_read_b64_tr_b16 v[196:197], v11 offset:8768
 ds_read_b64_tr_b16 v[198:199], v11 offset:9856
 ds_read_b64_tr_b16 v[200:201], v11 offset:8800
 ds_read_b64_tr_b16 v[202:203], v11 offset:9888
 ds_read_b64_tr_b16 v[204:205], v11 offset:8832
 ds_read_b64_tr_b16 v[206:207], v11 offset:9920
 ds_read_b64_tr_b16 v[208:209], v11 offset:8864
 ds_read_b64_tr_b16 v[210:211], v11 offset:9952
 ds_read_b64_tr_b16 v[212:213], v11 offset:8896
 ds_read_b64_tr_b16 v[214:215], v11 offset:9984
 s_waitcnt lgkmcnt(15)
 v_mfma_f32_16x16x32_bf16 v[16:19], v[128:131], v[160:163], v[16:19]
 v_mfma_f32_16x16x32_bf16 v[20:23], v[128:131], v[164:167], v[20:23]
 v_mfma_f32_16x16x32_bf16 v[24:27], v[128:131], v[168:171], v[24:27]
 v_mfma_f32_16x16x32_bf16 v[28:31], v[128:131], v[172:175], v[28:31]
 v_mfma_f32_16x16x32_bf16 v[32:35], v[128:131], v[176:179], v[32:35]
 v_mfma_f32_16x16x32_bf16 v[36:39], v[128:131], v[180:183], v[36:39]
 v_mfma_f32_16x16x32_bf16 v[40:43], v[128:131], v[184:187], v[40:43]
 v_mfma_f32_16x16x32_bf16 v[44:47], v[132:135], v[160:163], v[44:47]
 v_mfma_f32_16x16x32_bf16 v[48:51], v[132:135], v[164:167], v[48:51]
 v_mfma_f32_16x16x32_bf16 v[52:55], v[132:135], v[168:171], v[52:55]
 v_mfma_f32_16x16x32_bf16 v[56:59], v[132:135], v[172:175], v[56:59]
 v_mfma_f32_16x16x32_bf16 v[60:63], v[132:135], v[176:179], v[60:63]
 v_mfma_f32_16x16x32_bf16 v[64:67], v[132:135], v[180:183], v[64:67]
 v_mfma_f32_16x16x32_bf16 v[68:71], v[132:135], v[184:187], v[68:71]
 v_mfma_f32_16x16x32_bf16 v[72:75], v[136:139], v[160:163], v[72:75]
 v_mfma_f32_16x16x32_bf16 v[76:79], v[136:139], v[164:167], v[76:79]
 v_mfma_f32_16x16x32_bf16 v[80:83], v[136:139], v[168:171], v[80:83]
 v_mfma_f32_16x16x32_bf16 v[84:87], v[136:139], v[172:175], v[84:87]
 v_mfma_f32_16x16x32_bf16 v[88:91], v[136:139], v[176:179], v[88:91]
 v_mfma_f32_16x16x32_bf16 v[92:95], v[136:139], v[180:183], v[92:95]
 v_mfma_f32_16x16x32_bf16 v[96:99], v[136:139], v[184:187], v[96:99]
 v_mfma_f32_16x16x32_bf16 v[100:103], v[140:143], v[160:163], v[100:103]
 v_mfma_f32_16x16x32_bf16 v[104:107], v[140:143], v[164:167], v[104:107]
 v_mfma_f32_16x16x32_bf16 v[108:111], v[140:143], v[168:171], v[108:111]
 v_mfma_f32_16x16x32_bf16 v[112:115], v[140:143], v[172:175], v[112:115]
 v_mfma_f32_16x16x32_bf16 v[116:119], v[140:143], v[176:179], v[116:119]
 v_mfma_f32_16x16x32_bf16 v[120:123], v[140:143], v[180:183], v[120:123]
 v_mfma_f32_16x16x32_bf16 v[124:127], v[140:143], v[184:187], v[124:127]
 s_waitcnt lgkmcnt(0)
 v_mfma_f32_16x16x32_bf16 v[16:19], v[144:147], v[188:191], v[16:19]
 v_mfma_f32_16x16x32_bf16 v[20:23], v[144:147], v[192:195], v[20:23]
 v_mfma_f32_16x16x32_bf16 v[24:27], v[144:147], v[196:199], v[24:27]
 v_mfma_f32_16x16x32_bf16 v[28:31], v[144:147], v[200:203], v[28:31]
 v_mfma_f32_16x16x32_bf16 v[32:35], v[144:147], v[204:207], v[32:35]
 v_mfma_f32_16x16x32_bf16 v[36:39], v[144:147], v[208:211], v[36:39]
 v_mfma_f32_16x16x32_bf16 v[40:43], v[144:147], v[212:215], v[40:43]
 v_mfma_f32_16x16x32_bf16 v[44:47], v[148:151], v[188:191], v[44:47]
 v_mfma_f32_16x16x32_bf16 v[48:51], v[148:151], v[192:195], v[48:51]
 v_mfma_f32_16x16x32_bf16 v[52:55], v[148:151], v[196:199], v[52:55]
 v_mfma_f32_16x16x32_bf16 v[56:59], v[148:151], v[200:203], v[56:59]
 v_mfma_f32_16x16x32_bf16 v[60:63], v[148:151], v[204:207], v[60:63]
 v_mfma_f32_16x16x32_bf16 v[64:67], v[148:151], v[208:211], v[64:67]
 v_mfma_f32_16x16x32_bf16 v[68:71], v[148:151], v[212:215], v[68:71]
 v_mfma_f32_16x16x32_bf16 v[72:75], v[152:155], v[188:191], v[72:75]
 v_mfma_f32_16x16x32_bf16 v[76:79], v[152:155], v[192:195], v[76:79]
 v_mfma_f32_16x16x32_bf16 v[80:83], v[152:155], v[196:199], v[80:83]
 v_mfma_f32_16x16x32_bf16 v[84:87], v[152:155], v[200:203], v[84:87]
 v_mfma_f32_16x16x32_bf16 v[88:91], v[152:155], v[204:207], v[88:91]
 v_mfma_f32_16x16x32_bf16 v[92:95], v[152:155], v[208:211], v[92:95]
 v_mfma_f32_16x16x32_bf16 v[96:99], v[152:155], v[212:215], v[96:99]
 v_mfma_f32_16x16x32_bf16 v[100:103], v[156:159], v[188:191], v[100:103]
 v_mfma_f32_16x16x32_bf16 v[104:107], v[156:159], v[192:195], v[104:107]
 v_mfma_f32_16x16x32_bf16 v[108:111], v[156:159], v[196:199], v[108:111]
 v_mfma_f32_16x16x32_bf16 v[112:115], v[156:159], v[200:203], v[112:115]
 v_mfma_f32_16x16x32_bf16 v[116:119], v[156:159], v[204:207], v[116:119]
 v_mfma_f32_16x16x32_bf16 v[120:123], v[156:159], v[208:211], v[120:123]
 v_mfma_f32_16x16x32_bf16 v[124:127], v[156:159], v[212:215], v[124:127]
 s_waitcnt vmcnt(0)
 s_barrier
 ds_read_b128 v[128:131], v8 offset:8192
 ds_read_b128 v[132:135], v8 offset:10240
 ds_read_b128 v[136:139], v8 offset:12288
 ds_read_b128 v[140:143], v8 offset:14336
 ds_read_b64_tr_b16 v[160:161], v11 offset:17408
 ds_read_b64_tr_b16 v[162:163], v11 offset:18496
 ds_read_b64_tr_b16 v[164:165], v11 offset:17440
 ds_read_b64_tr_b16 v[166:167], v11 offset:18528
 ds_read_b64_tr_b16 v[168:169], v11 offset:17472
 ds_read_b64_tr_b16 v[170:171], v11 offset:18560
 ds_read_b64_tr_b16 v[172:173], v11 offset:17504
 ds_read_b64_tr_b16 v[174:175], v11 offset:18592
 ds_read_b64_tr_b16 v[176:177], v11 offset:17536
 ds_read_b64_tr_b16 v[178:179], v11 offset:18624
 ds_read_b64_tr_b16 v[180:181], v11 offset:17568
 ds_read_b64_tr_b16 v[182:183], v11 offset:18656
 ds_read_b64_tr_b16 v[184:185], v11 offset:17600
 ds_read_b64_tr_b16 v[186:187], v11 offset:18688
 ds_read_b128 v[144:147], v9 offset:8192
 ds_read_b128 v[148:151], v9 offset:10240
 ds_read_b128 v[152:155], v9 offset:12288
 ds_read_b128 v[156:159], v9 offset:14336
 ds_read_b64_tr_b16 v[188:189], v11 offset:26112
 ds_read_b64_tr_b16 v[190:191], v11 offset:27200
 ds_read_b64_tr_b16 v[192:193], v11 offset:26144
 ds_read_b64_tr_b16 v[194:195], v11 offset:27232
 ds_read_b64_tr_b16 v[196:197], v11 offset:26176
 ds_read_b64_tr_b16 v[198:199], v11 offset:27264
 ds_read_b64_tr_b16 v[200:201], v11 offset:26208
 ds_read_b64_tr_b16 v[202:203], v11 offset:27296
 ds_read_b64_tr_b16 v[204:205], v11 offset:26240
 ds_read_b64_tr_b16 v[206:207], v11 offset:27328
 ds_read_b64_tr_b16 v[208:209], v11 offset:26272
 ds_read_b64_tr_b16 v[210:211], v11 offset:27360
 ds_read_b64_tr_b16 v[212:213], v11 offset:26304
 ds_read_b64_tr_b16 v[214:215], v11 offset:27392
 s_waitcnt lgkmcnt(15)
 v_mfma_f32_16x16x32_bf16 v[16:19], v[128:131], v[160:163], v[16:19]
 v_mfma_f32_16x16x32_bf16 v[20:23], v[128:131], v[164:167], v[20:23]
 v_mfma_f32_16x16x32_bf16 v[24:27], v[128:131], v[168:171], v[24:27]
 v_mfma_f32_16x16x32_bf16 v[28:31], v[128:131], v[172:175], v[28:31]
 v_mfma_f32_16x16x32_bf16 v[32:35], v[128:131], v[176:179], v[32:35]
 v_mfma_f32_16x16x32_bf16 v[36:39], v[128:131], v[180:183], v[36:39]
 v_mfma_f32_16x16x32_bf16 v[40:43], v[128:131], v[184:187], v[40:43]
 v_mfma_f32_16x16x32_bf16 v[44:47], v[132:135], v[160:163], v[44:47]
 v_mfma_f32_16x16x32_bf16 v[48:51], v[132:135], v[164:167], v[48:51]
 v_mfma_f32_16x16x32_bf16 v[52:55], v[132:135], v[168:171], v[52:55]
 v_mfma_f32_16x16x32_bf16 v[56:59], v[132:135], v[172:175], v[56:59]
 v_mfma_f32_16x16x32_bf16 v[60:63], v[132:135], v[176:179], v[60:63]
 v_mfma_f32_16x16x32_bf16 v[64:67], v[132:135], v[180:183], v[64:67]
 v_mfma_f32_16x16x32_bf16 v[68:71], v[132:135], v[184:187], v[68:71]
 v_mfma_f32_16x16x32_bf16 v[72:75], v[136:139], v[160:163], v[72:75]
 v_mfma_f32_16x16x32_bf16 v[76:79], v[136:139], v[164:167], v[76:79]
 v_mfma_f32_16x16x32_bf16 v[80:83], v[136:139], v[168:171], v[80:83]
 v_mfma_f32_16x16x32_bf16 v[84:87], v[136:139], v[172:175], v[84:87]
 v_mfma_f32_16x16x32_bf16 v[88:91], v[136:139], v[176:179], v[88:91]
 v_mfma_f32_16x16x32_bf16 v[92:95], v[136:139], v[180:183], v[92:95]
 v_mfma_f32_16x16x32_bf16 v[96:99], v[136:139], v[184:187], v[96:99]
 v_mfma_f32_16x16x32_bf16 v[100:103], v[140:143], v[160:163], v[100:103]
 v_mfma_f32_16x16x32_bf16 v[104:107], v[140:143], v[164:167], v[104:107]
 v_mfma_f32_16x16x32_bf16 v[108:111], v[140:143], v[168:171], v[108:111]
 v_mfma_f32_16x16x32_bf16 v[112:115], v[140:143], v[172:175], v[112:115]
 v_mfma_f32_16x16x32_bf16 v[116:119], v[140:143], v[176:179], v[116:119]
 v_mfma_f32_16x16x32_bf16 v[120:123], v[140:143], v[180:183], v[120:123]
 v_mfma_f32_16x16x32_bf16 v[124:127], v[140:143], v[184:187], v[124:127]
 s_waitcnt lgkmcnt(0)
 v_mfma_f32_16x16x32_bf16 v[16:19], v[144:147], v[188:191], v[16:19]
 v_mfma_f32_16x16x32_bf16 v[20:23], v[144:147], v[192:195], v[20:23]
 v_mfma_f32_16x16x32_bf16 v[24:27], v[144:147], v[196:199], v[24:27]
 v_mfma_f32_16x16x32_bf16 v[28:31], v[144:147], v[200:203], v[28:31]
 v_mfma_f32_16x16x32_bf16 v[32:35], v[144:147], v[204:207], v[32:35]
 v_mfma_f32_16x16x32_bf16 v[36:39], v[144:147], v[208:211], v[36:39]
 v_mfma_f32_16x16x32_bf16 v[40:43], v[144:147], v[212:215], v[40:43]
 v_mfma_f32_16x16x32_bf16 v[44:47], v[148:151], v[188:191], v[44:47]
 v_mfma_f32_16x16x32_bf16 v[48:51], v[148:151], v[192:195], v[48:51]
 v_mfma_f32_16x16x32_bf16 v[52:55], v[148:151], v[196:199], v[52:55]
 v_mfma_f32_16x16x32_bf16 v[56:59], v[148:151], v[200:203], v[56:59]
 v_mfma_f32_16x16x32_bf16 v[60:63], v[148:151], v[204:207], v[60:63]
 v_mfma_f32_16x16x32_bf16 v[64:67], v[148:151], v[208:211], v[64:67]
 v_mfma_f32_16x16x32_bf16 v[68:71], v[148:151], v[212:215], v[68:71]
 v_mfma_f32_16x16x32_bf16 v[72:75], v[152:155], v[188:191], v[72:75]
 v_mfma_f32_16x16x32_bf16 v[76:79], v[152:155], v[192:195], v[76:79]
 v_mfma_f32_16x16x32_bf16 v[80:83], v[152:155], v[196:199], v[80:83]
 v_mfma_f32_16x16x32_bf16 v[84:87], v[152:155], v[200:203], v[84:87]
 v_mfma_f32_16x16x32_bf16 v[88:91], v[152:155], v[204:207], v[88:91]
 v_mfma_f32_16x16x32_bf16 v[92:95], v[152:155], v[208:211], v[92:95]
 v_mfma_f32_16x16x32_bf16 v[96:99], v[152:155], v[212:215], v[96:99]
 v_mfma_f32_16x16x32_bf16 v[100:103], v[156:159], v[188:191], v[100:103]
 v_mfma_f32_16x16x32_bf16 v[104:107], v[156:159], v[192:195], v[104:107]
 v_mfma_f32_16x16x32_bf16 v[108:111], v[156:159], v[196:199], v[108:111]
 v_mfma_f32_16x16x32_bf16 v[112:115], v[156:159], v[200:203], v[112:115]
 v_mfma_f32_16x16x32_bf16 v[116:119], v[156:159], v[204:207], v[116:119]
 v_mfma_f32_16x16x32_bf16 v[120:123], v[156:159], v[208:211], v[120:123]
 v_mfma_f32_16x16x32_bf16 v[124:127], v[156:159], v[212:215], v[124:127]
 s_nop 7
 v_cvt_pk_bf16_f32 v128, v16, v17
 v_cvt_pk_bf16_f32 v129, v44, v45
 v_cvt_pk_bf16_f32 v130, v18, v19
 v_cvt_pk_bf16_f32 v131, v46, v47
 s_add_u32 s11, s58, 9437184
 buffer_store_dwordx4 v[128:131], v1, s[4:7], s11 offen
 v_cvt_pk_bf16_f32 v132, v20, v21
 v_cvt_pk_bf16_f32 v133, v48, v49
 v_cvt_pk_bf16_f32 v134, v22, v23
 v_cvt_pk_bf16_f32 v135, v50, v51
 s_add_u32 s11, s58, 9451520
 buffer_store_dwordx4 v[132:135], v1, s[4:7], s11 offen
 v_cvt_pk_bf16_f32 v136, v24, v25
 v_cvt_pk_bf16_f32 v137, v52, v53
 v_cvt_pk_bf16_f32 v138, v26, v27
 v_cvt_pk_bf16_f32 v139, v54, v55
 s_add_u32 s11, s58, 9465856
 buffer_store_dwordx4 v[136:139], v1, s[4:7], s11 offen
 v_cvt_pk_bf16_f32 v140, v28, v29
 v_cvt_pk_bf16_f32 v141, v56, v57
 v_cvt_pk_bf16_f32 v142, v30, v31
 v_cvt_pk_bf16_f32 v143, v58, v59
 s_add_u32 s11, s58, 9480192
 buffer_store_dwordx4 v[140:143], v1, s[4:7], s11 offen
 v_cvt_pk_bf16_f32 v128, v32, v33
 v_cvt_pk_bf16_f32 v129, v60, v61
 v_cvt_pk_bf16_f32 v130, v34, v35
 v_cvt_pk_bf16_f32 v131, v62, v63
 s_add_u32 s11, s58, 9494528
 buffer_store_dwordx4 v[128:131], v1, s[4:7], s11 offen
 v_cvt_pk_bf16_f32 v132, v36, v37
 v_cvt_pk_bf16_f32 v133, v64, v65
 v_cvt_pk_bf16_f32 v134, v38, v39
 v_cvt_pk_bf16_f32 v135, v66, v67
 s_add_u32 s11, s58, 9508864
 buffer_store_dwordx4 v[132:135], v1, s[4:7], s11 offen
 v_cvt_pk_bf16_f32 v136, v40, v41
 v_cvt_pk_bf16_f32 v137, v68, v69
 v_cvt_pk_bf16_f32 v138, v42, v43
 v_cvt_pk_bf16_f32 v139, v70, v71
 s_add_u32 s11, s58, 9523200
 buffer_store_dwordx4 v[136:139], v1, s[4:7], s11 offen
 v_cvt_pk_bf16_f32 v140, v72, v73
 v_cvt_pk_bf16_f32 v141, v100, v101
 v_cvt_pk_bf16_f32 v142, v74, v75
 v_cvt_pk_bf16_f32 v143, v102, v103
 s_add_u32 s11, s58, 9438208
 buffer_store_dwordx4 v[140:143], v1, s[4:7], s11 offen
 v_cvt_pk_bf16_f32 v128, v76, v77
 v_cvt_pk_bf16_f32 v129, v104, v105
 v_cvt_pk_bf16_f32 v130, v78, v79
 v_cvt_pk_bf16_f32 v131, v106, v107
 s_add_u32 s11, s58, 9452544
 buffer_store_dwordx4 v[128:131], v1, s[4:7], s11 offen
 v_cvt_pk_bf16_f32 v132, v80, v81
 v_cvt_pk_bf16_f32 v133, v108, v109
 v_cvt_pk_bf16_f32 v134, v82, v83
 v_cvt_pk_bf16_f32 v135, v110, v111
 s_add_u32 s11, s58, 9466880
 buffer_store_dwordx4 v[132:135], v1, s[4:7], s11 offen
 v_cvt_pk_bf16_f32 v136, v84, v85
 v_cvt_pk_bf16_f32 v137, v112, v113
 v_cvt_pk_bf16_f32 v138, v86, v87
 v_cvt_pk_bf16_f32 v139, v114, v115
 s_add_u32 s11, s58, 9481216
 buffer_store_dwordx4 v[136:139], v1, s[4:7], s11 offen
 v_cvt_pk_bf16_f32 v140, v88, v89
 v_cvt_pk_bf16_f32 v141, v116, v117
 v_cvt_pk_bf16_f32 v142, v90, v91
 v_cvt_pk_bf16_f32 v143, v118, v119
 s_add_u32 s11, s58, 9495552
 buffer_store_dwordx4 v[140:143], v1, s[4:7], s11 offen
 v_cvt_pk_bf16_f32 v128, v92, v93
 v_cvt_pk_bf16_f32 v129, v120, v121
 v_cvt_pk_bf16_f32 v130, v94, v95
 v_cvt_pk_bf16_f32 v131, v122, v123
 s_add_u32 s11, s58, 9509888
 buffer_store_dwordx4 v[128:131], v1, s[4:7], s11 offen
 v_cvt_pk_bf16_f32 v132, v96, v97
 v_cvt_pk_bf16_f32 v133, v124, v125
 v_cvt_pk_bf16_f32 v134, v98, v99
 v_cvt_pk_bf16_f32 v135, v126, v127
 s_add_u32 s11, s58, 9524224
 buffer_store_dwordx4 v[132:135], v1, s[4:7], s11 offen
 s_branch P_done
P_ln:
 s_sub_u32 s22, s21, 28
 s_lshl_b32 s22, s22, 3
 s_add_u32 s22, s22, s20
 s_load_dwordx2 s[24:25], s[0:1], 0
 s_load_dwordx2 s[28:29], s[0:1], 8
 s_lshl_b32 s48, s22, 2
 s_add_u32 s48, s48, s8
 v_and_b32 v2, 15, v0
 v_lshrrev_b32 v3, 4, v0
 s_waitcnt lgkmcnt(0)
 s_and_b32 s25, s25, 0xffff
 s_mov_b32 s26, 1835008
 s_mov_b32 s27, 0x00020000
 s_and_b32 s29, s29, 0xffff
 s_mov_b32 s30, 7168
 s_mov_b32 s31, 0x00020000
 s_mul_i32 s49, s48, 14336
 s_mul_i32 s60, s8, 14336
 s_add_u32 s11, s60, 0
 s_mov_b32 m0, s11
 s_add_u32 s12, s49, 0
 buffer_load_dwordx4 v1, s[24:27], s12 offen offset:0 lds
 buffer_load_dwordx4 v1, s[24:27], s12 offen offset:1024 lds
 buffer_load_dwordx4 v1, s[24:27], s12 offen offset:2048 lds
 buffer_load_dwordx4 v1, s[24:27], s12 offen offset:3072 lds
 s_add_u32 s11, s60, 4096
 s_mov_b32 m0, s11
 s_add_u32 s12, s49, 4096
 buffer_load_dwordx4 v1, s[24:27], s12 offen offset:0 lds
 buffer_load_dwordx4 v1, s[24:27], s12 offen offset:1024 lds
 buffer_load_dwordx4 v1, s[24:27], s12 offen offset:2048 lds
 buffer_load_dwordx4 v1, s[24:27], s12 offen offset:3072 lds
 s_add_u32 s11, s60, 8192
 s_mov_b32 m0, s11
 s_add_u32 s12, s49, 8192
 buffer_load_dwordx4 v1, s[24:27], s12 offen offset:0 lds
 buffer_load_dwordx4 v1, s[24:27], s12 offen offset:1024 lds
 buffer_load_dwordx4 v1, s[24:27], s12 offen offset:2048 lds
 buffer_load_dwordx4 v1, s[24:27], s12 offen offset:3072 lds
 s_add_u32 s11, s60, 12288
 s_mov_b32 m0, s11
 s_add_u32 s12, s49, 12288
 buffer_load_dwordx4 v1, s[24:27], s12 offen offset:0 lds
 buffer_load_dwordx4 v1, s[24:27], s12 offen offset:1024 lds
 v_mul_u32_u24 v4, 896, v2
 v_lshl_add_u32 v4, v3, 3, v4
 v_add_u32 v4, s60, v4
 s_waitcnt vmcnt(0)
 ds_read_b64 v[24:25], v4 offset:0
 ds_read_b64 v[26:27], v4 offset:32
 ds_read_b64 v[28:29], v4 offset:64
 ds_read_b64 v[30:31], v4 offset:96
 ds_read_b64 v[32:33], v4 offset:128
 ds_read_b64 v[34:35], v4 offset:160
 ds_read_b64 v[36:37], v4 offset:192
 ds_read_b64 v[38:39], v4 offset:224
 ds_read_b64 v[40:41], v4 offset:256
 ds_read_b64 v[42:43], v4 offset:288
 ds_read_b64 v[44:45], v4 offset:320
 ds_read_b64 v[46:47], v4 offset:352
 ds_read_b64 v[48:49], v4 offset:384
 ds_read_b64 v[50:51], v4 offset:416
 ds_read_b64 v[52:53], v4 offset:448
 ds_read_b64 v[54:55], v4 offset:480
 ds_read_b64 v[56:57], v4 offset:512
 ds_read_b64 v[58:59], v4 offset:544
 ds_read_b64 v[60:61], v4 offset:576
 ds_read_b64 v[62:63], v4 offset:608
 ds_read_b64 v[64:65], v4 offset:640
 ds_read_b64 v[66:67], v4 offset:672
 ds_read_b64 v[68:69], v4 offset:704
 ds_read_b64 v[70:71], v4 offset:736
 ds_read_b64 v[72:73], v4 offset:768
 ds_read_b64 v[74:75], v4 offset:800
 ds_read_b64 v[76:77], v4 offset:832
 ds_read_b64 v[78:79], v4 offset:864
 s_waitcnt lgkmcnt(0)
 v_lshlrev_b32 v80, 16, v24
 v_and_b32 v81, 0xffff0000, v24
 v_lshlrev_b32 v82, 16, v25
 v_and_b32 v83, 0xffff0000, v25
 v_lshlrev_b32 v84, 16, v26
 v_and_b32 v85, 0xffff0000, v26
 v_lshlrev_b32 v86, 16, v27
 v_and_b32 v87, 0xffff0000, v27
 v_lshlrev_b32 v88, 16, v28
 v_and_b32 v89, 0xffff0000, v28
 v_lshlrev_b32 v90, 16, v29
 v_and_b32 v91, 0xffff0000, v29
 v_lshlrev_b32 v92, 16, v30
 v_and_b32 v93, 0xffff0000, v30
 v_lshlrev_b32 v94, 16, v31
 v_and_b32 v95, 0xffff0000, v31
 v_lshlrev_b32 v96, 16, v32
 v_and_b32 v97, 0xffff0000, v32
 v_lshlrev_b32 v98, 16, v33
 v_and_b32 v99, 0xffff0000, v33
 v_lshlrev_b32 v100, 16, v34
 v_and_b32 v101, 0xffff0000, v34
 v_lshlrev_b32 v102, 16, v35
 v_and_b32 v103, 0xffff0000, v35
 v_lshlrev_b32 v104, 16, v36
 v_and_b32 v105, 0xffff0000, v36
 v_lshlrev_b32 v106, 16, v37
 v_and_b32 v107, 0xffff0000, v37
 v_lshlrev_b32 v108, 16, v38
 v_and_b32 v109, 0xffff0000, v38
 v_lshlrev_b32 v110, 16, v39
 v_and_b32 v111, 0xffff0000, v39
 v_lshlrev_b32 v112, 16, v40
 v_and_b32 v113, 0xffff0000, v40
 v_lshlrev_b32 v114, 16, v41
 v_and_b32 v115, 0xffff0000, v41
 v_lshlrev_b32 v116, 16, v42
 v_and_b32 v117, 0xffff0000, v42
 v_lshlrev_b32 v118, 16, v43
 v_and_b32 v119, 0xffff0000, v43
 v_lshlrev_b32 v120, 16, v44
 v_and_b32 v121, 0xffff0000, v44
 v_lshlrev_b32 v122, 16, v45
 v_and_b32 v123, 0xffff0000, v45
 v_lshlrev_b32 v124, 16, v46
 v_and_b32 v125, 0xffff0000, v46
 v_lshlrev_b32 v126, 16, v47
 v_and_b32 v127, 0xffff0000, v47
 v_lshlrev_b32 v128, 16, v48
 v_and_b32 v129, 0xffff0000, v48
 v_lshlrev_b32 v130, 16, v49
 v_and_b32 v131, 0xffff0000, v49
 v_lshlrev_b32 v132, 16, v50
 v_and_b32 v133, 0xffff0000, v50
 v_lshlrev_b32 v134, 16, v51
 v_and_b32 v135, 0xffff0000, v51
 v_lshlrev_b32 v136, 16, v52
 v_and_b32 v137, 0xffff0000, v52
 v_lshlrev_b32 v138, 16, v53
 v_and_b32 v139, 0xffff0000, v53
 v_lshlrev_b32 v140, 16, v54
 v_and_b32 v141, 0xffff0000, v54
 v_lshlrev_b32 v142, 16, v55
 v_and_b32 v143, 0xffff0000, v55
 v_lshlrev_b32 v144, 16, v56
 v_and_b32 v145, 0xffff0000, v56
 v_lshlrev_b32 v146, 16, v57
 v_and_b32 v147, 0xffff0000, v57
 v_lshlrev_b32 v148, 16, v58
 v_and_b32 v149, 0xffff0000, v58
 v_lshlrev_b32 v150, 16, v59
 v_and_b32 v151, 0xffff0000, v59
 v_lshlrev_b32 v152, 16, v60
 v_and_b32 v153, 0xffff0000, v60
 v_lshlrev_b32 v154, 16, v61
 v_and_b32 v155, 0xffff0000, v61
 v_lshlrev_b32 v156, 16, v62
 v_and_b32 v157, 0xffff0000, v62
 v_lshlrev_b32 v158, 16, v63
 v_and_b32 v159, 0xffff0000, v63
 v_lshlrev_b32 v160, 16, v64
 v_and_b32 v161, 0xffff0000, v64
 v_lshlrev_b32 v162, 16, v65
 v_and_b32 v163, 0xffff0000, v65
 v_lshlrev_b32 v164, 16, v66
 v_and_b32 v165, 0xffff0000, v66
 v_lshlrev_b32 v166, 16, v67
 v_and_b32 v167, 0xffff0000, v67
 v_lshlrev_b32 v168, 16, v68
 v_and_b32 v169, 0xffff0000, v68
 v_lshlrev_b32 v170, 16, v69
 v_and_b32 v171, 0xffff0000, v69
 v_lshlrev_b32 v172, 16, v70
 v_and_b32 v173, 0xffff0000, v70
 v_lshlrev_b32 v174, 16, v71
 v_and_b32 v175, 0xffff0000, v71
 v_lshlrev_b32 v176, 16, v72
 v_and_b32 v177, 0xffff0000, v72
 v_lshlrev_b32 v178, 16, v73
 v_and_b32 v179, 0xffff0000, v73
 v_lshlrev_b32 v180, 16, v74
 v_and_b32 v181, 0xffff0000, v74
 v_lshlrev_b32 v182, 16, v75
 v_and_b32 v183, 0xffff0000, v75
 v_lshlrev_b32 v184, 16, v76
 v_and_b32 v185, 0xffff0000, v76
 v_lshlrev_b32 v186, 16, v77
 v_and_b32 v187, 0xffff0000, v77
 v_lshlrev_b32 v188, 16, v78
 v_and_b32 v189, 0xffff0000, v78
 v_lshlrev_b32 v190, 16, v79
 v_and_b32 v191, 0xffff0000, v79
 v_pk_add_f32 v[8:9], v[80:81], v[82:83]
 v_pk_add_f32 v[8:9], v[8:9], v[84:85]
 v_pk_add_f32 v[8:9], v[8:9], v[86:87]
 v_pk_add_f32 v[8:9], v[8:9], v[88:89]
 v_pk_add_f32 v[8:9], v[8:9], v[90:91]
 v_pk_add_f32 v[8:9], v[8:9], v[92:93]
 v_pk_add_f32 v[8:9], v[8:9], v[94:95]
 v_pk_add_f32 v[8:9], v[8:9], v[96:97]
 v_pk_add_f32 v[8:9], v[8:9], v[98:99]
 v_pk_add_f32 v[8:9], v[8:9], v[100:101]
 v_pk_add_f32 v[8:9], v[8:9], v[102:103]
 v_pk_add_f32 v[8:9], v[8:9], v[104:105]
 v_pk_add_f32 v[8:9], v[8:9], v[106:107]
 v_pk_add_f32 v[8:9], v[8:9], v[108:109]
 v_pk_add_f32 v[8:9], v[8:9], v[110:111]
 v_pk_add_f32 v[8:9], v[8:9], v[112:113]
 v_pk_add_f32 v[8:9], v[8:9], v[114:115]
 v_pk_add_f32 v[8:9], v[8:9], v[116:117]
 v_pk_add_f32 v[8:9], v[8:9], v[118:119]
 v_pk_add_f32 v[8:9], v[8:9], v[120:121]
 v_pk_add_f32 v[8:9], v[8:9], v[122:123]
 v_pk_add_f32 v[8:9], v[8:9], v[124:125]
 v_pk_add_f32 v[8:9], v[8:9], v[126:127]
 v_pk_add_f32 v[8:9], v[8:9], v[128:129]
 v_pk_add_f32 v[8:9], v[8:9], v[130:131]
 v_pk_add_f32 v[8:9], v[8:9], v[132:133]
 v_pk_add_f32 v[8:9], v[8:9], v[134:135]
 v_pk_add_f32 v[8:9], v[8:9], v[136:137]
 v_pk_add_f32 v[8:9], v[8:9], v[138:139]
 v_pk_add_f32 v[8:9], v[8:9], v[140:141]
 v_pk_add_f32 v[8:9], v[8:9], v[142:143]
 v_pk_add_f32 v[8:9], v[8:9], v[144:145]
 v_pk_add_f32 v[8:9], v[8:9], v[146:147]
 v_pk_add_f32 v[8:9], v[8:9], v[148:149]
 v_pk_add_f32 v[8:9], v[8:9], v[150:151]
 v_pk_add_f32 v[8:9], v[8:9], v[152:153]
 v_pk_add_f32 v[8:9], v[8:9], v[154:155]
 v_pk_add_f32 v[8:9], v[8:9], v[156:157]
 v_pk_add_f32 v[8:9], v[8:9], v[158:159]
 v_pk_add_f32 v[8:9], v[8:9], v[160:161]
 v_pk_add_f32 v[8:9], v[8:9], v[162:163]
 v_pk_add_f32 v[8:9], v[8:9], v[164:165]
 v_pk_add_f32 v[8:9], v[8:9], v[166:167]
 v_pk_add_f32 v[8:9], v[8:9], v[168:169]
 v_pk_add_f32 v[8:9], v[8:9], v[170:171]
 v_pk_add_f32 v[8:9], v[8:9], v[172:173]
 v_pk_add_f32 v[8:9], v[8:9], v[174:175]
 v_pk_add_f32 v[8:9], v[8:9], v[176:177]
 v_pk_add_f32 v[8:9], v[8:9], v[178:179]
 v_pk_add_f32 v[8:9], v[8:9], v[180:181]
 v_pk_add_f32 v[8:9], v[8:9], v[182:183]
 v_pk_add_f32 v[8:9], v[8:9], v[184:185]
 v_pk_add_f32 v[8:9], v[8:9], v[186:187]
 v_pk_add_f32 v[8:9], v[8:9], v[188:189]
 v_pk_add_f32 v[8:9], v[8:9], v[190:191]
 v_add_f32 v8, v8, v9
 v_mov_b32 v9, v8
 s_nop 1
 v_permlane32_swap_b32 v8, v9
 v_add_f32 v8, v8, v9
 v_mov_b32 v9, v8
 s_nop 1
 v_permlane16_swap_b32 v8, v9
 v_add_f32 v8, v8, v9
 v_mul_f32 v8, 0x3b124925, v8
 v_mov_b32 v9, v8
 v_pk_add_f32 v[80:81], v[80:81], v[8:9] neg_lo:[0,1] neg_hi:[0,1]
 v_pk_add_f32 v[82:83], v[82:83], v[8:9] neg_lo:[0,1] neg_hi:[0,1]
 v_pk_add_f32 v[84:85], v[84:85], v[8:9] neg_lo:[0,1] neg_hi:[0,1]
 v_pk_add_f32 v[86:87], v[86:87], v[8:9] neg_lo:[0,1] neg_hi:[0,1]
 v_pk_add_f32 v[88:89], v[88:89], v[8:9] neg_lo:[0,1] neg_hi:[0,1]
 v_pk_add_f32 v[90:91], v[90:91], v[8:9] neg_lo:[0,1] neg_hi:[0,1]
 v_pk_add_f32 v[92:93], v[92:93], v[8:9] neg_lo:[0,1] neg_hi:[0,1]
 v_pk_add_f32 v[94:95], v[94:95], v[8:9] neg_lo:[0,1] neg_hi:[0,1]
 v_pk_add_f32 v[96:97], v[96:97], v[8:9] neg_lo:[0,1] neg_hi:[0,1]
 v_pk_add_f32 v[98:99], v[98:99], v[8:9] neg_lo:[0,1] neg_hi:[0,1]
 v_pk_add_f32 v[100:101], v[100:101], v[8:9] neg_lo:[0,1] neg_hi:[0,1]
 v_pk_add_f32 v[102:103], v[102:103], v[8:9] neg_lo:[0,1] neg_hi:[0,1]
 v_pk_add_f32 v[104:105], v[104:105], v[8:9] neg_lo:[0,1] neg_hi:[0,1]
 v_pk_add_f32 v[106:107], v[106:107], v[8:9] neg_lo:[0,1] neg_hi:[0,1]
 v_pk_add_f32 v[108:109], v[108:109], v[8:9] neg_lo:[0,1] neg_hi:[0,1]
 v_pk_add_f32 v[110:111], v[110:111], v[8:9] neg_lo:[0,1] neg_hi:[0,1]
 v_pk_add_f32 v[112:113], v[112:113], v[8:9] neg_lo:[0,1] neg_hi:[0,1]
 v_pk_add_f32 v[114:115], v[114:115], v[8:9] neg_lo:[0,1] neg_hi:[0,1]
 v_pk_add_f32 v[116:117], v[116:117], v[8:9] neg_lo:[0,1] neg_hi:[0,1]
 v_pk_add_f32 v[118:119], v[118:119], v[8:9] neg_lo:[0,1] neg_hi:[0,1]
 v_pk_add_f32 v[120:121], v[120:121], v[8:9] neg_lo:[0,1] neg_hi:[0,1]
 v_pk_add_f32 v[122:123], v[122:123], v[8:9] neg_lo:[0,1] neg_hi:[0,1]
 v_pk_add_f32 v[124:125], v[124:125], v[8:9] neg_lo:[0,1] neg_hi:[0,1]
 v_pk_add_f32 v[126:127], v[126:127], v[8:9] neg_lo:[0,1] neg_hi:[0,1]
 v_pk_add_f32 v[128:129], v[128:129], v[8:9] neg_lo:[0,1] neg_hi:[0,1]
 v_pk_add_f32 v[130:131], v[130:131], v[8:9] neg_lo:[0,1] neg_hi:[0,1]
 v_pk_add_f32 v[132:133], v[132:133], v[8:9] neg_lo:[0,1] neg_hi:[0,1]
 v_pk_add_f32 v[134:135], v[134:135], v[8:9] neg_lo:[0,1] neg_hi:[0,1]
 v_pk_add_f32 v[136:137], v[136:137], v[8:9] neg_lo:[0,1] neg_hi:[0,1]
 v_pk_add_f32 v[138:139], v[138:139], v[8:9] neg_lo:[0,1] neg_hi:[0,1]
 v_pk_add_f32 v[140:141], v[140:141], v[8:9] neg_lo:[0,1] neg_hi:[0,1]
 v_pk_add_f32 v[142:143], v[142:143], v[8:9] neg_lo:[0,1] neg_hi:[0,1]
 v_pk_add_f32 v[144:145], v[144:145], v[8:9] neg_lo:[0,1] neg_hi:[0,1]
 v_pk_add_f32 v[146:147], v[146:147], v[8:9] neg_lo:[0,1] neg_hi:[0,1]
 v_pk_add_f32 v[148:149], v[148:149], v[8:9] neg_lo:[0,1] neg_hi:[0,1]
 v_pk_add_f32 v[150:151], v[150:151], v[8:9] neg_lo:[0,1] neg_hi:[0,1]
 v_pk_add_f32 v[152:153], v[152:153], v[8:9] neg_lo:[0,1] neg_hi:[0,1]
 v_pk_add_f32 v[154:155], v[154:155], v[8:9] neg_lo:[0,1] neg_hi:[0,1]
 v_pk_add_f32 v[156:157], v[156:157], v[8:9] neg_lo:[0,1] neg_hi:[0,1]
 v_pk_add_f32 v[158:159], v[158:159], v[8:9] neg_lo:[0,1] neg_hi:[0,1]
 v_pk_add_f32 v[160:161], v[160:161], v[8:9] neg_lo:[0,1] neg_hi:[0,1]
 v_pk_add_f32 v[162:163], v[162:163], v[8:9] neg_lo:[0,1] neg_hi:[0,1]
 v_pk_add_f32 v[164:165], v[164:165], v[8:9] neg_lo:[0,1] neg_hi:[0,1]
 v_pk_add_f32 v[166:167], v[166:167], v[8:9] neg_lo:[0,1] neg_hi:[0,1]
 v_pk_add_f32 v[168:169], v[168:169], v[8:9] neg_lo:[0,1] neg_hi:[0,1]
 v_pk_add_f32 v[170:171], v[170:171], v[8:9] neg_lo:[0,1] neg_hi:[0,1]
 v_pk_add_f32 v[172:173], v[172:173], v[8:9] neg_lo:[0,1] neg_hi:[0,1]
 v_pk_add_f32 v[174:175], v[174:175], v[8:9] neg_lo:[0,1] neg_hi:[0,1]
 v_pk_add_f32 v[176:177], v[176:177], v[8:9] neg_lo:[0,1] neg_hi:[0,1]
 v_pk_add_f32 v[178:179], v[178:179], v[8:9] neg_lo:[0,1] neg_hi:[0,1]
 v_pk_add_f32 v[180:181], v[180:181], v[8:9] neg_lo:[0,1] neg_hi:[0,1]
 v_pk_add_f32 v[182:183], v[182:183], v[8:9] neg_lo:[0,1] neg_hi:[0,1]
 v_pk_add_f32 v[184:185], v[184:185], v[8:9] neg_lo:[0,1] neg_hi:[0,1]
 v_pk_add_f32 v[186:187], v[186:187], v[8:9] neg_lo:[0,1] neg_hi:[0,1]
 v_pk_add_f32 v[188:189], v[188:189], v[8:9] neg_lo:[0,1] neg_hi:[0,1]
 v_pk_add_f32 v[190:191], v[190:191], v[8:9] neg_lo:[0,1] neg_hi:[0,1]
 v_pk_mul_f32 v[10:11], v[80:81], v[80:81]
 v_pk_fma_f32 v[10:11], v[82:83], v[82:83], v[10:11]
 v_pk_fma_f32 v[10:11], v[84:85], v[84:85], v[10:11]
 v_pk_fma_f32 v[10:11], v[86:87], v[86:87], v[10:11]
 v_pk_fma_f32 v[10:11], v[88:89], v[88:89], v[10:11]
 v_pk_fma_f32 v[10:11], v[90:91], v[90:91], v[10:11]
 v_pk_fma_f32 v[10:11], v[92:93], v[92:93], v[10:11]
 v_pk_fma_f32 v[10:11], v[94:95], v[94:95], v[10:11]
 v_pk_fma_f32 v[10:11], v[96:97], v[96:97], v[10:11]
 v_pk_fma_f32 v[10:11], v[98:99], v[98:99], v[10:11]
 v_pk_fma_f32 v[10:11], v[100:101], v[100:101], v[10:11]
 v_pk_fma_f32 v[10:11], v[102:103], v[102:103], v[10:11]
 v_pk_fma_f32 v[10:11], v[104:105], v[104:105], v[10:11]
 v_pk_fma_f32 v[10:11], v[106:107], v[106:107], v[10:11]
 v_pk_fma_f32 v[10:11], v[108:109], v[108:109], v[10:11]
 v_pk_fma_f32 v[10:11], v[110:111], v[110:111], v[10:11]
 v_pk_fma_f32 v[10:11], v[112:113], v[112:113], v[10:11]
 v_pk_fma_f32 v[10:11], v[114:115], v[114:115], v[10:11]
 v_pk_fma_f32 v[10:11], v[116:117], v[116:117], v[10:11]
 v_pk_fma_f32 v[10:11], v[118:119], v[118:119], v[10:11]
 v_pk_fma_f32 v[10:11], v[120:121], v[120:121], v[10:11]
 v_pk_fma_f32 v[10:11], v[122:123], v[122:123], v[10:11]
 v_pk_fma_f32 v[10:11], v[124:125], v[124:125], v[10:11]
 v_pk_fma_f32 v[10:11], v[126:127], v[126:127], v[10:11]
 v_pk_fma_f32 v[10:11], v[128:129], v[128:129], v[10:11]
 v_pk_fma_f32 v[10:11], v[130:131], v[130:131], v[10:11]
 v_pk_fma_f32 v[10:11], v[132:133], v[132:133], v[10:11]
 v_pk_fma_f32 v[10:11], v[134:135], v[134:135], v[10:11]
 v_pk_fma_f32 v[10:11], v[136:137], v[136:137], v[10:11]
 v_pk_fma_f32 v[10:11], v[138:139], v[138:139], v[10:11]
 v_pk_fma_f32 v[10:11], v[140:141], v[140:141], v[10:11]
 v_pk_fma_f32 v[10:11], v[142:143], v[142:143], v[10:11]
 v_pk_fma_f32 v[10:11], v[144:145], v[144:145], v[10:11]
 v_pk_fma_f32 v[10:11], v[146:147], v[146:147], v[10:11]
 v_pk_fma_f32 v[10:11], v[148:149], v[148:149], v[10:11]
 v_pk_fma_f32 v[10:11], v[150:151], v[150:151], v[10:11]
 v_pk_fma_f32 v[10:11], v[152:153], v[152:153], v[10:11]
 v_pk_fma_f32 v[10:11], v[154:155], v[154:155], v[10:11]
 v_pk_fma_f32 v[10:11], v[156:157], v[156:157], v[10:11]
 v_pk_fma_f32 v[10:11], v[158:159], v[158:159], v[10:11]
 v_pk_fma_f32 v[10:11], v[160:161], v[160:161], v[10:11]
 v_pk_fma_f32 v[10:11], v[162:163], v[162:163], v[10:11]
 v_pk_fma_f32 v[10:11], v[164:165], v[164:165], v[10:11]
 v_pk_fma_f32 v[10:11], v[166:167], v[166:167], v[10:11]
 v_pk_fma_f32 v[10:11], v[168:169], v[168:169], v[10:11]
 v_pk_fma_f32 v[10:11], v[170:171], v[170:171], v[10:11]
 v_pk_fma_f32 v[10:11], v[172:173], v[172:173], v[10:11]
 v_pk_fma_f32 v[10:11], v[174:175], v[174:175], v[10:11]
 v_pk_fma_f32 v[10:11], v[176:177], v[176:177], v[10:11]
 v_pk_fma_f32 v[10:11], v[178:179], v[178:179], v[10:11]
 v_pk_fma_f32 v[10:11], v[180:181], v[180:181], v[10:11]
 v_pk_fma_f32 v[10:11], v[182:183], v[182:183], v[10:11]
 v_pk_fma_f32 v[10:11], v[184:185], v[184:185], v[10:11]
 v_pk_fma_f32 v[10:11], v[186:187], v[186:187], v[10:11]
 v_pk_fma_f32 v[10:11], v[188:189], v[188:189], v[10:11]
 v_pk_fma_f32 v[10:11], v[190:191], v[190:191], v[10:11]
 v_add_f32 v10, v10, v11
 v_mov_b32 v11, v10
 s_nop 1
 v_permlane32_swap_b32 v10, v11
 v_add_f32 v10, v10, v11
 v_mov_b32 v11, v10
 s_nop 1
 v_permlane16_swap_b32 v10, v11
 v_add_f32 v10, v10, v11
 v_mul_f32 v10, 0x3b124925, v10
 v_add_f32 v10, 0x3727c5ac, v10
 v_rsq_f32 v10, v10
 s_nop 0
 v_mov_b32 v11, v10
 v_pk_mul_f32 v[80:81], v[80:81], v[10:11]
 v_pk_mul_f32 v[82:83], v[82:83], v[10:11]
 v_pk_mul_f32 v[84:85], v[84:85], v[10:11]
 v_pk_mul_f32 v[86:87], v[86:87], v[10:11]
 v_pk_mul_f32 v[88:89], v[88:89], v[10:11]
 v_pk_mul_f32 v[90:91], v[90:91], v[10:11]
 v_pk_mul_f32 v[92:93], v[92:93], v[10:11]
 v_pk_mul_f32 v[94:95], v[94:95], v[10:11]
 v_pk_mul_f32 v[96:97], v[96:97], v[10:11]
 v_pk_mul_f32 v[98:99], v[98:99], v[10:11]
 v_pk_mul_f32 v[100:101], v[100:101], v[10:11]
 v_pk_mul_f32 v[102:103], v[102:103], v[10:11]
 v_pk_mul_f32 v[104:105], v[104:105], v[10:11]
 v_pk_mul_f32 v[106:107], v[106:107], v[10:11]
 v_pk_mul_f32 v[108:109], v[108:109], v[10:11]
 v_pk_mul_f32 v[110:111], v[110:111], v[10:11]
 v_pk_mul_f32 v[112:113], v[112:113], v[10:11]
 v_pk_mul_f32 v[114:115], v[114:115], v[10:11]
 v_pk_mul_f32 v[116:117], v[116:117], v[10:11]
 v_pk_mul_f32 v[118:119], v[118:119], v[10:11]
 v_pk_mul_f32 v[120:121], v[120:121], v[10:11]
 v_pk_mul_f32 v[122:123], v[122:123], v[10:11]
 v_pk_mul_f32 v[124:125], v[124:125], v[10:11]
 v_pk_mul_f32 v[126:127], v[126:127], v[10:11]
 v_pk_mul_f32 v[128:129], v[128:129], v[10:11]
 v_pk_mul_f32 v[130:131], v[130:131], v[10:11]
 v_pk_mul_f32 v[132:133], v[132:133], v[10:11]
 v_pk_mul_f32 v[134:135], v[134:135], v[10:11]
 v_pk_mul_f32 v[136:137], v[136:137], v[10:11]
 v_pk_mul_f32 v[138:139], v[138:139], v[10:11]
 v_pk_mul_f32 v[140:141], v[140:141], v[10:11]
 v_pk_mul_f32 v[142:143], v[142:143], v[10:11]
 v_pk_mul_f32 v[144:145], v[144:145], v[10:11]
 v_pk_mul_f32 v[146:147], v[146:147], v[10:11]
 v_pk_mul_f32 v[148:149], v[148:149], v[10:11]
 v_pk_mul_f32 v[150:151], v[150:151], v[10:11]
 v_pk_mul_f32 v[152:153], v[152:153], v[10:11]
 v_pk_mul_f32 v[154:155], v[154:155], v[10:11]
 v_pk_mul_f32 v[156:157], v[156:157], v[10:11]
 v_pk_mul_f32 v[158:159], v[158:159], v[10:11]
 v_pk_mul_f32 v[160:161], v[160:161], v[10:11]
 v_pk_mul_f32 v[162:163], v[162:163], v[10:11]
 v_pk_mul_f32 v[164:165], v[164:165], v[10:11]
 v_pk_mul_f32 v[166:167], v[166:167], v[10:11]
 v_pk_mul_f32 v[168:169], v[168:169], v[10:11]
 v_pk_mul_f32 v[170:171], v[170:171], v[10:11]
 v_pk_mul_f32 v[172:173], v[172:173], v[10:11]
 v_pk_mul_f32 v[174:175], v[174:175], v[10:11]
 v_pk_mul_f32 v[176:177], v[176:177], v[10:11]
 v_pk_mul_f32 v[178:179], v[178:179], v[10:11]
 v_pk_mul_f32 v[180:181], v[180:181], v[10:11]
 v_pk_mul_f32 v[182:183], v[182:183], v[10:11]
 v_pk_mul_f32 v[184:185], v[184:185], v[10:11]
 v_pk_mul_f32 v[186:187], v[186:187], v[10:11]
 v_pk_mul_f32 v[188:189], v[188:189], v[10:11]
 v_pk_mul_f32 v[190:191], v[190:191], v[10:11]
 v_cvt_pk_bf16_f32 v24, v80, v81
 v_cvt_pk_bf16_f32 v25, v84, v85
 v_cvt_pk_bf16_f32 v26, v82, v83
 v_cvt_pk_bf16_f32 v27, v86, v87
 s_add_u32 s11, s49, 0
 buffer_store_dwordx4 v[24:27], v1, s[4:7], s11 offen
 v_cvt_pk_bf16_f32 v28, v88, v89
 v_cvt_pk_bf16_f32 v29, v92, v93
 v_cvt_pk_bf16_f32 v30, v90, v91
 v_cvt_pk_bf16_f32 v31, v94, v95
 s_add_u32 s11, s49, 1024
 buffer_store_dwordx4 v[28:31], v1, s[4:7], s11 offen
 v_cvt_pk_bf16_f32 v32, v96, v97
 v_cvt_pk_bf16_f32 v33, v100, v101
 v_cvt_pk_bf16_f32 v34, v98, v99
 v_cvt_pk_bf16_f32 v35, v102, v103
 s_add_u32 s11, s49, 2048
 buffer_store_dwordx4 v[32:35], v1, s[4:7], s11 offen
 v_cvt_pk_bf16_f32 v36, v104, v105
 v_cvt_pk_bf16_f32 v37, v108, v109
 v_cvt_pk_bf16_f32 v38, v106, v107
 v_cvt_pk_bf16_f32 v39, v110, v111
 s_add_u32 s11, s49, 3072
 buffer_store_dwordx4 v[36:39], v1, s[4:7], s11 offen
 v_cvt_pk_bf16_f32 v40, v112, v113
 v_cvt_pk_bf16_f32 v41, v116, v117
 v_cvt_pk_bf16_f32 v42, v114, v115
 v_cvt_pk_bf16_f32 v43, v118, v119
 s_add_u32 s11, s49, 4096
 buffer_store_dwordx4 v[40:43], v1, s[4:7], s11 offen
 v_cvt_pk_bf16_f32 v44, v120, v121
 v_cvt_pk_bf16_f32 v45, v124, v125
 v_cvt_pk_bf16_f32 v46, v122, v123
 v_cvt_pk_bf16_f32 v47, v126, v127
 s_add_u32 s11, s49, 5120
 buffer_store_dwordx4 v[44:47], v1, s[4:7], s11 offen
 v_cvt_pk_bf16_f32 v48, v128, v129
 v_cvt_pk_bf16_f32 v49, v132, v133
 v_cvt_pk_bf16_f32 v50, v130, v131
 v_cvt_pk_bf16_f32 v51, v134, v135
 s_add_u32 s11, s49, 6144
 buffer_store_dwordx4 v[48:51], v1, s[4:7], s11 offen
 v_cvt_pk_bf16_f32 v52, v136, v137
 v_cvt_pk_bf16_f32 v53, v140, v141
 v_cvt_pk_bf16_f32 v54, v138, v139
 v_cvt_pk_bf16_f32 v55, v142, v143
 s_add_u32 s11, s49, 7168
 buffer_store_dwordx4 v[52:55], v1, s[4:7], s11 offen
 v_cvt_pk_bf16_f32 v56, v144, v145
 v_cvt_pk_bf16_f32 v57, v148, v149
 v_cvt_pk_bf16_f32 v58, v146, v147
 v_cvt_pk_bf16_f32 v59, v150, v151
 s_add_u32 s11, s49, 8192
 buffer_store_dwordx4 v[56:59], v1, s[4:7], s11 offen
 v_cvt_pk_bf16_f32 v60, v152, v153
 v_cvt_pk_bf16_f32 v61, v156, v157
 v_cvt_pk_bf16_f32 v62, v154, v155
 v_cvt_pk_bf16_f32 v63, v158, v159
 s_add_u32 s11, s49, 9216
 buffer_store_dwordx4 v[60:63], v1, s[4:7], s11 offen
 v_cvt_pk_bf16_f32 v64, v160, v161
 v_cvt_pk_bf16_f32 v65, v164, v165
 v_cvt_pk_bf16_f32 v66, v162, v163
 v_cvt_pk_bf16_f32 v67, v166, v167
 s_add_u32 s11, s49, 10240
 buffer_store_dwordx4 v[64:67], v1, s[4:7], s11 offen
 v_cvt_pk_bf16_f32 v68, v168, v169
 v_cvt_pk_bf16_f32 v69, v172, v173
 v_cvt_pk_bf16_f32 v70, v170, v171
 v_cvt_pk_bf16_f32 v71, v174, v175
 s_add_u32 s11, s49, 11264
 buffer_store_dwordx4 v[68:71], v1, s[4:7], s11 offen
 v_cvt_pk_bf16_f32 v72, v176, v177
 v_cvt_pk_bf16_f32 v73, v180, v181
 v_cvt_pk_bf16_f32 v74, v178, v179
 v_cvt_pk_bf16_f32 v75, v182, v183
 s_add_u32 s11, s49, 12288
 buffer_store_dwordx4 v[72:75], v1, s[4:7], s11 offen
 v_cvt_pk_bf16_f32 v76, v184, v185
 v_cvt_pk_bf16_f32 v77, v188, v189
 v_cvt_pk_bf16_f32 v78, v186, v187
 v_cvt_pk_bf16_f32 v79, v190, v191
 s_add_u32 s11, s49, 13312
 buffer_store_dwordx4 v[76:79], v1, s[4:7], s11 offen
 v_mov_b32 v16, -1
 v_mov_b32 v17, -1
 v_mov_b32 v18, -1
 v_mov_b32 v19, -1
 v_mov_b32 v20, 0
 v_mov_b32 v21, 0
 v_mov_b32 v22, 0
 v_mov_b32 v23, 0
 s_add_u32 s50, s22, 0
 s_cmp_eq_u32 s22, 0
 s_cbranch_scc1 P_pc_4
 s_mul_i32 s51, s50, 7168
 s_lshl_b32 s11, s8, 10
 s_add_u32 s51, s51, s11
 s_add_u32 s51, s51, 16777216
 buffer_store_dwordx4 v[16:19], v1, s[4:7], s51 offen
 s_cmp_eq_u32 s8, 3
 s_cbranch_scc1 P_pe_6
 s_add_u32 s52, s51, 4096
 buffer_store_dwordx4 v[16:19], v1, s[4:7], s52 offen
P_pe_6:
P_pc_4:
 s_add_u32 s50, s22, 32
 s_mul_i32 s51, s50, 7168
 s_lshl_b32 s11, s8, 10
 s_add_u32 s51, s51, s11
 s_add_u32 s51, s51, 16777216
 buffer_store_dwordx4 v[16:19], v1, s[4:7], s51 offen
 s_cmp_eq_u32 s8, 3
 s_cbranch_scc1 P_pe_9
 s_add_u32 s52, s51, 4096
 buffer_store_dwordx4 v[16:19], v1, s[4:7], s52 offen
P_pe_9:
P_pc_7:
 s_add_u32 s50, s22, 64
 s_cmp_eq_u32 s22, 0
 s_cbranch_scc1 P_pc_10
 s_mul_i32 s51, s50, 7168
 s_lshl_b32 s11, s8, 10
 s_add_u32 s51, s51, s11
 s_add_u32 s51, s51, 16777216
 buffer_store_dwordx4 v[16:19], v1, s[4:7], s51 offen
 s_cmp_eq_u32 s8, 3
 s_cbranch_scc1 P_pe_12
 s_add_u32 s52, s51, 4096
 buffer_store_dwordx4 v[16:19], v1, s[4:7], s52 offen
P_pe_12:
P_pc_10:
 s_add_u32 s50, s22, 96
 s_mul_i32 s51, s50, 7168
 s_lshl_b32 s11, s8, 10
 s_add_u32 s51, s51, s11
 s_add_u32 s51, s51, 16777216
 buffer_store_dwordx4 v[16:19], v1, s[4:7], s51 offen
 s_cmp_eq_u32 s8, 3
 s_cbranch_scc1 P_pe_15
 s_add_u32 s52, s51, 4096
 buffer_store_dwordx4 v[16:19], v1, s[4:7], s52 offen
P_pe_15:
P_pc_13:
 s_add_u32 s50, s22, 128
 s_mul_i32 s51, s50, 7168
 s_lshl_b32 s11, s8, 10
 s_add_u32 s51, s51, s11
 s_add_u32 s51, s51, 16777216
 buffer_store_dwordx4 v[16:19], v1, s[4:7], s51 offen
 s_cmp_eq_u32 s8, 3
 s_cbranch_scc1 P_pe_18
 s_add_u32 s52, s51, 4096
 buffer_store_dwordx4 v[16:19], v1, s[4:7], s52 offen
P_pe_18:
P_pc_16:
 s_add_u32 s50, s22, 160
 s_mul_i32 s51, s50, 7168
 s_lshl_b32 s11, s8, 10
 s_add_u32 s51, s51, s11
 s_add_u32 s51, s51, 16777216
 buffer_store_dwordx4 v[16:19], v1, s[4:7], s51 offen
 s_cmp_eq_u32 s8, 3
 s_cbranch_scc1 P_pe_21
 s_add_u32 s52, s51, 4096
 buffer_store_dwordx4 v[16:19], v1, s[4:7], s52 offen
P_pe_21:
P_pc_19:
 s_add_u32 s50, s22, 192
 s_mul_i32 s51, s50, 7168
 s_lshl_b32 s11, s8, 10
 s_add_u32 s51, s51, s11
 s_add_u32 s51, s51, 16777216
 buffer_store_dwordx4 v[16:19], v1, s[4:7], s51 offen
 s_cmp_eq_u32 s8, 3
 s_cbranch_scc1 P_pe_24
 s_add_u32 s52, s51, 4096
 buffer_store_dwordx4 v[16:19], v1, s[4:7], s52 offen
P_pe_24:
P_pc_22:
 s_add_u32 s50, s22, 224
 s_cmp_ge_u32 s50, 230
 s_cbranch_scc1 P_pc_25
 s_mul_i32 s51, s50, 7168
 s_lshl_b32 s11, s8, 10
 s_add_u32 s51, s51, s11
 s_add_u32 s51, s51, 16777216
 s_cmp_ge_u32 s50, 226
 s_cbranch_scc1 P_pz_26
 buffer_store_dwordx4 v[16:19], v1, s[4:7], s51 offen
 s_cmp_eq_u32 s8, 3
 s_cbranch_scc1 P_pe_27
 s_add_u32 s52, s51, 4096
 buffer_store_dwordx4 v[16:19], v1, s[4:7], s52 offen
P_pe_27:
 s_branch P_pc_25
P_pz_26:
 buffer_store_dwordx4 v[20:23], v1, s[4:7], s51 offen
 s_cmp_eq_u32 s8, 3
 s_cbranch_scc1 P_pe_28
 s_add_u32 s52, s51, 4096
 buffer_store_dwordx4 v[20:23], v1, s[4:7], s52 offen
P_pe_28:
P_pc_25:
 s_cmp_lg_u32 s48, 0
 s_cbranch_scc1 P_m0_29
 v_and_b32 v4, 7, v0
 v_mul_u32_u24 v4, 896, v4
 v_lshrrev_b32 v5, 5, v0
 v_lshl_add_u32 v4, v5, 6, v4
 v_bfe_u32 v5, v0, 3, 1
 v_lshl_add_u32 v4, v5, 5, v4
 v_bfe_u32 v5, v0, 4, 1
 v_lshl_add_u32 v4, v5, 4, v4
 buffer_load_dwordx4 v[200:203], v4, s[28:31], 0 offen offset:0
 buffer_load_dwordx4 v[204:207], v4, s[28:31], 0 offen offset:128
 buffer_load_dwordx4 v[208:211], v4, s[28:31], 0 offen offset:256
 buffer_load_dwordx4 v[212:215], v4, s[28:31], 0 offen offset:384
 buffer_load_dwordx4 v[216:219], v4, s[28:31], 0 offen offset:512
 buffer_load_dwordx4 v[220:223], v4, s[28:31], 0 offen offset:640
 buffer_load_dwordx4 v[224:227], v4, s[28:31], 0 offen offset:768
 s_waitcnt vmcnt(0)
 s_mov_b32 s11, 16777216
 buffer_store_dwordx4 v[200:203], v1, s[4:7], s11 offen
 s_mov_b32 s11, 17235968
 buffer_store_dwordx4 v[200:203], v1, s[4:7], s11 offen
 s_mov_b32 s11, 16778240
 buffer_store_dwordx4 v[204:207], v1, s[4:7], s11 offen
 s_mov_b32 s11, 17236992
 buffer_store_dwordx4 v[204:207], v1, s[4:7], s11 offen
 s_mov_b32 s11, 16779264
 buffer_store_dwordx4 v[208:211], v1, s[4:7], s11 offen
 s_mov_b32 s11, 17238016
 buffer_store_dwordx4 v[208:211], v1, s[4:7], s11 offen
 s_mov_b32 s11, 16780288
 buffer_store_dwordx4 v[212:215], v1, s[4:7], s11 offen
 s_mov_b32 s11, 17239040
 buffer_store_dwordx4 v[212:215], v1, s[4:7], s11 offen
 s_mov_b32 s11, 16781312
 buffer_store_dwordx4 v[216:219], v1, s[4:7], s11 offen
 s_mov_b32 s11, 17240064
 buffer_store_dwordx4 v[216:219], v1, s[4:7], s11 offen
 s_mov_b32 s11, 16782336
 buffer_store_dwordx4 v[220:223], v1, s[4:7], s11 offen
 s_mov_b32 s11, 17241088
 buffer_store_dwordx4 v[220:223], v1, s[4:7], s11 offen
 s_mov_b32 s11, 16783360
 buffer_store_dwordx4 v[224:227], v1, s[4:7], s11 offen
 s_mov_b32 s11, 17242112
 buffer_store_dwordx4 v[224:227], v1, s[4:7], s11 offen
P_m0_29:
 s_branch P_done
P_done:
P_exit:
 s_endpgm
.globl recurrent_scan__memory_aug_recurrent_mem_tr__glu_gated_reglu__prompt_kernel
.p2align 8
.type recurrent_scan__memory_aug_recurrent_mem_tr__glu_gated_reglu__prompt_kernel,@function
recurrent_scan__memory_aug_recurrent_mem_tr__glu_gated_reglu__prompt_kernel:
 s_cmp_ge_u32 s2, 256
 s_cbranch_scc1 K_exit
 s_load_dwordx2 s[4:5], s[0:1], 104
 s_load_dwordx2 s[84:85], s[0:1], 0
 s_load_dwordx2 s[88:89], s[0:1], 88
 s_load_dwordx2 s[80:81], s[0:1], 96
 v_lshrrev_b32 v4, 6, v0
 v_and_b32 v0, 63, v0
 s_getreg_b32 s94, hwreg(HW_REG_XCC_ID)
 v_readfirstlane_b32 s8, v4
 s_and_b32 s94, s94, 0xf
 s_waitcnt lgkmcnt(0)
 s_and_b32 s5, s5, 0xffff
 s_mov_b32 s6, 0x10000000
 s_mov_b32 s7, 0x00020000
 s_and_b32 s81, s81, 0xffff
 s_mov_b32 s82, 256
 s_mov_b32 s83, 0x00020000
 s_and_b32 s85, s85, 0xffff
 s_mov_b32 s86, 1835008
 s_mov_b32 s87, 0x00020000
 s_and_b32 s89, s89, 0xffff
 s_mov_b32 s90, 1835008
 s_mov_b32 s91, 0x00020000
 s_mov_b32 s19, 0
 s_mov_b32 s70, 0
 s_mov_b32 s71, 0
 s_mov_b32 s72, 0
 v_lshlrev_b32 v1, 4, v0
 v_mov_b32 v5, 163808
 v_mov_b32 v6, 0
 ds_write_b32 v5, v6
 s_waitcnt lgkmcnt(0)
 s_barrier
 s_cmp_lg_u32 s8, 0
 s_cbranch_scc1 K_first_1
 s_cmp_eq_u32 s94, 0
 s_cselect_b32 s11, 128, 0
 s_mov_b64 exec, 1
 v_mov_b32 v250, 1
 v_mov_b32 v251, s11
 buffer_atomic_add v250, v251, s[80:83], 0 offen sc0 sc1
 s_mov_b64 exec, -1
K_first_1:
 s_mov_b32 s95, 0
 s_mov_b32 s93, 0
K_ready:
 v_lshlrev_b32 v1, 4, v0
 v_mov_b32 v2, 1
 v_cmp_eq_u32 vcc, 0, v0
 s_cmp_eq_u32 s8, 0
 s_cselect_b64 vcc, vcc, 0
 v_mov_b32 v5, 0x7ffffff0
 v_cndmask_b32 v3, v5, 0, vcc
 s_cmp_lg_u32 s8, 0
 s_cbranch_scc1 K_n0
 s_waitcnt vmcnt(0)
 v_mov_b32 v8, v250
K_n0:
 s_cmp_lg_u32 s8, 0
 s_cbranch_scc1 K_bc_2
 v_lshlrev_b32 v5, 2, v0
 v_add_u32 v5, 163776, v5
 s_mov_b64 exec, 1
 ds_write_b32 v5, v8
 s_waitcnt lgkmcnt(0)
 s_mov_b64 exec, -1
K_bc_2:
 s_barrier
 v_and_b32 v5, 7, v0
 v_lshlrev_b32 v5, 2, v5
 v_add_u32 v5, 163776, v5
 ds_read_b32 v6, v5
 v_mov_b32 v5, 163808
 ds_read_b32 v7, v5
 s_waitcnt lgkmcnt(0)
 v_cmp_ne_u32 vcc, 0, v7
 s_cbranch_vccnz K_done
 s_barrier
 v_readfirstlane_b32 s92, v6
 s_max_u32 s77, s94, 1
 s_sub_u32 s77, s77, 1
 s_min_u32 s77, s77, 6
 s_mov_b32 s76, 0
 s_cmp_lg_u32 s94, 0
 s_cbranch_scc1 K_entry
 s_mov_b32 s9, s92
 s_cmp_ge_u32 s9, 32
 s_cbranch_scc1 K_next0
 s_cmp_eq_u32 s9, 29
 s_cbranch_scc0 K_not30
 s_cmp_lg_u32 s8, 0
 s_cbranch_scc1 K_not30
 s_mov_b64 exec, 1
 v_mov_b32 v5, 132
 v_mov_b32 v8, 1
 v_mov_b32 v9, 0
 buffer_atomic_cmpswap v[8:9], v5, s[80:83], 0 offen sc1
 s_mov_b64 exec, -1
K_not30:
 s_cmp_lt_u32 s9, 30
 s_cbranch_scc1 K_cand
 s_cmp_lg_u32 s93, 0
 s_cbranch_scc1 K_wm_3_ok
 s_mov_b32 s19, 0
K_wm_3:
 s_cmp_lg_u32 s8, 0
 s_cbranch_scc1 K_wmr_4
 v_mov_b32 v5, 132
 buffer_load_dword v8, v5, s[80:83], 0 offen sc1
 s_waitcnt vmcnt(0)
K_wmr_4:
 s_cmp_lg_u32 s8, 0
 s_cbranch_scc1 K_bc_5
 v_lshlrev_b32 v5, 2, v0
 v_add_u32 v5, 163776, v5
 s_mov_b64 exec, 1
 ds_write_b32 v5, v8
 s_waitcnt lgkmcnt(0)
 s_mov_b64 exec, -1
K_bc_5:
 s_barrier
 v_and_b32 v5, 7, v0
 v_lshlrev_b32 v5, 2, v5
 v_add_u32 v5, 163776, v5
 ds_read_b32 v6, v5
 v_mov_b32 v5, 163808
 ds_read_b32 v7, v5
 s_waitcnt lgkmcnt(0)
 v_cmp_ne_u32 vcc, 0, v7
 s_cbranch_vccnz K_done
 s_barrier
 v_readfirstlane_b32 s93, v6
 s_cmp_lg_u32 s93, 0
 s_cbranch_scc1 K_wm_3_ok
 s_add_u32 s19, s19, 1
 s_cmp_lt_u32 s19, 1024
 s_cbranch_scc1 K_wm_3
 s_cmp_lg_u32 s8, 0
 s_cbranch_scc1 K_at_6
 s_mov_b64 exec, 1
 v_mov_b32 v5, 132
 v_mov_b32 v8, 2
 v_mov_b32 v9, 0
 buffer_atomic_cmpswap v[8:9], v5, s[80:83], 0 offen sc0 sc1
 s_waitcnt vmcnt(0)
 s_mov_b64 exec, -1
K_at_6:
 s_cmp_lg_u32 s8, 0
 s_cbranch_scc1 K_bc_7
 v_lshlrev_b32 v5, 2, v0
 v_add_u32 v5, 163776, v5
 s_mov_b64 exec, 1
 ds_write_b32 v5, v8
 s_waitcnt lgkmcnt(0)
 s_mov_b64 exec, -1
K_bc_7:
 s_barrier
 v_and_b32 v5, 7, v0
 v_lshlrev_b32 v5, 2, v5
 v_add_u32 v5, 163776, v5
 ds_read_b32 v6, v5
 v_mov_b32 v5, 163808
 ds_read_b32 v7, v5
 s_waitcnt lgkmcnt(0)
 v_cmp_ne_u32 vcc, 0, v7
 s_cbranch_vccnz K_done
 s_barrier
 v_readfirstlane_b32 s93, v6
 s_cmp_eq_u32 s93, 0
 s_cselect_b32 s93, 2, s93
K_wm_3_ok:
 s_cmp_eq_u32 s93, 2
 s_cbranch_scc1 K_slowq
 s_branch K_exit
K_cand:
 s_cmp_ge_u32 s9, 16
 s_cbranch_scc1 K_fastB
 v_lshlrev_b32 v1, 4, v0
 v_lshlrev_b32 v2, 2, v0
 v_and_b32 v4, 8, v0
 v_cmp_ne_u32 vcc, 0, v4
 v_mov_b32 v5, 0x4444
 v_mov_b32 v4, 0xeeee
 v_cndmask_b32 v5, v5, v4, vcc
 v_and_b32 v16, 15, v0
 v_lshrrev_b32 v17, 4, v0
 v_and_b32 v18, 1, v17
 v_bfe_u32 v19, v16, 2, 1
 v_cmp_eq_u32 vcc, v18, v19
 v_and_b32 v20, 1, v16
 v_lshlrev_b32 v20, 4, v20
 v_mov_b32 v21, 0x3f80
 v_lshlrev_b32 v21, v20, v21
 v_cndmask_b32 v21, 0, v21, vcc
 v_and_b32 v20, 2, v16
 v_cmp_eq_u32 vcc, 0, v20
 s_nop 1
 v_cndmask_b32 v22, 0, v21, vcc
 v_cndmask_b32 v23, v21, 0, vcc
 v_cmp_gt_u32 vcc, 8, v16
 s_nop 1
 v_cndmask_b32 v104, 0, v22, vcc
 v_cndmask_b32 v105, 0, v23, vcc
 v_cndmask_b32 v106, v22, 0, vcc
 v_cndmask_b32 v107, v23, 0, vcc
 s_and_b32 s26, s8, 1
 s_lshr_b32 s11, s8, 1
 s_mul_i32 s12, s11, 7
 s_add_u32 s25, s12, 3
 s_lshl_b32 s13, s26, 2
 s_add_u32 s24, s12, s13
 s_lshl_b32 s11, s8, 13
 s_add_u32 s27, s11, 32768
 v_add_u32 v6, s27, v1
 s_lshl_b32 s11, s26, 2
 v_add_u32 v7, s11, v6
 v_and_b32 v18, 7, v0
 v_lshrrev_b32 v19, 5, v0
 v_lshl_add_u32 v18, v19, 4, v18
 v_lshlrev_b32 v18, 4, v18
 v_and_b32 v19, 1, v17
 v_lshl_add_u32 v18, v19, 3, v18
 s_lshl_b32 s11, s24, 9
 v_add_u32 v8, s11, v18
 v_add_u32 v9, 1024, v8
 s_lshl_b32 s11, s25, 9
 v_add_u32 v10, s11, v18
 s_cmp_eq_u32 s26, 0
 s_cselect_b64 s[36:37], -1, 0
 s_cselect_b64 s[38:39], 0, -1
 v_mov_b32 v56, 0
 v_mov_b32 v57, 0
 v_mov_b32 v58, 0
 v_mov_b32 v59, 0
 v_mul_u32_u24 v18, 160, v17
 v_lshl_add_u32 v18, v16, 4, v18
 s_lshl_b32 s11, s8, 11
 s_add_u32 s11, s11, 8192
 v_add_u32 v11, s11, v18
 s_add_u32 s11, s11, 1920
 v_mov_b32 v22, s11
 v_mov_b32 v20, 0xff800000
 v_mov_b32 v21, 0xff800000
 ds_write_b64 v22, v[20:21]
 s_lshl_b32 s11, s8, 2
 v_add_u32 v18, s11, v17
 v_lshrrev_b32 v19, 1, v16
 v_and_b32 v19, 3, v19
 v_mul_u32_u24 v19, 160, v19
 v_lshl_add_u32 v19, v18, 4, v19
 v_and_b32 v20, 1, v16
 v_lshl_add_u32 v19, v20, 3, v19
 v_add_u32 v13, 8192, v19
 v_lshrrev_b32 v20, 3, v16
 v_add_u32 v20, 1, v20
 v_mul_u32_u24 v20, 640, v20
 v_add_u32 v12, v20, v13
 v_cmp_gt_u32 s[22:23], 4, v16
 v_mov_b32 v20, 10112
 s_nop 0
 v_cndmask_b32 v13, v20, v13, s[22:23]
 v_lshrrev_b32 v19, 3, v16
 v_lshlrev_b32 v19, 7, v19
 v_bfe_u32 v20, v16, 2, 1
 v_lshl_add_u32 v19, v20, 8, v19
 v_lshl_add_u32 v19, v18, 4, v19
 v_and_b32 v20, 3, v16
 v_lshl_add_u32 v14, v20, 2, v19
 v_lshlrev_b32 v19, 4, v18
 v_lshl_add_u32 v15, v16, 2, v19
 v_cmp_gt_u32 s[20:21], 8, v16
 s_and_b32 s11, s9, 3
 s_lshl_b32 s11, s11, 1
 s_add_u32 s11, s11, s8
 s_lshl_b32 s11, s11, 2
 v_cmp_eq_u32 vcc, 0, v0
 v_mov_b32 v18, s11
 v_mov_b32 v19, 0x7ffffff0
 v_cndmask_b32 v3, v19, v18, vcc
 s_lshr_b32 s11, s9, 2
 s_lshl_b32 s12, s11, 7
 s_add_u32 s31, s12, 18361344
 s_lshl_b32 s11, s11, 11
 s_bfe_u32 s12, s9, 0x10001
 s_lshl_b32 s12, s12, 10
 s_add_u32 s11, s11, s12
 s_and_b32 s12, s9, 1
 s_lshl_b32 s12, s12, 9
 s_add_u32 s11, s11, s12
 s_add_u32 s15, s11, 17694720
 s_lshl_b32 s11, s9, 7
 s_add_u32 s16, s11, 18210816
 s_mov_b32 s14, 16777216
 s_mov_b32 s30, 18339840
 s_lshl_b32 s11, s24, 10
 s_add_u32 s17, s11, 0
 s_lshl_b32 s11, s25, 10
 s_add_u32 s18, s11, 0
 s_sub_u32 s18, s18, 3072
 v_lshlrev_b32 v18, 7, v0
 v_add_u32 v108, s15, v18
 v_mov_b32 v109, 8192
 v_cmp_eq_u32 vcc, 4, v0
 v_mov_b32 v18, s16
 v_mov_b32 v19, 2048
 v_cndmask_b32 v108, v108, v18, vcc
 v_cndmask_b32 v109, v109, v19, vcc
 v_cmp_eq_u32 vcc, 5, v0
 v_mov_b32 v18, s31
 v_mov_b32 v19, 512
 v_cndmask_b32 v108, v108, v18, vcc
 v_cndmask_b32 v109, v109, v19, vcc
 s_mul_i32 s11, s9, 14
 v_subrev_u32 v18, 6, v0
 v_add_u32 v18, s11, v18
 v_lshlrev_b32 v18, 7, v18
 v_add_u32 v18, 0, v18
 v_mov_b32 v19, 28672
 v_cmp_le_u32 vcc, 6, v0
 s_nop 1
 v_cndmask_b32 v108, v108, v18, vcc
 v_cndmask_b32 v109, v109, v19, vcc
 s_lshl_b32 s11, s9, 2
 v_subrev_u32 v18, 20, v0
 v_add_u32 v18, s11, v18
 v_lshlrev_b32 v18, 7, v18
 v_add_u32 v18, 16784384, v18
 v_mov_b32 v19, 7168
 v_cmp_le_u32 vcc, 20, v0
 s_nop 1
 v_cndmask_b32 v108, v108, v18, vcc
 v_cndmask_b32 v109, v109, v19, vcc
 s_lshl_b32 s11, s9, 7
 s_add_u32 s11, s11, 18340096
 v_mov_b32 v18, s11
 v_mov_b32 v19, 256
 v_cmp_eq_u32 vcc, 24, v0
 s_nop 1
 v_cndmask_b32 v108, v108, v18, vcc
 v_cndmask_b32 v109, v109, v19, vcc
 s_mov_b32 s11, 0xfffff
 s_cmp_lt_u32 s9, 14
 s_cselect_b32 s12, 0xf00000, 0
 s_or_b32 s11, s11, s12
 s_cmp_lt_u32 s9, 2
 s_cselect_b32 s12, 0x1000000, 0
 s_or_b32 s11, s11, s12
 s_cmp_eq_u32 s8, 2
 s_cselect_b32 vcc_lo, s11, 0
 s_mov_b32 vcc_hi, 0
 v_mov_b32 v18, 0x7ffffff0
 v_cndmask_b32 v108, v18, v108, vcc
 v_cndmask_b32 v109, 0, v109, vcc
 buffer_load_dword v110, v108, s[4:7], 0 offen sc1
 v_add_u32 v108, v108, v109
 buffer_load_dword v110, v108, s[4:7], 0 offen sc1
 v_add_u32 v108, v108, v109
 s_mul_i32 s11, s9, 28672
 s_mul_i32 s12, s8, 7168
 s_add_u32 s11, s11, s12
 s_add_u32 s11, s11, 35520512
 v_lshlrev_b32 v18, 7, v0
 v_add_u32 v18, s11, v18
 v_cmp_gt_u32 vcc, 56, v0
 v_mov_b32 v19, 0x7ffffff0
 s_nop 0
 v_cndmask_b32 v114, v19, v18, vcc
 s_mov_b32 s28, 0
 s_min_u32 s11, s9, 6
 s_lshl_b32 s11, s11, 10
 v_add_u32 v115, s11, v1
 s_cmp_lt_u32 s9, 7
 s_cselect_b32 s12, 1, 0
 s_cmp_eq_u32 s8, 0
 s_cselect_b32 s12, s12, 0
 s_cmp_eq_u32 s12, 1
 s_cselect_b64 vcc, -1, 0
 v_mov_b32 v18, 0x7ffffff0
 v_cndmask_b32 v111, v18, v115, vcc
 s_mul_i32 s11, s9, 28
 s_lshl_b32 s12, s24, 1
 s_add_u32 s12, s12, s11
 s_mul_i32 s12, s12, 14336
 s_add_u32 s12, s12, 2097152
 s_lshl_b32 s13, s25, 1
 s_add_u32 s13, s13, s26
 s_add_u32 s13, s13, s11
 s_mul_i32 s13, s13, 14336
 s_add_u32 s13, s13, 2097152
 s_add_u32 s11, s12, 0
 buffer_load_dwordx4 v[120:123], v1, s[4:7], s11 offen nt
 buffer_load_dwordx4 v[124:127], v1, s[4:7], s11 offen offset:1024 nt
 s_add_u32 s11, s12, 2048
 buffer_load_dwordx4 v[128:131], v1, s[4:7], s11 offen nt
 buffer_load_dwordx4 v[132:135], v1, s[4:7], s11 offen offset:1024 nt
 s_add_u32 s11, s12, 4096
 buffer_load_dwordx4 v[136:139], v1, s[4:7], s11 offen nt
 buffer_load_dwordx4 v[140:143], v1, s[4:7], s11 offen offset:1024 nt
 s_add_u32 s11, s12, 6144
 buffer_load_dwordx4 v[144:147], v1, s[4:7], s11 offen nt
 buffer_load_dwordx4 v[148:151], v1, s[4:7], s11 offen offset:1024 nt
 s_add_u32 s11, s12, 8192
 buffer_load_dwordx4 v[152:155], v1, s[4:7], s11 offen nt
 buffer_load_dwordx4 v[156:159], v1, s[4:7], s11 offen offset:1024 nt
 s_add_u32 s11, s12, 10240
 buffer_load_dwordx4 v[160:163], v1, s[4:7], s11 offen nt
 buffer_load_dwordx4 v[164:167], v1, s[4:7], s11 offen offset:1024 nt
 s_add_u32 s11, s12, 12288
 buffer_load_dwordx4 v[168:171], v1, s[4:7], s11 offen nt
 buffer_load_dwordx4 v[172:175], v1, s[4:7], s11 offen offset:1024 nt
 s_add_u32 s11, s12, 14336
 buffer_load_dwordx4 v[176:179], v1, s[4:7], s11 offen nt
 buffer_load_dwordx4 v[180:183], v1, s[4:7], s11 offen offset:1024 nt
 s_add_u32 s11, s12, 16384
 buffer_load_dwordx4 v[184:187], v1, s[4:7], s11 offen nt
 buffer_load_dwordx4 v[188:191], v1, s[4:7], s11 offen offset:1024 nt
 s_add_u32 s11, s12, 18432
 buffer_load_dwordx4 v[192:195], v1, s[4:7], s11 offen nt
 buffer_load_dwordx4 v[196:199], v1, s[4:7], s11 offen offset:1024 nt
 s_add_u32 s11, s12, 20480
 buffer_load_dwordx4 v[200:203], v1, s[4:7], s11 offen nt
 buffer_load_dwordx4 v[204:207], v1, s[4:7], s11 offen offset:1024 nt
 s_add_u32 s11, s12, 22528
 buffer_load_dwordx4 v[208:211], v1, s[4:7], s11 offen nt
 buffer_load_dwordx4 v[212:215], v1, s[4:7], s11 offen offset:1024 nt
 s_add_u32 s11, s12, 24576
 buffer_load_dwordx4 v[216:219], v1, s[4:7], s11 offen nt
 buffer_load_dwordx4 v[220:223], v1, s[4:7], s11 offen offset:1024 nt
 s_add_u32 s11, s12, 26624
 buffer_load_dwordx4 v[224:227], v1, s[4:7], s11 offen nt
 buffer_load_dwordx4 v[228:231], v1, s[4:7], s11 offen offset:1024 nt
 s_add_u32 s11, s12, 28672
 buffer_load_dwordx4 v[232:235], v1, s[4:7], s11 offen nt
 buffer_load_dwordx4 v[236:239], v1, s[4:7], s11 offen offset:1024 nt
 s_add_u32 s11, s12, 30720
 buffer_load_dwordx4 v[240:243], v1, s[4:7], s11 offen nt
 buffer_load_dwordx4 v[244:247], v1, s[4:7], s11 offen offset:1024 nt
 s_add_u32 s11, s12, 32768
 buffer_load_dwordx4 v[248:251], v1, s[4:7], s11 offen nt
 buffer_load_dwordx4 v[252:255], v1, s[4:7], s11 offen offset:1024 nt
 s_add_u32 s11, s12, 34816
 buffer_load_dwordx4 a[0:3], v1, s[4:7], s11 offen nt
 buffer_load_dwordx4 a[4:7], v1, s[4:7], s11 offen offset:1024 nt
 s_add_u32 s11, s12, 36864
 buffer_load_dwordx4 a[8:11], v1, s[4:7], s11 offen nt
 buffer_load_dwordx4 a[12:15], v1, s[4:7], s11 offen offset:1024 nt
 s_add_u32 s11, s12, 38912
 buffer_load_dwordx4 a[16:19], v1, s[4:7], s11 offen nt
 buffer_load_dwordx4 a[20:23], v1, s[4:7], s11 offen offset:1024 nt
 s_add_u32 s11, s12, 40960
 buffer_load_dwordx4 a[24:27], v1, s[4:7], s11 offen nt
 buffer_load_dwordx4 a[28:31], v1, s[4:7], s11 offen offset:1024 nt
 s_add_u32 s11, s12, 43008
 buffer_load_dwordx4 a[32:35], v1, s[4:7], s11 offen nt
 buffer_load_dwordx4 a[36:39], v1, s[4:7], s11 offen offset:1024 nt
 s_add_u32 s11, s12, 45056
 buffer_load_dwordx4 a[40:43], v1, s[4:7], s11 offen nt
 buffer_load_dwordx4 a[44:47], v1, s[4:7], s11 offen offset:1024 nt
 s_add_u32 s11, s12, 47104
 buffer_load_dwordx4 a[48:51], v1, s[4:7], s11 offen nt
 buffer_load_dwordx4 a[52:55], v1, s[4:7], s11 offen offset:1024 nt
 s_add_u32 s11, s12, 49152
 buffer_load_dwordx4 a[56:59], v1, s[4:7], s11 offen nt
 buffer_load_dwordx4 a[60:63], v1, s[4:7], s11 offen offset:1024 nt
 s_add_u32 s11, s12, 51200
 buffer_load_dwordx4 a[64:67], v1, s[4:7], s11 offen nt
 buffer_load_dwordx4 a[68:71], v1, s[4:7], s11 offen offset:1024 nt
 s_add_u32 s11, s12, 53248
 buffer_load_dwordx4 a[72:75], v1, s[4:7], s11 offen nt
 buffer_load_dwordx4 a[76:79], v1, s[4:7], s11 offen offset:1024 nt
 s_add_u32 s11, s12, 55296
 buffer_load_dwordx4 a[80:83], v1, s[4:7], s11 offen nt
 buffer_load_dwordx4 a[84:87], v1, s[4:7], s11 offen offset:1024 nt
 s_add_u32 s11, s12, 57344
 buffer_load_dwordx4 a[88:91], v1, s[4:7], s11 offen nt
 buffer_load_dwordx4 a[92:95], v1, s[4:7], s11 offen offset:1024 nt
 s_add_u32 s11, s12, 59392
 buffer_load_dwordx4 a[96:99], v1, s[4:7], s11 offen nt
 buffer_load_dwordx4 a[100:103], v1, s[4:7], s11 offen offset:1024 nt
 s_add_u32 s11, s12, 61440
 buffer_load_dwordx4 a[104:107], v1, s[4:7], s11 offen nt
 buffer_load_dwordx4 a[108:111], v1, s[4:7], s11 offen offset:1024 nt
 s_add_u32 s11, s12, 63488
 buffer_load_dwordx4 a[112:115], v1, s[4:7], s11 offen nt
 buffer_load_dwordx4 a[116:119], v1, s[4:7], s11 offen offset:1024 nt
 s_add_u32 s11, s12, 65536
 buffer_load_dwordx4 a[120:123], v1, s[4:7], s11 offen nt
 buffer_load_dwordx4 a[124:127], v1, s[4:7], s11 offen offset:1024 nt
 s_add_u32 s11, s12, 67584
 buffer_load_dwordx4 a[128:131], v1, s[4:7], s11 offen nt
 buffer_load_dwordx4 a[132:135], v1, s[4:7], s11 offen offset:1024 nt
 s_add_u32 s11, s12, 69632
 buffer_load_dwordx4 a[136:139], v1, s[4:7], s11 offen nt
 buffer_load_dwordx4 a[140:143], v1, s[4:7], s11 offen offset:1024 nt
 s_add_u32 s11, s12, 71680
 buffer_load_dwordx4 a[144:147], v1, s[4:7], s11 offen nt
 buffer_load_dwordx4 a[148:151], v1, s[4:7], s11 offen offset:1024 nt
 s_add_u32 s11, s12, 73728
 buffer_load_dwordx4 a[152:155], v1, s[4:7], s11 offen nt
 buffer_load_dwordx4 a[156:159], v1, s[4:7], s11 offen offset:1024 nt
 s_add_u32 s11, s12, 75776
 buffer_load_dwordx4 a[160:163], v1, s[4:7], s11 offen nt
 buffer_load_dwordx4 a[164:167], v1, s[4:7], s11 offen offset:1024 nt
 s_add_u32 s11, s12, 77824
 buffer_load_dwordx4 a[168:171], v1, s[4:7], s11 offen nt
 buffer_load_dwordx4 a[172:175], v1, s[4:7], s11 offen offset:1024 nt
 s_add_u32 s11, s12, 79872
 buffer_load_dwordx4 a[176:179], v1, s[4:7], s11 offen nt
 buffer_load_dwordx4 a[180:183], v1, s[4:7], s11 offen offset:1024 nt
 s_add_u32 s11, s12, 81920
 buffer_load_dwordx4 a[184:187], v1, s[4:7], s11 offen nt
 buffer_load_dwordx4 a[188:191], v1, s[4:7], s11 offen offset:1024 nt
 s_add_u32 s11, s12, 83968
 buffer_load_dwordx4 a[192:195], v1, s[4:7], s11 offen nt
 buffer_load_dwordx4 a[196:199], v1, s[4:7], s11 offen offset:1024 nt
 s_add_u32 s11, s13, 0
 buffer_load_dwordx4 a[200:203], v1, s[4:7], s11 offen nt
 buffer_load_dwordx4 a[204:207], v1, s[4:7], s11 offen offset:1024 nt
 s_add_u32 s11, s13, 2048
 buffer_load_dwordx4 a[208:211], v1, s[4:7], s11 offen nt
 buffer_load_dwordx4 a[212:215], v1, s[4:7], s11 offen offset:1024 nt
 s_add_u32 s11, s13, 4096
 buffer_load_dwordx4 a[216:219], v1, s[4:7], s11 offen nt
 buffer_load_dwordx4 a[220:223], v1, s[4:7], s11 offen offset:1024 nt
 s_add_u32 s11, s13, 6144
 buffer_load_dwordx4 a[224:227], v1, s[4:7], s11 offen nt
 buffer_load_dwordx4 a[228:231], v1, s[4:7], s11 offen offset:1024 nt
 s_add_u32 s11, s13, 8192
 buffer_load_dwordx4 a[232:235], v1, s[4:7], s11 offen nt
 buffer_load_dwordx4 a[236:239], v1, s[4:7], s11 offen offset:1024 nt
 s_add_u32 s11, s13, 10240
 buffer_load_dwordx4 a[240:243], v1, s[4:7], s11 offen nt
 buffer_load_dwordx4 a[244:247], v1, s[4:7], s11 offen offset:1024 nt
 s_add_u32 s11, s13, 12288
 buffer_load_dwordx4 a[248:251], v1, s[4:7], s11 offen nt
 buffer_load_dwordx4 a[252:255], v1, s[4:7], s11 offen offset:1024 nt
 s_add_u32 s11, s27, 0
 s_mov_b32 m0, s11
 s_add_u32 s12, s17, 0
 s_add_u32 s13, s18, 0
 buffer_load_dwordx4 v1, s[4:7], s12 offen offset:0 lds
 buffer_load_dwordx4 v1, s[4:7], s12 offen offset:1024 lds
 buffer_load_dwordx4 v1, s[4:7], s12 offen offset:2048 lds
 buffer_load_dwordx4 v1, s[4:7], s13 offen offset:3072 lds
 s_add_u32 s11, s27, 4096
 s_mov_b32 m0, s11
 s_add_u32 s12, s17, 14336
 s_add_u32 s13, s18, 14336
 buffer_load_dwordx4 v1, s[4:7], s12 offen offset:0 lds
 buffer_load_dwordx4 v1, s[4:7], s12 offen offset:1024 lds
 buffer_load_dwordx4 v1, s[4:7], s12 offen offset:2048 lds
 buffer_load_dwordx4 v1, s[4:7], s13 offen offset:3072 lds
 s_add_u32 s17, s17, 28672
 s_add_u32 s18, s18, 28672
 s_mov_b32 s10, 0
 v_mov_b64 v[44:45], 0
 v_mov_b64 v[46:47], 0
 v_mov_b64 v[48:49], 0
 v_mov_b64 v[50:51], 0
 v_mov_b64 v[52:53], 0
 v_mov_b64 v[54:55], 0
 s_waitcnt vmcnt(0) lgkmcnt(0)
 s_mov_b32 s19, 0
K_mh_8:
 v_mov_b32 v16, 132
 buffer_load_dword v17, v16, s[80:83], 0 offen sc1
 s_waitcnt vmcnt(0)
 v_readfirstlane_b32 s93, v17
 s_cmp_lg_u32 s93, 0
 s_cbranch_scc1 K_mh_8_k
 s_add_u32 s19, s19, 1
 s_cmp_lt_u32 s19, 1024
 s_cbranch_scc1 K_mh_8
 s_mov_b64 exec, 1
 v_mov_b32 v18, 2
 v_mov_b32 v19, 0
 buffer_atomic_cmpswap v[18:19], v16, s[80:83], 0 offen sc1
 s_waitcnt vmcnt(0)
 s_mov_b64 exec, -1
 s_mov_b32 s19, 0
 s_branch K_mh_8
K_mh_8_k:
 s_mov_b32 s19, 0
 s_cmp_eq_u32 s93, 2
 s_cbranch_scc1 K_slowq
L_A_loop_9:
 s_cmp_lg_u32 s8, 3
 s_cbranch_scc1 L_A_nofetch_11
 s_cmp_eq_u32 s10, 0
 s_cbranch_scc1 L_A_fetch_10
 s_mov_b32 exec_lo, 0xffffffff
 s_mov_b32 exec_hi, 0xffffff
 s_mov_b32 s19, 0
 buffer_load_dword v64, v2, s[4:7], s30 offen sc1
 s_nop 15
 s_nop 3
 buffer_load_dword v65, v2, s[4:7], s30 offen sc1
 s_nop 15
 s_nop 3
 buffer_load_dword v66, v2, s[4:7], s30 offen sc1
L_pwA_13:
 s_waitcnt vmcnt(2)
 v_cmp_eq_u32 vcc, -1, v64
 s_cbranch_vccz L_pwA_13_ok
 buffer_load_dword v64, v2, s[4:7], s30 offen sc1
 s_waitcnt vmcnt(2)
 v_cmp_eq_u32 vcc, -1, v65
 s_cbranch_vccz L_pwA_13_ok
 buffer_load_dword v65, v2, s[4:7], s30 offen sc1
 s_waitcnt vmcnt(2)
 v_cmp_eq_u32 vcc, -1, v66
 s_cbranch_vccz L_pwA_13_ok
 buffer_load_dword v66, v2, s[4:7], s30 offen sc1
 s_add_u32 s19, s19, 1
 s_cmp_le_u32 s19, 8192
 s_cbranch_scc1 L_pwA_13
 s_mov_b32 s72, 1
 s_branch K_fail
L_pwA_13_ok:
 s_mov_b64 exec, -1
L_A_fetch_10:
 s_cmp_lg_u32 s8, 3
 s_cbranch_scc1 L_A_nofetch_11
 s_mov_b32 m0, 0
 s_add_u32 s11, s14, 4096
 buffer_load_dwordx4 v1, s[4:7], s14 offen offset:0 sc1 lds
 buffer_load_dwordx4 v1, s[4:7], s14 offen offset:1024 sc1 lds
 buffer_load_dwordx4 v1, s[4:7], s14 offen offset:2048 sc1 lds
 buffer_load_dwordx4 v1, s[4:7], s14 offen offset:3072 sc1 lds
 s_mov_b32 m0, 4096
 s_nop 0
 buffer_load_dwordx4 v1, s[4:7], s11 offen offset:0 sc1 lds
 buffer_load_dwordx4 v1, s[4:7], s11 offen offset:1024 sc1 lds
 buffer_load_dwordx4 v1, s[4:7], s11 offen offset:2048 sc1 lds
L_A_nofetch_11:
 s_waitcnt vmcnt(0)
 s_barrier
 ds_read_b128 v[16:19], v1 offset:0
 ds_read_b128 v[20:23], v1 offset:1024
 ds_read_b128 v[24:27], v1 offset:2048
 s_waitcnt lgkmcnt(2)
 v_smfmac_f32_16x16x64_bf16 v[44:47], v[16:19], a[200:207], v5
 ds_read_b128 v[28:31], v1 offset:3072
 v_smfmac_f32_16x16x64_bf16 v[48:51], v[16:19], v[120:127], v5
 ds_read_b128 v[32:35], v1 offset:4096
 s_waitcnt lgkmcnt(3)
 v_smfmac_f32_16x16x64_bf16 v[44:47], v[20:23], a[208:215], v5
 ds_read_b128 v[36:39], v1 offset:5120
 v_smfmac_f32_16x16x64_bf16 v[48:51], v[20:23], v[128:135], v5
 ds_read_b128 v[40:43], v1 offset:6144
 s_waitcnt lgkmcnt(4)
 v_smfmac_f32_16x16x64_bf16 v[44:47], v[24:27], a[216:223], v5
 ds_read2_b32 v[68:69], v10 offset0:0 offset1:32
 v_smfmac_f32_16x16x64_bf16 v[48:51], v[24:27], v[136:143], v5
 ds_read2_b32 v[70:71], v10 offset0:1 offset1:33
 s_waitcnt lgkmcnt(5)
 v_smfmac_f32_16x16x64_bf16 v[44:47], v[28:31], a[224:231], v5
 ds_read_b128 v[72:75], v6 offset:3072
 v_smfmac_f32_16x16x64_bf16 v[48:51], v[28:31], v[144:151], v5
 ds_read_b128 v[76:79], v6 offset:7168
 s_waitcnt lgkmcnt(6)
 v_smfmac_f32_16x16x64_bf16 v[44:47], v[32:35], a[232:239], v5
 ds_read2_b32 v[80:81], v8 offset0:0 offset1:32
 v_smfmac_f32_16x16x64_bf16 v[48:51], v[32:35], v[152:159], v5
 ds_read2_b32 v[82:83], v8 offset0:1 offset1:33
 s_waitcnt lgkmcnt(7)
 v_smfmac_f32_16x16x64_bf16 v[44:47], v[36:39], a[240:247], v5
 ds_read_b128 v[84:87], v6 offset:0
 v_smfmac_f32_16x16x64_bf16 v[48:51], v[36:39], v[160:167], v5
 ds_read_b128 v[88:91], v6 offset:4096
 s_waitcnt lgkmcnt(8)
 v_smfmac_f32_16x16x64_bf16 v[44:47], v[40:43], a[248:255], v5
 ds_read_b128 v[116:119], v115 offset:0
 v_smfmac_f32_16x16x64_bf16 v[48:51], v[40:43], v[168:175], v5
 buffer_load_dword v110, v108, s[4:7], 0 offen sc1
 v_smfmac_f32_16x16x64_bf16 v[52:55], v[16:19], v[176:183], v5
 v_cvt_pk_bf16_f32 v56, v44, v45
 v_smfmac_f32_16x16x64_bf16 v[52:55], v[20:23], v[184:191], v5
 v_cvt_pk_bf16_f32 v57, v46, v47
 v_smfmac_f32_16x16x64_bf16 v[52:55], v[24:27], v[192:199], v5
 v_mov_b64 v[44:45], 0
 v_mfma_f32_16x16x32_bf16 v[60:63], v[56:59], v[104:107], 0
 v_mov_b64 v[46:47], 0
 v_cvt_pk_bf16_f32 v56, v48, v49
 v_smfmac_f32_16x16x64_bf16 v[52:55], v[28:31], v[200:207], v5
 v_cvt_pk_bf16_f32 v57, v50, v51
 v_smfmac_f32_16x16x64_bf16 v[52:55], v[32:35], v[208:215], v5
 s_waitcnt lgkmcnt(0)
 s_add_u32 s29, s14, 458752
 buffer_store_dwordx4 v[116:119], v111, s[4:7], s29 offen sc1
 v_cvt_pk_bf16_f32 v112, v60, v61
 v_smfmac_f32_16x16x64_bf16 v[52:55], v[36:39], v[216:223], v5
 v_cvt_pk_bf16_f32 v113, v62, v63
 v_smfmac_f32_16x16x64_bf16 v[52:55], v[40:43], v[224:231], v5
 v_cndmask_b32 v64, 0, v112, s[36:37]
 v_smfmac_f32_16x16x64_bf16 v[44:47], v[16:19], v[232:239], v5
 v_cndmask_b32 v65, 0, v112, s[38:39]
 v_smfmac_f32_16x16x64_bf16 v[44:47], v[20:23], v[240:247], v5
 v_cndmask_b32 v66, 0, v113, s[36:37]
 v_smfmac_f32_16x16x64_bf16 v[44:47], v[24:27], v[248:255], v5
 v_cndmask_b32 v67, 0, v113, s[38:39]
 v_smfmac_f32_16x16x64_bf16 v[44:47], v[28:31], a[0:7], v5
 v_mov_b64 v[48:49], 0
 v_mfma_f32_16x16x32_bf16 v[92:95], v[68:71], v[64:67], 0
 v_mov_b64 v[50:51], 0
 v_cvt_pk_bf16_f32 v58, v52, v53
 v_mfma_f32_16x16x32_bf16 v[96:99], v[72:75], v[64:67], 0
 v_cvt_pk_bf16_f32 v59, v54, v55
 v_mov_b64 v[52:53], 0
 v_mfma_f32_16x16x32_bf16 v[100:103], v[76:79], v[64:67], 0
 ds_read2_b32 v[68:69], v8 offset0:128 offset1:160
 v_mov_b64 v[54:55], 0
 v_max3_u32 v4, v16, v17, v18
 v_mfma_f32_16x16x32_bf16 v[60:63], v[56:59], v[104:107], 0
 ds_read2_b32 v[70:71], v8 offset0:129 offset1:161
 v_max_u32 v4, v4, v19
 v_max3_u32 v4, v4, v20, v21
 v_smfmac_f32_16x16x64_bf16 v[44:47], v[32:35], a[8:15], v5
 ds_read_b128 v[72:75], v6 offset:1024
 v_max3_u32 v4, v4, v22, v23
 v_smfmac_f32_16x16x64_bf16 v[44:47], v[36:39], a[16:23], v5
 ds_read_b128 v[76:79], v6 offset:5120
 v_cvt_pk_bf16_f32 v64, v60, v61
 v_smfmac_f32_16x16x64_bf16 v[44:47], v[40:43], a[24:31], v5
 v_cvt_pk_bf16_f32 v66, v62, v63
 v_smfmac_f32_16x16x64_bf16 v[48:51], v[16:19], a[32:39], v5
 v_mov_b32_dpp v65, v64 row_ror:8 row_mask:0xf bank_mask:0xf
 v_smfmac_f32_16x16x64_bf16 v[48:51], v[20:23], a[40:47], v5
 v_mov_b32_dpp v67, v66 row_ror:8 row_mask:0xf bank_mask:0xf
 v_smfmac_f32_16x16x64_bf16 v[48:51], v[24:27], a[48:55], v5
 v_cvt_pk_bf16_f32 v56, v44, v45
 v_mfma_f32_16x16x32_bf16 v[92:95], v[80:83], v[64:67], v[92:95]
 v_cvt_pk_bf16_f32 v57, v46, v47
 v_mov_b64 v[44:45], 0
 v_mfma_f32_16x16x32_bf16 v[96:99], v[84:87], v[64:67], v[96:99]
 v_mov_b64 v[46:47], 0
 v_max3_u32 v4, v4, v24, v25
 v_mfma_f32_16x16x32_bf16 v[100:103], v[88:91], v[64:67], v[100:103]
 ds_read2_b32 v[80:81], v9 offset0:0 offset1:32
 v_max3_u32 v4, v4, v26, v27
 v_max3_u32 v4, v4, v28, v29
 v_smfmac_f32_16x16x64_bf16 v[48:51], v[28:31], a[56:63], v5
 ds_read2_b32 v[82:83], v9 offset0:1 offset1:33
 v_max3_u32 v4, v4, v30, v31
 v_smfmac_f32_16x16x64_bf16 v[48:51], v[32:35], a[64:71], v5
 ds_read_b128 v[84:87], v6 offset:2048
 v_max3_u32 v4, v4, v32, v33
 v_smfmac_f32_16x16x64_bf16 v[48:51], v[36:39], a[72:79], v5
 ds_read_b128 v[88:91], v6 offset:6144
 v_max3_u32 v4, v4, v34, v35
 v_smfmac_f32_16x16x64_bf16 v[48:51], v[40:43], a[80:87], v5
 v_max3_u32 v4, v4, v36, v37
 v_smfmac_f32_16x16x64_bf16 v[52:55], v[16:19], a[88:95], v5
 v_max3_u32 v4, v4, v38, v39
 v_smfmac_f32_16x16x64_bf16 v[52:55], v[20:23], a[96:103], v5
 v_cvt_pk_bf16_f32 v58, v48, v49
 v_smfmac_f32_16x16x64_bf16 v[52:55], v[24:27], a[104:111], v5
 v_cvt_pk_bf16_f32 v59, v50, v51
 v_smfmac_f32_16x16x64_bf16 v[52:55], v[28:31], a[112:119], v5
 v_max3_u32 v4, v4, v40, v41
 v_mfma_f32_16x16x32_bf16 v[60:63], v[56:59], v[104:107], 0
 v_max3_u32 v4, v4, v42, v43
 v_cmp_eq_u32 vcc, -1, v4
 v_smfmac_f32_16x16x64_bf16 v[52:55], v[32:35], a[120:127], v5
 v_smfmac_f32_16x16x64_bf16 v[52:55], v[36:39], a[128:135], v5
 v_cvt_pk_bf16_f32 v64, v60, v61
 v_smfmac_f32_16x16x64_bf16 v[52:55], v[40:43], a[136:143], v5
 v_cvt_pk_bf16_f32 v66, v62, v63
 v_smfmac_f32_16x16x64_bf16 v[44:47], v[16:19], a[144:151], v5
 v_mov_b32_dpp v65, v64 row_ror:8 row_mask:0xf bank_mask:0xf
 v_smfmac_f32_16x16x64_bf16 v[44:47], v[20:23], a[152:159], v5
 v_mov_b32_dpp v67, v66 row_ror:8 row_mask:0xf bank_mask:0xf
 v_smfmac_f32_16x16x64_bf16 v[44:47], v[24:27], a[160:167], v5
 v_cvt_pk_bf16_f32 v56, v52, v53
 s_waitcnt lgkmcnt(4)
 v_mfma_f32_16x16x32_bf16 v[92:95], v[68:71], v[64:67], v[92:95]
 v_cvt_pk_bf16_f32 v57, v54, v55
 v_mfma_f32_16x16x32_bf16 v[96:99], v[72:75], v[64:67], v[96:99]
 v_mfma_f32_16x16x32_bf16 v[100:103], v[76:79], v[64:67], v[100:103]
 s_cbranch_vccnz L_A_retry_12
 v_smfmac_f32_16x16x64_bf16 v[44:47], v[28:31], a[168:175], v5
 v_add_u32 v108, v108, v109
 v_smfmac_f32_16x16x64_bf16 v[44:47], v[32:35], a[176:183], v5
 v_smfmac_f32_16x16x64_bf16 v[44:47], v[36:39], a[184:191], v5
 v_smfmac_f32_16x16x64_bf16 v[44:47], v[40:43], a[192:199], v5
 s_nop 7
 v_cvt_pk_bf16_f32 v58, v44, v45
 v_cvt_pk_bf16_f32 v59, v46, v47
 s_nop 1
 v_mfma_f32_16x16x32_bf16 v[60:63], v[56:59], v[104:107], 0
 s_nop 7
 v_cvt_pk_bf16_f32 v64, v60, v61
 v_cvt_pk_bf16_f32 v66, v62, v63
 s_nop 0
 v_mov_b32_dpp v65, v64 row_ror:8 row_mask:0xf bank_mask:0xf
 v_mov_b32_dpp v67, v66 row_ror:8 row_mask:0xf bank_mask:0xf
 s_nop 1
 s_waitcnt lgkmcnt(0)
 v_mfma_f32_16x16x32_bf16 v[92:95], v[80:83], v[64:67], v[92:95]
 v_mfma_f32_16x16x32_bf16 v[96:99], v[84:87], v[64:67], v[96:99]
 v_mfma_f32_16x16x32_bf16 v[100:103], v[88:91], v[64:67], v[100:103]
 s_nop 7
 s_mov_b64 exec, s[20:21]
 ds_write_b128 v11, v[92:95] offset:0
 ds_write_b128 v11, v[96:99] offset:640
 ds_write_b128 v11, v[100:103] offset:1280
 s_mov_b64 exec, -1
 v_mov_b64 v[44:45], 0
 v_mov_b64 v[46:47], 0
 v_mov_b64 v[48:49], 0
 v_mov_b64 v[50:51], 0
 v_mov_b64 v[52:53], 0
 v_mov_b64 v[54:55], 0
 s_waitcnt lgkmcnt(0)
 s_barrier
 s_cmp_ge_u32 s8, 2
 s_cbranch_scc1 L_A_nosm_14
 ds_read_b64 v[16:17], v12 offset:0
 ds_read_b64 v[24:25], v13 offset:0
 ds_read_b64 v[18:19], v12 offset:2048
 ds_read_b64 v[26:27], v13 offset:2048
 ds_read_b64 v[20:21], v12 offset:4096
 ds_read_b64 v[28:29], v13 offset:4096
 ds_read_b64 v[22:23], v12 offset:6144
 ds_read_b64 v[30:31], v13 offset:6144
 s_waitcnt lgkmcnt(4)
 v_pk_add_f32 v[16:17], v[16:17], v[18:19]
 v_pk_add_f32 v[24:25], v[24:25], v[26:27]
 s_waitcnt lgkmcnt(0)
 v_pk_add_f32 v[20:21], v[20:21], v[22:23]
 v_pk_add_f32 v[28:29], v[28:29], v[30:31]
 v_pk_add_f32 v[16:17], v[16:17], v[20:21]
 v_pk_add_f32 v[24:25], v[24:25], v[28:29]
 v_max_f32 v32, v16, v17
 v_max3_f32 v32, v32, v24, v25
 s_nop 1
 v_max_f32_dpp v32, v32, v32 quad_perm:[1,0,3,2] row_mask:0xf bank_mask:0xf
 s_nop 1
 v_max_f32_dpp v32, v32, v32 quad_perm:[2,3,0,1] row_mask:0xf bank_mask:0xf
 s_nop 1
 v_max_f32_dpp v32, v32, v32 row_half_mirror row_mask:0xf bank_mask:0xf
 s_nop 1
 v_max_f32_dpp v32, v32, v32 row_mirror row_mask:0xf bank_mask:0xf
 buffer_store_dword v0, v3, s[4:7], s31 offen
 v_sub_f32 v16, v16, v32
 v_sub_f32 v17, v17, v32
 v_sub_f32 v24, v24, v32
 v_sub_f32 v25, v25, v32
 v_exp_f32 v16, v16
 v_exp_f32 v17, v17
 v_exp_f32 v24, v24
 v_exp_f32 v25, v25
 s_nop 0
 v_add_f32 v32, v16, v17
 v_add_f32 v33, v24, v25
 v_add_f32 v32, v32, v33
 s_nop 1
 v_add_f32_dpp v32, v32, v32 quad_perm:[1,0,3,2] row_mask:0xf bank_mask:0xf
 s_nop 1
 v_add_f32_dpp v32, v32, v32 quad_perm:[2,3,0,1] row_mask:0xf bank_mask:0xf
 s_nop 1
 v_add_f32_dpp v32, v32, v32 row_half_mirror row_mask:0xf bank_mask:0xf
 s_nop 1
 v_add_f32_dpp v32, v32, v32 row_mirror row_mask:0xf bank_mask:0xf
 v_rcp_f32 v32, v32
 s_nop 0
 v_pk_mul_f32 v[16:17], v[16:17], v[32:33] op_sel_hi:[1,0]
 v_pk_mul_f32 v[24:25], v[24:25], v[32:33] op_sel_hi:[1,0]
 v_cvt_pk_bf16_f32 v16, v16, v17
 v_cvt_pk_bf16_f32 v24, v24, v25
 v_min_u32 v16, -2, v16
 v_min_u32 v24, -2, v24
 buffer_store_dword v16, v14, s[4:7], s15 offen
 s_mov_b64 exec, s[22:23]
 buffer_store_dword v24, v15, s[4:7], s16 offen
 s_mov_b64 exec, -1
L_A_nosm_14:
 s_barrier
 s_add_u32 s10, s10, 1
 s_cmp_ge_u32 s10, 63
 s_cbranch_scc1 K_done
 s_add_u32 s11, s27, 0
 s_mov_b32 m0, s11
 s_add_u32 s12, s17, 0
 s_add_u32 s13, s18, 0
 buffer_load_dwordx4 v1, s[4:7], s12 offen offset:0 lds
 buffer_load_dwordx4 v1, s[4:7], s12 offen offset:1024 lds
 buffer_load_dwordx4 v1, s[4:7], s12 offen offset:2048 lds
 buffer_load_dwordx4 v1, s[4:7], s13 offen offset:3072 lds
 s_add_u32 s11, s27, 4096
 s_mov_b32 m0, s11
 s_add_u32 s12, s17, 14336
 s_add_u32 s13, s18, 14336
 buffer_load_dwordx4 v1, s[4:7], s12 offen offset:0 lds
 buffer_load_dwordx4 v1, s[4:7], s12 offen offset:1024 lds
 buffer_load_dwordx4 v1, s[4:7], s12 offen offset:2048 lds
 buffer_load_dwordx4 v1, s[4:7], s13 offen offset:3072 lds
 s_add_u32 s17, s17, 28672
 s_add_u32 s18, s18, 28672
 s_add_u32 s14, s14, 7168
 s_add_u32 s15, s15, 8192
 s_add_u32 s16, s16, 2048
 s_add_u32 s30, s30, 256
 s_add_u32 s31, s31, 512
 s_branch L_A_loop_9
L_A_retry_12:
 s_mov_b32 s72, 4
 s_add_u32 s19, s19, 1
 s_cmp_gt_u32 s19, 8192
 s_cbranch_scc1 K_fail
 s_add_u32 s70, s70, 1
 s_waitcnt lgkmcnt(0)
 s_nop 7
 v_mov_b64 v[44:45], 0
 v_mov_b64 v[46:47], 0
 v_mov_b64 v[48:49], 0
 v_mov_b64 v[50:51], 0
 v_mov_b64 v[52:53], 0
 v_mov_b64 v[54:55], 0
 v_mov_b64 v[56:57], 0
 v_mov_b64 v[58:59], 0
 s_barrier
 s_branch L_A_fetch_10
K_fastB:
 s_sub_u32 s9, s9, 16
 v_lshlrev_b32 v1, 4, v0
 v_lshlrev_b32 v2, 2, v0
 v_and_b32 v4, 8, v0
 v_cmp_ne_u32 vcc, 0, v4
 v_mov_b32 v5, 0x4444
 v_mov_b32 v4, 0xeeee
 v_cndmask_b32 v5, v5, v4, vcc
 v_and_b32 v16, 15, v0
 v_lshrrev_b32 v17, 4, v0
 s_mul_i32 s11, s8, 14336
 s_add_u32 s27, s11, 8192
 v_add_u32 v6, s27, v1
 v_mov_b32 v13, 0
 s_lshl_b32 s12, s9, 1
 s_lshl_b32 s11, s8, 13
 s_add_u32 s26, s11, 65536
 v_add_u32 v7, s26, v1
 v_lshrrev_b32 v18, 5, v0
 v_bfe_u32 v19, v0, 3, 1
 v_lshl_add_u32 v18, v18, 1, v19
 s_lshl_b32 s11, s8, 2
 v_add_u32 v18, s11, v18
 v_lshlrev_b32 v18, 7, v18
 v_and_b32 v19, 7, v0
 v_lshl_add_u32 v8, v19, 4, v18
 v_mov_b32 v14, v1
 v_mul_u32_u24 v18, 272, v17
 v_lshl_add_u32 v18, v16, 4, v18
 s_mul_i32 s11, s8, 1280
 s_add_u32 s11, s11, 131072
 v_add_u32 v9, s11, v18
 v_lshrrev_b32 v18, 5, v0
 v_bfe_u32 v19, v0, 4, 1
 v_lshl_add_u32 v18, v18, 1, v19
 v_mul_u32_u24 v18, 272, v18
 v_and_b32 v19, 3, v0
 v_lshl_add_u32 v18, v19, 5, v18
 v_bfe_u32 v19, v0, 2, 2
 v_lshl_add_u32 v18, v19, 2, v18
 s_lshl_b32 s11, s8, 7
 s_add_u32 s11, s11, 131072
 v_add_u32 v10, s11, v18
 v_add_u32 v11, 16, v10
 s_lshl_b32 s11, s9, 9
 s_lshl_b32 s13, s8, 8
 s_add_u32 s11, s11, s13
 v_lshlrev_b32 v18, 2, v0
 v_add_u32 v12, s11, v18
 s_lshl_b32 s11, s9, 2
 s_add_u32 s11, s11, s8
 s_lshl_b32 s11, s11, 2
 v_cmp_eq_u32 vcc, 0, v0
 v_mov_b32 v18, s11
 v_mov_b32 v19, 0x7ffffff0
 v_cndmask_b32 v3, v19, v18, vcc
 s_mov_b32 s14, 16777216
 s_mov_b32 s30, 18339840
 s_lshl_b32 s11, s8, 7
 s_add_u32 s31, s11, 18361344
 s_lshl_b32 s11, s8, 11
 s_add_u32 s15, s11, 17694720
 s_mov_b32 s16, 18210816
 s_mul_i32 s11, s8, 112
 s_add_u32 s11, s11, s12
 s_lshl_b32 s11, s11, 10
 s_add_u32 s17, s11, 34603008
 s_mul_i32 s11, s8, 112
 s_add_u32 s11, s11, s12
 s_mul_i32 s11, s11, 14336
 s_add_u32 s13, s11, 9437184
 s_add_u32 s11, s13, 0
 buffer_load_dwordx4 v[120:123], v1, s[4:7], s11 offen nt
 buffer_load_dwordx4 v[124:127], v1, s[4:7], s11 offen offset:1024 nt
 s_add_u32 s11, s13, 2048
 buffer_load_dwordx4 v[128:131], v1, s[4:7], s11 offen nt
 buffer_load_dwordx4 v[132:135], v1, s[4:7], s11 offen offset:1024 nt
 s_add_u32 s11, s13, 4096
 buffer_load_dwordx4 v[136:139], v1, s[4:7], s11 offen nt
 buffer_load_dwordx4 v[140:143], v1, s[4:7], s11 offen offset:1024 nt
 s_add_u32 s11, s13, 6144
 buffer_load_dwordx4 v[144:147], v1, s[4:7], s11 offen nt
 buffer_load_dwordx4 v[148:151], v1, s[4:7], s11 offen offset:1024 nt
 s_add_u32 s11, s13, 8192
 buffer_load_dwordx4 v[152:155], v1, s[4:7], s11 offen nt
 buffer_load_dwordx4 v[156:159], v1, s[4:7], s11 offen offset:1024 nt
 s_add_u32 s11, s13, 10240
 buffer_load_dwordx4 v[160:163], v1, s[4:7], s11 offen nt
 buffer_load_dwordx4 v[164:167], v1, s[4:7], s11 offen offset:1024 nt
 s_add_u32 s11, s13, 12288
 buffer_load_dwordx4 v[168:171], v1, s[4:7], s11 offen nt
 buffer_load_dwordx4 v[172:175], v1, s[4:7], s11 offen offset:1024 nt
 s_add_u32 s11, s13, 14336
 buffer_load_dwordx4 v[176:179], v1, s[4:7], s11 offen nt
 buffer_load_dwordx4 v[180:183], v1, s[4:7], s11 offen offset:1024 nt
 s_add_u32 s11, s13, 16384
 buffer_load_dwordx4 v[184:187], v1, s[4:7], s11 offen nt
 buffer_load_dwordx4 v[188:191], v1, s[4:7], s11 offen offset:1024 nt
 s_add_u32 s11, s13, 18432
 buffer_load_dwordx4 v[192:195], v1, s[4:7], s11 offen nt
 buffer_load_dwordx4 v[196:199], v1, s[4:7], s11 offen offset:1024 nt
 s_add_u32 s11, s13, 20480
 buffer_load_dwordx4 v[200:203], v1, s[4:7], s11 offen nt
 buffer_load_dwordx4 v[204:207], v1, s[4:7], s11 offen offset:1024 nt
 s_add_u32 s11, s13, 22528
 buffer_load_dwordx4 v[208:211], v1, s[4:7], s11 offen nt
 buffer_load_dwordx4 v[212:215], v1, s[4:7], s11 offen offset:1024 nt
 s_add_u32 s11, s13, 24576
 buffer_load_dwordx4 v[216:219], v1, s[4:7], s11 offen nt
 buffer_load_dwordx4 v[220:223], v1, s[4:7], s11 offen offset:1024 nt
 s_add_u32 s11, s13, 26624
 buffer_load_dwordx4 v[224:227], v1, s[4:7], s11 offen nt
 buffer_load_dwordx4 v[228:231], v1, s[4:7], s11 offen offset:1024 nt
 s_add_u32 s11, s13, 401408
 buffer_load_dwordx4 v[232:235], v1, s[4:7], s11 offen nt
 buffer_load_dwordx4 v[236:239], v1, s[4:7], s11 offen offset:1024 nt
 s_add_u32 s11, s13, 403456
 buffer_load_dwordx4 v[240:243], v1, s[4:7], s11 offen nt
 buffer_load_dwordx4 v[244:247], v1, s[4:7], s11 offen offset:1024 nt
 s_add_u32 s11, s13, 405504
 buffer_load_dwordx4 v[248:251], v1, s[4:7], s11 offen nt
 buffer_load_dwordx4 v[252:255], v1, s[4:7], s11 offen offset:1024 nt
 s_add_u32 s11, s13, 407552
 buffer_load_dwordx4 a[0:3], v1, s[4:7], s11 offen nt
 buffer_load_dwordx4 a[4:7], v1, s[4:7], s11 offen offset:1024 nt
 s_add_u32 s11, s13, 409600
 buffer_load_dwordx4 a[8:11], v1, s[4:7], s11 offen nt
 buffer_load_dwordx4 a[12:15], v1, s[4:7], s11 offen offset:1024 nt
 s_add_u32 s11, s13, 411648
 buffer_load_dwordx4 a[16:19], v1, s[4:7], s11 offen nt
 buffer_load_dwordx4 a[20:23], v1, s[4:7], s11 offen offset:1024 nt
 s_add_u32 s11, s13, 413696
 buffer_load_dwordx4 a[24:27], v1, s[4:7], s11 offen nt
 buffer_load_dwordx4 a[28:31], v1, s[4:7], s11 offen offset:1024 nt
 s_add_u32 s11, s13, 415744
 buffer_load_dwordx4 a[32:35], v1, s[4:7], s11 offen nt
 buffer_load_dwordx4 a[36:39], v1, s[4:7], s11 offen offset:1024 nt
 s_add_u32 s11, s13, 417792
 buffer_load_dwordx4 a[40:43], v1, s[4:7], s11 offen nt
 buffer_load_dwordx4 a[44:47], v1, s[4:7], s11 offen offset:1024 nt
 s_add_u32 s11, s13, 419840
 buffer_load_dwordx4 a[48:51], v1, s[4:7], s11 offen nt
 buffer_load_dwordx4 a[52:55], v1, s[4:7], s11 offen offset:1024 nt
 s_add_u32 s11, s13, 421888
 buffer_load_dwordx4 a[56:59], v1, s[4:7], s11 offen nt
 buffer_load_dwordx4 a[60:63], v1, s[4:7], s11 offen offset:1024 nt
 s_add_u32 s11, s13, 423936
 buffer_load_dwordx4 a[64:67], v1, s[4:7], s11 offen nt
 buffer_load_dwordx4 a[68:71], v1, s[4:7], s11 offen offset:1024 nt
 s_add_u32 s11, s13, 425984
 buffer_load_dwordx4 a[72:75], v1, s[4:7], s11 offen nt
 buffer_load_dwordx4 a[76:79], v1, s[4:7], s11 offen offset:1024 nt
 s_add_u32 s11, s13, 428032
 buffer_load_dwordx4 a[80:83], v1, s[4:7], s11 offen nt
 buffer_load_dwordx4 a[84:87], v1, s[4:7], s11 offen offset:1024 nt
 s_add_u32 s11, s13, 802816
 buffer_load_dwordx4 a[88:91], v1, s[4:7], s11 offen nt
 buffer_load_dwordx4 a[92:95], v1, s[4:7], s11 offen offset:1024 nt
 s_add_u32 s11, s13, 804864
 buffer_load_dwordx4 a[96:99], v1, s[4:7], s11 offen nt
 buffer_load_dwordx4 a[100:103], v1, s[4:7], s11 offen offset:1024 nt
 s_add_u32 s11, s13, 806912
 buffer_load_dwordx4 a[104:107], v1, s[4:7], s11 offen nt
 buffer_load_dwordx4 a[108:111], v1, s[4:7], s11 offen offset:1024 nt
 s_add_u32 s11, s13, 808960
 buffer_load_dwordx4 a[112:115], v1, s[4:7], s11 offen nt
 buffer_load_dwordx4 a[116:119], v1, s[4:7], s11 offen offset:1024 nt
 s_add_u32 s11, s13, 811008
 buffer_load_dwordx4 a[120:123], v1, s[4:7], s11 offen nt
 buffer_load_dwordx4 a[124:127], v1, s[4:7], s11 offen offset:1024 nt
 s_add_u32 s11, s13, 813056
 buffer_load_dwordx4 a[128:131], v1, s[4:7], s11 offen nt
 buffer_load_dwordx4 a[132:135], v1, s[4:7], s11 offen offset:1024 nt
 s_add_u32 s11, s13, 815104
 buffer_load_dwordx4 a[136:139], v1, s[4:7], s11 offen nt
 buffer_load_dwordx4 a[140:143], v1, s[4:7], s11 offen offset:1024 nt
 s_add_u32 s11, s13, 817152
 buffer_load_dwordx4 a[144:147], v1, s[4:7], s11 offen nt
 buffer_load_dwordx4 a[148:151], v1, s[4:7], s11 offen offset:1024 nt
 s_add_u32 s11, s13, 819200
 buffer_load_dwordx4 a[152:155], v1, s[4:7], s11 offen nt
 buffer_load_dwordx4 a[156:159], v1, s[4:7], s11 offen offset:1024 nt
 s_add_u32 s11, s13, 821248
 buffer_load_dwordx4 a[160:163], v1, s[4:7], s11 offen nt
 buffer_load_dwordx4 a[164:167], v1, s[4:7], s11 offen offset:1024 nt
 s_add_u32 s11, s13, 823296
 buffer_load_dwordx4 a[168:171], v1, s[4:7], s11 offen nt
 buffer_load_dwordx4 a[172:175], v1, s[4:7], s11 offen offset:1024 nt
 s_add_u32 s11, s13, 825344
 buffer_load_dwordx4 a[176:179], v1, s[4:7], s11 offen nt
 buffer_load_dwordx4 a[180:183], v1, s[4:7], s11 offen offset:1024 nt
 s_add_u32 s11, s13, 827392
 buffer_load_dwordx4 a[184:187], v1, s[4:7], s11 offen nt
 buffer_load_dwordx4 a[188:191], v1, s[4:7], s11 offen offset:1024 nt
 s_add_u32 s11, s13, 829440
 buffer_load_dwordx4 a[192:195], v1, s[4:7], s11 offen nt
 buffer_load_dwordx4 a[196:199], v1, s[4:7], s11 offen offset:1024 nt
 s_add_u32 s11, s13, 1204224
 buffer_load_dwordx4 a[200:203], v1, s[4:7], s11 offen nt
 buffer_load_dwordx4 a[204:207], v1, s[4:7], s11 offen offset:1024 nt
 s_add_u32 s11, s13, 1206272
 buffer_load_dwordx4 a[208:211], v1, s[4:7], s11 offen nt
 buffer_load_dwordx4 a[212:215], v1, s[4:7], s11 offen offset:1024 nt
 s_add_u32 s11, s13, 1208320
 buffer_load_dwordx4 a[216:219], v1, s[4:7], s11 offen nt
 buffer_load_dwordx4 a[220:223], v1, s[4:7], s11 offen offset:1024 nt
 s_add_u32 s11, s13, 1210368
 buffer_load_dwordx4 a[224:227], v1, s[4:7], s11 offen nt
 buffer_load_dwordx4 a[228:231], v1, s[4:7], s11 offen offset:1024 nt
 s_add_u32 s11, s13, 1212416
 buffer_load_dwordx4 a[232:235], v1, s[4:7], s11 offen nt
 buffer_load_dwordx4 a[236:239], v1, s[4:7], s11 offen offset:1024 nt
 s_add_u32 s11, s13, 1214464
 buffer_load_dwordx4 a[240:243], v1, s[4:7], s11 offen nt
 buffer_load_dwordx4 a[244:247], v1, s[4:7], s11 offen offset:1024 nt
 s_add_u32 s11, s13, 1216512
 buffer_load_dwordx4 a[248:251], v1, s[4:7], s11 offen nt
 buffer_load_dwordx4 a[252:255], v1, s[4:7], s11 offen offset:1024 nt
 s_add_u32 s11, s27, 0
 s_mov_b32 m0, s11
 s_add_u32 s11, s13, 1218560
 buffer_load_dwordx4 v1, s[4:7], s11 offen offset:0 nt lds
 buffer_load_dwordx4 v1, s[4:7], s11 offen offset:1024 nt lds
 buffer_load_dwordx4 v1, s[4:7], s11 offen offset:2048 nt lds
 buffer_load_dwordx4 v1, s[4:7], s11 offen offset:3072 nt lds
 s_add_u32 s11, s27, 4096
 s_mov_b32 m0, s11
 s_add_u32 s11, s13, 1222656
 buffer_load_dwordx4 v1, s[4:7], s11 offen offset:0 nt lds
 buffer_load_dwordx4 v1, s[4:7], s11 offen offset:1024 nt lds
 buffer_load_dwordx4 v1, s[4:7], s11 offen offset:2048 nt lds
 buffer_load_dwordx4 v1, s[4:7], s11 offen offset:3072 nt lds
 s_add_u32 s11, s27, 8192
 s_mov_b32 m0, s11
 s_add_u32 s11, s13, 1226752
 buffer_load_dwordx4 v1, s[4:7], s11 offen offset:0 nt lds
 buffer_load_dwordx4 v1, s[4:7], s11 offen offset:1024 nt lds
 buffer_load_dwordx4 v1, s[4:7], s11 offen offset:2048 nt lds
 buffer_load_dwordx4 v1, s[4:7], s11 offen offset:3072 nt lds
 s_add_u32 s11, s27, 12288
 s_mov_b32 m0, s11
 s_add_u32 s11, s13, 1230848
 buffer_load_dwordx4 v1, s[4:7], s11 offen offset:0 nt lds
 buffer_load_dwordx4 v1, s[4:7], s11 offen offset:1024 nt lds
 s_waitcnt vmcnt(0)
 s_mov_b32 s19, 0
K_mh_15:
 v_mov_b32 v16, 132
 buffer_load_dword v17, v16, s[80:83], 0 offen sc1
 s_waitcnt vmcnt(0)
 v_readfirstlane_b32 s93, v17
 s_cmp_lg_u32 s93, 0
 s_cbranch_scc1 K_mh_15_k
 s_add_u32 s19, s19, 1
 s_cmp_lt_u32 s19, 1024
 s_cbranch_scc1 K_mh_15
 s_mov_b64 exec, 1
 v_mov_b32 v18, 2
 v_mov_b32 v19, 0
 buffer_atomic_cmpswap v[18:19], v16, s[80:83], 0 offen sc1
 s_waitcnt vmcnt(0)
 s_mov_b64 exec, -1
 s_mov_b32 s19, 0
 s_branch K_mh_15
K_mh_15_k:
 s_mov_b32 s19, 0
 s_cmp_eq_u32 s93, 2
 s_cbranch_scc1 K_slowq
 s_mov_b32 s35, 0
 s_mov_b32 s34, 0
 s_cmp_lt_u32 s34, s35
 s_cbranch_scc1 L_B_ur_16_ok
 s_mov_b64 exec, 0xffff
 v_lshlrev_b32 v4, 7, v0
 s_mov_b32 s19, 0
 s_mov_b32 s13, 18413568
L_B_ur_16:
 buffer_load_dword v119, v4, s[4:7], s13 offen sc1
 s_waitcnt vmcnt(0)
 v_cmp_le_u32 vcc, 28, v119
 s_nop 1
 s_ff0_i32_b32 s35, vcc_lo
 s_cmp_lt_u32 s34, s35
 s_cbranch_scc1 L_B_ur_16_got
 s_sleep 4
 s_add_u32 s19, s19, 1
 s_cmp_le_u32 s19, 16384
 s_cbranch_scc1 L_B_ur_16
 s_mov_b32 s72, 6
 s_branch K_fail
L_B_ur_16_got:
 s_mov_b64 exec, -1
L_B_ur_16_ok:
 s_add_u32 s11, s26, 0
 s_mov_b32 m0, s11
 s_add_u32 s12, s17, 0
 buffer_load_dwordx4 v1, s[4:7], s12 offen sc1 lds
 buffer_load_dwordx4 v1, s[4:7], s12 offen offset:1024 sc1 lds
 s_add_u32 s11, s26, 2048
 s_mov_b32 m0, s11
 s_add_u32 s12, s17, 28672
 buffer_load_dwordx4 v1, s[4:7], s12 offen sc1 lds
 buffer_load_dwordx4 v1, s[4:7], s12 offen offset:1024 sc1 lds
 s_add_u32 s11, s26, 4096
 s_mov_b32 m0, s11
 s_add_u32 s12, s17, 57344
 buffer_load_dwordx4 v1, s[4:7], s12 offen sc1 lds
 buffer_load_dwordx4 v1, s[4:7], s12 offen offset:1024 sc1 lds
 s_add_u32 s11, s26, 6144
 s_mov_b32 m0, s11
 s_add_u32 s12, s17, 86016
 buffer_load_dwordx4 v1, s[4:7], s12 offen sc1 lds
 buffer_load_dwordx4 v1, s[4:7], s12 offen offset:1024 sc1 lds
 s_add_u32 s17, s17, 458752
 s_mov_b32 s25, 0
 s_mov_b32 s10, 0
 s_waitcnt vmcnt(0)
L_B_loop_17:
 s_cmp_lg_u32 s8, 3
 s_cbranch_scc1 L_B_nofetch_19
 s_cmp_eq_u32 s10, 0
 s_cbranch_scc1 L_B_fetch_18
 s_mov_b32 exec_lo, 0xffffffff
 s_mov_b32 exec_hi, 0xffffff
 s_mov_b32 s19, 0
 buffer_load_dword v112, v2, s[4:7], s30 offen sc1
 s_nop 15
 s_nop 3
 buffer_load_dword v113, v2, s[4:7], s30 offen sc1
 s_nop 15
 s_nop 3
 buffer_load_dword v114, v2, s[4:7], s30 offen sc1
L_pwB_21:
 s_waitcnt vmcnt(2)
 v_cmp_eq_u32 vcc, -1, v112
 s_cbranch_vccz L_pwB_21_ok
 buffer_load_dword v112, v2, s[4:7], s30 offen sc1
 s_waitcnt vmcnt(2)
 v_cmp_eq_u32 vcc, -1, v113
 s_cbranch_vccz L_pwB_21_ok
 buffer_load_dword v113, v2, s[4:7], s30 offen sc1
 s_waitcnt vmcnt(2)
 v_cmp_eq_u32 vcc, -1, v114
 s_cbranch_vccz L_pwB_21_ok
 buffer_load_dword v114, v2, s[4:7], s30 offen sc1
 s_add_u32 s19, s19, 1
 s_cmp_le_u32 s19, 8192
 s_cbranch_scc1 L_pwB_21
 s_mov_b32 s72, 2
 s_branch K_fail
L_pwB_21_ok:
 s_mov_b64 exec, -1
L_B_fetch_18:
 s_cmp_lg_u32 s8, 3
 s_cbranch_scc1 L_B_nofetch_19
 s_mov_b32 m0, 0
 s_add_u32 s11, s14, 4096
 buffer_load_dwordx4 v1, s[4:7], s14 offen offset:0 sc1 lds
 buffer_load_dwordx4 v1, s[4:7], s14 offen offset:1024 sc1 lds
 buffer_load_dwordx4 v1, s[4:7], s14 offen offset:2048 sc1 lds
 buffer_load_dwordx4 v1, s[4:7], s14 offen offset:3072 sc1 lds
 s_mov_b32 m0, 4096
 s_nop 0
 buffer_load_dwordx4 v1, s[4:7], s11 offen offset:0 sc1 lds
 buffer_load_dwordx4 v1, s[4:7], s11 offen offset:1024 sc1 lds
 buffer_load_dwordx4 v1, s[4:7], s11 offen offset:2048 sc1 lds
 ds_read_b128 v[72:75], v6 offset:0
 ds_read_b128 v[76:79], v6 offset:1024
 ds_read_b128 v[80:83], v6 offset:2048
 ds_read_b128 v[84:87], v6 offset:3072
 ds_read_b128 v[88:91], v6 offset:4096
 ds_read_b128 v[92:95], v6 offset:5120
 ds_read_b128 v[96:99], v6 offset:6144
 ds_read_b128 v[100:103], v6 offset:7168
 v_mov_b64 v[60:61], 0
 v_mov_b64 v[62:63], 0
 v_mov_b64 v[64:65], 0
 v_mov_b64 v[66:67], 0
 v_mov_b64 v[68:69], 0
 v_mov_b64 v[70:71], 0
 s_waitcnt vmcnt(0)
 s_branch L_B_nofetch_19_j
L_B_nofetch_19:
 ds_read_b128 v[72:75], v6 offset:0
 ds_read_b128 v[76:79], v6 offset:1024
 ds_read_b128 v[80:83], v6 offset:2048
 ds_read_b128 v[84:87], v6 offset:3072
 ds_read_b128 v[88:91], v6 offset:4096
 ds_read_b128 v[92:95], v6 offset:5120
 ds_read_b128 v[96:99], v6 offset:6144
 ds_read_b128 v[100:103], v6 offset:7168
 v_mov_b64 v[60:61], 0
 v_mov_b64 v[62:63], 0
 v_mov_b64 v[64:65], 0
 v_mov_b64 v[66:67], 0
 v_mov_b64 v[68:69], 0
 v_mov_b64 v[70:71], 0
L_B_nofetch_19_j:
 s_waitcnt lgkmcnt(0)
 s_barrier
 s_cmp_ge_u32 s10, 62
 s_cbranch_scc1 L_B_nou_22
 s_add_u32 s34, s10, 1
 s_lshr_b32 s34, s34, 2
 s_cmp_lt_u32 s34, s35
 s_cbranch_scc1 L_B_ur_23_ok
 s_mov_b64 exec, 0xffff
 v_lshlrev_b32 v4, 7, v0
 s_mov_b32 s19, 0
 s_mov_b32 s13, 18413568
L_B_ur_23:
 buffer_load_dword v119, v4, s[4:7], s13 offen sc1
 s_waitcnt vmcnt(0)
 v_cmp_le_u32 vcc, 28, v119
 s_nop 1
 s_ff0_i32_b32 s35, vcc_lo
 s_cmp_lt_u32 s34, s35
 s_cbranch_scc1 L_B_ur_23_got
 s_sleep 4
 s_add_u32 s19, s19, 1
 s_cmp_le_u32 s19, 16384
 s_cbranch_scc1 L_B_ur_23
 s_mov_b32 s72, 6
 s_branch K_fail
L_B_ur_23_got:
 s_mov_b64 exec, -1
L_B_ur_23_ok:
L_B_nou_22:
 s_xor_b32 s12, s25, 32768
 s_add_u32 s24, s26, s12
 ds_read_b128 v[16:19], v1 offset:0
 ds_read_b128 v[20:23], v1 offset:1024
 ds_read_b128 v[24:27], v1 offset:2048
 s_waitcnt lgkmcnt(2)
 v_smfmac_f32_16x16x64_bf16 v[68:71], v[16:19], v[72:79], v5
 ds_read_b128 v[28:31], v1 offset:3072
 s_add_u32 s11, s24, 0
 s_mov_b32 m0, s11
 s_add_u32 s12, s17, 0
 v_max3_u32 v4, v16, v17, v18
 buffer_load_dwordx4 v1, s[4:7], s12 offen sc1 lds
 s_waitcnt lgkmcnt(2)
 v_smfmac_f32_16x16x64_bf16 v[68:71], v[20:23], v[80:87], v5
 ds_read_b128 v[32:35], v1 offset:4096
 buffer_load_dwordx4 v1, s[4:7], s12 offen offset:1024 sc1 lds
 v_max_u32 v4, v4, v19
 s_add_u32 s11, s24, 2048
 s_mov_b32 m0, s11
 s_add_u32 s12, s17, 28672
 s_waitcnt lgkmcnt(2)
 v_smfmac_f32_16x16x64_bf16 v[68:71], v[24:27], v[88:95], v5
 ds_read_b128 v[36:39], v1 offset:5120
 buffer_load_dwordx4 v1, s[4:7], s12 offen sc1 lds
 v_max3_u32 v4, v4, v20, v21
 buffer_load_dwordx4 v1, s[4:7], s12 offen offset:1024 sc1 lds
 s_waitcnt lgkmcnt(2)
 v_smfmac_f32_16x16x64_bf16 v[68:71], v[28:31], v[96:103], v5
 ds_read_b128 v[40:43], v1 offset:6144
 s_add_u32 s11, s24, 4096
 s_mov_b32 m0, s11
 s_add_u32 s12, s17, 57344
 v_max3_u32 v4, v4, v22, v23
 buffer_load_dwordx4 v1, s[4:7], s12 offen sc1 lds
 v_smfmac_f32_16x16x64_bf16 v[60:63], v[16:19], v[120:127], v5
 ds_read_b128 v[72:75], v6 offset:8192
 buffer_load_dwordx4 v1, s[4:7], s12 offen offset:1024 sc1 lds
 v_max3_u32 v4, v4, v24, v25
 s_add_u32 s11, s24, 6144
 s_mov_b32 m0, s11
 s_add_u32 s12, s17, 86016
 v_smfmac_f32_16x16x64_bf16 v[60:63], v[20:23], v[128:135], v5
 ds_read_b128 v[76:79], v6 offset:9216
 buffer_load_dwordx4 v1, s[4:7], s12 offen sc1 lds
 v_max3_u32 v4, v4, v26, v27
 buffer_load_dwordx4 v1, s[4:7], s12 offen offset:1024 sc1 lds
 v_smfmac_f32_16x16x64_bf16 v[60:63], v[24:27], v[136:143], v5
 ds_read_b128 v[80:83], v6 offset:10240
 v_max3_u32 v4, v4, v28, v29
 v_smfmac_f32_16x16x64_bf16 v[60:63], v[28:31], v[144:151], v5
 ds_read_b128 v[84:87], v6 offset:11264
 v_max3_u32 v4, v4, v30, v31
 s_waitcnt lgkmcnt(6)
 v_smfmac_f32_16x16x64_bf16 v[60:63], v[32:35], v[152:159], v5
 ds_read_b128 v[88:91], v6 offset:12288
 v_max3_u32 v4, v4, v32, v33
 s_waitcnt lgkmcnt(6)
 v_smfmac_f32_16x16x64_bf16 v[60:63], v[36:39], v[160:167], v5
 ds_read_b128 v[92:95], v6 offset:13312
 v_max3_u32 v4, v4, v34, v35
 s_waitcnt lgkmcnt(6)
 v_smfmac_f32_16x16x64_bf16 v[60:63], v[40:43], v[168:175], v5
 v_max3_u32 v4, v4, v36, v37
 s_waitcnt lgkmcnt(4)
 v_smfmac_f32_16x16x64_bf16 v[68:71], v[32:35], v[72:79], v5
 v_max3_u32 v4, v4, v38, v39
 s_waitcnt lgkmcnt(2)
 v_smfmac_f32_16x16x64_bf16 v[68:71], v[36:39], v[80:87], v5
 v_cvt_pk_bf16_f32 v44, v60, v61
 s_waitcnt lgkmcnt(0)
 v_smfmac_f32_16x16x64_bf16 v[68:71], v[40:43], v[88:95], v5
 v_cvt_pk_bf16_f32 v46, v62, v63
 v_smfmac_f32_16x16x64_bf16 v[64:67], v[16:19], v[176:183], v5
 v_mov_b64 v[60:61], 0
 v_smfmac_f32_16x16x64_bf16 v[64:67], v[20:23], v[184:191], v5
 v_mov_b64 v[62:63], 0
 v_smfmac_f32_16x16x64_bf16 v[64:67], v[24:27], v[192:199], v5
 v_cvt_pk_bf16_f32 v57, v68, v69
 v_smfmac_f32_16x16x64_bf16 v[64:67], v[28:31], v[200:207], v5
 v_cvt_pk_bf16_f32 v59, v70, v71
 v_smfmac_f32_16x16x64_bf16 v[64:67], v[32:35], v[208:215], v5
 v_mov_b64 v[68:69], 0
 v_smfmac_f32_16x16x64_bf16 v[64:67], v[36:39], v[216:223], v5
 v_mov_b64 v[70:71], 0
 v_smfmac_f32_16x16x64_bf16 v[64:67], v[40:43], v[224:231], v5
 v_max3_u32 v4, v4, v40, v41
 v_smfmac_f32_16x16x64_bf16 v[60:63], v[16:19], v[232:239], v5
 v_max3_u32 v4, v4, v42, v43
 v_smfmac_f32_16x16x64_bf16 v[60:63], v[20:23], v[240:247], v5
 v_cvt_pk_bf16_f32 v52, v64, v65
 v_smfmac_f32_16x16x64_bf16 v[60:63], v[24:27], v[248:255], v5
 v_cvt_pk_bf16_f32 v54, v66, v67
 v_smfmac_f32_16x16x64_bf16 v[60:63], v[28:31], a[0:7], v5
 v_mov_b64 v[64:65], 0
 v_smfmac_f32_16x16x64_bf16 v[60:63], v[32:35], a[8:15], v5
 v_mov_b64 v[66:67], 0
 v_smfmac_f32_16x16x64_bf16 v[60:63], v[36:39], a[16:23], v5
 v_cmp_eq_u32 vcc, -1, v4
 v_smfmac_f32_16x16x64_bf16 v[60:63], v[40:43], a[24:31], v5
 v_smfmac_f32_16x16x64_bf16 v[68:71], v[16:19], a[32:39], v5
 v_smfmac_f32_16x16x64_bf16 v[68:71], v[20:23], a[40:47], v5
 v_cvt_pk_bf16_f32 v45, v60, v61
 v_smfmac_f32_16x16x64_bf16 v[68:71], v[24:27], a[48:55], v5
 v_cvt_pk_bf16_f32 v47, v62, v63
 v_smfmac_f32_16x16x64_bf16 v[68:71], v[28:31], a[56:63], v5
 v_mov_b64 v[60:61], 0
 v_smfmac_f32_16x16x64_bf16 v[68:71], v[32:35], a[64:71], v5
 v_mov_b64 v[62:63], 0
 v_smfmac_f32_16x16x64_bf16 v[68:71], v[36:39], a[72:79], v5
 v_smfmac_f32_16x16x64_bf16 v[68:71], v[40:43], a[80:87], v5
 s_cbranch_vccnz L_B_retry_20
 v_smfmac_f32_16x16x64_bf16 v[64:67], v[16:19], a[88:95], v5
 s_add_u32 s17, s17, 458752
 v_smfmac_f32_16x16x64_bf16 v[64:67], v[20:23], a[96:103], v5
 v_cvt_pk_bf16_f32 v53, v68, v69
 v_smfmac_f32_16x16x64_bf16 v[64:67], v[24:27], a[104:111], v5
 v_cvt_pk_bf16_f32 v55, v70, v71
 v_smfmac_f32_16x16x64_bf16 v[64:67], v[28:31], a[112:119], v5
 v_mov_b64 v[68:69], 0
 v_smfmac_f32_16x16x64_bf16 v[64:67], v[32:35], a[120:127], v5
 v_mov_b64 v[70:71], 0
 v_smfmac_f32_16x16x64_bf16 v[64:67], v[36:39], a[128:135], v5
 v_smfmac_f32_16x16x64_bf16 v[64:67], v[40:43], a[136:143], v5
 v_smfmac_f32_16x16x64_bf16 v[60:63], v[16:19], a[144:151], v5
 v_smfmac_f32_16x16x64_bf16 v[60:63], v[20:23], a[152:159], v5
 v_cvt_pk_bf16_f32 v48, v64, v65
 v_smfmac_f32_16x16x64_bf16 v[60:63], v[24:27], a[160:167], v5
 v_cvt_pk_bf16_f32 v50, v66, v67
 v_smfmac_f32_16x16x64_bf16 v[60:63], v[28:31], a[168:175], v5
 v_mov_b64 v[64:65], 0
 v_smfmac_f32_16x16x64_bf16 v[60:63], v[32:35], a[176:183], v5
 v_mov_b64 v[66:67], 0
 v_smfmac_f32_16x16x64_bf16 v[60:63], v[36:39], a[184:191], v5
 v_smfmac_f32_16x16x64_bf16 v[60:63], v[40:43], a[192:199], v5
 v_smfmac_f32_16x16x64_bf16 v[68:71], v[16:19], a[200:207], v5
 v_smfmac_f32_16x16x64_bf16 v[68:71], v[20:23], a[208:215], v5
 v_cvt_pk_bf16_f32 v56, v60, v61
 v_smfmac_f32_16x16x64_bf16 v[68:71], v[24:27], a[216:223], v5
 v_cvt_pk_bf16_f32 v58, v62, v63
 v_smfmac_f32_16x16x64_bf16 v[68:71], v[28:31], a[224:231], v5
 v_mov_b64 v[60:61], 0
 v_smfmac_f32_16x16x64_bf16 v[68:71], v[32:35], a[232:239], v5
 v_mov_b64 v[62:63], 0
 v_smfmac_f32_16x16x64_bf16 v[68:71], v[36:39], a[240:247], v5
 v_smfmac_f32_16x16x64_bf16 v[68:71], v[40:43], a[248:255], v5
 s_nop 7
 v_cvt_pk_bf16_f32 v49, v68, v69
 v_cvt_pk_bf16_f32 v51, v70, v71
 v_add_u32 v4, s25, v7
 ds_read_b128 v[72:75], v4 offset:0
 ds_read_b128 v[76:79], v4 offset:2048
 ds_read_b128 v[80:83], v4 offset:4096
 ds_read_b128 v[84:87], v4 offset:6144
 ds_read_b128 v[88:91], v4 offset:1024
 ds_read_b128 v[92:95], v4 offset:3072
 ds_read_b128 v[96:99], v4 offset:5120
 ds_read_b128 v[100:103], v4 offset:7168
 s_mov_b64 exec, 0xff
 s_mov_b32 s19, 0
 buffer_load_dword v112, v2, s[4:7], s31 offen sc1
 s_nop 15
 s_nop 3
 buffer_load_dword v113, v2, s[4:7], s31 offen sc1
 s_nop 15
 s_nop 3
 buffer_load_dword v114, v2, s[4:7], s31 offen sc1
L_pwP_24:
 s_waitcnt vmcnt(2)
 v_cmp_eq_u32 vcc, -1, v112
 s_cbranch_vccz L_pwP_24_ok
 buffer_load_dword v112, v2, s[4:7], s31 offen sc1
 s_waitcnt vmcnt(2)
 v_cmp_eq_u32 vcc, -1, v113
 s_cbranch_vccz L_pwP_24_ok
 buffer_load_dword v113, v2, s[4:7], s31 offen sc1
 s_waitcnt vmcnt(2)
 v_cmp_eq_u32 vcc, -1, v114
 s_cbranch_vccz L_pwP_24_ok
 buffer_load_dword v114, v2, s[4:7], s31 offen sc1
 s_add_u32 s19, s19, 1
 s_cmp_le_u32 s19, 8192
 s_cbranch_scc1 L_pwP_24
 s_mov_b32 s72, 3
 s_branch K_fail
L_pwP_24_ok:
 s_mov_b64 exec, -1
 s_waitcnt lgkmcnt(0)
L_B_pf_25:
 buffer_load_dwordx4 v[104:107], v14, s[4:7], s15 offen sc1
 buffer_load_dwordx4 v[108:111], v14, s[4:7], s15 offen offset:1024 sc1
 buffer_load_dwordx4 v[112:115], v8, s[4:7], s16 offen sc1
 s_waitcnt vmcnt(2)
 v_smfmac_f32_16x16x64_bf16 v[60:63], v[104:107], v[72:79], v5
 v_max3_u32 v4, v104, v105, v106
 v_smfmac_f32_16x16x64_bf16 v[64:67], v[104:107], v[88:95], v5
 s_waitcnt vmcnt(1)
 v_max3_u32 v4, v4, v107, v108
 v_smfmac_f32_16x16x64_bf16 v[60:63], v[108:111], v[80:87], v5
 v_max3_u32 v4, v4, v109, v110
 v_smfmac_f32_16x16x64_bf16 v[64:67], v[108:111], v[96:103], v5
 s_waitcnt vmcnt(0)
 v_max3_u32 v4, v4, v111, v112
 v_smfmac_f32_16x16x64_bf16 v[60:63], v[112:115], v[44:51], v5
 v_max3_u32 v4, v4, v113, v114
 v_smfmac_f32_16x16x64_bf16 v[64:67], v[112:115], v[52:59], v5
 v_max_u32 v4, v4, v115
 v_cmp_eq_u32 vcc, -1, v4
 s_cbranch_vccnz L_B_pretry_26
 s_add_u32 s13, s30, 256
 s_nop 3
 v_permlane32_swap_b32 v60, v64
 v_permlane32_swap_b32 v61, v65
 v_permlane32_swap_b32 v62, v66
 v_permlane32_swap_b32 v63, v67
 v_add_f32 v60, v60, v64
 v_add_f32 v61, v61, v65
 v_add_f32 v62, v62, v66
 v_add_f32 v63, v63, v67
 ds_write_b128 v9, v[60:63]
 buffer_store_dword v13, v3, s[4:7], s13 offen
 s_waitcnt lgkmcnt(0)
 s_barrier
 s_cmp_ge_u32 s8, 2
 s_cbranch_scc1 L_B_nored_27
 ds_read2st64_b32 v[104:105], v10 offset0:0 offset1:5
 ds_read2st64_b32 v[106:107], v11 offset0:0 offset1:5
 ds_read2st64_b32 v[108:109], v10 offset0:10 offset1:15
 ds_read2st64_b32 v[110:111], v11 offset0:10 offset1:15
 s_add_u32 s11, s14, 7168
 s_add_u32 s12, s11, 458752
 s_waitcnt lgkmcnt(2)
 v_add_f32 v104, v104, v105
 v_add_f32 v106, v106, v107
 s_waitcnt lgkmcnt(0)
 v_add_f32 v108, v108, v109
 v_add_f32 v110, v110, v111
 v_add_f32 v104, v104, v108
 v_add_f32 v106, v106, v110
 v_cvt_pk_bf16_f32 v104, v104, v106
 v_min_u32 v104, -2, v104
 buffer_store_dword v104, v12, s[4:7], s11 offen
 s_cmp_lg_u32 s10, 62
 s_cbranch_scc1 L_B_nored_27
 buffer_store_dword v104, v12, s[4:7], s12 offen sc1
L_B_nored_27:
 s_add_u32 s10, s10, 1
 s_cmp_ge_u32 s10, 63
 s_cbranch_scc1 K_done
 s_add_u32 s14, s14, 7168
 s_add_u32 s15, s15, 8192
 s_add_u32 s16, s16, 2048
 s_add_u32 s30, s30, 256
 s_add_u32 s31, s31, 512
 s_xor_b32 s25, s25, 32768
 s_branch L_B_loop_17
L_B_retry_20:
 s_mov_b32 s72, 4
 s_add_u32 s19, s19, 1
 s_cmp_gt_u32 s19, 16384
 s_cbranch_scc1 K_fail
 s_add_u32 s70, s70, 1
 s_waitcnt lgkmcnt(0)
 s_nop 7
 s_barrier
 s_branch L_B_fetch_18
L_B_pretry_26:
 s_mov_b32 s72, 5
 s_add_u32 s19, s19, 1
 s_cmp_gt_u32 s19, 16384
 s_cbranch_scc1 K_fail
 s_add_u32 s71, s71, 1
 s_nop 7
 v_mov_b64 v[60:61], 0
 v_mov_b64 v[62:63], 0
 v_mov_b64 v[64:65], 0
 v_mov_b64 v[66:67], 0
 s_branch L_B_pf_25
K_slowq:
 s_mov_b32 s95, 1
 s_cmp_lg_u32 s8, 0
 s_cbranch_scc1 K_at_28
 s_mov_b64 exec, 1
 v_mov_b32 v5, 136
 v_mov_b32 v8, 1
 buffer_atomic_add v8, v5, s[80:83], 0 offen sc0 sc1
 s_waitcnt vmcnt(0)
 s_mov_b64 exec, -1
K_at_28:
 s_cmp_lg_u32 s8, 0
 s_cbranch_scc1 K_bc_29
 v_lshlrev_b32 v5, 2, v0
 v_add_u32 v5, 163776, v5
 s_mov_b64 exec, 1
 ds_write_b32 v5, v8
 s_waitcnt lgkmcnt(0)
 s_mov_b64 exec, -1
K_bc_29:
 s_barrier
 v_and_b32 v5, 7, v0
 v_lshlrev_b32 v5, 2, v5
 v_add_u32 v5, 163776, v5
 ds_read_b32 v6, v5
 v_mov_b32 v5, 163808
 ds_read_b32 v7, v5
 s_waitcnt lgkmcnt(0)
 v_cmp_ne_u32 vcc, 0, v7
 s_cbranch_vccnz K_done
 s_barrier
 v_readfirstlane_b32 s9, v6
 s_cmp_ge_u32 s9, 30
 s_cbranch_scc1 K_loop
 s_cmp_ge_u32 s9, 16
 s_cbranch_scc1 K_slowB
 v_lshlrev_b32 v1, 4, v0
 v_lshlrev_b32 v2, 2, v0
 v_and_b32 v4, 8, v0
 v_cmp_ne_u32 vcc, 0, v4
 v_mov_b32 v5, 0x4444
 v_mov_b32 v4, 0xeeee
 v_cndmask_b32 v5, v5, v4, vcc
 v_and_b32 v16, 15, v0
 v_lshrrev_b32 v17, 4, v0
 v_and_b32 v18, 1, v17
 v_bfe_u32 v19, v16, 2, 1
 v_cmp_eq_u32 vcc, v18, v19
 v_and_b32 v20, 1, v16
 v_lshlrev_b32 v20, 4, v20
 v_mov_b32 v21, 0x3f80
 v_lshlrev_b32 v21, v20, v21
 v_cndmask_b32 v21, 0, v21, vcc
 v_and_b32 v20, 2, v16
 v_cmp_eq_u32 vcc, 0, v20
 s_nop 1
 v_cndmask_b32 v22, 0, v21, vcc
 v_cndmask_b32 v23, v21, 0, vcc
 v_cmp_gt_u32 vcc, 8, v16
 s_nop 1
 v_cndmask_b32 v104, 0, v22, vcc
 v_cndmask_b32 v105, 0, v23, vcc
 v_cndmask_b32 v106, v22, 0, vcc
 v_cndmask_b32 v107, v23, 0, vcc
 s_and_b32 s26, s8, 1
 s_lshr_b32 s11, s8, 1
 s_mul_i32 s12, s11, 7
 s_add_u32 s25, s12, 3
 s_lshl_b32 s13, s26, 2
 s_add_u32 s24, s12, s13
 s_lshl_b32 s11, s8, 13
 s_add_u32 s27, s11, 32768
 v_add_u32 v6, s27, v1
 s_lshl_b32 s11, s26, 2
 v_add_u32 v7, s11, v6
 v_and_b32 v18, 7, v0
 v_lshrrev_b32 v19, 5, v0
 v_lshl_add_u32 v18, v19, 4, v18
 v_lshlrev_b32 v18, 4, v18
 v_and_b32 v19, 1, v17
 v_lshl_add_u32 v18, v19, 3, v18
 s_lshl_b32 s11, s24, 9
 v_add_u32 v8, s11, v18
 v_add_u32 v9, 1024, v8
 s_lshl_b32 s11, s25, 9
 v_add_u32 v10, s11, v18
 s_cmp_eq_u32 s26, 0
 s_cselect_b64 s[36:37], -1, 0
 s_cselect_b64 s[38:39], 0, -1
 v_mov_b32 v56, 0
 v_mov_b32 v57, 0
 v_mov_b32 v58, 0
 v_mov_b32 v59, 0
 v_mul_u32_u24 v18, 160, v17
 v_lshl_add_u32 v18, v16, 4, v18
 s_lshl_b32 s11, s8, 11
 s_add_u32 s11, s11, 8192
 v_add_u32 v11, s11, v18
 s_add_u32 s11, s11, 1920
 v_mov_b32 v22, s11
 v_mov_b32 v20, 0xff800000
 v_mov_b32 v21, 0xff800000
 ds_write_b64 v22, v[20:21]
 s_lshl_b32 s11, s8, 2
 v_add_u32 v18, s11, v17
 v_lshrrev_b32 v19, 1, v16
 v_and_b32 v19, 3, v19
 v_mul_u32_u24 v19, 160, v19
 v_lshl_add_u32 v19, v18, 4, v19
 v_and_b32 v20, 1, v16
 v_lshl_add_u32 v19, v20, 3, v19
 v_add_u32 v13, 8192, v19
 v_lshrrev_b32 v20, 3, v16
 v_add_u32 v20, 1, v20
 v_mul_u32_u24 v20, 640, v20
 v_add_u32 v12, v20, v13
 v_cmp_gt_u32 s[22:23], 4, v16
 v_mov_b32 v20, 10112
 s_nop 0
 v_cndmask_b32 v13, v20, v13, s[22:23]
 v_lshrrev_b32 v19, 3, v16
 v_lshlrev_b32 v19, 7, v19
 v_bfe_u32 v20, v16, 2, 1
 v_lshl_add_u32 v19, v20, 8, v19
 v_lshl_add_u32 v19, v18, 4, v19
 v_and_b32 v20, 3, v16
 v_lshl_add_u32 v14, v20, 2, v19
 v_lshlrev_b32 v19, 4, v18
 v_lshl_add_u32 v15, v16, 2, v19
 v_cmp_gt_u32 s[20:21], 8, v16
 s_and_b32 s11, s9, 3
 s_lshl_b32 s11, s11, 1
 s_add_u32 s11, s11, s8
 s_lshl_b32 s11, s11, 2
 v_cmp_eq_u32 vcc, 0, v0
 v_mov_b32 v18, s11
 v_mov_b32 v19, 0x7ffffff0
 v_cndmask_b32 v3, v19, v18, vcc
 s_lshr_b32 s11, s9, 2
 s_lshl_b32 s12, s11, 7
 s_add_u32 s31, s12, 18361344
 s_lshl_b32 s11, s11, 11
 s_bfe_u32 s12, s9, 0x10001
 s_lshl_b32 s12, s12, 10
 s_add_u32 s11, s11, s12
 s_and_b32 s12, s9, 1
 s_lshl_b32 s12, s12, 9
 s_add_u32 s11, s11, s12
 s_add_u32 s15, s11, 17694720
 s_lshl_b32 s11, s9, 7
 s_add_u32 s16, s11, 18210816
 s_mov_b32 s14, 16777216
 s_mov_b32 s30, 18339840
 s_lshl_b32 s11, s24, 10
 s_add_u32 s17, s11, 0
 s_lshl_b32 s11, s25, 10
 s_add_u32 s18, s11, 0
 s_sub_u32 s18, s18, 3072
 v_lshlrev_b32 v18, 7, v0
 v_add_u32 v108, s15, v18
 v_mov_b32 v109, 8192
 v_cmp_eq_u32 vcc, 4, v0
 v_mov_b32 v18, s16
 v_mov_b32 v19, 2048
 v_cndmask_b32 v108, v108, v18, vcc
 v_cndmask_b32 v109, v109, v19, vcc
 v_cmp_eq_u32 vcc, 5, v0
 v_mov_b32 v18, s31
 v_mov_b32 v19, 512
 v_cndmask_b32 v108, v108, v18, vcc
 v_cndmask_b32 v109, v109, v19, vcc
 s_mul_i32 s11, s9, 14
 v_subrev_u32 v18, 6, v0
 v_add_u32 v18, s11, v18
 v_lshlrev_b32 v18, 7, v18
 v_add_u32 v18, 0, v18
 v_mov_b32 v19, 28672
 v_cmp_le_u32 vcc, 6, v0
 s_nop 1
 v_cndmask_b32 v108, v108, v18, vcc
 v_cndmask_b32 v109, v109, v19, vcc
 s_lshl_b32 s11, s9, 2
 v_subrev_u32 v18, 20, v0
 v_add_u32 v18, s11, v18
 v_lshlrev_b32 v18, 7, v18
 v_add_u32 v18, 16784384, v18
 v_mov_b32 v19, 7168
 v_cmp_le_u32 vcc, 20, v0
 s_nop 1
 v_cndmask_b32 v108, v108, v18, vcc
 v_cndmask_b32 v109, v109, v19, vcc
 s_lshl_b32 s11, s9, 7
 s_add_u32 s11, s11, 18340096
 v_mov_b32 v18, s11
 v_mov_b32 v19, 256
 v_cmp_eq_u32 vcc, 24, v0
 s_nop 1
 v_cndmask_b32 v108, v108, v18, vcc
 v_cndmask_b32 v109, v109, v19, vcc
 s_mov_b32 s11, 0xfffff
 s_cmp_lt_u32 s9, 14
 s_cselect_b32 s12, 0xf00000, 0
 s_or_b32 s11, s11, s12
 s_cmp_lt_u32 s9, 2
 s_cselect_b32 s12, 0x1000000, 0
 s_or_b32 s11, s11, s12
 s_cmp_eq_u32 s8, 2
 s_cselect_b32 vcc_lo, s11, 0
 s_mov_b32 vcc_hi, 0
 v_mov_b32 v18, 0x7ffffff0
 v_cndmask_b32 v108, v18, v108, vcc
 v_cndmask_b32 v109, 0, v109, vcc
 buffer_load_dword v110, v108, s[4:7], 0 offen sc1
 v_add_u32 v108, v108, v109
 buffer_load_dword v110, v108, s[4:7], 0 offen sc1
 v_add_u32 v108, v108, v109
 s_mul_i32 s11, s9, 28672
 s_mul_i32 s12, s8, 7168
 s_add_u32 s11, s11, s12
 s_add_u32 s11, s11, 35520512
 v_lshlrev_b32 v18, 7, v0
 v_add_u32 v18, s11, v18
 v_cmp_gt_u32 vcc, 56, v0
 v_mov_b32 v19, 0x7ffffff0
 s_nop 0
 v_cndmask_b32 v114, v19, v18, vcc
 s_mov_b32 s28, 0
 s_min_u32 s11, s9, 6
 s_lshl_b32 s11, s11, 10
 v_add_u32 v115, s11, v1
 s_cmp_lt_u32 s9, 7
 s_cselect_b32 s12, 1, 0
 s_cmp_eq_u32 s8, 0
 s_cselect_b32 s12, s12, 0
 s_cmp_eq_u32 s12, 1
 s_cselect_b64 vcc, -1, 0
 v_mov_b32 v18, 0x7ffffff0
 v_cndmask_b32 v111, v18, v115, vcc
 s_mul_i32 s11, s9, 28
 s_lshl_b32 s12, s24, 1
 s_add_u32 s12, s12, s11
 s_mul_i32 s12, s12, 14336
 s_add_u32 s12, s12, 2097152
 s_lshl_b32 s13, s25, 1
 s_add_u32 s13, s13, s26
 s_add_u32 s13, s13, s11
 s_mul_i32 s13, s13, 14336
 s_add_u32 s13, s13, 2097152
 s_add_u32 s11, s12, 0
 buffer_load_dwordx4 v[120:123], v1, s[4:7], s11 offen nt
 buffer_load_dwordx4 v[124:127], v1, s[4:7], s11 offen offset:1024 nt
 s_add_u32 s11, s12, 2048
 buffer_load_dwordx4 v[128:131], v1, s[4:7], s11 offen nt
 buffer_load_dwordx4 v[132:135], v1, s[4:7], s11 offen offset:1024 nt
 s_add_u32 s11, s12, 4096
 buffer_load_dwordx4 v[136:139], v1, s[4:7], s11 offen nt
 buffer_load_dwordx4 v[140:143], v1, s[4:7], s11 offen offset:1024 nt
 s_add_u32 s11, s12, 6144
 buffer_load_dwordx4 v[144:147], v1, s[4:7], s11 offen nt
 buffer_load_dwordx4 v[148:151], v1, s[4:7], s11 offen offset:1024 nt
 s_add_u32 s11, s12, 8192
 buffer_load_dwordx4 v[152:155], v1, s[4:7], s11 offen nt
 buffer_load_dwordx4 v[156:159], v1, s[4:7], s11 offen offset:1024 nt
 s_add_u32 s11, s12, 10240
 buffer_load_dwordx4 v[160:163], v1, s[4:7], s11 offen nt
 buffer_load_dwordx4 v[164:167], v1, s[4:7], s11 offen offset:1024 nt
 s_add_u32 s11, s12, 12288
 buffer_load_dwordx4 v[168:171], v1, s[4:7], s11 offen nt
 buffer_load_dwordx4 v[172:175], v1, s[4:7], s11 offen offset:1024 nt
 s_add_u32 s11, s12, 14336
 buffer_load_dwordx4 v[176:179], v1, s[4:7], s11 offen nt
 buffer_load_dwordx4 v[180:183], v1, s[4:7], s11 offen offset:1024 nt
 s_add_u32 s11, s12, 16384
 buffer_load_dwordx4 v[184:187], v1, s[4:7], s11 offen nt
 buffer_load_dwordx4 v[188:191], v1, s[4:7], s11 offen offset:1024 nt
 s_add_u32 s11, s12, 18432
 buffer_load_dwordx4 v[192:195], v1, s[4:7], s11 offen nt
 buffer_load_dwordx4 v[196:199], v1, s[4:7], s11 offen offset:1024 nt
 s_add_u32 s11, s12, 20480
 buffer_load_dwordx4 v[200:203], v1, s[4:7], s11 offen nt
 buffer_load_dwordx4 v[204:207], v1, s[4:7], s11 offen offset:1024 nt
 s_add_u32 s11, s12, 22528
 buffer_load_dwordx4 v[208:211], v1, s[4:7], s11 offen nt
 buffer_load_dwordx4 v[212:215], v1, s[4:7], s11 offen offset:1024 nt
 s_add_u32 s11, s12, 24576
 buffer_load_dwordx4 v[216:219], v1, s[4:7], s11 offen nt
 buffer_load_dwordx4 v[220:223], v1, s[4:7], s11 offen offset:1024 nt
 s_add_u32 s11, s12, 26624
 buffer_load_dwordx4 v[224:227], v1, s[4:7], s11 offen nt
 buffer_load_dwordx4 v[228:231], v1, s[4:7], s11 offen offset:1024 nt
 s_add_u32 s11, s12, 28672
 buffer_load_dwordx4 v[232:235], v1, s[4:7], s11 offen nt
 buffer_load_dwordx4 v[236:239], v1, s[4:7], s11 offen offset:1024 nt
 s_add_u32 s11, s12, 30720
 buffer_load_dwordx4 v[240:243], v1, s[4:7], s11 offen nt
 buffer_load_dwordx4 v[244:247], v1, s[4:7], s11 offen offset:1024 nt
 s_add_u32 s11, s12, 32768
 buffer_load_dwordx4 v[248:251], v1, s[4:7], s11 offen nt
 buffer_load_dwordx4 v[252:255], v1, s[4:7], s11 offen offset:1024 nt
 s_add_u32 s11, s12, 34816
 buffer_load_dwordx4 a[0:3], v1, s[4:7], s11 offen nt
 buffer_load_dwordx4 a[4:7], v1, s[4:7], s11 offen offset:1024 nt
 s_add_u32 s11, s12, 36864
 buffer_load_dwordx4 a[8:11], v1, s[4:7], s11 offen nt
 buffer_load_dwordx4 a[12:15], v1, s[4:7], s11 offen offset:1024 nt
 s_add_u32 s11, s12, 38912
 buffer_load_dwordx4 a[16:19], v1, s[4:7], s11 offen nt
 buffer_load_dwordx4 a[20:23], v1, s[4:7], s11 offen offset:1024 nt
 s_add_u32 s11, s12, 40960
 buffer_load_dwordx4 a[24:27], v1, s[4:7], s11 offen nt
 buffer_load_dwordx4 a[28:31], v1, s[4:7], s11 offen offset:1024 nt
 s_add_u32 s11, s12, 43008
 buffer_load_dwordx4 a[32:35], v1, s[4:7], s11 offen nt
 buffer_load_dwordx4 a[36:39], v1, s[4:7], s11 offen offset:1024 nt
 s_add_u32 s11, s12, 45056
 buffer_load_dwordx4 a[40:43], v1, s[4:7], s11 offen nt
 buffer_load_dwordx4 a[44:47], v1, s[4:7], s11 offen offset:1024 nt
 s_add_u32 s11, s12, 47104
 buffer_load_dwordx4 a[48:51], v1, s[4:7], s11 offen nt
 buffer_load_dwordx4 a[52:55], v1, s[4:7], s11 offen offset:1024 nt
 s_add_u32 s11, s12, 49152
 buffer_load_dwordx4 a[56:59], v1, s[4:7], s11 offen nt
 buffer_load_dwordx4 a[60:63], v1, s[4:7], s11 offen offset:1024 nt
 s_add_u32 s11, s12, 51200
 buffer_load_dwordx4 a[64:67], v1, s[4:7], s11 offen nt
 buffer_load_dwordx4 a[68:71], v1, s[4:7], s11 offen offset:1024 nt
 s_add_u32 s11, s12, 53248
 buffer_load_dwordx4 a[72:75], v1, s[4:7], s11 offen nt
 buffer_load_dwordx4 a[76:79], v1, s[4:7], s11 offen offset:1024 nt
 s_add_u32 s11, s12, 55296
 buffer_load_dwordx4 a[80:83], v1, s[4:7], s11 offen nt
 buffer_load_dwordx4 a[84:87], v1, s[4:7], s11 offen offset:1024 nt
 s_add_u32 s11, s12, 57344
 buffer_load_dwordx4 a[88:91], v1, s[4:7], s11 offen nt
 buffer_load_dwordx4 a[92:95], v1, s[4:7], s11 offen offset:1024 nt
 s_add_u32 s11, s12, 59392
 buffer_load_dwordx4 a[96:99], v1, s[4:7], s11 offen nt
 buffer_load_dwordx4 a[100:103], v1, s[4:7], s11 offen offset:1024 nt
 s_add_u32 s11, s12, 61440
 buffer_load_dwordx4 a[104:107], v1, s[4:7], s11 offen nt
 buffer_load_dwordx4 a[108:111], v1, s[4:7], s11 offen offset:1024 nt
 s_add_u32 s11, s12, 63488
 buffer_load_dwordx4 a[112:115], v1, s[4:7], s11 offen nt
 buffer_load_dwordx4 a[116:119], v1, s[4:7], s11 offen offset:1024 nt
 s_add_u32 s11, s12, 65536
 buffer_load_dwordx4 a[120:123], v1, s[4:7], s11 offen nt
 buffer_load_dwordx4 a[124:127], v1, s[4:7], s11 offen offset:1024 nt
 s_add_u32 s11, s12, 67584
 buffer_load_dwordx4 a[128:131], v1, s[4:7], s11 offen nt
 buffer_load_dwordx4 a[132:135], v1, s[4:7], s11 offen offset:1024 nt
 s_add_u32 s11, s12, 69632
 buffer_load_dwordx4 a[136:139], v1, s[4:7], s11 offen nt
 buffer_load_dwordx4 a[140:143], v1, s[4:7], s11 offen offset:1024 nt
 s_add_u32 s11, s12, 71680
 buffer_load_dwordx4 a[144:147], v1, s[4:7], s11 offen nt
 buffer_load_dwordx4 a[148:151], v1, s[4:7], s11 offen offset:1024 nt
 s_add_u32 s11, s12, 73728
 buffer_load_dwordx4 a[152:155], v1, s[4:7], s11 offen nt
 buffer_load_dwordx4 a[156:159], v1, s[4:7], s11 offen offset:1024 nt
 s_add_u32 s11, s12, 75776
 buffer_load_dwordx4 a[160:163], v1, s[4:7], s11 offen nt
 buffer_load_dwordx4 a[164:167], v1, s[4:7], s11 offen offset:1024 nt
 s_add_u32 s11, s12, 77824
 buffer_load_dwordx4 a[168:171], v1, s[4:7], s11 offen nt
 buffer_load_dwordx4 a[172:175], v1, s[4:7], s11 offen offset:1024 nt
 s_add_u32 s11, s12, 79872
 buffer_load_dwordx4 a[176:179], v1, s[4:7], s11 offen nt
 buffer_load_dwordx4 a[180:183], v1, s[4:7], s11 offen offset:1024 nt
 s_add_u32 s11, s12, 81920
 buffer_load_dwordx4 a[184:187], v1, s[4:7], s11 offen nt
 buffer_load_dwordx4 a[188:191], v1, s[4:7], s11 offen offset:1024 nt
 s_add_u32 s11, s12, 83968
 buffer_load_dwordx4 a[192:195], v1, s[4:7], s11 offen nt
 buffer_load_dwordx4 a[196:199], v1, s[4:7], s11 offen offset:1024 nt
 s_add_u32 s11, s13, 0
 buffer_load_dwordx4 a[200:203], v1, s[4:7], s11 offen nt
 buffer_load_dwordx4 a[204:207], v1, s[4:7], s11 offen offset:1024 nt
 s_add_u32 s11, s13, 2048
 buffer_load_dwordx4 a[208:211], v1, s[4:7], s11 offen nt
 buffer_load_dwordx4 a[212:215], v1, s[4:7], s11 offen offset:1024 nt
 s_add_u32 s11, s13, 4096
 buffer_load_dwordx4 a[216:219], v1, s[4:7], s11 offen nt
 buffer_load_dwordx4 a[220:223], v1, s[4:7], s11 offen offset:1024 nt
 s_add_u32 s11, s13, 6144
 buffer_load_dwordx4 a[224:227], v1, s[4:7], s11 offen nt
 buffer_load_dwordx4 a[228:231], v1, s[4:7], s11 offen offset:1024 nt
 s_add_u32 s11, s13, 8192
 buffer_load_dwordx4 a[232:235], v1, s[4:7], s11 offen nt
 buffer_load_dwordx4 a[236:239], v1, s[4:7], s11 offen offset:1024 nt
 s_add_u32 s11, s13, 10240
 buffer_load_dwordx4 a[240:243], v1, s[4:7], s11 offen nt
 buffer_load_dwordx4 a[244:247], v1, s[4:7], s11 offen offset:1024 nt
 s_add_u32 s11, s13, 12288
 buffer_load_dwordx4 a[248:251], v1, s[4:7], s11 offen nt
 buffer_load_dwordx4 a[252:255], v1, s[4:7], s11 offen offset:1024 nt
 s_add_u32 s11, s27, 0
 s_mov_b32 m0, s11
 s_add_u32 s12, s17, 0
 s_add_u32 s13, s18, 0
 buffer_load_dwordx4 v1, s[4:7], s12 offen offset:0 lds
 buffer_load_dwordx4 v1, s[4:7], s12 offen offset:1024 lds
 buffer_load_dwordx4 v1, s[4:7], s12 offen offset:2048 lds
 buffer_load_dwordx4 v1, s[4:7], s13 offen offset:3072 lds
 s_add_u32 s11, s27, 4096
 s_mov_b32 m0, s11
 s_add_u32 s12, s17, 14336
 s_add_u32 s13, s18, 14336
 buffer_load_dwordx4 v1, s[4:7], s12 offen offset:0 lds
 buffer_load_dwordx4 v1, s[4:7], s12 offen offset:1024 lds
 buffer_load_dwordx4 v1, s[4:7], s12 offen offset:2048 lds
 buffer_load_dwordx4 v1, s[4:7], s13 offen offset:3072 lds
 s_add_u32 s17, s17, 28672
 s_add_u32 s18, s18, 28672
 s_mov_b32 s10, 0
 v_mov_b64 v[44:45], 0
 v_mov_b64 v[46:47], 0
 v_mov_b64 v[48:49], 0
 v_mov_b64 v[50:51], 0
 v_mov_b64 v[52:53], 0
 v_mov_b64 v[54:55], 0
 s_waitcnt vmcnt(0) lgkmcnt(0)
L_A_loop_30:
 s_cmp_lg_u32 s8, 3
 s_cbranch_scc1 L_A_nofetch_32
 s_cmp_eq_u32 s10, 0
 s_cbranch_scc1 L_A_fetch_31
 s_mov_b32 exec_lo, 0xffffffff
 s_mov_b32 exec_hi, 0xffffff
 s_mov_b32 s19, 0
 buffer_load_dword v64, v2, s[4:7], s30 offen sc1
 s_nop 15
 s_nop 3
 buffer_load_dword v65, v2, s[4:7], s30 offen sc1
 s_nop 15
 s_nop 3
 buffer_load_dword v66, v2, s[4:7], s30 offen sc1
L_pwA_34:
 s_waitcnt vmcnt(2)
 v_cmp_eq_u32 vcc, -1, v64
 s_cbranch_vccz L_pwA_34_ok
 buffer_load_dword v64, v2, s[4:7], s30 offen sc1
 s_waitcnt vmcnt(2)
 v_cmp_eq_u32 vcc, -1, v65
 s_cbranch_vccz L_pwA_34_ok
 buffer_load_dword v65, v2, s[4:7], s30 offen sc1
 s_waitcnt vmcnt(2)
 v_cmp_eq_u32 vcc, -1, v66
 s_cbranch_vccz L_pwA_34_ok
 buffer_load_dword v66, v2, s[4:7], s30 offen sc1
 s_add_u32 s19, s19, 1
 s_cmp_le_u32 s19, 8192
 s_cbranch_scc1 L_pwA_34
 s_mov_b32 s72, 1
 s_branch K_fail
L_pwA_34_ok:
 s_mov_b64 exec, -1
L_A_fetch_31:
 s_cmp_lg_u32 s8, 3
 s_cbranch_scc1 L_A_nofetch_32
 s_mov_b32 m0, 0
 s_add_u32 s11, s14, 4096
 buffer_load_dwordx4 v1, s[4:7], s14 offen offset:0 sc1 lds
 buffer_load_dwordx4 v1, s[4:7], s14 offen offset:1024 sc1 lds
 buffer_load_dwordx4 v1, s[4:7], s14 offen offset:2048 sc1 lds
 buffer_load_dwordx4 v1, s[4:7], s14 offen offset:3072 sc1 lds
 s_mov_b32 m0, 4096
 s_nop 0
 buffer_load_dwordx4 v1, s[4:7], s11 offen offset:0 sc1 lds
 buffer_load_dwordx4 v1, s[4:7], s11 offen offset:1024 sc1 lds
 buffer_load_dwordx4 v1, s[4:7], s11 offen offset:2048 sc1 lds
L_A_nofetch_32:
 s_waitcnt vmcnt(0)
 s_barrier
 ds_read_b128 v[16:19], v1 offset:0
 ds_read_b128 v[20:23], v1 offset:1024
 ds_read_b128 v[24:27], v1 offset:2048
 s_waitcnt lgkmcnt(2)
 v_smfmac_f32_16x16x64_bf16 v[44:47], v[16:19], a[200:207], v5
 ds_read_b128 v[28:31], v1 offset:3072
 v_smfmac_f32_16x16x64_bf16 v[48:51], v[16:19], v[120:127], v5
 ds_read_b128 v[32:35], v1 offset:4096
 s_waitcnt lgkmcnt(3)
 v_smfmac_f32_16x16x64_bf16 v[44:47], v[20:23], a[208:215], v5
 ds_read_b128 v[36:39], v1 offset:5120
 v_smfmac_f32_16x16x64_bf16 v[48:51], v[20:23], v[128:135], v5
 ds_read_b128 v[40:43], v1 offset:6144
 s_waitcnt lgkmcnt(4)
 v_smfmac_f32_16x16x64_bf16 v[44:47], v[24:27], a[216:223], v5
 ds_read2_b32 v[68:69], v10 offset0:0 offset1:32
 v_smfmac_f32_16x16x64_bf16 v[48:51], v[24:27], v[136:143], v5
 ds_read2_b32 v[70:71], v10 offset0:1 offset1:33
 s_waitcnt lgkmcnt(5)
 v_smfmac_f32_16x16x64_bf16 v[44:47], v[28:31], a[224:231], v5
 ds_read_b128 v[72:75], v6 offset:3072
 v_smfmac_f32_16x16x64_bf16 v[48:51], v[28:31], v[144:151], v5
 ds_read_b128 v[76:79], v6 offset:7168
 s_waitcnt lgkmcnt(6)
 v_smfmac_f32_16x16x64_bf16 v[44:47], v[32:35], a[232:239], v5
 ds_read2_b32 v[80:81], v8 offset0:0 offset1:32
 v_smfmac_f32_16x16x64_bf16 v[48:51], v[32:35], v[152:159], v5
 ds_read2_b32 v[82:83], v8 offset0:1 offset1:33
 s_waitcnt lgkmcnt(7)
 v_smfmac_f32_16x16x64_bf16 v[44:47], v[36:39], a[240:247], v5
 ds_read_b128 v[84:87], v6 offset:0
 v_smfmac_f32_16x16x64_bf16 v[48:51], v[36:39], v[160:167], v5
 ds_read_b128 v[88:91], v6 offset:4096
 s_waitcnt lgkmcnt(8)
 v_smfmac_f32_16x16x64_bf16 v[44:47], v[40:43], a[248:255], v5
 ds_read_b128 v[116:119], v115 offset:0
 v_smfmac_f32_16x16x64_bf16 v[48:51], v[40:43], v[168:175], v5
 buffer_load_dword v110, v108, s[4:7], 0 offen sc1
 v_smfmac_f32_16x16x64_bf16 v[52:55], v[16:19], v[176:183], v5
 v_cvt_pk_bf16_f32 v56, v44, v45
 v_smfmac_f32_16x16x64_bf16 v[52:55], v[20:23], v[184:191], v5
 v_cvt_pk_bf16_f32 v57, v46, v47
 v_smfmac_f32_16x16x64_bf16 v[52:55], v[24:27], v[192:199], v5
 v_mov_b64 v[44:45], 0
 v_mfma_f32_16x16x32_bf16 v[60:63], v[56:59], v[104:107], 0
 v_mov_b64 v[46:47], 0
 v_cvt_pk_bf16_f32 v56, v48, v49
 v_smfmac_f32_16x16x64_bf16 v[52:55], v[28:31], v[200:207], v5
 v_cvt_pk_bf16_f32 v57, v50, v51
 v_smfmac_f32_16x16x64_bf16 v[52:55], v[32:35], v[208:215], v5
 s_waitcnt lgkmcnt(0)
 s_add_u32 s29, s14, 458752
 buffer_store_dwordx4 v[116:119], v111, s[4:7], s29 offen sc1
 v_cvt_pk_bf16_f32 v112, v60, v61
 v_smfmac_f32_16x16x64_bf16 v[52:55], v[36:39], v[216:223], v5
 v_cvt_pk_bf16_f32 v113, v62, v63
 v_smfmac_f32_16x16x64_bf16 v[52:55], v[40:43], v[224:231], v5
 v_cndmask_b32 v64, 0, v112, s[36:37]
 v_smfmac_f32_16x16x64_bf16 v[44:47], v[16:19], v[232:239], v5
 v_cndmask_b32 v65, 0, v112, s[38:39]
 v_smfmac_f32_16x16x64_bf16 v[44:47], v[20:23], v[240:247], v5
 v_cndmask_b32 v66, 0, v113, s[36:37]
 v_smfmac_f32_16x16x64_bf16 v[44:47], v[24:27], v[248:255], v5
 v_cndmask_b32 v67, 0, v113, s[38:39]
 v_smfmac_f32_16x16x64_bf16 v[44:47], v[28:31], a[0:7], v5
 v_mov_b64 v[48:49], 0
 v_mfma_f32_16x16x32_bf16 v[92:95], v[68:71], v[64:67], 0
 v_mov_b64 v[50:51], 0
 v_cvt_pk_bf16_f32 v58, v52, v53
 v_mfma_f32_16x16x32_bf16 v[96:99], v[72:75], v[64:67], 0
 v_cvt_pk_bf16_f32 v59, v54, v55
 v_mov_b64 v[52:53], 0
 v_mfma_f32_16x16x32_bf16 v[100:103], v[76:79], v[64:67], 0
 ds_read2_b32 v[68:69], v8 offset0:128 offset1:160
 v_mov_b64 v[54:55], 0
 v_max3_u32 v4, v16, v17, v18
 v_mfma_f32_16x16x32_bf16 v[60:63], v[56:59], v[104:107], 0
 ds_read2_b32 v[70:71], v8 offset0:129 offset1:161
 v_max_u32 v4, v4, v19
 v_max3_u32 v4, v4, v20, v21
 v_smfmac_f32_16x16x64_bf16 v[44:47], v[32:35], a[8:15], v5
 ds_read_b128 v[72:75], v6 offset:1024
 v_max3_u32 v4, v4, v22, v23
 v_smfmac_f32_16x16x64_bf16 v[44:47], v[36:39], a[16:23], v5
 ds_read_b128 v[76:79], v6 offset:5120
 v_cvt_pk_bf16_f32 v64, v60, v61
 v_smfmac_f32_16x16x64_bf16 v[44:47], v[40:43], a[24:31], v5
 v_cvt_pk_bf16_f32 v66, v62, v63
 v_smfmac_f32_16x16x64_bf16 v[48:51], v[16:19], a[32:39], v5
 v_mov_b32_dpp v65, v64 row_ror:8 row_mask:0xf bank_mask:0xf
 v_smfmac_f32_16x16x64_bf16 v[48:51], v[20:23], a[40:47], v5
 v_mov_b32_dpp v67, v66 row_ror:8 row_mask:0xf bank_mask:0xf
 v_smfmac_f32_16x16x64_bf16 v[48:51], v[24:27], a[48:55], v5
 v_cvt_pk_bf16_f32 v56, v44, v45
 v_mfma_f32_16x16x32_bf16 v[92:95], v[80:83], v[64:67], v[92:95]
 v_cvt_pk_bf16_f32 v57, v46, v47
 v_mov_b64 v[44:45], 0
 v_mfma_f32_16x16x32_bf16 v[96:99], v[84:87], v[64:67], v[96:99]
 v_mov_b64 v[46:47], 0
 v_max3_u32 v4, v4, v24, v25
 v_mfma_f32_16x16x32_bf16 v[100:103], v[88:91], v[64:67], v[100:103]
 ds_read2_b32 v[80:81], v9 offset0:0 offset1:32
 v_max3_u32 v4, v4, v26, v27
 v_max3_u32 v4, v4, v28, v29
 v_smfmac_f32_16x16x64_bf16 v[48:51], v[28:31], a[56:63], v5
 ds_read2_b32 v[82:83], v9 offset0:1 offset1:33
 v_max3_u32 v4, v4, v30, v31
 v_smfmac_f32_16x16x64_bf16 v[48:51], v[32:35], a[64:71], v5
 ds_read_b128 v[84:87], v6 offset:2048
 v_max3_u32 v4, v4, v32, v33
 v_smfmac_f32_16x16x64_bf16 v[48:51], v[36:39], a[72:79], v5
 ds_read_b128 v[88:91], v6 offset:6144
 v_max3_u32 v4, v4, v34, v35
 v_smfmac_f32_16x16x64_bf16 v[48:51], v[40:43], a[80:87], v5
 v_max3_u32 v4, v4, v36, v37
 v_smfmac_f32_16x16x64_bf16 v[52:55], v[16:19], a[88:95], v5
 v_max3_u32 v4, v4, v38, v39
 v_smfmac_f32_16x16x64_bf16 v[52:55], v[20:23], a[96:103], v5
 v_cvt_pk_bf16_f32 v58, v48, v49
 v_smfmac_f32_16x16x64_bf16 v[52:55], v[24:27], a[104:111], v5
 v_cvt_pk_bf16_f32 v59, v50, v51
 v_smfmac_f32_16x16x64_bf16 v[52:55], v[28:31], a[112:119], v5
 v_max3_u32 v4, v4, v40, v41
 v_mfma_f32_16x16x32_bf16 v[60:63], v[56:59], v[104:107], 0
 v_max3_u32 v4, v4, v42, v43
 v_cmp_eq_u32 vcc, -1, v4
 v_smfmac_f32_16x16x64_bf16 v[52:55], v[32:35], a[120:127], v5
 v_smfmac_f32_16x16x64_bf16 v[52:55], v[36:39], a[128:135], v5
 v_cvt_pk_bf16_f32 v64, v60, v61
 v_smfmac_f32_16x16x64_bf16 v[52:55], v[40:43], a[136:143], v5
 v_cvt_pk_bf16_f32 v66, v62, v63
 v_smfmac_f32_16x16x64_bf16 v[44:47], v[16:19], a[144:151], v5
 v_mov_b32_dpp v65, v64 row_ror:8 row_mask:0xf bank_mask:0xf
 v_smfmac_f32_16x16x64_bf16 v[44:47], v[20:23], a[152:159], v5
 v_mov_b32_dpp v67, v66 row_ror:8 row_mask:0xf bank_mask:0xf
 v_smfmac_f32_16x16x64_bf16 v[44:47], v[24:27], a[160:167], v5
 v_cvt_pk_bf16_f32 v56, v52, v53
 s_waitcnt lgkmcnt(4)
 v_mfma_f32_16x16x32_bf16 v[92:95], v[68:71], v[64:67], v[92:95]
 v_cvt_pk_bf16_f32 v57, v54, v55
 v_mfma_f32_16x16x32_bf16 v[96:99], v[72:75], v[64:67], v[96:99]
 v_mfma_f32_16x16x32_bf16 v[100:103], v[76:79], v[64:67], v[100:103]
 s_cbranch_vccnz L_A_retry_33
 v_smfmac_f32_16x16x64_bf16 v[44:47], v[28:31], a[168:175], v5
 v_add_u32 v108, v108, v109
 v_smfmac_f32_16x16x64_bf16 v[44:47], v[32:35], a[176:183], v5
 v_smfmac_f32_16x16x64_bf16 v[44:47], v[36:39], a[184:191], v5
 v_smfmac_f32_16x16x64_bf16 v[44:47], v[40:43], a[192:199], v5
 s_nop 7
 v_cvt_pk_bf16_f32 v58, v44, v45
 v_cvt_pk_bf16_f32 v59, v46, v47
 s_nop 1
 v_mfma_f32_16x16x32_bf16 v[60:63], v[56:59], v[104:107], 0
 s_nop 7
 v_cvt_pk_bf16_f32 v64, v60, v61
 v_cvt_pk_bf16_f32 v66, v62, v63
 s_nop 0
 v_mov_b32_dpp v65, v64 row_ror:8 row_mask:0xf bank_mask:0xf
 v_mov_b32_dpp v67, v66 row_ror:8 row_mask:0xf bank_mask:0xf
 s_nop 1
 s_waitcnt lgkmcnt(0)
 v_mfma_f32_16x16x32_bf16 v[92:95], v[80:83], v[64:67], v[92:95]
 v_mfma_f32_16x16x32_bf16 v[96:99], v[84:87], v[64:67], v[96:99]
 v_mfma_f32_16x16x32_bf16 v[100:103], v[88:91], v[64:67], v[100:103]
 s_nop 7
 s_mov_b64 exec, s[20:21]
 ds_write_b128 v11, v[92:95] offset:0
 ds_write_b128 v11, v[96:99] offset:640
 ds_write_b128 v11, v[100:103] offset:1280
 s_mov_b64 exec, -1
 v_mov_b64 v[44:45], 0
 v_mov_b64 v[46:47], 0
 v_mov_b64 v[48:49], 0
 v_mov_b64 v[50:51], 0
 v_mov_b64 v[52:53], 0
 v_mov_b64 v[54:55], 0
 s_waitcnt lgkmcnt(0)
 s_barrier
 s_cmp_ge_u32 s8, 2
 s_cbranch_scc1 L_A_nosm_35
 ds_read_b64 v[16:17], v12 offset:0
 ds_read_b64 v[24:25], v13 offset:0
 ds_read_b64 v[18:19], v12 offset:2048
 ds_read_b64 v[26:27], v13 offset:2048
 ds_read_b64 v[20:21], v12 offset:4096
 ds_read_b64 v[28:29], v13 offset:4096
 ds_read_b64 v[22:23], v12 offset:6144
 ds_read_b64 v[30:31], v13 offset:6144
 s_waitcnt lgkmcnt(4)
 v_pk_add_f32 v[16:17], v[16:17], v[18:19]
 v_pk_add_f32 v[24:25], v[24:25], v[26:27]
 s_waitcnt lgkmcnt(0)
 v_pk_add_f32 v[20:21], v[20:21], v[22:23]
 v_pk_add_f32 v[28:29], v[28:29], v[30:31]
 v_pk_add_f32 v[16:17], v[16:17], v[20:21]
 v_pk_add_f32 v[24:25], v[24:25], v[28:29]
 v_max_f32 v32, v16, v17
 v_max3_f32 v32, v32, v24, v25
 s_nop 1
 v_max_f32_dpp v32, v32, v32 quad_perm:[1,0,3,2] row_mask:0xf bank_mask:0xf
 s_nop 1
 v_max_f32_dpp v32, v32, v32 quad_perm:[2,3,0,1] row_mask:0xf bank_mask:0xf
 s_nop 1
 v_max_f32_dpp v32, v32, v32 row_half_mirror row_mask:0xf bank_mask:0xf
 s_nop 1
 v_max_f32_dpp v32, v32, v32 row_mirror row_mask:0xf bank_mask:0xf
 buffer_store_dword v0, v3, s[4:7], s31 offen sc1
 v_sub_f32 v16, v16, v32
 v_sub_f32 v17, v17, v32
 v_sub_f32 v24, v24, v32
 v_sub_f32 v25, v25, v32
 v_exp_f32 v16, v16
 v_exp_f32 v17, v17
 v_exp_f32 v24, v24
 v_exp_f32 v25, v25
 s_nop 0
 v_add_f32 v32, v16, v17
 v_add_f32 v33, v24, v25
 v_add_f32 v32, v32, v33
 s_nop 1
 v_add_f32_dpp v32, v32, v32 quad_perm:[1,0,3,2] row_mask:0xf bank_mask:0xf
 s_nop 1
 v_add_f32_dpp v32, v32, v32 quad_perm:[2,3,0,1] row_mask:0xf bank_mask:0xf
 s_nop 1
 v_add_f32_dpp v32, v32, v32 row_half_mirror row_mask:0xf bank_mask:0xf
 s_nop 1
 v_add_f32_dpp v32, v32, v32 row_mirror row_mask:0xf bank_mask:0xf
 v_rcp_f32 v32, v32
 s_nop 0
 v_pk_mul_f32 v[16:17], v[16:17], v[32:33] op_sel_hi:[1,0]
 v_pk_mul_f32 v[24:25], v[24:25], v[32:33] op_sel_hi:[1,0]
 v_cvt_pk_bf16_f32 v16, v16, v17
 v_cvt_pk_bf16_f32 v24, v24, v25
 v_min_u32 v16, -2, v16
 v_min_u32 v24, -2, v24
 buffer_store_dword v16, v14, s[4:7], s15 offen sc1
 s_mov_b64 exec, s[22:23]
 buffer_store_dword v24, v15, s[4:7], s16 offen sc1
 s_mov_b64 exec, -1
L_A_nosm_35:
 s_barrier
 s_add_u32 s10, s10, 1
 s_cmp_ge_u32 s10, 63
 s_cbranch_scc1 K_done
 s_add_u32 s11, s27, 0
 s_mov_b32 m0, s11
 s_add_u32 s12, s17, 0
 s_add_u32 s13, s18, 0
 buffer_load_dwordx4 v1, s[4:7], s12 offen offset:0 lds
 buffer_load_dwordx4 v1, s[4:7], s12 offen offset:1024 lds
 buffer_load_dwordx4 v1, s[4:7], s12 offen offset:2048 lds
 buffer_load_dwordx4 v1, s[4:7], s13 offen offset:3072 lds
 s_add_u32 s11, s27, 4096
 s_mov_b32 m0, s11
 s_add_u32 s12, s17, 14336
 s_add_u32 s13, s18, 14336
 buffer_load_dwordx4 v1, s[4:7], s12 offen offset:0 lds
 buffer_load_dwordx4 v1, s[4:7], s12 offen offset:1024 lds
 buffer_load_dwordx4 v1, s[4:7], s12 offen offset:2048 lds
 buffer_load_dwordx4 v1, s[4:7], s13 offen offset:3072 lds
 s_add_u32 s17, s17, 28672
 s_add_u32 s18, s18, 28672
 s_add_u32 s14, s14, 7168
 s_add_u32 s15, s15, 8192
 s_add_u32 s16, s16, 2048
 s_add_u32 s30, s30, 256
 s_add_u32 s31, s31, 512
 s_branch L_A_loop_30
L_A_retry_33:
 s_mov_b32 s72, 4
 s_add_u32 s19, s19, 1
 s_cmp_gt_u32 s19, 8192
 s_cbranch_scc1 K_fail
 s_add_u32 s70, s70, 1
 s_waitcnt lgkmcnt(0)
 s_nop 7
 v_mov_b64 v[44:45], 0
 v_mov_b64 v[46:47], 0
 v_mov_b64 v[48:49], 0
 v_mov_b64 v[50:51], 0
 v_mov_b64 v[52:53], 0
 v_mov_b64 v[54:55], 0
 v_mov_b64 v[56:57], 0
 v_mov_b64 v[58:59], 0
 s_barrier
 s_branch L_A_fetch_31
K_slowB:
 s_sub_u32 s9, s9, 16
 v_lshlrev_b32 v1, 4, v0
 v_lshlrev_b32 v2, 2, v0
 v_and_b32 v4, 8, v0
 v_cmp_ne_u32 vcc, 0, v4
 v_mov_b32 v5, 0x4444
 v_mov_b32 v4, 0xeeee
 v_cndmask_b32 v5, v5, v4, vcc
 v_and_b32 v16, 15, v0
 v_lshrrev_b32 v17, 4, v0
 s_mul_i32 s11, s8, 14336
 s_add_u32 s27, s11, 8192
 v_add_u32 v6, s27, v1
 v_mov_b32 v13, 0
 s_lshl_b32 s12, s9, 1
 s_lshl_b32 s11, s8, 13
 s_add_u32 s26, s11, 65536
 v_add_u32 v7, s26, v1
 v_lshrrev_b32 v18, 5, v0
 v_bfe_u32 v19, v0, 3, 1
 v_lshl_add_u32 v18, v18, 1, v19
 s_lshl_b32 s11, s8, 2
 v_add_u32 v18, s11, v18
 v_lshlrev_b32 v18, 7, v18
 v_and_b32 v19, 7, v0
 v_lshl_add_u32 v8, v19, 4, v18
 v_mov_b32 v14, v1
 v_mul_u32_u24 v18, 272, v17
 v_lshl_add_u32 v18, v16, 4, v18
 s_mul_i32 s11, s8, 1280
 s_add_u32 s11, s11, 131072
 v_add_u32 v9, s11, v18
 v_lshrrev_b32 v18, 5, v0
 v_bfe_u32 v19, v0, 4, 1
 v_lshl_add_u32 v18, v18, 1, v19
 v_mul_u32_u24 v18, 272, v18
 v_and_b32 v19, 3, v0
 v_lshl_add_u32 v18, v19, 5, v18
 v_bfe_u32 v19, v0, 2, 2
 v_lshl_add_u32 v18, v19, 2, v18
 s_lshl_b32 s11, s8, 7
 s_add_u32 s11, s11, 131072
 v_add_u32 v10, s11, v18
 v_add_u32 v11, 16, v10
 s_lshl_b32 s11, s9, 9
 s_lshl_b32 s13, s8, 8
 s_add_u32 s11, s11, s13
 v_lshlrev_b32 v18, 2, v0
 v_add_u32 v12, s11, v18
 s_lshl_b32 s11, s9, 2
 s_add_u32 s11, s11, s8
 s_lshl_b32 s11, s11, 2
 v_cmp_eq_u32 vcc, 0, v0
 v_mov_b32 v18, s11
 v_mov_b32 v19, 0x7ffffff0
 v_cndmask_b32 v3, v19, v18, vcc
 s_mov_b32 s14, 16777216
 s_mov_b32 s30, 18339840
 s_lshl_b32 s11, s8, 7
 s_add_u32 s31, s11, 18361344
 s_lshl_b32 s11, s8, 11
 s_add_u32 s15, s11, 17694720
 s_mov_b32 s16, 18210816
 s_mul_i32 s11, s8, 112
 s_add_u32 s11, s11, s12
 s_lshl_b32 s11, s11, 10
 s_add_u32 s17, s11, 34603008
 s_mul_i32 s11, s8, 112
 s_add_u32 s11, s11, s12
 s_mul_i32 s11, s11, 14336
 s_add_u32 s13, s11, 9437184
 s_add_u32 s11, s13, 0
 buffer_load_dwordx4 v[120:123], v1, s[4:7], s11 offen nt
 buffer_load_dwordx4 v[124:127], v1, s[4:7], s11 offen offset:1024 nt
 s_add_u32 s11, s13, 2048
 buffer_load_dwordx4 v[128:131], v1, s[4:7], s11 offen nt
 buffer_load_dwordx4 v[132:135], v1, s[4:7], s11 offen offset:1024 nt
 s_add_u32 s11, s13, 4096
 buffer_load_dwordx4 v[136:139], v1, s[4:7], s11 offen nt
 buffer_load_dwordx4 v[140:143], v1, s[4:7], s11 offen offset:1024 nt
 s_add_u32 s11, s13, 6144
 buffer_load_dwordx4 v[144:147], v1, s[4:7], s11 offen nt
 buffer_load_dwordx4 v[148:151], v1, s[4:7], s11 offen offset:1024 nt
 s_add_u32 s11, s13, 8192
 buffer_load_dwordx4 v[152:155], v1, s[4:7], s11 offen nt
 buffer_load_dwordx4 v[156:159], v1, s[4:7], s11 offen offset:1024 nt
 s_add_u32 s11, s13, 10240
 buffer_load_dwordx4 v[160:163], v1, s[4:7], s11 offen nt
 buffer_load_dwordx4 v[164:167], v1, s[4:7], s11 offen offset:1024 nt
 s_add_u32 s11, s13, 12288
 buffer_load_dwordx4 v[168:171], v1, s[4:7], s11 offen nt
 buffer_load_dwordx4 v[172:175], v1, s[4:7], s11 offen offset:1024 nt
 s_add_u32 s11, s13, 14336
 buffer_load_dwordx4 v[176:179], v1, s[4:7], s11 offen nt
 buffer_load_dwordx4 v[180:183], v1, s[4:7], s11 offen offset:1024 nt
 s_add_u32 s11, s13, 16384
 buffer_load_dwordx4 v[184:187], v1, s[4:7], s11 offen nt
 buffer_load_dwordx4 v[188:191], v1, s[4:7], s11 offen offset:1024 nt
 s_add_u32 s11, s13, 18432
 buffer_load_dwordx4 v[192:195], v1, s[4:7], s11 offen nt
 buffer_load_dwordx4 v[196:199], v1, s[4:7], s11 offen offset:1024 nt
 s_add_u32 s11, s13, 20480
 buffer_load_dwordx4 v[200:203], v1, s[4:7], s11 offen nt
 buffer_load_dwordx4 v[204:207], v1, s[4:7], s11 offen offset:1024 nt
 s_add_u32 s11, s13, 22528
 buffer_load_dwordx4 v[208:211], v1, s[4:7], s11 offen nt
 buffer_load_dwordx4 v[212:215], v1, s[4:7], s11 offen offset:1024 nt
 s_add_u32 s11, s13, 24576
 buffer_load_dwordx4 v[216:219], v1, s[4:7], s11 offen nt
 buffer_load_dwordx4 v[220:223], v1, s[4:7], s11 offen offset:1024 nt
 s_add_u32 s11, s13, 26624
 buffer_load_dwordx4 v[224:227], v1, s[4:7], s11 offen nt
 buffer_load_dwordx4 v[228:231], v1, s[4:7], s11 offen offset:1024 nt
 s_add_u32 s11, s13, 401408
 buffer_load_dwordx4 v[232:235], v1, s[4:7], s11 offen nt
 buffer_load_dwordx4 v[236:239], v1, s[4:7], s11 offen offset:1024 nt
 s_add_u32 s11, s13, 403456
 buffer_load_dwordx4 v[240:243], v1, s[4:7], s11 offen nt
 buffer_load_dwordx4 v[244:247], v1, s[4:7], s11 offen offset:1024 nt
 s_add_u32 s11, s13, 405504
 buffer_load_dwordx4 v[248:251], v1, s[4:7], s11 offen nt
 buffer_load_dwordx4 v[252:255], v1, s[4:7], s11 offen offset:1024 nt
 s_add_u32 s11, s13, 407552
 buffer_load_dwordx4 a[0:3], v1, s[4:7], s11 offen nt
 buffer_load_dwordx4 a[4:7], v1, s[4:7], s11 offen offset:1024 nt
 s_add_u32 s11, s13, 409600
 buffer_load_dwordx4 a[8:11], v1, s[4:7], s11 offen nt
 buffer_load_dwordx4 a[12:15], v1, s[4:7], s11 offen offset:1024 nt
 s_add_u32 s11, s13, 411648
 buffer_load_dwordx4 a[16:19], v1, s[4:7], s11 offen nt
 buffer_load_dwordx4 a[20:23], v1, s[4:7], s11 offen offset:1024 nt
 s_add_u32 s11, s13, 413696
 buffer_load_dwordx4 a[24:27], v1, s[4:7], s11 offen nt
 buffer_load_dwordx4 a[28:31], v1, s[4:7], s11 offen offset:1024 nt
 s_add_u32 s11, s13, 415744
 buffer_load_dwordx4 a[32:35], v1, s[4:7], s11 offen nt
 buffer_load_dwordx4 a[36:39], v1, s[4:7], s11 offen offset:1024 nt
 s_add_u32 s11, s13, 417792
 buffer_load_dwordx4 a[40:43], v1, s[4:7], s11 offen nt
 buffer_load_dwordx4 a[44:47], v1, s[4:7], s11 offen offset:1024 nt
 s_add_u32 s11, s13, 419840
 buffer_load_dwordx4 a[48:51], v1, s[4:7], s11 offen nt
 buffer_load_dwordx4 a[52:55], v1, s[4:7], s11 offen offset:1024 nt
 s_add_u32 s11, s13, 421888
 buffer_load_dwordx4 a[56:59], v1, s[4:7], s11 offen nt
 buffer_load_dwordx4 a[60:63], v1, s[4:7], s11 offen offset:1024 nt
 s_add_u32 s11, s13, 423936
 buffer_load_dwordx4 a[64:67], v1, s[4:7], s11 offen nt
 buffer_load_dwordx4 a[68:71], v1, s[4:7], s11 offen offset:1024 nt
 s_add_u32 s11, s13, 425984
 buffer_load_dwordx4 a[72:75], v1, s[4:7], s11 offen nt
 buffer_load_dwordx4 a[76:79], v1, s[4:7], s11 offen offset:1024 nt
 s_add_u32 s11, s13, 428032
 buffer_load_dwordx4 a[80:83], v1, s[4:7], s11 offen nt
 buffer_load_dwordx4 a[84:87], v1, s[4:7], s11 offen offset:1024 nt
 s_add_u32 s11, s13, 802816
 buffer_load_dwordx4 a[88:91], v1, s[4:7], s11 offen nt
 buffer_load_dwordx4 a[92:95], v1, s[4:7], s11 offen offset:1024 nt
 s_add_u32 s11, s13, 804864
 buffer_load_dwordx4 a[96:99], v1, s[4:7], s11 offen nt
 buffer_load_dwordx4 a[100:103], v1, s[4:7], s11 offen offset:1024 nt
 s_add_u32 s11, s13, 806912
 buffer_load_dwordx4 a[104:107], v1, s[4:7], s11 offen nt
 buffer_load_dwordx4 a[108:111], v1, s[4:7], s11 offen offset:1024 nt
 s_add_u32 s11, s13, 808960
 buffer_load_dwordx4 a[112:115], v1, s[4:7], s11 offen nt
 buffer_load_dwordx4 a[116:119], v1, s[4:7], s11 offen offset:1024 nt
 s_add_u32 s11, s13, 811008
 buffer_load_dwordx4 a[120:123], v1, s[4:7], s11 offen nt
 buffer_load_dwordx4 a[124:127], v1, s[4:7], s11 offen offset:1024 nt
 s_add_u32 s11, s13, 813056
 buffer_load_dwordx4 a[128:131], v1, s[4:7], s11 offen nt
 buffer_load_dwordx4 a[132:135], v1, s[4:7], s11 offen offset:1024 nt
 s_add_u32 s11, s13, 815104
 buffer_load_dwordx4 a[136:139], v1, s[4:7], s11 offen nt
 buffer_load_dwordx4 a[140:143], v1, s[4:7], s11 offen offset:1024 nt
 s_add_u32 s11, s13, 817152
 buffer_load_dwordx4 a[144:147], v1, s[4:7], s11 offen nt
 buffer_load_dwordx4 a[148:151], v1, s[4:7], s11 offen offset:1024 nt
 s_add_u32 s11, s13, 819200
 buffer_load_dwordx4 a[152:155], v1, s[4:7], s11 offen nt
 buffer_load_dwordx4 a[156:159], v1, s[4:7], s11 offen offset:1024 nt
 s_add_u32 s11, s13, 821248
 buffer_load_dwordx4 a[160:163], v1, s[4:7], s11 offen nt
 buffer_load_dwordx4 a[164:167], v1, s[4:7], s11 offen offset:1024 nt
 s_add_u32 s11, s13, 823296
 buffer_load_dwordx4 a[168:171], v1, s[4:7], s11 offen nt
 buffer_load_dwordx4 a[172:175], v1, s[4:7], s11 offen offset:1024 nt
 s_add_u32 s11, s13, 825344
 buffer_load_dwordx4 a[176:179], v1, s[4:7], s11 offen nt
 buffer_load_dwordx4 a[180:183], v1, s[4:7], s11 offen offset:1024 nt
 s_add_u32 s11, s13, 827392
 buffer_load_dwordx4 a[184:187], v1, s[4:7], s11 offen nt
 buffer_load_dwordx4 a[188:191], v1, s[4:7], s11 offen offset:1024 nt
 s_add_u32 s11, s13, 829440
 buffer_load_dwordx4 a[192:195], v1, s[4:7], s11 offen nt
 buffer_load_dwordx4 a[196:199], v1, s[4:7], s11 offen offset:1024 nt
 s_add_u32 s11, s13, 1204224
 buffer_load_dwordx4 a[200:203], v1, s[4:7], s11 offen nt
 buffer_load_dwordx4 a[204:207], v1, s[4:7], s11 offen offset:1024 nt
 s_add_u32 s11, s13, 1206272
 buffer_load_dwordx4 a[208:211], v1, s[4:7], s11 offen nt
 buffer_load_dwordx4 a[212:215], v1, s[4:7], s11 offen offset:1024 nt
 s_add_u32 s11, s13, 1208320
 buffer_load_dwordx4 a[216:219], v1, s[4:7], s11 offen nt
 buffer_load_dwordx4 a[220:223], v1, s[4:7], s11 offen offset:1024 nt
 s_add_u32 s11, s13, 1210368
 buffer_load_dwordx4 a[224:227], v1, s[4:7], s11 offen nt
 buffer_load_dwordx4 a[228:231], v1, s[4:7], s11 offen offset:1024 nt
 s_add_u32 s11, s13, 1212416
 buffer_load_dwordx4 a[232:235], v1, s[4:7], s11 offen nt
 buffer_load_dwordx4 a[236:239], v1, s[4:7], s11 offen offset:1024 nt
 s_add_u32 s11, s13, 1214464
 buffer_load_dwordx4 a[240:243], v1, s[4:7], s11 offen nt
 buffer_load_dwordx4 a[244:247], v1, s[4:7], s11 offen offset:1024 nt
 s_add_u32 s11, s13, 1216512
 buffer_load_dwordx4 a[248:251], v1, s[4:7], s11 offen nt
 buffer_load_dwordx4 a[252:255], v1, s[4:7], s11 offen offset:1024 nt
 s_add_u32 s11, s27, 0
 s_mov_b32 m0, s11
 s_add_u32 s11, s13, 1218560
 buffer_load_dwordx4 v1, s[4:7], s11 offen offset:0 nt lds
 buffer_load_dwordx4 v1, s[4:7], s11 offen offset:1024 nt lds
 buffer_load_dwordx4 v1, s[4:7], s11 offen offset:2048 nt lds
 buffer_load_dwordx4 v1, s[4:7], s11 offen offset:3072 nt lds
 s_add_u32 s11, s27, 4096
 s_mov_b32 m0, s11
 s_add_u32 s11, s13, 1222656
 buffer_load_dwordx4 v1, s[4:7], s11 offen offset:0 nt lds
 buffer_load_dwordx4 v1, s[4:7], s11 offen offset:1024 nt lds
 buffer_load_dwordx4 v1, s[4:7], s11 offen offset:2048 nt lds
 buffer_load_dwordx4 v1, s[4:7], s11 offen offset:3072 nt lds
 s_add_u32 s11, s27, 8192
 s_mov_b32 m0, s11
 s_add_u32 s11, s13, 1226752
 buffer_load_dwordx4 v1, s[4:7], s11 offen offset:0 nt lds
 buffer_load_dwordx4 v1, s[4:7], s11 offen offset:1024 nt lds
 buffer_load_dwordx4 v1, s[4:7], s11 offen offset:2048 nt lds
 buffer_load_dwordx4 v1, s[4:7], s11 offen offset:3072 nt lds
 s_add_u32 s11, s27, 12288
 s_mov_b32 m0, s11
 s_add_u32 s11, s13, 1230848
 buffer_load_dwordx4 v1, s[4:7], s11 offen offset:0 nt lds
 buffer_load_dwordx4 v1, s[4:7], s11 offen offset:1024 nt lds
 s_mov_b32 s35, 0
 s_mov_b32 s34, 0
 s_cmp_lt_u32 s34, s35
 s_cbranch_scc1 L_B_ur_36_ok
 s_mov_b64 exec, 0xffff
 v_lshlrev_b32 v4, 7, v0
 s_mov_b32 s19, 0
 s_mov_b32 s13, 18413568
L_B_ur_36:
 buffer_load_dword v119, v4, s[4:7], s13 offen sc1
 s_waitcnt vmcnt(0)
 v_cmp_le_u32 vcc, 28, v119
 s_nop 1
 s_ff0_i32_b32 s35, vcc_lo
 s_cmp_lt_u32 s34, s35
 s_cbranch_scc1 L_B_ur_36_got
 s_sleep 4
 s_add_u32 s19, s19, 1
 s_cmp_le_u32 s19, 16384
 s_cbranch_scc1 L_B_ur_36
 s_mov_b32 s72, 6
 s_branch K_fail
L_B_ur_36_got:
 s_mov_b64 exec, -1
L_B_ur_36_ok:
 s_add_u32 s11, s26, 0
 s_mov_b32 m0, s11
 s_add_u32 s12, s17, 0
 buffer_load_dwordx4 v1, s[4:7], s12 offen sc1 lds
 buffer_load_dwordx4 v1, s[4:7], s12 offen offset:1024 sc1 lds
 s_add_u32 s11, s26, 2048
 s_mov_b32 m0, s11
 s_add_u32 s12, s17, 28672
 buffer_load_dwordx4 v1, s[4:7], s12 offen sc1 lds
 buffer_load_dwordx4 v1, s[4:7], s12 offen offset:1024 sc1 lds
 s_add_u32 s11, s26, 4096
 s_mov_b32 m0, s11
 s_add_u32 s12, s17, 57344
 buffer_load_dwordx4 v1, s[4:7], s12 offen sc1 lds
 buffer_load_dwordx4 v1, s[4:7], s12 offen offset:1024 sc1 lds
 s_add_u32 s11, s26, 6144
 s_mov_b32 m0, s11
 s_add_u32 s12, s17, 86016
 buffer_load_dwordx4 v1, s[4:7], s12 offen sc1 lds
 buffer_load_dwordx4 v1, s[4:7], s12 offen offset:1024 sc1 lds
 s_add_u32 s17, s17, 458752
 s_mov_b32 s25, 0
 s_mov_b32 s10, 0
 s_waitcnt vmcnt(0)
L_B_loop_37:
 s_cmp_lg_u32 s8, 3
 s_cbranch_scc1 L_B_nofetch_39
 s_cmp_eq_u32 s10, 0
 s_cbranch_scc1 L_B_fetch_38
 s_mov_b32 exec_lo, 0xffffffff
 s_mov_b32 exec_hi, 0xffffff
 s_mov_b32 s19, 0
 buffer_load_dword v112, v2, s[4:7], s30 offen sc1
 s_nop 15
 s_nop 3
 buffer_load_dword v113, v2, s[4:7], s30 offen sc1
 s_nop 15
 s_nop 3
 buffer_load_dword v114, v2, s[4:7], s30 offen sc1
L_pwB_41:
 s_waitcnt vmcnt(2)
 v_cmp_eq_u32 vcc, -1, v112
 s_cbranch_vccz L_pwB_41_ok
 buffer_load_dword v112, v2, s[4:7], s30 offen sc1
 s_waitcnt vmcnt(2)
 v_cmp_eq_u32 vcc, -1, v113
 s_cbranch_vccz L_pwB_41_ok
 buffer_load_dword v113, v2, s[4:7], s30 offen sc1
 s_waitcnt vmcnt(2)
 v_cmp_eq_u32 vcc, -1, v114
 s_cbranch_vccz L_pwB_41_ok
 buffer_load_dword v114, v2, s[4:7], s30 offen sc1
 s_add_u32 s19, s19, 1
 s_cmp_le_u32 s19, 8192
 s_cbranch_scc1 L_pwB_41
 s_mov_b32 s72, 2
 s_branch K_fail
L_pwB_41_ok:
 s_mov_b64 exec, -1
L_B_fetch_38:
 s_cmp_lg_u32 s8, 3
 s_cbranch_scc1 L_B_nofetch_39
 s_mov_b32 m0, 0
 s_add_u32 s11, s14, 4096
 buffer_load_dwordx4 v1, s[4:7], s14 offen offset:0 sc1 lds
 buffer_load_dwordx4 v1, s[4:7], s14 offen offset:1024 sc1 lds
 buffer_load_dwordx4 v1, s[4:7], s14 offen offset:2048 sc1 lds
 buffer_load_dwordx4 v1, s[4:7], s14 offen offset:3072 sc1 lds
 s_mov_b32 m0, 4096
 s_nop 0
 buffer_load_dwordx4 v1, s[4:7], s11 offen offset:0 sc1 lds
 buffer_load_dwordx4 v1, s[4:7], s11 offen offset:1024 sc1 lds
 buffer_load_dwordx4 v1, s[4:7], s11 offen offset:2048 sc1 lds
 ds_read_b128 v[72:75], v6 offset:0
 ds_read_b128 v[76:79], v6 offset:1024
 ds_read_b128 v[80:83], v6 offset:2048
 ds_read_b128 v[84:87], v6 offset:3072
 ds_read_b128 v[88:91], v6 offset:4096
 ds_read_b128 v[92:95], v6 offset:5120
 ds_read_b128 v[96:99], v6 offset:6144
 ds_read_b128 v[100:103], v6 offset:7168
 v_mov_b64 v[60:61], 0
 v_mov_b64 v[62:63], 0
 v_mov_b64 v[64:65], 0
 v_mov_b64 v[66:67], 0
 v_mov_b64 v[68:69], 0
 v_mov_b64 v[70:71], 0
 s_waitcnt vmcnt(0)
 s_branch L_B_nofetch_39_j
L_B_nofetch_39:
 ds_read_b128 v[72:75], v6 offset:0
 ds_read_b128 v[76:79], v6 offset:1024
 ds_read_b128 v[80:83], v6 offset:2048
 ds_read_b128 v[84:87], v6 offset:3072
 ds_read_b128 v[88:91], v6 offset:4096
 ds_read_b128 v[92:95], v6 offset:5120
 ds_read_b128 v[96:99], v6 offset:6144
 ds_read_b128 v[100:103], v6 offset:7168
 v_mov_b64 v[60:61], 0
 v_mov_b64 v[62:63], 0
 v_mov_b64 v[64:65], 0
 v_mov_b64 v[66:67], 0
 v_mov_b64 v[68:69], 0
 v_mov_b64 v[70:71], 0
L_B_nofetch_39_j:
 s_waitcnt lgkmcnt(0)
 s_barrier
 s_cmp_ge_u32 s10, 62
 s_cbranch_scc1 L_B_nou_42
 s_add_u32 s34, s10, 1
 s_lshr_b32 s34, s34, 2
 s_cmp_lt_u32 s34, s35
 s_cbranch_scc1 L_B_ur_43_ok
 s_mov_b64 exec, 0xffff
 v_lshlrev_b32 v4, 7, v0
 s_mov_b32 s19, 0
 s_mov_b32 s13, 18413568
L_B_ur_43:
 buffer_load_dword v119, v4, s[4:7], s13 offen sc1
 s_waitcnt vmcnt(0)
 v_cmp_le_u32 vcc, 28, v119
 s_nop 1
 s_ff0_i32_b32 s35, vcc_lo
 s_cmp_lt_u32 s34, s35
 s_cbranch_scc1 L_B_ur_43_got
 s_sleep 4
 s_add_u32 s19, s19, 1
 s_cmp_le_u32 s19, 16384
 s_cbranch_scc1 L_B_ur_43
 s_mov_b32 s72, 6
 s_branch K_fail
L_B_ur_43_got:
 s_mov_b64 exec, -1
L_B_ur_43_ok:
L_B_nou_42:
 s_xor_b32 s12, s25, 32768
 s_add_u32 s24, s26, s12
 ds_read_b128 v[16:19], v1 offset:0
 ds_read_b128 v[20:23], v1 offset:1024
 ds_read_b128 v[24:27], v1 offset:2048
 s_waitcnt lgkmcnt(2)
 v_smfmac_f32_16x16x64_bf16 v[68:71], v[16:19], v[72:79], v5
 ds_read_b128 v[28:31], v1 offset:3072
 s_add_u32 s11, s24, 0
 s_mov_b32 m0, s11
 s_add_u32 s12, s17, 0
 v_max3_u32 v4, v16, v17, v18
 buffer_load_dwordx4 v1, s[4:7], s12 offen sc1 lds
 s_waitcnt lgkmcnt(2)
 v_smfmac_f32_16x16x64_bf16 v[68:71], v[20:23], v[80:87], v5
 ds_read_b128 v[32:35], v1 offset:4096
 buffer_load_dwordx4 v1, s[4:7], s12 offen offset:1024 sc1 lds
 v_max_u32 v4, v4, v19
 s_add_u32 s11, s24, 2048
 s_mov_b32 m0, s11
 s_add_u32 s12, s17, 28672
 s_waitcnt lgkmcnt(2)
 v_smfmac_f32_16x16x64_bf16 v[68:71], v[24:27], v[88:95], v5
 ds_read_b128 v[36:39], v1 offset:5120
 buffer_load_dwordx4 v1, s[4:7], s12 offen sc1 lds
 v_max3_u32 v4, v4, v20, v21
 buffer_load_dwordx4 v1, s[4:7], s12 offen offset:1024 sc1 lds
 s_waitcnt lgkmcnt(2)
 v_smfmac_f32_16x16x64_bf16 v[68:71], v[28:31], v[96:103], v5
 ds_read_b128 v[40:43], v1 offset:6144
 s_add_u32 s11, s24, 4096
 s_mov_b32 m0, s11
 s_add_u32 s12, s17, 57344
 v_max3_u32 v4, v4, v22, v23
 buffer_load_dwordx4 v1, s[4:7], s12 offen sc1 lds
 v_smfmac_f32_16x16x64_bf16 v[60:63], v[16:19], v[120:127], v5
 ds_read_b128 v[72:75], v6 offset:8192
 buffer_load_dwordx4 v1, s[4:7], s12 offen offset:1024 sc1 lds
 v_max3_u32 v4, v4, v24, v25
 s_add_u32 s11, s24, 6144
 s_mov_b32 m0, s11
 s_add_u32 s12, s17, 86016
 v_smfmac_f32_16x16x64_bf16 v[60:63], v[20:23], v[128:135], v5
 ds_read_b128 v[76:79], v6 offset:9216
 buffer_load_dwordx4 v1, s[4:7], s12 offen sc1 lds
 v_max3_u32 v4, v4, v26, v27
 buffer_load_dwordx4 v1, s[4:7], s12 offen offset:1024 sc1 lds
 v_smfmac_f32_16x16x64_bf16 v[60:63], v[24:27], v[136:143], v5
 ds_read_b128 v[80:83], v6 offset:10240
 v_max3_u32 v4, v4, v28, v29
 v_smfmac_f32_16x16x64_bf16 v[60:63], v[28:31], v[144:151], v5
 ds_read_b128 v[84:87], v6 offset:11264
 v_max3_u32 v4, v4, v30, v31
 s_waitcnt lgkmcnt(6)
 v_smfmac_f32_16x16x64_bf16 v[60:63], v[32:35], v[152:159], v5
 ds_read_b128 v[88:91], v6 offset:12288
 v_max3_u32 v4, v4, v32, v33
 s_waitcnt lgkmcnt(6)
 v_smfmac_f32_16x16x64_bf16 v[60:63], v[36:39], v[160:167], v5
 ds_read_b128 v[92:95], v6 offset:13312
 v_max3_u32 v4, v4, v34, v35
 s_waitcnt lgkmcnt(6)
 v_smfmac_f32_16x16x64_bf16 v[60:63], v[40:43], v[168:175], v5
 v_max3_u32 v4, v4, v36, v37
 s_waitcnt lgkmcnt(4)
 v_smfmac_f32_16x16x64_bf16 v[68:71], v[32:35], v[72:79], v5
 v_max3_u32 v4, v4, v38, v39
 s_waitcnt lgkmcnt(2)
 v_smfmac_f32_16x16x64_bf16 v[68:71], v[36:39], v[80:87], v5
 v_cvt_pk_bf16_f32 v44, v60, v61
 s_waitcnt lgkmcnt(0)
 v_smfmac_f32_16x16x64_bf16 v[68:71], v[40:43], v[88:95], v5
 v_cvt_pk_bf16_f32 v46, v62, v63
 v_smfmac_f32_16x16x64_bf16 v[64:67], v[16:19], v[176:183], v5
 v_mov_b64 v[60:61], 0
 v_smfmac_f32_16x16x64_bf16 v[64:67], v[20:23], v[184:191], v5
 v_mov_b64 v[62:63], 0
 v_smfmac_f32_16x16x64_bf16 v[64:67], v[24:27], v[192:199], v5
 v_cvt_pk_bf16_f32 v57, v68, v69
 v_smfmac_f32_16x16x64_bf16 v[64:67], v[28:31], v[200:207], v5
 v_cvt_pk_bf16_f32 v59, v70, v71
 v_smfmac_f32_16x16x64_bf16 v[64:67], v[32:35], v[208:215], v5
 v_mov_b64 v[68:69], 0
 v_smfmac_f32_16x16x64_bf16 v[64:67], v[36:39], v[216:223], v5
 v_mov_b64 v[70:71], 0
 v_smfmac_f32_16x16x64_bf16 v[64:67], v[40:43], v[224:231], v5
 v_max3_u32 v4, v4, v40, v41
 v_smfmac_f32_16x16x64_bf16 v[60:63], v[16:19], v[232:239], v5
 v_max3_u32 v4, v4, v42, v43
 v_smfmac_f32_16x16x64_bf16 v[60:63], v[20:23], v[240:247], v5
 v_cvt_pk_bf16_f32 v52, v64, v65
 v_smfmac_f32_16x16x64_bf16 v[60:63], v[24:27], v[248:255], v5
 v_cvt_pk_bf16_f32 v54, v66, v67
 v_smfmac_f32_16x16x64_bf16 v[60:63], v[28:31], a[0:7], v5
 v_mov_b64 v[64:65], 0
 v_smfmac_f32_16x16x64_bf16 v[60:63], v[32:35], a[8:15], v5
 v_mov_b64 v[66:67], 0
 v_smfmac_f32_16x16x64_bf16 v[60:63], v[36:39], a[16:23], v5
 v_cmp_eq_u32 vcc, -1, v4
 v_smfmac_f32_16x16x64_bf16 v[60:63], v[40:43], a[24:31], v5
 v_smfmac_f32_16x16x64_bf16 v[68:71], v[16:19], a[32:39], v5
 v_smfmac_f32_16x16x64_bf16 v[68:71], v[20:23], a[40:47], v5
 v_cvt_pk_bf16_f32 v45, v60, v61
 v_smfmac_f32_16x16x64_bf16 v[68:71], v[24:27], a[48:55], v5
 v_cvt_pk_bf16_f32 v47, v62, v63
 v_smfmac_f32_16x16x64_bf16 v[68:71], v[28:31], a[56:63], v5
 v_mov_b64 v[60:61], 0
 v_smfmac_f32_16x16x64_bf16 v[68:71], v[32:35], a[64:71], v5
 v_mov_b64 v[62:63], 0
 v_smfmac_f32_16x16x64_bf16 v[68:71], v[36:39], a[72:79], v5
 v_smfmac_f32_16x16x64_bf16 v[68:71], v[40:43], a[80:87], v5
 s_cbranch_vccnz L_B_retry_40
 v_smfmac_f32_16x16x64_bf16 v[64:67], v[16:19], a[88:95], v5
 s_add_u32 s17, s17, 458752
 v_smfmac_f32_16x16x64_bf16 v[64:67], v[20:23], a[96:103], v5
 v_cvt_pk_bf16_f32 v53, v68, v69
 v_smfmac_f32_16x16x64_bf16 v[64:67], v[24:27], a[104:111], v5
 v_cvt_pk_bf16_f32 v55, v70, v71
 v_smfmac_f32_16x16x64_bf16 v[64:67], v[28:31], a[112:119], v5
 v_mov_b64 v[68:69], 0
 v_smfmac_f32_16x16x64_bf16 v[64:67], v[32:35], a[120:127], v5
 v_mov_b64 v[70:71], 0
 v_smfmac_f32_16x16x64_bf16 v[64:67], v[36:39], a[128:135], v5
 v_smfmac_f32_16x16x64_bf16 v[64:67], v[40:43], a[136:143], v5
 v_smfmac_f32_16x16x64_bf16 v[60:63], v[16:19], a[144:151], v5
 v_smfmac_f32_16x16x64_bf16 v[60:63], v[20:23], a[152:159], v5
 v_cvt_pk_bf16_f32 v48, v64, v65
 v_smfmac_f32_16x16x64_bf16 v[60:63], v[24:27], a[160:167], v5
 v_cvt_pk_bf16_f32 v50, v66, v67
 v_smfmac_f32_16x16x64_bf16 v[60:63], v[28:31], a[168:175], v5
 v_mov_b64 v[64:65], 0
 v_smfmac_f32_16x16x64_bf16 v[60:63], v[32:35], a[176:183], v5
 v_mov_b64 v[66:67], 0
 v_smfmac_f32_16x16x64_bf16 v[60:63], v[36:39], a[184:191], v5
 v_smfmac_f32_16x16x64_bf16 v[60:63], v[40:43], a[192:199], v5
 v_smfmac_f32_16x16x64_bf16 v[68:71], v[16:19], a[200:207], v5
 v_smfmac_f32_16x16x64_bf16 v[68:71], v[20:23], a[208:215], v5
 v_cvt_pk_bf16_f32 v56, v60, v61
 v_smfmac_f32_16x16x64_bf16 v[68:71], v[24:27], a[216:223], v5
 v_cvt_pk_bf16_f32 v58, v62, v63
 v_smfmac_f32_16x16x64_bf16 v[68:71], v[28:31], a[224:231], v5
 v_mov_b64 v[60:61], 0
 v_smfmac_f32_16x16x64_bf16 v[68:71], v[32:35], a[232:239], v5
 v_mov_b64 v[62:63], 0
 v_smfmac_f32_16x16x64_bf16 v[68:71], v[36:39], a[240:247], v5
 v_smfmac_f32_16x16x64_bf16 v[68:71], v[40:43], a[248:255], v5
 s_nop 7
 v_cvt_pk_bf16_f32 v49, v68, v69
 v_cvt_pk_bf16_f32 v51, v70, v71
 v_add_u32 v4, s25, v7
 ds_read_b128 v[72:75], v4 offset:0
 ds_read_b128 v[76:79], v4 offset:2048
 ds_read_b128 v[80:83], v4 offset:4096
 ds_read_b128 v[84:87], v4 offset:6144
 ds_read_b128 v[88:91], v4 offset:1024
 ds_read_b128 v[92:95], v4 offset:3072
 ds_read_b128 v[96:99], v4 offset:5120
 ds_read_b128 v[100:103], v4 offset:7168
 s_mov_b64 exec, 0xff
 s_mov_b32 s19, 0
 buffer_load_dword v112, v2, s[4:7], s31 offen sc1
 s_nop 15
 s_nop 3
 buffer_load_dword v113, v2, s[4:7], s31 offen sc1
 s_nop 15
 s_nop 3
 buffer_load_dword v114, v2, s[4:7], s31 offen sc1
L_pwP_44:
 s_waitcnt vmcnt(2)
 v_cmp_eq_u32 vcc, -1, v112
 s_cbranch_vccz L_pwP_44_ok
 buffer_load_dword v112, v2, s[4:7], s31 offen sc1
 s_waitcnt vmcnt(2)
 v_cmp_eq_u32 vcc, -1, v113
 s_cbranch_vccz L_pwP_44_ok
 buffer_load_dword v113, v2, s[4:7], s31 offen sc1
 s_waitcnt vmcnt(2)
 v_cmp_eq_u32 vcc, -1, v114
 s_cbranch_vccz L_pwP_44_ok
 buffer_load_dword v114, v2, s[4:7], s31 offen sc1
 s_add_u32 s19, s19, 1
 s_cmp_le_u32 s19, 8192
 s_cbranch_scc1 L_pwP_44
 s_mov_b32 s72, 3
 s_branch K_fail
L_pwP_44_ok:
 s_mov_b64 exec, -1
 s_waitcnt lgkmcnt(0)
L_B_pf_45:
 buffer_load_dwordx4 v[104:107], v14, s[4:7], s15 offen sc1
 buffer_load_dwordx4 v[108:111], v14, s[4:7], s15 offen offset:1024 sc1
 buffer_load_dwordx4 v[112:115], v8, s[4:7], s16 offen sc1
 s_waitcnt vmcnt(2)
 v_smfmac_f32_16x16x64_bf16 v[60:63], v[104:107], v[72:79], v5
 v_max3_u32 v4, v104, v105, v106
 v_smfmac_f32_16x16x64_bf16 v[64:67], v[104:107], v[88:95], v5
 s_waitcnt vmcnt(1)
 v_max3_u32 v4, v4, v107, v108
 v_smfmac_f32_16x16x64_bf16 v[60:63], v[108:111], v[80:87], v5
 v_max3_u32 v4, v4, v109, v110
 v_smfmac_f32_16x16x64_bf16 v[64:67], v[108:111], v[96:103], v5
 s_waitcnt vmcnt(0)
 v_max3_u32 v4, v4, v111, v112
 v_smfmac_f32_16x16x64_bf16 v[60:63], v[112:115], v[44:51], v5
 v_max3_u32 v4, v4, v113, v114
 v_smfmac_f32_16x16x64_bf16 v[64:67], v[112:115], v[52:59], v5
 v_max_u32 v4, v4, v115
 v_cmp_eq_u32 vcc, -1, v4
 s_cbranch_vccnz L_B_pretry_46
 s_add_u32 s13, s30, 256
 s_nop 3
 v_permlane32_swap_b32 v60, v64
 v_permlane32_swap_b32 v61, v65
 v_permlane32_swap_b32 v62, v66
 v_permlane32_swap_b32 v63, v67
 v_add_f32 v60, v60, v64
 v_add_f32 v61, v61, v65
 v_add_f32 v62, v62, v66
 v_add_f32 v63, v63, v67
 ds_write_b128 v9, v[60:63]
 buffer_store_dword v13, v3, s[4:7], s13 offen sc1
 s_waitcnt lgkmcnt(0)
 s_barrier
 s_cmp_ge_u32 s8, 2
 s_cbranch_scc1 L_B_nored_47
 ds_read2st64_b32 v[104:105], v10 offset0:0 offset1:5
 ds_read2st64_b32 v[106:107], v11 offset0:0 offset1:5
 ds_read2st64_b32 v[108:109], v10 offset0:10 offset1:15
 ds_read2st64_b32 v[110:111], v11 offset0:10 offset1:15
 s_add_u32 s11, s14, 7168
 s_add_u32 s12, s11, 458752
 s_waitcnt lgkmcnt(2)
 v_add_f32 v104, v104, v105
 v_add_f32 v106, v106, v107
 s_waitcnt lgkmcnt(0)
 v_add_f32 v108, v108, v109
 v_add_f32 v110, v110, v111
 v_add_f32 v104, v104, v108
 v_add_f32 v106, v106, v110
 v_cvt_pk_bf16_f32 v104, v104, v106
 v_min_u32 v104, -2, v104
 buffer_store_dword v104, v12, s[4:7], s11 offen sc1
 s_cmp_lg_u32 s10, 62
 s_cbranch_scc1 L_B_nored_47
 buffer_store_dword v104, v12, s[4:7], s12 offen sc1
L_B_nored_47:
 s_add_u32 s10, s10, 1
 s_cmp_ge_u32 s10, 63
 s_cbranch_scc1 K_done
 s_add_u32 s14, s14, 7168
 s_add_u32 s15, s15, 8192
 s_add_u32 s16, s16, 2048
 s_add_u32 s30, s30, 256
 s_add_u32 s31, s31, 512
 s_xor_b32 s25, s25, 32768
 s_branch L_B_loop_37
L_B_retry_40:
 s_mov_b32 s72, 4
 s_add_u32 s19, s19, 1
 s_cmp_gt_u32 s19, 16384
 s_cbranch_scc1 K_fail
 s_add_u32 s70, s70, 1
 s_waitcnt lgkmcnt(0)
 s_nop 7
 s_barrier
 s_branch L_B_fetch_38
L_B_pretry_46:
 s_mov_b32 s72, 5
 s_add_u32 s19, s19, 1
 s_cmp_gt_u32 s19, 16384
 s_cbranch_scc1 K_fail
 s_add_u32 s71, s71, 1
 s_nop 7
 v_mov_b64 v[60:61], 0
 v_mov_b64 v[62:63], 0
 v_mov_b64 v[64:65], 0
 v_mov_b64 v[66:67], 0
 s_branch L_B_pf_45
K_next0:
 s_cmp_lg_u32 s8, 0
 s_cbranch_scc1 K_at_48
 s_mov_b64 exec, 1
 v_mov_b32 v5, 0
 v_mov_b32 v8, 1
 buffer_atomic_add v8, v5, s[80:83], 0 offen sc0 sc1
 s_waitcnt vmcnt(0)
 s_mov_b64 exec, -1
K_at_48:
 s_cmp_lg_u32 s8, 0
 s_cbranch_scc1 K_bc_49
 v_lshlrev_b32 v5, 2, v0
 v_add_u32 v5, 163776, v5
 s_mov_b64 exec, 1
 ds_write_b32 v5, v8
 s_waitcnt lgkmcnt(0)
 s_mov_b64 exec, -1
K_bc_49:
 s_barrier
 v_and_b32 v5, 7, v0
 v_lshlrev_b32 v5, 2, v5
 v_add_u32 v5, 163776, v5
 ds_read_b32 v6, v5
 v_mov_b32 v5, 163808
 ds_read_b32 v7, v5
 s_waitcnt lgkmcnt(0)
 v_cmp_ne_u32 vcc, 0, v7
 s_cbranch_vccnz K_done
 s_barrier
 v_readfirstlane_b32 s92, v6
K_entry:
 s_cmp_ge_u32 s92, 126
 s_cbranch_scc1 K_g
 s_cmp_ge_u32 s92, 70
 s_cbranch_scc1 K_rp
 s_cmp_ge_u32 s92, 56
 s_cbranch_scc1 K_y
 s_cmp_ge_u32 s92, 28
 s_cselect_b32 s21, 1, 0
 s_mul_i32 s11, s21, 28
 s_sub_u32 s22, s92, s11
 s_branch K_u
K_y:
 s_sub_u32 s9, s92, 56
 s_mov_b32 s33, 18413568
 s_cmp_lg_u32 s8, 0
 s_cbranch_scc1 L_wcyg_50_ok
 s_mov_b32 s19, 0
 v_mov_b32 v5, 0
 s_mov_b64 exec, 1
L_wcyg_50:
 buffer_load_dword v6, v5, s[4:7], s33 offen sc1
 s_waitcnt vmcnt(0)
 v_readfirstlane_b32 s11, v6
 s_cmp_ge_u32 s11, 28
 s_cbranch_scc1 L_wcyg_50_got
 s_sleep 12
 s_add_u32 s19, s19, 1
 s_cmp_le_u32 s19, 8192
 s_cbranch_scc1 L_wcyg_50
 s_branch K_failw
L_wcyg_50_got:
 s_mov_b64 exec, -1
L_wcyg_50_ok:
 s_barrier
 v_lshlrev_b32 v1, 4, v0
 v_lshlrev_b32 v2, 2, v0
 v_and_b32 v4, 8, v0
 v_cmp_ne_u32 vcc, 0, v4
 v_mov_b32 v5, 0x4444
 v_mov_b32 v4, 0xeeee
 v_cndmask_b32 v5, v5, v4, vcc
 v_and_b32 v16, 15, v0
 v_lshrrev_b32 v17, 4, v0
 s_mul_i32 s11, s8, 14336
 s_add_u32 s27, s11, 8192
 v_add_u32 v6, s27, v1
 v_mov_b32 v13, 0
 s_lshl_b32 s12, s9, 1
 v_lshlrev_b32 v2, 7, v0
 v_add_u32 v2, 124, v2
 s_mov_b32 s14, 17235968
 s_mul_i32 s11, s8, 56
 s_add_u32 s11, s11, s12
 s_lshl_b32 s11, s11, 10
 s_add_u32 s18, s11, 19136512
 v_mov_b32 v116, 1
 v_cmp_eq_u32 vcc, 0, v0
 s_cmp_eq_u32 s8, 0
 s_cselect_b64 vcc, vcc, 0
 v_mov_b32 v18, 0x7ffffff0
 v_cndmask_b32 v117, v18, 0, vcc
 s_mov_b32 s33, 18397184
 s_mov_b32 s32, 0
 s_mul_i32 s11, s8, 112
 s_add_u32 s11, s11, s12
 s_mul_i32 s11, s11, 14336
 s_add_u32 s13, s11, 9437184
 s_add_u32 s11, s13, 0
 buffer_load_dwordx4 v[120:123], v1, s[4:7], s11 offen nt
 buffer_load_dwordx4 v[124:127], v1, s[4:7], s11 offen offset:1024 nt
 s_add_u32 s11, s13, 2048
 buffer_load_dwordx4 v[128:131], v1, s[4:7], s11 offen nt
 buffer_load_dwordx4 v[132:135], v1, s[4:7], s11 offen offset:1024 nt
 s_add_u32 s11, s13, 4096
 buffer_load_dwordx4 v[136:139], v1, s[4:7], s11 offen nt
 buffer_load_dwordx4 v[140:143], v1, s[4:7], s11 offen offset:1024 nt
 s_add_u32 s11, s13, 6144
 buffer_load_dwordx4 v[144:147], v1, s[4:7], s11 offen nt
 buffer_load_dwordx4 v[148:151], v1, s[4:7], s11 offen offset:1024 nt
 s_add_u32 s11, s13, 8192
 buffer_load_dwordx4 v[152:155], v1, s[4:7], s11 offen nt
 buffer_load_dwordx4 v[156:159], v1, s[4:7], s11 offen offset:1024 nt
 s_add_u32 s11, s13, 10240
 buffer_load_dwordx4 v[160:163], v1, s[4:7], s11 offen nt
 buffer_load_dwordx4 v[164:167], v1, s[4:7], s11 offen offset:1024 nt
 s_add_u32 s11, s13, 12288
 buffer_load_dwordx4 v[168:171], v1, s[4:7], s11 offen nt
 buffer_load_dwordx4 v[172:175], v1, s[4:7], s11 offen offset:1024 nt
 s_add_u32 s11, s13, 14336
 buffer_load_dwordx4 v[176:179], v1, s[4:7], s11 offen nt
 buffer_load_dwordx4 v[180:183], v1, s[4:7], s11 offen offset:1024 nt
 s_add_u32 s11, s13, 16384
 buffer_load_dwordx4 v[184:187], v1, s[4:7], s11 offen nt
 buffer_load_dwordx4 v[188:191], v1, s[4:7], s11 offen offset:1024 nt
 s_add_u32 s11, s13, 18432
 buffer_load_dwordx4 v[192:195], v1, s[4:7], s11 offen nt
 buffer_load_dwordx4 v[196:199], v1, s[4:7], s11 offen offset:1024 nt
 s_add_u32 s11, s13, 20480
 buffer_load_dwordx4 v[200:203], v1, s[4:7], s11 offen nt
 buffer_load_dwordx4 v[204:207], v1, s[4:7], s11 offen offset:1024 nt
 s_add_u32 s11, s13, 22528
 buffer_load_dwordx4 v[208:211], v1, s[4:7], s11 offen nt
 buffer_load_dwordx4 v[212:215], v1, s[4:7], s11 offen offset:1024 nt
 s_add_u32 s11, s13, 24576
 buffer_load_dwordx4 v[216:219], v1, s[4:7], s11 offen nt
 buffer_load_dwordx4 v[220:223], v1, s[4:7], s11 offen offset:1024 nt
 s_add_u32 s11, s13, 26624
 buffer_load_dwordx4 v[224:227], v1, s[4:7], s11 offen nt
 buffer_load_dwordx4 v[228:231], v1, s[4:7], s11 offen offset:1024 nt
 s_add_u32 s11, s13, 401408
 buffer_load_dwordx4 v[232:235], v1, s[4:7], s11 offen nt
 buffer_load_dwordx4 v[236:239], v1, s[4:7], s11 offen offset:1024 nt
 s_add_u32 s11, s13, 403456
 buffer_load_dwordx4 v[240:243], v1, s[4:7], s11 offen nt
 buffer_load_dwordx4 v[244:247], v1, s[4:7], s11 offen offset:1024 nt
 s_add_u32 s11, s13, 405504
 buffer_load_dwordx4 v[248:251], v1, s[4:7], s11 offen nt
 buffer_load_dwordx4 v[252:255], v1, s[4:7], s11 offen offset:1024 nt
 s_add_u32 s11, s13, 407552
 buffer_load_dwordx4 a[0:3], v1, s[4:7], s11 offen nt
 buffer_load_dwordx4 a[4:7], v1, s[4:7], s11 offen offset:1024 nt
 s_add_u32 s11, s13, 409600
 buffer_load_dwordx4 a[8:11], v1, s[4:7], s11 offen nt
 buffer_load_dwordx4 a[12:15], v1, s[4:7], s11 offen offset:1024 nt
 s_add_u32 s11, s13, 411648
 buffer_load_dwordx4 a[16:19], v1, s[4:7], s11 offen nt
 buffer_load_dwordx4 a[20:23], v1, s[4:7], s11 offen offset:1024 nt
 s_add_u32 s11, s13, 413696
 buffer_load_dwordx4 a[24:27], v1, s[4:7], s11 offen nt
 buffer_load_dwordx4 a[28:31], v1, s[4:7], s11 offen offset:1024 nt
 s_add_u32 s11, s13, 415744
 buffer_load_dwordx4 a[32:35], v1, s[4:7], s11 offen nt
 buffer_load_dwordx4 a[36:39], v1, s[4:7], s11 offen offset:1024 nt
 s_add_u32 s11, s13, 417792
 buffer_load_dwordx4 a[40:43], v1, s[4:7], s11 offen nt
 buffer_load_dwordx4 a[44:47], v1, s[4:7], s11 offen offset:1024 nt
 s_add_u32 s11, s13, 419840
 buffer_load_dwordx4 a[48:51], v1, s[4:7], s11 offen nt
 buffer_load_dwordx4 a[52:55], v1, s[4:7], s11 offen offset:1024 nt
 s_add_u32 s11, s13, 421888
 buffer_load_dwordx4 a[56:59], v1, s[4:7], s11 offen nt
 buffer_load_dwordx4 a[60:63], v1, s[4:7], s11 offen offset:1024 nt
 s_add_u32 s11, s13, 423936
 buffer_load_dwordx4 a[64:67], v1, s[4:7], s11 offen nt
 buffer_load_dwordx4 a[68:71], v1, s[4:7], s11 offen offset:1024 nt
 s_add_u32 s11, s13, 425984
 buffer_load_dwordx4 a[72:75], v1, s[4:7], s11 offen nt
 buffer_load_dwordx4 a[76:79], v1, s[4:7], s11 offen offset:1024 nt
 s_add_u32 s11, s13, 428032
 buffer_load_dwordx4 a[80:83], v1, s[4:7], s11 offen nt
 buffer_load_dwordx4 a[84:87], v1, s[4:7], s11 offen offset:1024 nt
 s_add_u32 s11, s13, 802816
 buffer_load_dwordx4 a[88:91], v1, s[4:7], s11 offen nt
 buffer_load_dwordx4 a[92:95], v1, s[4:7], s11 offen offset:1024 nt
 s_add_u32 s11, s13, 804864
 buffer_load_dwordx4 a[96:99], v1, s[4:7], s11 offen nt
 buffer_load_dwordx4 a[100:103], v1, s[4:7], s11 offen offset:1024 nt
 s_add_u32 s11, s13, 806912
 buffer_load_dwordx4 a[104:107], v1, s[4:7], s11 offen nt
 buffer_load_dwordx4 a[108:111], v1, s[4:7], s11 offen offset:1024 nt
 s_add_u32 s11, s13, 808960
 buffer_load_dwordx4 a[112:115], v1, s[4:7], s11 offen nt
 buffer_load_dwordx4 a[116:119], v1, s[4:7], s11 offen offset:1024 nt
 s_add_u32 s11, s13, 811008
 buffer_load_dwordx4 a[120:123], v1, s[4:7], s11 offen nt
 buffer_load_dwordx4 a[124:127], v1, s[4:7], s11 offen offset:1024 nt
 s_add_u32 s11, s13, 813056
 buffer_load_dwordx4 a[128:131], v1, s[4:7], s11 offen nt
 buffer_load_dwordx4 a[132:135], v1, s[4:7], s11 offen offset:1024 nt
 s_add_u32 s11, s13, 815104
 buffer_load_dwordx4 a[136:139], v1, s[4:7], s11 offen nt
 buffer_load_dwordx4 a[140:143], v1, s[4:7], s11 offen offset:1024 nt
 s_add_u32 s11, s13, 817152
 buffer_load_dwordx4 a[144:147], v1, s[4:7], s11 offen nt
 buffer_load_dwordx4 a[148:151], v1, s[4:7], s11 offen offset:1024 nt
 s_add_u32 s11, s13, 819200
 buffer_load_dwordx4 a[152:155], v1, s[4:7], s11 offen nt
 buffer_load_dwordx4 a[156:159], v1, s[4:7], s11 offen offset:1024 nt
 s_add_u32 s11, s13, 821248
 buffer_load_dwordx4 a[160:163], v1, s[4:7], s11 offen nt
 buffer_load_dwordx4 a[164:167], v1, s[4:7], s11 offen offset:1024 nt
 s_add_u32 s11, s13, 823296
 buffer_load_dwordx4 a[168:171], v1, s[4:7], s11 offen nt
 buffer_load_dwordx4 a[172:175], v1, s[4:7], s11 offen offset:1024 nt
 s_add_u32 s11, s13, 825344
 buffer_load_dwordx4 a[176:179], v1, s[4:7], s11 offen nt
 buffer_load_dwordx4 a[180:183], v1, s[4:7], s11 offen offset:1024 nt
 s_add_u32 s11, s13, 827392
 buffer_load_dwordx4 a[184:187], v1, s[4:7], s11 offen nt
 buffer_load_dwordx4 a[188:191], v1, s[4:7], s11 offen offset:1024 nt
 s_add_u32 s11, s13, 829440
 buffer_load_dwordx4 a[192:195], v1, s[4:7], s11 offen nt
 buffer_load_dwordx4 a[196:199], v1, s[4:7], s11 offen offset:1024 nt
 s_add_u32 s11, s13, 1204224
 buffer_load_dwordx4 a[200:203], v1, s[4:7], s11 offen nt
 buffer_load_dwordx4 a[204:207], v1, s[4:7], s11 offen offset:1024 nt
 s_add_u32 s11, s13, 1206272
 buffer_load_dwordx4 a[208:211], v1, s[4:7], s11 offen nt
 buffer_load_dwordx4 a[212:215], v1, s[4:7], s11 offen offset:1024 nt
 s_add_u32 s11, s13, 1208320
 buffer_load_dwordx4 a[216:219], v1, s[4:7], s11 offen nt
 buffer_load_dwordx4 a[220:223], v1, s[4:7], s11 offen offset:1024 nt
 s_add_u32 s11, s13, 1210368
 buffer_load_dwordx4 a[224:227], v1, s[4:7], s11 offen nt
 buffer_load_dwordx4 a[228:231], v1, s[4:7], s11 offen offset:1024 nt
 s_add_u32 s11, s13, 1212416
 buffer_load_dwordx4 a[232:235], v1, s[4:7], s11 offen nt
 buffer_load_dwordx4 a[236:239], v1, s[4:7], s11 offen offset:1024 nt
 s_add_u32 s11, s13, 1214464
 buffer_load_dwordx4 a[240:243], v1, s[4:7], s11 offen nt
 buffer_load_dwordx4 a[244:247], v1, s[4:7], s11 offen offset:1024 nt
 s_add_u32 s11, s13, 1216512
 buffer_load_dwordx4 a[248:251], v1, s[4:7], s11 offen nt
 buffer_load_dwordx4 a[252:255], v1, s[4:7], s11 offen offset:1024 nt
 s_add_u32 s11, s27, 0
 s_mov_b32 m0, s11
 s_add_u32 s11, s13, 1218560
 buffer_load_dwordx4 v1, s[4:7], s11 offen offset:0 nt lds
 buffer_load_dwordx4 v1, s[4:7], s11 offen offset:1024 nt lds
 buffer_load_dwordx4 v1, s[4:7], s11 offen offset:2048 nt lds
 buffer_load_dwordx4 v1, s[4:7], s11 offen offset:3072 nt lds
 s_add_u32 s11, s27, 4096
 s_mov_b32 m0, s11
 s_add_u32 s11, s13, 1222656
 buffer_load_dwordx4 v1, s[4:7], s11 offen offset:0 nt lds
 buffer_load_dwordx4 v1, s[4:7], s11 offen offset:1024 nt lds
 buffer_load_dwordx4 v1, s[4:7], s11 offen offset:2048 nt lds
 buffer_load_dwordx4 v1, s[4:7], s11 offen offset:3072 nt lds
 s_add_u32 s11, s27, 8192
 s_mov_b32 m0, s11
 s_add_u32 s11, s13, 1226752
 buffer_load_dwordx4 v1, s[4:7], s11 offen offset:0 nt lds
 buffer_load_dwordx4 v1, s[4:7], s11 offen offset:1024 nt lds
 buffer_load_dwordx4 v1, s[4:7], s11 offen offset:2048 nt lds
 buffer_load_dwordx4 v1, s[4:7], s11 offen offset:3072 nt lds
 s_add_u32 s11, s27, 12288
 s_mov_b32 m0, s11
 s_add_u32 s11, s13, 1230848
 buffer_load_dwordx4 v1, s[4:7], s11 offen offset:0 nt lds
 buffer_load_dwordx4 v1, s[4:7], s11 offen offset:1024 nt lds
 s_mov_b32 s10, 0
 s_waitcnt vmcnt(0)
L_B_loop_51:
 s_cmp_lg_u32 s8, 3
 s_cbranch_scc1 L_B_nofetch_53
 s_cmp_eq_u32 s10, 0
 s_cbranch_scc1 L_B_fetch_52
 s_mov_b32 exec_lo, -1
 s_mov_b32 exec_hi, 0xffffff
 s_mov_b32 s19, 0
L_Y_poll_55:
 buffer_load_dword v112, v2, s[4:7], s14 offen sc1
 s_waitcnt vmcnt(0)
 v_cmp_eq_u32 vcc, -1, v112
 s_cbranch_vccz L_Y_poll_55_ok
 s_add_u32 s19, s19, 1
 s_cmp_le_u32 s19, 16384
 s_cbranch_scc1 L_Y_poll_55
 s_mov_b32 s72, 7
 s_branch K_failw
L_Y_poll_55_ok:
 s_mov_b64 exec, -1
L_B_fetch_52:
 s_cmp_lg_u32 s8, 3
 s_cbranch_scc1 L_B_nofetch_53
 s_mov_b32 m0, 0
 s_add_u32 s11, s14, 4096
 buffer_load_dwordx4 v1, s[4:7], s14 offen offset:0 sc1 lds
 buffer_load_dwordx4 v1, s[4:7], s14 offen offset:1024 sc1 lds
 buffer_load_dwordx4 v1, s[4:7], s14 offen offset:2048 sc1 lds
 buffer_load_dwordx4 v1, s[4:7], s14 offen offset:3072 sc1 lds
 s_mov_b32 m0, 4096
 s_nop 0
 buffer_load_dwordx4 v1, s[4:7], s11 offen offset:0 sc1 lds
 buffer_load_dwordx4 v1, s[4:7], s11 offen offset:1024 sc1 lds
 buffer_load_dwordx4 v1, s[4:7], s11 offen offset:2048 sc1 lds
 ds_read_b128 v[72:75], v6 offset:0
 ds_read_b128 v[76:79], v6 offset:1024
 ds_read_b128 v[80:83], v6 offset:2048
 ds_read_b128 v[84:87], v6 offset:3072
 ds_read_b128 v[88:91], v6 offset:4096
 ds_read_b128 v[92:95], v6 offset:5120
 ds_read_b128 v[96:99], v6 offset:6144
 ds_read_b128 v[100:103], v6 offset:7168
 v_mov_b64 v[60:61], 0
 v_mov_b64 v[62:63], 0
 v_mov_b64 v[64:65], 0
 v_mov_b64 v[66:67], 0
 v_mov_b64 v[68:69], 0
 v_mov_b64 v[70:71], 0
 s_waitcnt vmcnt(0)
 s_branch L_B_nofetch_53_j
L_B_nofetch_53:
 ds_read_b128 v[72:75], v6 offset:0
 ds_read_b128 v[76:79], v6 offset:1024
 ds_read_b128 v[80:83], v6 offset:2048
 ds_read_b128 v[84:87], v6 offset:3072
 ds_read_b128 v[88:91], v6 offset:4096
 ds_read_b128 v[92:95], v6 offset:5120
 ds_read_b128 v[96:99], v6 offset:6144
 ds_read_b128 v[100:103], v6 offset:7168
 v_mov_b64 v[60:61], 0
 v_mov_b64 v[62:63], 0
 v_mov_b64 v[64:65], 0
 v_mov_b64 v[66:67], 0
 v_mov_b64 v[68:69], 0
 v_mov_b64 v[70:71], 0
 s_waitcnt vmcnt(0)
L_B_nofetch_53_j:
 s_waitcnt lgkmcnt(0)
 s_barrier
 s_cmp_le_u32 s10, s32
 s_cbranch_scc1 L_Y_cnt_56
 s_mov_b32 s32, s10
 buffer_atomic_add v116, v117, s[4:7], s33 offen sc1
 s_add_u32 s33, s33, 128
L_Y_cnt_56:
 ds_read_b128 v[16:19], v1 offset:0
 ds_read_b128 v[20:23], v1 offset:1024
 ds_read_b128 v[24:27], v1 offset:2048
 s_waitcnt lgkmcnt(2)
 v_smfmac_f32_16x16x64_bf16 v[68:71], v[16:19], v[72:79], v5
 ds_read_b128 v[28:31], v1 offset:3072
 v_max3_u32 v4, v16, v17, v18
 s_waitcnt lgkmcnt(2)
 v_smfmac_f32_16x16x64_bf16 v[68:71], v[20:23], v[80:87], v5
 ds_read_b128 v[32:35], v1 offset:4096
 v_max_u32 v4, v4, v19
 s_waitcnt lgkmcnt(2)
 v_smfmac_f32_16x16x64_bf16 v[68:71], v[24:27], v[88:95], v5
 ds_read_b128 v[36:39], v1 offset:5120
 v_max3_u32 v4, v4, v20, v21
 s_waitcnt lgkmcnt(2)
 v_smfmac_f32_16x16x64_bf16 v[68:71], v[28:31], v[96:103], v5
 ds_read_b128 v[40:43], v1 offset:6144
 v_max3_u32 v4, v4, v22, v23
 v_smfmac_f32_16x16x64_bf16 v[60:63], v[16:19], v[120:127], v5
 ds_read_b128 v[72:75], v6 offset:8192
 v_max3_u32 v4, v4, v24, v25
 v_smfmac_f32_16x16x64_bf16 v[60:63], v[20:23], v[128:135], v5
 ds_read_b128 v[76:79], v6 offset:9216
 v_max3_u32 v4, v4, v26, v27
 v_smfmac_f32_16x16x64_bf16 v[60:63], v[24:27], v[136:143], v5
 ds_read_b128 v[80:83], v6 offset:10240
 v_max3_u32 v4, v4, v28, v29
 v_smfmac_f32_16x16x64_bf16 v[60:63], v[28:31], v[144:151], v5
 ds_read_b128 v[84:87], v6 offset:11264
 v_max3_u32 v4, v4, v30, v31
 s_waitcnt lgkmcnt(6)
 v_smfmac_f32_16x16x64_bf16 v[60:63], v[32:35], v[152:159], v5
 ds_read_b128 v[88:91], v6 offset:12288
 v_max3_u32 v4, v4, v32, v33
 s_waitcnt lgkmcnt(6)
 v_smfmac_f32_16x16x64_bf16 v[60:63], v[36:39], v[160:167], v5
 ds_read_b128 v[92:95], v6 offset:13312
 v_max3_u32 v4, v4, v34, v35
 s_waitcnt lgkmcnt(6)
 v_smfmac_f32_16x16x64_bf16 v[60:63], v[40:43], v[168:175], v5
 v_max3_u32 v4, v4, v36, v37
 s_waitcnt lgkmcnt(4)
 v_smfmac_f32_16x16x64_bf16 v[68:71], v[32:35], v[72:79], v5
 v_max3_u32 v4, v4, v38, v39
 s_waitcnt lgkmcnt(2)
 v_smfmac_f32_16x16x64_bf16 v[68:71], v[36:39], v[80:87], v5
 v_cvt_pk_bf16_f32 v44, v60, v61
 s_waitcnt lgkmcnt(0)
 v_smfmac_f32_16x16x64_bf16 v[68:71], v[40:43], v[88:95], v5
 v_cvt_pk_bf16_f32 v46, v62, v63
 v_smfmac_f32_16x16x64_bf16 v[64:67], v[16:19], v[176:183], v5
 v_mov_b64 v[60:61], 0
 v_smfmac_f32_16x16x64_bf16 v[64:67], v[20:23], v[184:191], v5
 v_mov_b64 v[62:63], 0
 v_smfmac_f32_16x16x64_bf16 v[64:67], v[24:27], v[192:199], v5
 v_cvt_pk_bf16_f32 v57, v68, v69
 v_smfmac_f32_16x16x64_bf16 v[64:67], v[28:31], v[200:207], v5
 v_cvt_pk_bf16_f32 v59, v70, v71
 v_smfmac_f32_16x16x64_bf16 v[64:67], v[32:35], v[208:215], v5
 v_mov_b64 v[68:69], 0
 v_smfmac_f32_16x16x64_bf16 v[64:67], v[36:39], v[216:223], v5
 v_mov_b64 v[70:71], 0
 v_smfmac_f32_16x16x64_bf16 v[64:67], v[40:43], v[224:231], v5
 v_max3_u32 v4, v4, v40, v41
 v_smfmac_f32_16x16x64_bf16 v[60:63], v[16:19], v[232:239], v5
 v_max3_u32 v4, v4, v42, v43
 v_smfmac_f32_16x16x64_bf16 v[60:63], v[20:23], v[240:247], v5
 v_cvt_pk_bf16_f32 v52, v64, v65
 v_smfmac_f32_16x16x64_bf16 v[60:63], v[24:27], v[248:255], v5
 v_cvt_pk_bf16_f32 v54, v66, v67
 v_smfmac_f32_16x16x64_bf16 v[60:63], v[28:31], a[0:7], v5
 v_mov_b64 v[64:65], 0
 v_smfmac_f32_16x16x64_bf16 v[60:63], v[32:35], a[8:15], v5
 v_mov_b64 v[66:67], 0
 v_smfmac_f32_16x16x64_bf16 v[60:63], v[36:39], a[16:23], v5
 v_cmp_eq_u32 vcc, -1, v4
 v_smfmac_f32_16x16x64_bf16 v[60:63], v[40:43], a[24:31], v5
 v_smfmac_f32_16x16x64_bf16 v[68:71], v[16:19], a[32:39], v5
 v_smfmac_f32_16x16x64_bf16 v[68:71], v[20:23], a[40:47], v5
 v_cvt_pk_bf16_f32 v45, v60, v61
 v_smfmac_f32_16x16x64_bf16 v[68:71], v[24:27], a[48:55], v5
 v_cvt_pk_bf16_f32 v47, v62, v63
 v_smfmac_f32_16x16x64_bf16 v[68:71], v[28:31], a[56:63], v5
 v_mov_b64 v[60:61], 0
 v_smfmac_f32_16x16x64_bf16 v[68:71], v[32:35], a[64:71], v5
 v_mov_b64 v[62:63], 0
 v_smfmac_f32_16x16x64_bf16 v[68:71], v[36:39], a[72:79], v5
 v_smfmac_f32_16x16x64_bf16 v[68:71], v[40:43], a[80:87], v5
 s_cbranch_vccnz L_B_retry_54
 v_smfmac_f32_16x16x64_bf16 v[64:67], v[16:19], a[88:95], v5
 v_smfmac_f32_16x16x64_bf16 v[64:67], v[20:23], a[96:103], v5
 v_cvt_pk_bf16_f32 v53, v68, v69
 v_smfmac_f32_16x16x64_bf16 v[64:67], v[24:27], a[104:111], v5
 v_cvt_pk_bf16_f32 v55, v70, v71
 v_smfmac_f32_16x16x64_bf16 v[64:67], v[28:31], a[112:119], v5
 v_mov_b64 v[68:69], 0
 v_smfmac_f32_16x16x64_bf16 v[64:67], v[32:35], a[120:127], v5
 v_mov_b64 v[70:71], 0
 v_smfmac_f32_16x16x64_bf16 v[64:67], v[36:39], a[128:135], v5
 v_smfmac_f32_16x16x64_bf16 v[64:67], v[40:43], a[136:143], v5
 v_smfmac_f32_16x16x64_bf16 v[60:63], v[16:19], a[144:151], v5
 v_smfmac_f32_16x16x64_bf16 v[60:63], v[20:23], a[152:159], v5
 v_cvt_pk_bf16_f32 v48, v64, v65
 v_smfmac_f32_16x16x64_bf16 v[60:63], v[24:27], a[160:167], v5
 v_cvt_pk_bf16_f32 v50, v66, v67
 v_smfmac_f32_16x16x64_bf16 v[60:63], v[28:31], a[168:175], v5
 v_smfmac_f32_16x16x64_bf16 v[60:63], v[32:35], a[176:183], v5
 v_smfmac_f32_16x16x64_bf16 v[60:63], v[36:39], a[184:191], v5
 v_smfmac_f32_16x16x64_bf16 v[60:63], v[40:43], a[192:199], v5
 v_smfmac_f32_16x16x64_bf16 v[68:71], v[16:19], a[200:207], v5
 v_smfmac_f32_16x16x64_bf16 v[68:71], v[20:23], a[208:215], v5
 v_cvt_pk_bf16_f32 v56, v60, v61
 v_smfmac_f32_16x16x64_bf16 v[68:71], v[24:27], a[216:223], v5
 v_cvt_pk_bf16_f32 v58, v62, v63
 v_smfmac_f32_16x16x64_bf16 v[68:71], v[28:31], a[224:231], v5
 v_smfmac_f32_16x16x64_bf16 v[68:71], v[32:35], a[232:239], v5
 v_smfmac_f32_16x16x64_bf16 v[68:71], v[36:39], a[240:247], v5
 v_smfmac_f32_16x16x64_bf16 v[68:71], v[40:43], a[248:255], v5
 s_nop 7
 v_cvt_pk_bf16_f32 v49, v68, v69
 v_cvt_pk_bf16_f32 v51, v70, v71
 s_add_u32 s11, s18, 0
 buffer_store_dwordx4 v[44:47], v1, s[4:7], s11 offen sc1
 s_add_u32 s11, s18, 1024
 buffer_store_dwordx4 v[52:55], v1, s[4:7], s11 offen sc1
 s_add_u32 s11, s18, 28672
 buffer_store_dwordx4 v[48:51], v1, s[4:7], s11 offen sc1
 s_add_u32 s11, s18, 29696
 buffer_store_dwordx4 v[56:59], v1, s[4:7], s11 offen sc1
 s_add_u32 s10, s10, 1
 s_add_u32 s14, s14, 7168
 s_add_u32 s18, s18, 229376
 s_cmp_lt_u32 s10, 64
 s_cbranch_scc1 L_B_loop_51
 s_waitcnt vmcnt(0) lgkmcnt(0)
 s_barrier
 buffer_atomic_add v116, v117, s[4:7], s33 offen sc1
 s_waitcnt vmcnt(0)
 s_branch K_loop
L_B_retry_54:
 s_mov_b32 s72, 4
 s_add_u32 s19, s19, 1
 s_cmp_gt_u32 s19, 16384
 s_cbranch_scc1 K_failw
 s_add_u32 s70, s70, 1
 s_waitcnt lgkmcnt(0)
 s_nop 7
 s_barrier
 s_branch L_B_fetch_52
K_rp:
 s_mov_b32 s33, 18413568
 s_cmp_lg_u32 s8, 0
 s_cbranch_scc1 L_wcrg_57_ok
 s_mov_b32 s19, 0
 v_mov_b32 v5, 0
 s_mov_b64 exec, 1
L_wcrg_57:
 buffer_load_dword v6, v5, s[4:7], s33 offen sc1
 s_waitcnt vmcnt(0)
 v_readfirstlane_b32 s11, v6
 s_cmp_ge_u32 s11, 28
 s_cbranch_scc1 L_wcrg_57_got
 s_sleep 12
 s_add_u32 s19, s19, 1
 s_cmp_le_u32 s19, 8192
 s_cbranch_scc1 L_wcrg_57
 s_branch K_failw
L_wcrg_57_got:
 s_mov_b64 exec, -1
L_wcrg_57_ok:
 s_barrier
 s_sub_u32 s20, s92, 70
 s_load_dwordx2 s[36:37], s[0:1], 64
 s_load_dwordx2 s[40:41], s[0:1], 72
 s_load_dwordx2 s[44:45], s[0:1], 80
 v_lshrrev_b32 v8, 4, v0
 v_mul_u32_u24 v5, 74, v0
 v_lshrrev_b32 v5, 10, v5
 v_mul_u32_u24 v6, 14, v5
 v_sub_u32 v6, v0, v6
 v_lshlrev_b32 v6, 4, v6
 v_mul_u32_u24 v7, 3584, v5
 v_add_u32 v7, v7, v6
 v_mul_u32_u24 v5, 896, v5
 v_add_u32 v5, v5, v6
 s_mul_i32 s30, s8, 26112
 v_mul_u32_u24 v6, 1088, v8
 v_bfe_u32 v8, v0, 2, 2
 v_mul_u32_u24 v8, 224, v8
 v_add_u32 v6, v6, v8
 v_and_b32 v8, 3, v0
 v_lshl_add_u32 v6, v8, 3, v6
 v_add_u32 v6, s30, v6
 s_mul_i32 s31, s20, 12
 s_mul_i32 s11, s8, 3
 s_add_u32 s31, s31, s11
 s_waitcnt lgkmcnt(0)
 s_and_b32 s37, s37, 0xffff
 s_mov_b32 s38, 1605632
 s_mov_b32 s39, 0x00020000
 s_and_b32 s41, s41, 0xffff
 s_mov_b32 s42, 1605632
 s_mov_b32 s43, 0x00020000
 s_and_b32 s45, s45, 0xffff
 s_mov_b32 s46, 1605632
 s_mov_b32 s47, 0x00020000
 s_add_u32 s32, s31, 0
 s_cmp_ge_u32 s32, 448
 s_cbranch_scc1 P_u_58_down
 s_cmp_ge_u32 s32, 224
 s_cselect_b32 s23, 1, 0
 s_mul_i32 s33, s23, 224
 s_sub_u32 s32, s32, s33
 s_lshr_b32 s21, s32, 4
 s_and_b32 s22, s32, 15
 s_mul_i32 s34, s21, 114688
 s_mul_i32 s35, s22, 224
 s_add_u32 s34, s34, s35
 s_cmp_eq_u32 s23, 1
 s_cbranch_scc1 P_u_58_up
 s_add_u32 s11, s30, 0
 s_mov_b32 m0, s11
 s_add_u32 s35, s34, 0
 buffer_load_dwordx4 v7, s[36:39], s35 offen lds
 s_add_u32 s11, s30, 1088
 s_mov_b32 m0, s11
 s_add_u32 s35, s34, 14336
 buffer_load_dwordx4 v7, s[36:39], s35 offen lds
 s_add_u32 s11, s30, 2176
 s_mov_b32 m0, s11
 s_add_u32 s35, s34, 28672
 buffer_load_dwordx4 v7, s[36:39], s35 offen lds
 s_add_u32 s11, s30, 3264
 s_mov_b32 m0, s11
 s_add_u32 s35, s34, 43008
 buffer_load_dwordx4 v7, s[36:39], s35 offen lds
 s_add_u32 s11, s30, 4352
 s_mov_b32 m0, s11
 s_add_u32 s35, s34, 57344
 buffer_load_dwordx4 v7, s[36:39], s35 offen lds
 s_add_u32 s11, s30, 5440
 s_mov_b32 m0, s11
 s_add_u32 s35, s34, 71680
 buffer_load_dwordx4 v7, s[36:39], s35 offen lds
 s_add_u32 s11, s30, 6528
 s_mov_b32 m0, s11
 s_add_u32 s35, s34, 86016
 buffer_load_dwordx4 v7, s[36:39], s35 offen lds
 s_add_u32 s11, s30, 7616
 s_mov_b32 m0, s11
 s_add_u32 s35, s34, 100352
 buffer_load_dwordx4 v7, s[36:39], s35 offen lds
 s_branch P_u_58_done
P_u_58_up:
 s_add_u32 s11, s30, 0
 s_mov_b32 m0, s11
 s_add_u32 s35, s34, 0
 buffer_load_dwordx4 v7, s[40:43], s35 offen lds
 s_add_u32 s11, s30, 1088
 s_mov_b32 m0, s11
 s_add_u32 s35, s34, 14336
 buffer_load_dwordx4 v7, s[40:43], s35 offen lds
 s_add_u32 s11, s30, 2176
 s_mov_b32 m0, s11
 s_add_u32 s35, s34, 28672
 buffer_load_dwordx4 v7, s[40:43], s35 offen lds
 s_add_u32 s11, s30, 3264
 s_mov_b32 m0, s11
 s_add_u32 s35, s34, 43008
 buffer_load_dwordx4 v7, s[40:43], s35 offen lds
 s_add_u32 s11, s30, 4352
 s_mov_b32 m0, s11
 s_add_u32 s35, s34, 57344
 buffer_load_dwordx4 v7, s[40:43], s35 offen lds
 s_add_u32 s11, s30, 5440
 s_mov_b32 m0, s11
 s_add_u32 s35, s34, 71680
 buffer_load_dwordx4 v7, s[40:43], s35 offen lds
 s_add_u32 s11, s30, 6528
 s_mov_b32 m0, s11
 s_add_u32 s35, s34, 86016
 buffer_load_dwordx4 v7, s[40:43], s35 offen lds
 s_add_u32 s11, s30, 7616
 s_mov_b32 m0, s11
 s_add_u32 s35, s34, 100352
 buffer_load_dwordx4 v7, s[40:43], s35 offen lds
 s_branch P_u_58_done
P_u_58_down:
 s_sub_u32 s32, s32, 448
 s_lshr_b32 s21, s32, 2
 s_and_b32 s22, s32, 3
 s_mov_b32 s23, 2
 s_mul_i32 s34, s21, 28672
 s_mul_i32 s35, s22, 224
 s_add_u32 s34, s34, s35
 s_add_u32 s11, s30, 0
 s_mov_b32 m0, s11
 s_add_u32 s35, s34, 0
 buffer_load_dwordx4 v5, s[44:47], s35 offen lds
 s_add_u32 s11, s30, 1088
 s_mov_b32 m0, s11
 s_add_u32 s35, s34, 3584
 buffer_load_dwordx4 v5, s[44:47], s35 offen lds
 s_add_u32 s11, s30, 2176
 s_mov_b32 m0, s11
 s_add_u32 s35, s34, 7168
 buffer_load_dwordx4 v5, s[44:47], s35 offen lds
 s_add_u32 s11, s30, 3264
 s_mov_b32 m0, s11
 s_add_u32 s35, s34, 10752
 buffer_load_dwordx4 v5, s[44:47], s35 offen lds
 s_add_u32 s11, s30, 4352
 s_mov_b32 m0, s11
 s_add_u32 s35, s34, 14336
 buffer_load_dwordx4 v5, s[44:47], s35 offen lds
 s_add_u32 s11, s30, 5440
 s_mov_b32 m0, s11
 s_add_u32 s35, s34, 17920
 buffer_load_dwordx4 v5, s[44:47], s35 offen lds
 s_add_u32 s11, s30, 6528
 s_mov_b32 m0, s11
 s_add_u32 s35, s34, 21504
 buffer_load_dwordx4 v5, s[44:47], s35 offen lds
 s_add_u32 s11, s30, 7616
 s_mov_b32 m0, s11
 s_add_u32 s35, s34, 25088
 buffer_load_dwordx4 v5, s[44:47], s35 offen lds
P_u_58_done:
 s_add_u32 s32, s31, 1
 s_cmp_ge_u32 s32, 448
 s_cbranch_scc1 P_u_59_down
 s_cmp_ge_u32 s32, 224
 s_cselect_b32 s26, 1, 0
 s_mul_i32 s33, s26, 224
 s_sub_u32 s32, s32, s33
 s_lshr_b32 s24, s32, 4
 s_and_b32 s25, s32, 15
 s_mul_i32 s34, s24, 114688
 s_mul_i32 s35, s25, 224
 s_add_u32 s34, s34, s35
 s_cmp_eq_u32 s26, 1
 s_cbranch_scc1 P_u_59_up
 s_add_u32 s11, s30, 8704
 s_mov_b32 m0, s11
 s_add_u32 s35, s34, 0
 buffer_load_dwordx4 v7, s[36:39], s35 offen lds
 s_add_u32 s11, s30, 9792
 s_mov_b32 m0, s11
 s_add_u32 s35, s34, 14336
 buffer_load_dwordx4 v7, s[36:39], s35 offen lds
 s_add_u32 s11, s30, 10880
 s_mov_b32 m0, s11
 s_add_u32 s35, s34, 28672
 buffer_load_dwordx4 v7, s[36:39], s35 offen lds
 s_add_u32 s11, s30, 11968
 s_mov_b32 m0, s11
 s_add_u32 s35, s34, 43008
 buffer_load_dwordx4 v7, s[36:39], s35 offen lds
 s_add_u32 s11, s30, 13056
 s_mov_b32 m0, s11
 s_add_u32 s35, s34, 57344
 buffer_load_dwordx4 v7, s[36:39], s35 offen lds
 s_add_u32 s11, s30, 14144
 s_mov_b32 m0, s11
 s_add_u32 s35, s34, 71680
 buffer_load_dwordx4 v7, s[36:39], s35 offen lds
 s_add_u32 s11, s30, 15232
 s_mov_b32 m0, s11
 s_add_u32 s35, s34, 86016
 buffer_load_dwordx4 v7, s[36:39], s35 offen lds
 s_add_u32 s11, s30, 16320
 s_mov_b32 m0, s11
 s_add_u32 s35, s34, 100352
 buffer_load_dwordx4 v7, s[36:39], s35 offen lds
 s_branch P_u_59_done
P_u_59_up:
 s_add_u32 s11, s30, 8704
 s_mov_b32 m0, s11
 s_add_u32 s35, s34, 0
 buffer_load_dwordx4 v7, s[40:43], s35 offen lds
 s_add_u32 s11, s30, 9792
 s_mov_b32 m0, s11
 s_add_u32 s35, s34, 14336
 buffer_load_dwordx4 v7, s[40:43], s35 offen lds
 s_add_u32 s11, s30, 10880
 s_mov_b32 m0, s11
 s_add_u32 s35, s34, 28672
 buffer_load_dwordx4 v7, s[40:43], s35 offen lds
 s_add_u32 s11, s30, 11968
 s_mov_b32 m0, s11
 s_add_u32 s35, s34, 43008
 buffer_load_dwordx4 v7, s[40:43], s35 offen lds
 s_add_u32 s11, s30, 13056
 s_mov_b32 m0, s11
 s_add_u32 s35, s34, 57344
 buffer_load_dwordx4 v7, s[40:43], s35 offen lds
 s_add_u32 s11, s30, 14144
 s_mov_b32 m0, s11
 s_add_u32 s35, s34, 71680
 buffer_load_dwordx4 v7, s[40:43], s35 offen lds
 s_add_u32 s11, s30, 15232
 s_mov_b32 m0, s11
 s_add_u32 s35, s34, 86016
 buffer_load_dwordx4 v7, s[40:43], s35 offen lds
 s_add_u32 s11, s30, 16320
 s_mov_b32 m0, s11
 s_add_u32 s35, s34, 100352
 buffer_load_dwordx4 v7, s[40:43], s35 offen lds
 s_branch P_u_59_done
P_u_59_down:
 s_sub_u32 s32, s32, 448
 s_lshr_b32 s24, s32, 2
 s_and_b32 s25, s32, 3
 s_mov_b32 s26, 2
 s_mul_i32 s34, s24, 28672
 s_mul_i32 s35, s25, 224
 s_add_u32 s34, s34, s35
 s_add_u32 s11, s30, 8704
 s_mov_b32 m0, s11
 s_add_u32 s35, s34, 0
 buffer_load_dwordx4 v5, s[44:47], s35 offen lds
 s_add_u32 s11, s30, 9792
 s_mov_b32 m0, s11
 s_add_u32 s35, s34, 3584
 buffer_load_dwordx4 v5, s[44:47], s35 offen lds
 s_add_u32 s11, s30, 10880
 s_mov_b32 m0, s11
 s_add_u32 s35, s34, 7168
 buffer_load_dwordx4 v5, s[44:47], s35 offen lds
 s_add_u32 s11, s30, 11968
 s_mov_b32 m0, s11
 s_add_u32 s35, s34, 10752
 buffer_load_dwordx4 v5, s[44:47], s35 offen lds
 s_add_u32 s11, s30, 13056
 s_mov_b32 m0, s11
 s_add_u32 s35, s34, 14336
 buffer_load_dwordx4 v5, s[44:47], s35 offen lds
 s_add_u32 s11, s30, 14144
 s_mov_b32 m0, s11
 s_add_u32 s35, s34, 17920
 buffer_load_dwordx4 v5, s[44:47], s35 offen lds
 s_add_u32 s11, s30, 15232
 s_mov_b32 m0, s11
 s_add_u32 s35, s34, 21504
 buffer_load_dwordx4 v5, s[44:47], s35 offen lds
 s_add_u32 s11, s30, 16320
 s_mov_b32 m0, s11
 s_add_u32 s35, s34, 25088
 buffer_load_dwordx4 v5, s[44:47], s35 offen lds
P_u_59_done:
 s_add_u32 s32, s31, 2
 s_cmp_ge_u32 s32, 448
 s_cbranch_scc1 P_u_60_down
 s_cmp_ge_u32 s32, 224
 s_cselect_b32 s29, 1, 0
 s_mul_i32 s33, s29, 224
 s_sub_u32 s32, s32, s33
 s_lshr_b32 s27, s32, 4
 s_and_b32 s28, s32, 15
 s_mul_i32 s34, s27, 114688
 s_mul_i32 s35, s28, 224
 s_add_u32 s34, s34, s35
 s_cmp_eq_u32 s29, 1
 s_cbranch_scc1 P_u_60_up
 s_add_u32 s11, s30, 17408
 s_mov_b32 m0, s11
 s_add_u32 s35, s34, 0
 buffer_load_dwordx4 v7, s[36:39], s35 offen lds
 s_add_u32 s11, s30, 18496
 s_mov_b32 m0, s11
 s_add_u32 s35, s34, 14336
 buffer_load_dwordx4 v7, s[36:39], s35 offen lds
 s_add_u32 s11, s30, 19584
 s_mov_b32 m0, s11
 s_add_u32 s35, s34, 28672
 buffer_load_dwordx4 v7, s[36:39], s35 offen lds
 s_add_u32 s11, s30, 20672
 s_mov_b32 m0, s11
 s_add_u32 s35, s34, 43008
 buffer_load_dwordx4 v7, s[36:39], s35 offen lds
 s_add_u32 s11, s30, 21760
 s_mov_b32 m0, s11
 s_add_u32 s35, s34, 57344
 buffer_load_dwordx4 v7, s[36:39], s35 offen lds
 s_add_u32 s11, s30, 22848
 s_mov_b32 m0, s11
 s_add_u32 s35, s34, 71680
 buffer_load_dwordx4 v7, s[36:39], s35 offen lds
 s_add_u32 s11, s30, 23936
 s_mov_b32 m0, s11
 s_add_u32 s35, s34, 86016
 buffer_load_dwordx4 v7, s[36:39], s35 offen lds
 s_add_u32 s11, s30, 25024
 s_mov_b32 m0, s11
 s_add_u32 s35, s34, 100352
 buffer_load_dwordx4 v7, s[36:39], s35 offen lds
 s_branch P_u_60_done
P_u_60_up:
 s_add_u32 s11, s30, 17408
 s_mov_b32 m0, s11
 s_add_u32 s35, s34, 0
 buffer_load_dwordx4 v7, s[40:43], s35 offen lds
 s_add_u32 s11, s30, 18496
 s_mov_b32 m0, s11
 s_add_u32 s35, s34, 14336
 buffer_load_dwordx4 v7, s[40:43], s35 offen lds
 s_add_u32 s11, s30, 19584
 s_mov_b32 m0, s11
 s_add_u32 s35, s34, 28672
 buffer_load_dwordx4 v7, s[40:43], s35 offen lds
 s_add_u32 s11, s30, 20672
 s_mov_b32 m0, s11
 s_add_u32 s35, s34, 43008
 buffer_load_dwordx4 v7, s[40:43], s35 offen lds
 s_add_u32 s11, s30, 21760
 s_mov_b32 m0, s11
 s_add_u32 s35, s34, 57344
 buffer_load_dwordx4 v7, s[40:43], s35 offen lds
 s_add_u32 s11, s30, 22848
 s_mov_b32 m0, s11
 s_add_u32 s35, s34, 71680
 buffer_load_dwordx4 v7, s[40:43], s35 offen lds
 s_add_u32 s11, s30, 23936
 s_mov_b32 m0, s11
 s_add_u32 s35, s34, 86016
 buffer_load_dwordx4 v7, s[40:43], s35 offen lds
 s_add_u32 s11, s30, 25024
 s_mov_b32 m0, s11
 s_add_u32 s35, s34, 100352
 buffer_load_dwordx4 v7, s[40:43], s35 offen lds
 s_branch P_u_60_done
P_u_60_down:
 s_sub_u32 s32, s32, 448
 s_lshr_b32 s27, s32, 2
 s_and_b32 s28, s32, 3
 s_mov_b32 s29, 2
 s_mul_i32 s34, s27, 28672
 s_mul_i32 s35, s28, 224
 s_add_u32 s34, s34, s35
 s_add_u32 s11, s30, 17408
 s_mov_b32 m0, s11
 s_add_u32 s35, s34, 0
 buffer_load_dwordx4 v5, s[44:47], s35 offen lds
 s_add_u32 s11, s30, 18496
 s_mov_b32 m0, s11
 s_add_u32 s35, s34, 3584
 buffer_load_dwordx4 v5, s[44:47], s35 offen lds
 s_add_u32 s11, s30, 19584
 s_mov_b32 m0, s11
 s_add_u32 s35, s34, 7168
 buffer_load_dwordx4 v5, s[44:47], s35 offen lds
 s_add_u32 s11, s30, 20672
 s_mov_b32 m0, s11
 s_add_u32 s35, s34, 10752
 buffer_load_dwordx4 v5, s[44:47], s35 offen lds
 s_add_u32 s11, s30, 21760
 s_mov_b32 m0, s11
 s_add_u32 s35, s34, 14336
 buffer_load_dwordx4 v5, s[44:47], s35 offen lds
 s_add_u32 s11, s30, 22848
 s_mov_b32 m0, s11
 s_add_u32 s35, s34, 17920
 buffer_load_dwordx4 v5, s[44:47], s35 offen lds
 s_add_u32 s11, s30, 23936
 s_mov_b32 m0, s11
 s_add_u32 s35, s34, 21504
 buffer_load_dwordx4 v5, s[44:47], s35 offen lds
 s_add_u32 s11, s30, 25024
 s_mov_b32 m0, s11
 s_add_u32 s35, s34, 25088
 buffer_load_dwordx4 v5, s[44:47], s35 offen lds
P_u_60_done:
 s_waitcnt vmcnt(0)
 ds_read_b64_tr_b16 v[32:33], v6 offset:0
 ds_read_b64_tr_b16 v[34:35], v6 offset:4352
 ds_read_b64_tr_b16 v[36:37], v6 offset:32
 ds_read_b64_tr_b16 v[38:39], v6 offset:4384
 ds_read_b64_tr_b16 v[40:41], v6 offset:64
 ds_read_b64_tr_b16 v[42:43], v6 offset:4416
 ds_read_b64_tr_b16 v[44:45], v6 offset:96
 ds_read_b64_tr_b16 v[46:47], v6 offset:4448
 ds_read_b64_tr_b16 v[48:49], v6 offset:128
 ds_read_b64_tr_b16 v[50:51], v6 offset:4480
 ds_read_b64_tr_b16 v[52:53], v6 offset:160
 ds_read_b64_tr_b16 v[54:55], v6 offset:4512
 ds_read_b64_tr_b16 v[56:57], v6 offset:192
 ds_read_b64_tr_b16 v[58:59], v6 offset:4544
 s_waitcnt lgkmcnt(0)
 v_swap_b32 v33, v34
 v_swap_b32 v37, v38
 v_swap_b32 v41, v42
 v_swap_b32 v45, v46
 v_swap_b32 v49, v50
 v_swap_b32 v53, v54
 v_swap_b32 v57, v58
 s_mul_i32 s32, s22, 7
 s_add_u32 s33, s32, 0
 s_cmp_eq_u32 s23, 2
 s_cbranch_scc1 P_o_61_d0
 s_lshr_b32 s34, s33, 1
 s_lshl_b32 s34, s34, 2
 s_and_b32 s35, s33, 1
 s_add_u32 s34, s34, s35
 s_lshl_b32 s35, s23, 1
 s_add_u32 s34, s34, s35
 s_mul_i32 s34, s34, 14
 s_add_u32 s34, s34, s21
 s_lshl_b32 s34, s34, 10
 s_add_u32 s34, s34, 104857600
 s_branch P_o_61_s0
P_o_61_d0:
 s_mul_i32 s34, s33, 56
 s_add_u32 s34, s34, s21
 s_lshl_b32 s34, s34, 10
 s_add_u32 s34, s34, 109051904
P_o_61_s0:
 buffer_store_dwordx4 v[32:35], v1, s[4:7], s34 offen sc1
 s_add_u32 s33, s32, 1
 s_cmp_eq_u32 s23, 2
 s_cbranch_scc1 P_o_61_d1
 s_lshr_b32 s34, s33, 1
 s_lshl_b32 s34, s34, 2
 s_and_b32 s35, s33, 1
 s_add_u32 s34, s34, s35
 s_lshl_b32 s35, s23, 1
 s_add_u32 s34, s34, s35
 s_mul_i32 s34, s34, 14
 s_add_u32 s34, s34, s21
 s_lshl_b32 s34, s34, 10
 s_add_u32 s34, s34, 104857600
 s_branch P_o_61_s1
P_o_61_d1:
 s_mul_i32 s34, s33, 56
 s_add_u32 s34, s34, s21
 s_lshl_b32 s34, s34, 10
 s_add_u32 s34, s34, 109051904
P_o_61_s1:
 buffer_store_dwordx4 v[36:39], v1, s[4:7], s34 offen sc1
 s_add_u32 s33, s32, 2
 s_cmp_eq_u32 s23, 2
 s_cbranch_scc1 P_o_61_d2
 s_lshr_b32 s34, s33, 1
 s_lshl_b32 s34, s34, 2
 s_and_b32 s35, s33, 1
 s_add_u32 s34, s34, s35
 s_lshl_b32 s35, s23, 1
 s_add_u32 s34, s34, s35
 s_mul_i32 s34, s34, 14
 s_add_u32 s34, s34, s21
 s_lshl_b32 s34, s34, 10
 s_add_u32 s34, s34, 104857600
 s_branch P_o_61_s2
P_o_61_d2:
 s_mul_i32 s34, s33, 56
 s_add_u32 s34, s34, s21
 s_lshl_b32 s34, s34, 10
 s_add_u32 s34, s34, 109051904
P_o_61_s2:
 buffer_store_dwordx4 v[40:43], v1, s[4:7], s34 offen sc1
 s_add_u32 s33, s32, 3
 s_cmp_eq_u32 s23, 2
 s_cbranch_scc1 P_o_61_d3
 s_lshr_b32 s34, s33, 1
 s_lshl_b32 s34, s34, 2
 s_and_b32 s35, s33, 1
 s_add_u32 s34, s34, s35
 s_lshl_b32 s35, s23, 1
 s_add_u32 s34, s34, s35
 s_mul_i32 s34, s34, 14
 s_add_u32 s34, s34, s21
 s_lshl_b32 s34, s34, 10
 s_add_u32 s34, s34, 104857600
 s_branch P_o_61_s3
P_o_61_d3:
 s_mul_i32 s34, s33, 56
 s_add_u32 s34, s34, s21
 s_lshl_b32 s34, s34, 10
 s_add_u32 s34, s34, 109051904
P_o_61_s3:
 buffer_store_dwordx4 v[44:47], v1, s[4:7], s34 offen sc1
 s_add_u32 s33, s32, 4
 s_cmp_eq_u32 s23, 2
 s_cbranch_scc1 P_o_61_d4
 s_lshr_b32 s34, s33, 1
 s_lshl_b32 s34, s34, 2
 s_and_b32 s35, s33, 1
 s_add_u32 s34, s34, s35
 s_lshl_b32 s35, s23, 1
 s_add_u32 s34, s34, s35
 s_mul_i32 s34, s34, 14
 s_add_u32 s34, s34, s21
 s_lshl_b32 s34, s34, 10
 s_add_u32 s34, s34, 104857600
 s_branch P_o_61_s4
P_o_61_d4:
 s_mul_i32 s34, s33, 56
 s_add_u32 s34, s34, s21
 s_lshl_b32 s34, s34, 10
 s_add_u32 s34, s34, 109051904
P_o_61_s4:
 buffer_store_dwordx4 v[48:51], v1, s[4:7], s34 offen sc1
 s_add_u32 s33, s32, 5
 s_cmp_eq_u32 s23, 2
 s_cbranch_scc1 P_o_61_d5
 s_lshr_b32 s34, s33, 1
 s_lshl_b32 s34, s34, 2
 s_and_b32 s35, s33, 1
 s_add_u32 s34, s34, s35
 s_lshl_b32 s35, s23, 1
 s_add_u32 s34, s34, s35
 s_mul_i32 s34, s34, 14
 s_add_u32 s34, s34, s21
 s_lshl_b32 s34, s34, 10
 s_add_u32 s34, s34, 104857600
 s_branch P_o_61_s5
P_o_61_d5:
 s_mul_i32 s34, s33, 56
 s_add_u32 s34, s34, s21
 s_lshl_b32 s34, s34, 10
 s_add_u32 s34, s34, 109051904
P_o_61_s5:
 buffer_store_dwordx4 v[52:55], v1, s[4:7], s34 offen sc1
 s_add_u32 s33, s32, 6
 s_cmp_eq_u32 s23, 2
 s_cbranch_scc1 P_o_61_d6
 s_lshr_b32 s34, s33, 1
 s_lshl_b32 s34, s34, 2
 s_and_b32 s35, s33, 1
 s_add_u32 s34, s34, s35
 s_lshl_b32 s35, s23, 1
 s_add_u32 s34, s34, s35
 s_mul_i32 s34, s34, 14
 s_add_u32 s34, s34, s21
 s_lshl_b32 s34, s34, 10
 s_add_u32 s34, s34, 104857600
 s_branch P_o_61_s6
P_o_61_d6:
 s_mul_i32 s34, s33, 56
 s_add_u32 s34, s34, s21
 s_lshl_b32 s34, s34, 10
 s_add_u32 s34, s34, 109051904
P_o_61_s6:
 buffer_store_dwordx4 v[56:59], v1, s[4:7], s34 offen sc1
 ds_read_b64_tr_b16 v[60:61], v6 offset:8704
 ds_read_b64_tr_b16 v[62:63], v6 offset:13056
 ds_read_b64_tr_b16 v[64:65], v6 offset:8736
 ds_read_b64_tr_b16 v[66:67], v6 offset:13088
 ds_read_b64_tr_b16 v[68:69], v6 offset:8768
 ds_read_b64_tr_b16 v[70:71], v6 offset:13120
 ds_read_b64_tr_b16 v[72:73], v6 offset:8800
 ds_read_b64_tr_b16 v[74:75], v6 offset:13152
 ds_read_b64_tr_b16 v[76:77], v6 offset:8832
 ds_read_b64_tr_b16 v[78:79], v6 offset:13184
 ds_read_b64_tr_b16 v[80:81], v6 offset:8864
 ds_read_b64_tr_b16 v[82:83], v6 offset:13216
 ds_read_b64_tr_b16 v[84:85], v6 offset:8896
 ds_read_b64_tr_b16 v[86:87], v6 offset:13248
 s_waitcnt lgkmcnt(0)
 v_swap_b32 v61, v62
 v_swap_b32 v65, v66
 v_swap_b32 v69, v70
 v_swap_b32 v73, v74
 v_swap_b32 v77, v78
 v_swap_b32 v81, v82
 v_swap_b32 v85, v86
 s_mul_i32 s32, s25, 7
 s_add_u32 s33, s32, 0
 s_cmp_eq_u32 s26, 2
 s_cbranch_scc1 P_o_62_d0
 s_lshr_b32 s34, s33, 1
 s_lshl_b32 s34, s34, 2
 s_and_b32 s35, s33, 1
 s_add_u32 s34, s34, s35
 s_lshl_b32 s35, s26, 1
 s_add_u32 s34, s34, s35
 s_mul_i32 s34, s34, 14
 s_add_u32 s34, s34, s24
 s_lshl_b32 s34, s34, 10
 s_add_u32 s34, s34, 104857600
 s_branch P_o_62_s0
P_o_62_d0:
 s_mul_i32 s34, s33, 56
 s_add_u32 s34, s34, s24
 s_lshl_b32 s34, s34, 10
 s_add_u32 s34, s34, 109051904
P_o_62_s0:
 buffer_store_dwordx4 v[60:63], v1, s[4:7], s34 offen sc1
 s_add_u32 s33, s32, 1
 s_cmp_eq_u32 s26, 2
 s_cbranch_scc1 P_o_62_d1
 s_lshr_b32 s34, s33, 1
 s_lshl_b32 s34, s34, 2
 s_and_b32 s35, s33, 1
 s_add_u32 s34, s34, s35
 s_lshl_b32 s35, s26, 1
 s_add_u32 s34, s34, s35
 s_mul_i32 s34, s34, 14
 s_add_u32 s34, s34, s24
 s_lshl_b32 s34, s34, 10
 s_add_u32 s34, s34, 104857600
 s_branch P_o_62_s1
P_o_62_d1:
 s_mul_i32 s34, s33, 56
 s_add_u32 s34, s34, s24
 s_lshl_b32 s34, s34, 10
 s_add_u32 s34, s34, 109051904
P_o_62_s1:
 buffer_store_dwordx4 v[64:67], v1, s[4:7], s34 offen sc1
 s_add_u32 s33, s32, 2
 s_cmp_eq_u32 s26, 2
 s_cbranch_scc1 P_o_62_d2
 s_lshr_b32 s34, s33, 1
 s_lshl_b32 s34, s34, 2
 s_and_b32 s35, s33, 1
 s_add_u32 s34, s34, s35
 s_lshl_b32 s35, s26, 1
 s_add_u32 s34, s34, s35
 s_mul_i32 s34, s34, 14
 s_add_u32 s34, s34, s24
 s_lshl_b32 s34, s34, 10
 s_add_u32 s34, s34, 104857600
 s_branch P_o_62_s2
P_o_62_d2:
 s_mul_i32 s34, s33, 56
 s_add_u32 s34, s34, s24
 s_lshl_b32 s34, s34, 10
 s_add_u32 s34, s34, 109051904
P_o_62_s2:
 buffer_store_dwordx4 v[68:71], v1, s[4:7], s34 offen sc1
 s_add_u32 s33, s32, 3
 s_cmp_eq_u32 s26, 2
 s_cbranch_scc1 P_o_62_d3
 s_lshr_b32 s34, s33, 1
 s_lshl_b32 s34, s34, 2
 s_and_b32 s35, s33, 1
 s_add_u32 s34, s34, s35
 s_lshl_b32 s35, s26, 1
 s_add_u32 s34, s34, s35
 s_mul_i32 s34, s34, 14
 s_add_u32 s34, s34, s24
 s_lshl_b32 s34, s34, 10
 s_add_u32 s34, s34, 104857600
 s_branch P_o_62_s3
P_o_62_d3:
 s_mul_i32 s34, s33, 56
 s_add_u32 s34, s34, s24
 s_lshl_b32 s34, s34, 10
 s_add_u32 s34, s34, 109051904
P_o_62_s3:
 buffer_store_dwordx4 v[72:75], v1, s[4:7], s34 offen sc1
 s_add_u32 s33, s32, 4
 s_cmp_eq_u32 s26, 2
 s_cbranch_scc1 P_o_62_d4
 s_lshr_b32 s34, s33, 1
 s_lshl_b32 s34, s34, 2
 s_and_b32 s35, s33, 1
 s_add_u32 s34, s34, s35
 s_lshl_b32 s35, s26, 1
 s_add_u32 s34, s34, s35
 s_mul_i32 s34, s34, 14
 s_add_u32 s34, s34, s24
 s_lshl_b32 s34, s34, 10
 s_add_u32 s34, s34, 104857600
 s_branch P_o_62_s4
P_o_62_d4:
 s_mul_i32 s34, s33, 56
 s_add_u32 s34, s34, s24
 s_lshl_b32 s34, s34, 10
 s_add_u32 s34, s34, 109051904
P_o_62_s4:
 buffer_store_dwordx4 v[76:79], v1, s[4:7], s34 offen sc1
 s_add_u32 s33, s32, 5
 s_cmp_eq_u32 s26, 2
 s_cbranch_scc1 P_o_62_d5
 s_lshr_b32 s34, s33, 1
 s_lshl_b32 s34, s34, 2
 s_and_b32 s35, s33, 1
 s_add_u32 s34, s34, s35
 s_lshl_b32 s35, s26, 1
 s_add_u32 s34, s34, s35
 s_mul_i32 s34, s34, 14
 s_add_u32 s34, s34, s24
 s_lshl_b32 s34, s34, 10
 s_add_u32 s34, s34, 104857600
 s_branch P_o_62_s5
P_o_62_d5:
 s_mul_i32 s34, s33, 56
 s_add_u32 s34, s34, s24
 s_lshl_b32 s34, s34, 10
 s_add_u32 s34, s34, 109051904
P_o_62_s5:
 buffer_store_dwordx4 v[80:83], v1, s[4:7], s34 offen sc1
 s_add_u32 s33, s32, 6
 s_cmp_eq_u32 s26, 2
 s_cbranch_scc1 P_o_62_d6
 s_lshr_b32 s34, s33, 1
 s_lshl_b32 s34, s34, 2
 s_and_b32 s35, s33, 1
 s_add_u32 s34, s34, s35
 s_lshl_b32 s35, s26, 1
 s_add_u32 s34, s34, s35
 s_mul_i32 s34, s34, 14
 s_add_u32 s34, s34, s24
 s_lshl_b32 s34, s34, 10
 s_add_u32 s34, s34, 104857600
 s_branch P_o_62_s6
P_o_62_d6:
 s_mul_i32 s34, s33, 56
 s_add_u32 s34, s34, s24
 s_lshl_b32 s34, s34, 10
 s_add_u32 s34, s34, 109051904
P_o_62_s6:
 buffer_store_dwordx4 v[84:87], v1, s[4:7], s34 offen sc1
 ds_read_b64_tr_b16 v[88:89], v6 offset:17408
 ds_read_b64_tr_b16 v[90:91], v6 offset:21760
 ds_read_b64_tr_b16 v[92:93], v6 offset:17440
 ds_read_b64_tr_b16 v[94:95], v6 offset:21792
 ds_read_b64_tr_b16 v[96:97], v6 offset:17472
 ds_read_b64_tr_b16 v[98:99], v6 offset:21824
 ds_read_b64_tr_b16 v[100:101], v6 offset:17504
 ds_read_b64_tr_b16 v[102:103], v6 offset:21856
 ds_read_b64_tr_b16 v[104:105], v6 offset:17536
 ds_read_b64_tr_b16 v[106:107], v6 offset:21888
 ds_read_b64_tr_b16 v[108:109], v6 offset:17568
 ds_read_b64_tr_b16 v[110:111], v6 offset:21920
 ds_read_b64_tr_b16 v[112:113], v6 offset:17600
 ds_read_b64_tr_b16 v[114:115], v6 offset:21952
 s_waitcnt lgkmcnt(0)
 v_swap_b32 v89, v90
 v_swap_b32 v93, v94
 v_swap_b32 v97, v98
 v_swap_b32 v101, v102
 v_swap_b32 v105, v106
 v_swap_b32 v109, v110
 v_swap_b32 v113, v114
 s_mul_i32 s32, s28, 7
 s_add_u32 s33, s32, 0
 s_cmp_eq_u32 s29, 2
 s_cbranch_scc1 P_o_63_d0
 s_lshr_b32 s34, s33, 1
 s_lshl_b32 s34, s34, 2
 s_and_b32 s35, s33, 1
 s_add_u32 s34, s34, s35
 s_lshl_b32 s35, s29, 1
 s_add_u32 s34, s34, s35
 s_mul_i32 s34, s34, 14
 s_add_u32 s34, s34, s27
 s_lshl_b32 s34, s34, 10
 s_add_u32 s34, s34, 104857600
 s_branch P_o_63_s0
P_o_63_d0:
 s_mul_i32 s34, s33, 56
 s_add_u32 s34, s34, s27
 s_lshl_b32 s34, s34, 10
 s_add_u32 s34, s34, 109051904
P_o_63_s0:
 buffer_store_dwordx4 v[88:91], v1, s[4:7], s34 offen sc1
 s_add_u32 s33, s32, 1
 s_cmp_eq_u32 s29, 2
 s_cbranch_scc1 P_o_63_d1
 s_lshr_b32 s34, s33, 1
 s_lshl_b32 s34, s34, 2
 s_and_b32 s35, s33, 1
 s_add_u32 s34, s34, s35
 s_lshl_b32 s35, s29, 1
 s_add_u32 s34, s34, s35
 s_mul_i32 s34, s34, 14
 s_add_u32 s34, s34, s27
 s_lshl_b32 s34, s34, 10
 s_add_u32 s34, s34, 104857600
 s_branch P_o_63_s1
P_o_63_d1:
 s_mul_i32 s34, s33, 56
 s_add_u32 s34, s34, s27
 s_lshl_b32 s34, s34, 10
 s_add_u32 s34, s34, 109051904
P_o_63_s1:
 buffer_store_dwordx4 v[92:95], v1, s[4:7], s34 offen sc1
 s_add_u32 s33, s32, 2
 s_cmp_eq_u32 s29, 2
 s_cbranch_scc1 P_o_63_d2
 s_lshr_b32 s34, s33, 1
 s_lshl_b32 s34, s34, 2
 s_and_b32 s35, s33, 1
 s_add_u32 s34, s34, s35
 s_lshl_b32 s35, s29, 1
 s_add_u32 s34, s34, s35
 s_mul_i32 s34, s34, 14
 s_add_u32 s34, s34, s27
 s_lshl_b32 s34, s34, 10
 s_add_u32 s34, s34, 104857600
 s_branch P_o_63_s2
P_o_63_d2:
 s_mul_i32 s34, s33, 56
 s_add_u32 s34, s34, s27
 s_lshl_b32 s34, s34, 10
 s_add_u32 s34, s34, 109051904
P_o_63_s2:
 buffer_store_dwordx4 v[96:99], v1, s[4:7], s34 offen sc1
 s_add_u32 s33, s32, 3
 s_cmp_eq_u32 s29, 2
 s_cbranch_scc1 P_o_63_d3
 s_lshr_b32 s34, s33, 1
 s_lshl_b32 s34, s34, 2
 s_and_b32 s35, s33, 1
 s_add_u32 s34, s34, s35
 s_lshl_b32 s35, s29, 1
 s_add_u32 s34, s34, s35
 s_mul_i32 s34, s34, 14
 s_add_u32 s34, s34, s27
 s_lshl_b32 s34, s34, 10
 s_add_u32 s34, s34, 104857600
 s_branch P_o_63_s3
P_o_63_d3:
 s_mul_i32 s34, s33, 56
 s_add_u32 s34, s34, s27
 s_lshl_b32 s34, s34, 10
 s_add_u32 s34, s34, 109051904
P_o_63_s3:
 buffer_store_dwordx4 v[100:103], v1, s[4:7], s34 offen sc1
 s_add_u32 s33, s32, 4
 s_cmp_eq_u32 s29, 2
 s_cbranch_scc1 P_o_63_d4
 s_lshr_b32 s34, s33, 1
 s_lshl_b32 s34, s34, 2
 s_and_b32 s35, s33, 1
 s_add_u32 s34, s34, s35
 s_lshl_b32 s35, s29, 1
 s_add_u32 s34, s34, s35
 s_mul_i32 s34, s34, 14
 s_add_u32 s34, s34, s27
 s_lshl_b32 s34, s34, 10
 s_add_u32 s34, s34, 104857600
 s_branch P_o_63_s4
P_o_63_d4:
 s_mul_i32 s34, s33, 56
 s_add_u32 s34, s34, s27
 s_lshl_b32 s34, s34, 10
 s_add_u32 s34, s34, 109051904
P_o_63_s4:
 buffer_store_dwordx4 v[104:107], v1, s[4:7], s34 offen sc1
 s_add_u32 s33, s32, 5
 s_cmp_eq_u32 s29, 2
 s_cbranch_scc1 P_o_63_d5
 s_lshr_b32 s34, s33, 1
 s_lshl_b32 s34, s34, 2
 s_and_b32 s35, s33, 1
 s_add_u32 s34, s34, s35
 s_lshl_b32 s35, s29, 1
 s_add_u32 s34, s34, s35
 s_mul_i32 s34, s34, 14
 s_add_u32 s34, s34, s27
 s_lshl_b32 s34, s34, 10
 s_add_u32 s34, s34, 104857600
 s_branch P_o_63_s5
P_o_63_d5:
 s_mul_i32 s34, s33, 56
 s_add_u32 s34, s34, s27
 s_lshl_b32 s34, s34, 10
 s_add_u32 s34, s34, 109051904
P_o_63_s5:
 buffer_store_dwordx4 v[108:111], v1, s[4:7], s34 offen sc1
 s_add_u32 s33, s32, 6
 s_cmp_eq_u32 s29, 2
 s_cbranch_scc1 P_o_63_d6
 s_lshr_b32 s34, s33, 1
 s_lshl_b32 s34, s34, 2
 s_and_b32 s35, s33, 1
 s_add_u32 s34, s34, s35
 s_lshl_b32 s35, s29, 1
 s_add_u32 s34, s34, s35
 s_mul_i32 s34, s34, 14
 s_add_u32 s34, s34, s27
 s_lshl_b32 s34, s34, 10
 s_add_u32 s34, s34, 104857600
 s_branch P_o_63_s6
P_o_63_d6:
 s_mul_i32 s34, s33, 56
 s_add_u32 s34, s34, s27
 s_lshl_b32 s34, s34, 10
 s_add_u32 s34, s34, 109051904
P_o_63_s6:
 buffer_store_dwordx4 v[112:115], v1, s[4:7], s34 offen sc1
 s_waitcnt vmcnt(0)
 s_barrier
 s_mov_b32 s33, 18423808
 buffer_atomic_add v2, v3, s[4:7], s33 offen sc1
K_loop:
 v_lshlrev_b32 v1, 4, v0
 v_mov_b32 v2, 1
 v_cmp_eq_u32 vcc, 0, v0
 s_cmp_eq_u32 s8, 0
 s_cselect_b64 vcc, vcc, 0
 v_mov_b32 v5, 0x7ffffff0
 v_cndmask_b32 v3, v5, 0, vcc
 s_cmp_lg_u32 s93, 0
 s_cbranch_scc1 K_wm_64_ok
 s_mov_b32 s19, 0
K_wm_64:
 s_cmp_lg_u32 s8, 0
 s_cbranch_scc1 K_wmr_65
 v_mov_b32 v5, 132
 buffer_load_dword v8, v5, s[80:83], 0 offen sc1
 s_waitcnt vmcnt(0)
K_wmr_65:
 s_cmp_lg_u32 s8, 0
 s_cbranch_scc1 K_bc_66
 v_lshlrev_b32 v5, 2, v0
 v_add_u32 v5, 163776, v5
 s_mov_b64 exec, 1
 ds_write_b32 v5, v8
 s_waitcnt lgkmcnt(0)
 s_mov_b64 exec, -1
K_bc_66:
 s_barrier
 v_and_b32 v5, 7, v0
 v_lshlrev_b32 v5, 2, v5
 v_add_u32 v5, 163776, v5
 ds_read_b32 v6, v5
 v_mov_b32 v5, 163808
 ds_read_b32 v7, v5
 s_waitcnt lgkmcnt(0)
 v_cmp_ne_u32 vcc, 0, v7
 s_cbranch_vccnz K_done
 s_barrier
 v_readfirstlane_b32 s93, v6
 s_cmp_lg_u32 s93, 0
 s_cbranch_scc1 K_wm_64_ok
 s_add_u32 s19, s19, 1
 s_cmp_lt_u32 s19, 1024
 s_cbranch_scc1 K_wm_64
 s_cmp_lg_u32 s8, 0
 s_cbranch_scc1 K_at_67
 s_mov_b64 exec, 1
 v_mov_b32 v5, 132
 v_mov_b32 v8, 2
 v_mov_b32 v9, 0
 buffer_atomic_cmpswap v[8:9], v5, s[80:83], 0 offen sc0 sc1
 s_waitcnt vmcnt(0)
 s_mov_b64 exec, -1
K_at_67:
 s_cmp_lg_u32 s8, 0
 s_cbranch_scc1 K_bc_68
 v_lshlrev_b32 v5, 2, v0
 v_add_u32 v5, 163776, v5
 s_mov_b64 exec, 1
 ds_write_b32 v5, v8
 s_waitcnt lgkmcnt(0)
 s_mov_b64 exec, -1
K_bc_68:
 s_barrier
 v_and_b32 v5, 7, v0
 v_lshlrev_b32 v5, 2, v5
 v_add_u32 v5, 163776, v5
 ds_read_b32 v6, v5
 v_mov_b32 v5, 163808
 ds_read_b32 v7, v5
 s_waitcnt lgkmcnt(0)
 v_cmp_ne_u32 vcc, 0, v7
 s_cbranch_vccnz K_done
 s_barrier
 v_readfirstlane_b32 s93, v6
 s_cmp_eq_u32 s93, 0
 s_cselect_b32 s93, 2, s93
K_wm_64_ok:
 s_cmp_eq_u32 s93, 2
 s_cbranch_scc0 K_g
 s_cmp_eq_u32 s95, 0
 s_cbranch_scc1 K_slowq
K_g:
 s_cmp_ge_u32 s76, 7
 s_cbranch_scc1 K_q2
 s_add_u32 s75, s77, s76
 s_cmp_ge_u32 s75, 7
 s_cselect_b32 s11, 7, 0
 s_sub_u32 s75, s75, s11
 s_lshl_b32 s74, s75, 2
 s_add_u32 s74, s74, 64
 s_cmp_lg_u32 s8, 0
 s_cbranch_scc1 K_at_69
 s_mov_b64 exec, 1
 v_mov_b32 v5, s74
 v_mov_b32 v8, 1
 buffer_atomic_add v8, v5, s[80:83], 0 offen sc0 sc1
 s_waitcnt vmcnt(0)
 s_mov_b64 exec, -1
K_at_69:
 s_cmp_lg_u32 s8, 0
 s_cbranch_scc1 K_bc_70
 v_lshlrev_b32 v5, 2, v0
 v_add_u32 v5, 163776, v5
 s_mov_b64 exec, 1
 ds_write_b32 v5, v8
 s_waitcnt lgkmcnt(0)
 s_mov_b64 exec, -1
K_bc_70:
 s_barrier
 v_and_b32 v5, 7, v0
 v_lshlrev_b32 v5, 2, v5
 v_add_u32 v5, 163776, v5
 ds_read_b32 v6, v5
 v_mov_b32 v5, 163808
 ds_read_b32 v7, v5
 s_waitcnt lgkmcnt(0)
 v_cmp_ne_u32 vcc, 0, v7
 s_cbranch_vccnz K_done
 s_barrier
 v_readfirstlane_b32 s92, v6
 s_cmp_lt_u32 s92, 152
 s_cbranch_scc1 K_gt
 s_add_u32 s76, s76, 1
 s_branch K_g
K_gt:
 s_cmp_ge_u32 s92, 120
 s_cbranch_scc1 K_fa
 s_cmp_ge_u32 s92, 56
 s_cbranch_scc1 K_t
 s_lshr_b32 s21, s92, 2
 s_add_u32 s21, s21, 2
 s_and_b32 s11, s92, 3
 s_lshl_b32 s22, s75, 2
 s_add_u32 s22, s22, s11
K_u:
 s_lshl_b32 s23, s22, 4
 s_lshl_b32 s11, s8, 2
 s_add_u32 s23, s23, s11
 s_mul_i32 s11, s23, 14336
 s_add_u32 s24, s11, 9437184
 s_add_u32 s25, s11, 9451520
 s_add_u32 s26, s11, 9465856
 s_add_u32 s27, s11, 9480192
 s_cmp_lt_u32 s21, 2
 s_cbranch_scc1 L_gate_71
 s_cmp_ge_u32 s21, 8
 s_cbranch_scc1 L_gate_71
 s_mov_b32 s33, 18413568
 s_cmp_lg_u32 s8, 0
 s_cbranch_scc1 L_wcgate_72_ok
 s_mov_b32 s19, 0
 v_mov_b32 v5, 0
 s_mov_b64 exec, 1
L_wcgate_72:
 buffer_load_dword v6, v5, s[4:7], s33 offen sc1
 s_waitcnt vmcnt(0)
 v_readfirstlane_b32 s11, v6
 s_cmp_ge_u32 s11, 28
 s_cbranch_scc1 L_wcgate_72_got
 s_sleep 12
 s_add_u32 s19, s19, 1
 s_cmp_le_u32 s19, 8192
 s_cbranch_scc1 L_wcgate_72
 s_branch K_failw
L_wcgate_72_got:
 s_mov_b64 exec, -1
L_wcgate_72_ok:
 s_barrier
L_gate_71:
 s_mul_i32 s11, s21, 114688
 s_mul_i32 s12, s8, 28672
 s_add_u32 s11, s11, s12
 s_add_u32 s11, s11, 0
 s_add_u32 s13, s12, 0
 s_mov_b32 m0, s13
 s_add_u32 s13, s11, 0
 buffer_load_dwordx4 v1, s[4:7], s13 offen offset:0 lds
 buffer_load_dwordx4 v1, s[4:7], s13 offen offset:1024 lds
 buffer_load_dwordx4 v1, s[4:7], s13 offen offset:2048 lds
 buffer_load_dwordx4 v1, s[4:7], s13 offen offset:3072 lds
 s_add_u32 s13, s12, 4096
 s_mov_b32 m0, s13
 s_add_u32 s13, s11, 4096
 buffer_load_dwordx4 v1, s[4:7], s13 offen offset:0 lds
 buffer_load_dwordx4 v1, s[4:7], s13 offen offset:1024 lds
 buffer_load_dwordx4 v1, s[4:7], s13 offen offset:2048 lds
 buffer_load_dwordx4 v1, s[4:7], s13 offen offset:3072 lds
 s_add_u32 s13, s12, 8192
 s_mov_b32 m0, s13
 s_add_u32 s13, s11, 8192
 buffer_load_dwordx4 v1, s[4:7], s13 offen offset:0 lds
 buffer_load_dwordx4 v1, s[4:7], s13 offen offset:1024 lds
 buffer_load_dwordx4 v1, s[4:7], s13 offen offset:2048 lds
 buffer_load_dwordx4 v1, s[4:7], s13 offen offset:3072 lds
 s_add_u32 s13, s12, 12288
 s_mov_b32 m0, s13
 s_add_u32 s13, s11, 12288
 buffer_load_dwordx4 v1, s[4:7], s13 offen offset:0 lds
 buffer_load_dwordx4 v1, s[4:7], s13 offen offset:1024 lds
 buffer_load_dwordx4 v1, s[4:7], s13 offen offset:2048 lds
 buffer_load_dwordx4 v1, s[4:7], s13 offen offset:3072 lds
 s_add_u32 s13, s12, 16384
 s_mov_b32 m0, s13
 s_add_u32 s13, s11, 16384
 buffer_load_dwordx4 v1, s[4:7], s13 offen offset:0 lds
 buffer_load_dwordx4 v1, s[4:7], s13 offen offset:1024 lds
 buffer_load_dwordx4 v1, s[4:7], s13 offen offset:2048 lds
 buffer_load_dwordx4 v1, s[4:7], s13 offen offset:3072 lds
 s_add_u32 s13, s12, 20480
 s_mov_b32 m0, s13
 s_add_u32 s13, s11, 20480
 buffer_load_dwordx4 v1, s[4:7], s13 offen offset:0 lds
 buffer_load_dwordx4 v1, s[4:7], s13 offen offset:1024 lds
 buffer_load_dwordx4 v1, s[4:7], s13 offen offset:2048 lds
 buffer_load_dwordx4 v1, s[4:7], s13 offen offset:3072 lds
 s_add_u32 s13, s12, 24576
 s_mov_b32 m0, s13
 s_add_u32 s13, s11, 24576
 buffer_load_dwordx4 v1, s[4:7], s13 offen offset:0 lds
 buffer_load_dwordx4 v1, s[4:7], s13 offen offset:1024 lds
 buffer_load_dwordx4 v1, s[4:7], s13 offen offset:2048 lds
 buffer_load_dwordx4 v1, s[4:7], s13 offen offset:3072 lds
 v_add_u32 v12, 57344, v1
 v_add_u32 v8, 0, v1
 v_add_u32 v9, 1024, v1
 v_add_u32 v10, 2048, v1
 buffer_load_dwordx4 a[0:3], v8, s[4:7], s24 offen
 buffer_load_dwordx4 a[4:7], v8, s[4:7], s25 offen
 buffer_load_dwordx4 a[8:11], v8, s[4:7], s26 offen
 buffer_load_dwordx4 a[12:15], v8, s[4:7], s27 offen
 buffer_load_dwordx4 a[16:19], v9, s[4:7], s24 offen
 buffer_load_dwordx4 a[20:23], v9, s[4:7], s25 offen
 buffer_load_dwordx4 a[24:27], v9, s[4:7], s26 offen
 buffer_load_dwordx4 a[28:31], v9, s[4:7], s27 offen
 buffer_load_dwordx4 a[32:35], v10, s[4:7], s24 offen
 buffer_load_dwordx4 a[36:39], v10, s[4:7], s25 offen
 buffer_load_dwordx4 a[40:43], v10, s[4:7], s26 offen
 buffer_load_dwordx4 a[44:47], v10, s[4:7], s27 offen
 s_waitcnt vmcnt(12)
 s_barrier
 ds_read_b128 a[64:67], v1 offset:0
 ds_read_b128 a[68:71], v1 offset:14336
 ds_read_b128 a[72:75], v1 offset:28672
 ds_read_b128 a[76:79], v1 offset:43008
 ds_read_b128 a[80:83], v12 offset:0
 ds_read_b128 a[84:87], v12 offset:14336
 ds_read_b128 a[88:91], v12 offset:28672
 ds_read_b128 a[92:95], v12 offset:43008
 v_add_u32 v11, 3072, v1
 s_waitcnt vmcnt(8)
 s_waitcnt lgkmcnt(0)
 v_mfma_f32_16x16x32_bf16 v[128:131], a[64:67], a[0:3], 0
 buffer_load_dwordx4 a[48:51], v11, s[4:7], s24 offen
 v_mfma_f32_16x16x32_bf16 v[132:135], a[64:67], a[4:7], 0
 buffer_load_dwordx4 a[52:55], v11, s[4:7], s25 offen
 v_mfma_f32_16x16x32_bf16 v[136:139], a[64:67], a[8:11], 0
 buffer_load_dwordx4 a[56:59], v11, s[4:7], s26 offen
 v_mfma_f32_16x16x32_bf16 v[140:143], a[64:67], a[12:15], 0
 buffer_load_dwordx4 a[60:63], v11, s[4:7], s27 offen
 v_mfma_f32_16x16x32_bf16 v[144:147], a[68:71], a[0:3], 0
 ds_read_b128 a[96:99], v1 offset:1024
 v_mfma_f32_16x16x32_bf16 v[148:151], a[68:71], a[4:7], 0
 ds_read_b128 a[100:103], v1 offset:15360
 v_mfma_f32_16x16x32_bf16 v[152:155], a[68:71], a[8:11], 0
 ds_read_b128 a[104:107], v1 offset:29696
 v_mfma_f32_16x16x32_bf16 v[156:159], a[68:71], a[12:15], 0
 ds_read_b128 a[108:111], v1 offset:44032
 v_mfma_f32_16x16x32_bf16 v[160:163], a[72:75], a[0:3], 0
 ds_read_b128 a[112:115], v12 offset:1024
 v_mfma_f32_16x16x32_bf16 v[164:167], a[72:75], a[4:7], 0
 ds_read_b128 a[116:119], v12 offset:15360
 v_mfma_f32_16x16x32_bf16 v[168:171], a[72:75], a[8:11], 0
 ds_read_b128 a[120:123], v12 offset:29696
 v_mfma_f32_16x16x32_bf16 v[172:175], a[72:75], a[12:15], 0
 ds_read_b128 a[124:127], v12 offset:44032
 v_mfma_f32_16x16x32_bf16 v[176:179], a[76:79], a[0:3], 0
 v_mfma_f32_16x16x32_bf16 v[180:183], a[76:79], a[4:7], 0
 v_mfma_f32_16x16x32_bf16 v[184:187], a[76:79], a[8:11], 0
 v_mfma_f32_16x16x32_bf16 v[188:191], a[76:79], a[12:15], 0
 v_mfma_f32_16x16x32_bf16 v[192:195], a[80:83], a[0:3], 0
 v_mfma_f32_16x16x32_bf16 v[196:199], a[80:83], a[4:7], 0
 v_mfma_f32_16x16x32_bf16 v[200:203], a[80:83], a[8:11], 0
 v_mfma_f32_16x16x32_bf16 v[204:207], a[80:83], a[12:15], 0
 v_mfma_f32_16x16x32_bf16 v[208:211], a[84:87], a[0:3], 0
 v_mfma_f32_16x16x32_bf16 v[212:215], a[84:87], a[4:7], 0
 v_mfma_f32_16x16x32_bf16 v[216:219], a[84:87], a[8:11], 0
 v_mfma_f32_16x16x32_bf16 v[220:223], a[84:87], a[12:15], 0
 v_mfma_f32_16x16x32_bf16 v[224:227], a[88:91], a[0:3], 0
 v_mfma_f32_16x16x32_bf16 v[228:231], a[88:91], a[4:7], 0
 v_mfma_f32_16x16x32_bf16 v[232:235], a[88:91], a[8:11], 0
 v_mfma_f32_16x16x32_bf16 v[236:239], a[88:91], a[12:15], 0
 v_mfma_f32_16x16x32_bf16 v[240:243], a[92:95], a[0:3], 0
 v_mfma_f32_16x16x32_bf16 v[244:247], a[92:95], a[4:7], 0
 v_mfma_f32_16x16x32_bf16 v[248:251], a[92:95], a[8:11], 0
 v_mfma_f32_16x16x32_bf16 v[252:255], a[92:95], a[12:15], 0
 v_add_u32 v8, 4096, v1
 s_waitcnt vmcnt(8)
 s_waitcnt lgkmcnt(0)
 v_mfma_f32_16x16x32_bf16 v[128:131], a[96:99], a[16:19], v[128:131]
 buffer_load_dwordx4 a[0:3], v8, s[4:7], s24 offen
 v_mfma_f32_16x16x32_bf16 v[132:135], a[96:99], a[20:23], v[132:135]
 buffer_load_dwordx4 a[4:7], v8, s[4:7], s25 offen
 v_mfma_f32_16x16x32_bf16 v[136:139], a[96:99], a[24:27], v[136:139]
 buffer_load_dwordx4 a[8:11], v8, s[4:7], s26 offen
 v_mfma_f32_16x16x32_bf16 v[140:143], a[96:99], a[28:31], v[140:143]
 buffer_load_dwordx4 a[12:15], v8, s[4:7], s27 offen
 v_mfma_f32_16x16x32_bf16 v[144:147], a[100:103], a[16:19], v[144:147]
 ds_read_b128 a[64:67], v1 offset:2048
 v_mfma_f32_16x16x32_bf16 v[148:151], a[100:103], a[20:23], v[148:151]
 ds_read_b128 a[68:71], v1 offset:16384
 v_mfma_f32_16x16x32_bf16 v[152:155], a[100:103], a[24:27], v[152:155]
 ds_read_b128 a[72:75], v1 offset:30720
 v_mfma_f32_16x16x32_bf16 v[156:159], a[100:103], a[28:31], v[156:159]
 ds_read_b128 a[76:79], v1 offset:45056
 v_mfma_f32_16x16x32_bf16 v[160:163], a[104:107], a[16:19], v[160:163]
 ds_read_b128 a[80:83], v12 offset:2048
 v_mfma_f32_16x16x32_bf16 v[164:167], a[104:107], a[20:23], v[164:167]
 ds_read_b128 a[84:87], v12 offset:16384
 v_mfma_f32_16x16x32_bf16 v[168:171], a[104:107], a[24:27], v[168:171]
 ds_read_b128 a[88:91], v12 offset:30720
 v_mfma_f32_16x16x32_bf16 v[172:175], a[104:107], a[28:31], v[172:175]
 ds_read_b128 a[92:95], v12 offset:45056
 v_mfma_f32_16x16x32_bf16 v[176:179], a[108:111], a[16:19], v[176:179]
 v_mfma_f32_16x16x32_bf16 v[180:183], a[108:111], a[20:23], v[180:183]
 v_mfma_f32_16x16x32_bf16 v[184:187], a[108:111], a[24:27], v[184:187]
 v_mfma_f32_16x16x32_bf16 v[188:191], a[108:111], a[28:31], v[188:191]
 v_mfma_f32_16x16x32_bf16 v[192:195], a[112:115], a[16:19], v[192:195]
 v_mfma_f32_16x16x32_bf16 v[196:199], a[112:115], a[20:23], v[196:199]
 v_mfma_f32_16x16x32_bf16 v[200:203], a[112:115], a[24:27], v[200:203]
 v_mfma_f32_16x16x32_bf16 v[204:207], a[112:115], a[28:31], v[204:207]
 v_mfma_f32_16x16x32_bf16 v[208:211], a[116:119], a[16:19], v[208:211]
 v_mfma_f32_16x16x32_bf16 v[212:215], a[116:119], a[20:23], v[212:215]
 v_mfma_f32_16x16x32_bf16 v[216:219], a[116:119], a[24:27], v[216:219]
 v_mfma_f32_16x16x32_bf16 v[220:223], a[116:119], a[28:31], v[220:223]
 v_mfma_f32_16x16x32_bf16 v[224:227], a[120:123], a[16:19], v[224:227]
 v_mfma_f32_16x16x32_bf16 v[228:231], a[120:123], a[20:23], v[228:231]
 v_mfma_f32_16x16x32_bf16 v[232:235], a[120:123], a[24:27], v[232:235]
 v_mfma_f32_16x16x32_bf16 v[236:239], a[120:123], a[28:31], v[236:239]
 v_mfma_f32_16x16x32_bf16 v[240:243], a[124:127], a[16:19], v[240:243]
 v_mfma_f32_16x16x32_bf16 v[244:247], a[124:127], a[20:23], v[244:247]
 v_mfma_f32_16x16x32_bf16 v[248:251], a[124:127], a[24:27], v[248:251]
 v_mfma_f32_16x16x32_bf16 v[252:255], a[124:127], a[28:31], v[252:255]
 v_add_u32 v9, 5120, v1
 s_waitcnt vmcnt(8)
 s_waitcnt lgkmcnt(0)
 v_mfma_f32_16x16x32_bf16 v[128:131], a[64:67], a[32:35], v[128:131]
 buffer_load_dwordx4 a[16:19], v9, s[4:7], s24 offen
 v_mfma_f32_16x16x32_bf16 v[132:135], a[64:67], a[36:39], v[132:135]
 buffer_load_dwordx4 a[20:23], v9, s[4:7], s25 offen
 v_mfma_f32_16x16x32_bf16 v[136:139], a[64:67], a[40:43], v[136:139]
 buffer_load_dwordx4 a[24:27], v9, s[4:7], s26 offen
 v_mfma_f32_16x16x32_bf16 v[140:143], a[64:67], a[44:47], v[140:143]
 buffer_load_dwordx4 a[28:31], v9, s[4:7], s27 offen
 v_mfma_f32_16x16x32_bf16 v[144:147], a[68:71], a[32:35], v[144:147]
 ds_read_b128 a[96:99], v1 offset:3072
 v_mfma_f32_16x16x32_bf16 v[148:151], a[68:71], a[36:39], v[148:151]
 ds_read_b128 a[100:103], v1 offset:17408
 v_mfma_f32_16x16x32_bf16 v[152:155], a[68:71], a[40:43], v[152:155]
 ds_read_b128 a[104:107], v1 offset:31744
 v_mfma_f32_16x16x32_bf16 v[156:159], a[68:71], a[44:47], v[156:159]
 ds_read_b128 a[108:111], v1 offset:46080
 v_mfma_f32_16x16x32_bf16 v[160:163], a[72:75], a[32:35], v[160:163]
 ds_read_b128 a[112:115], v12 offset:3072
 v_mfma_f32_16x16x32_bf16 v[164:167], a[72:75], a[36:39], v[164:167]
 ds_read_b128 a[116:119], v12 offset:17408
 v_mfma_f32_16x16x32_bf16 v[168:171], a[72:75], a[40:43], v[168:171]
 ds_read_b128 a[120:123], v12 offset:31744
 v_mfma_f32_16x16x32_bf16 v[172:175], a[72:75], a[44:47], v[172:175]
 ds_read_b128 a[124:127], v12 offset:46080
 v_mfma_f32_16x16x32_bf16 v[176:179], a[76:79], a[32:35], v[176:179]
 v_mfma_f32_16x16x32_bf16 v[180:183], a[76:79], a[36:39], v[180:183]
 v_mfma_f32_16x16x32_bf16 v[184:187], a[76:79], a[40:43], v[184:187]
 v_mfma_f32_16x16x32_bf16 v[188:191], a[76:79], a[44:47], v[188:191]
 v_mfma_f32_16x16x32_bf16 v[192:195], a[80:83], a[32:35], v[192:195]
 v_mfma_f32_16x16x32_bf16 v[196:199], a[80:83], a[36:39], v[196:199]
 v_mfma_f32_16x16x32_bf16 v[200:203], a[80:83], a[40:43], v[200:203]
 v_mfma_f32_16x16x32_bf16 v[204:207], a[80:83], a[44:47], v[204:207]
 v_mfma_f32_16x16x32_bf16 v[208:211], a[84:87], a[32:35], v[208:211]
 v_mfma_f32_16x16x32_bf16 v[212:215], a[84:87], a[36:39], v[212:215]
 v_mfma_f32_16x16x32_bf16 v[216:219], a[84:87], a[40:43], v[216:219]
 v_mfma_f32_16x16x32_bf16 v[220:223], a[84:87], a[44:47], v[220:223]
 v_mfma_f32_16x16x32_bf16 v[224:227], a[88:91], a[32:35], v[224:227]
 v_mfma_f32_16x16x32_bf16 v[228:231], a[88:91], a[36:39], v[228:231]
 v_mfma_f32_16x16x32_bf16 v[232:235], a[88:91], a[40:43], v[232:235]
 v_mfma_f32_16x16x32_bf16 v[236:239], a[88:91], a[44:47], v[236:239]
 v_mfma_f32_16x16x32_bf16 v[240:243], a[92:95], a[32:35], v[240:243]
 v_mfma_f32_16x16x32_bf16 v[244:247], a[92:95], a[36:39], v[244:247]
 v_mfma_f32_16x16x32_bf16 v[248:251], a[92:95], a[40:43], v[248:251]
 v_mfma_f32_16x16x32_bf16 v[252:255], a[92:95], a[44:47], v[252:255]
 v_add_u32 v10, 6144, v1
 s_waitcnt vmcnt(8)
 s_waitcnt lgkmcnt(0)
 v_mfma_f32_16x16x32_bf16 v[128:131], a[96:99], a[48:51], v[128:131]
 buffer_load_dwordx4 a[32:35], v10, s[4:7], s24 offen
 v_mfma_f32_16x16x32_bf16 v[132:135], a[96:99], a[52:55], v[132:135]
 buffer_load_dwordx4 a[36:39], v10, s[4:7], s25 offen
 v_mfma_f32_16x16x32_bf16 v[136:139], a[96:99], a[56:59], v[136:139]
 buffer_load_dwordx4 a[40:43], v10, s[4:7], s26 offen
 v_mfma_f32_16x16x32_bf16 v[140:143], a[96:99], a[60:63], v[140:143]
 buffer_load_dwordx4 a[44:47], v10, s[4:7], s27 offen
 v_mfma_f32_16x16x32_bf16 v[144:147], a[100:103], a[48:51], v[144:147]
 ds_read_b128 a[64:67], v1 offset:4096
 v_mfma_f32_16x16x32_bf16 v[148:151], a[100:103], a[52:55], v[148:151]
 ds_read_b128 a[68:71], v1 offset:18432
 v_mfma_f32_16x16x32_bf16 v[152:155], a[100:103], a[56:59], v[152:155]
 ds_read_b128 a[72:75], v1 offset:32768
 v_mfma_f32_16x16x32_bf16 v[156:159], a[100:103], a[60:63], v[156:159]
 ds_read_b128 a[76:79], v1 offset:47104
 v_mfma_f32_16x16x32_bf16 v[160:163], a[104:107], a[48:51], v[160:163]
 ds_read_b128 a[80:83], v12 offset:4096
 v_mfma_f32_16x16x32_bf16 v[164:167], a[104:107], a[52:55], v[164:167]
 ds_read_b128 a[84:87], v12 offset:18432
 v_mfma_f32_16x16x32_bf16 v[168:171], a[104:107], a[56:59], v[168:171]
 ds_read_b128 a[88:91], v12 offset:32768
 v_mfma_f32_16x16x32_bf16 v[172:175], a[104:107], a[60:63], v[172:175]
 ds_read_b128 a[92:95], v12 offset:47104
 v_mfma_f32_16x16x32_bf16 v[176:179], a[108:111], a[48:51], v[176:179]
 v_mfma_f32_16x16x32_bf16 v[180:183], a[108:111], a[52:55], v[180:183]
 v_mfma_f32_16x16x32_bf16 v[184:187], a[108:111], a[56:59], v[184:187]
 v_mfma_f32_16x16x32_bf16 v[188:191], a[108:111], a[60:63], v[188:191]
 v_mfma_f32_16x16x32_bf16 v[192:195], a[112:115], a[48:51], v[192:195]
 v_mfma_f32_16x16x32_bf16 v[196:199], a[112:115], a[52:55], v[196:199]
 v_mfma_f32_16x16x32_bf16 v[200:203], a[112:115], a[56:59], v[200:203]
 v_mfma_f32_16x16x32_bf16 v[204:207], a[112:115], a[60:63], v[204:207]
 v_mfma_f32_16x16x32_bf16 v[208:211], a[116:119], a[48:51], v[208:211]
 v_mfma_f32_16x16x32_bf16 v[212:215], a[116:119], a[52:55], v[212:215]
 v_mfma_f32_16x16x32_bf16 v[216:219], a[116:119], a[56:59], v[216:219]
 v_mfma_f32_16x16x32_bf16 v[220:223], a[116:119], a[60:63], v[220:223]
 v_mfma_f32_16x16x32_bf16 v[224:227], a[120:123], a[48:51], v[224:227]
 v_mfma_f32_16x16x32_bf16 v[228:231], a[120:123], a[52:55], v[228:231]
 v_mfma_f32_16x16x32_bf16 v[232:235], a[120:123], a[56:59], v[232:235]
 v_mfma_f32_16x16x32_bf16 v[236:239], a[120:123], a[60:63], v[236:239]
 v_mfma_f32_16x16x32_bf16 v[240:243], a[124:127], a[48:51], v[240:243]
 v_mfma_f32_16x16x32_bf16 v[244:247], a[124:127], a[52:55], v[244:247]
 v_mfma_f32_16x16x32_bf16 v[248:251], a[124:127], a[56:59], v[248:251]
 v_mfma_f32_16x16x32_bf16 v[252:255], a[124:127], a[60:63], v[252:255]
 v_add_u32 v11, 7168, v1
 s_waitcnt vmcnt(8)
 s_waitcnt lgkmcnt(0)
 v_mfma_f32_16x16x32_bf16 v[128:131], a[64:67], a[0:3], v[128:131]
 buffer_load_dwordx4 a[48:51], v11, s[4:7], s24 offen
 v_mfma_f32_16x16x32_bf16 v[132:135], a[64:67], a[4:7], v[132:135]
 buffer_load_dwordx4 a[52:55], v11, s[4:7], s25 offen
 v_mfma_f32_16x16x32_bf16 v[136:139], a[64:67], a[8:11], v[136:139]
 buffer_load_dwordx4 a[56:59], v11, s[4:7], s26 offen
 v_mfma_f32_16x16x32_bf16 v[140:143], a[64:67], a[12:15], v[140:143]
 buffer_load_dwordx4 a[60:63], v11, s[4:7], s27 offen
 v_mfma_f32_16x16x32_bf16 v[144:147], a[68:71], a[0:3], v[144:147]
 ds_read_b128 a[96:99], v1 offset:5120
 v_mfma_f32_16x16x32_bf16 v[148:151], a[68:71], a[4:7], v[148:151]
 ds_read_b128 a[100:103], v1 offset:19456
 v_mfma_f32_16x16x32_bf16 v[152:155], a[68:71], a[8:11], v[152:155]
 ds_read_b128 a[104:107], v1 offset:33792
 v_mfma_f32_16x16x32_bf16 v[156:159], a[68:71], a[12:15], v[156:159]
 ds_read_b128 a[108:111], v1 offset:48128
 v_mfma_f32_16x16x32_bf16 v[160:163], a[72:75], a[0:3], v[160:163]
 ds_read_b128 a[112:115], v12 offset:5120
 v_mfma_f32_16x16x32_bf16 v[164:167], a[72:75], a[4:7], v[164:167]
 ds_read_b128 a[116:119], v12 offset:19456
 v_mfma_f32_16x16x32_bf16 v[168:171], a[72:75], a[8:11], v[168:171]
 ds_read_b128 a[120:123], v12 offset:33792
 v_mfma_f32_16x16x32_bf16 v[172:175], a[72:75], a[12:15], v[172:175]
 ds_read_b128 a[124:127], v12 offset:48128
 v_mfma_f32_16x16x32_bf16 v[176:179], a[76:79], a[0:3], v[176:179]
 v_mfma_f32_16x16x32_bf16 v[180:183], a[76:79], a[4:7], v[180:183]
 v_mfma_f32_16x16x32_bf16 v[184:187], a[76:79], a[8:11], v[184:187]
 v_mfma_f32_16x16x32_bf16 v[188:191], a[76:79], a[12:15], v[188:191]
 v_mfma_f32_16x16x32_bf16 v[192:195], a[80:83], a[0:3], v[192:195]
 v_mfma_f32_16x16x32_bf16 v[196:199], a[80:83], a[4:7], v[196:199]
 v_mfma_f32_16x16x32_bf16 v[200:203], a[80:83], a[8:11], v[200:203]
 v_mfma_f32_16x16x32_bf16 v[204:207], a[80:83], a[12:15], v[204:207]
 v_mfma_f32_16x16x32_bf16 v[208:211], a[84:87], a[0:3], v[208:211]
 v_mfma_f32_16x16x32_bf16 v[212:215], a[84:87], a[4:7], v[212:215]
 v_mfma_f32_16x16x32_bf16 v[216:219], a[84:87], a[8:11], v[216:219]
 v_mfma_f32_16x16x32_bf16 v[220:223], a[84:87], a[12:15], v[220:223]
 v_mfma_f32_16x16x32_bf16 v[224:227], a[88:91], a[0:3], v[224:227]
 v_mfma_f32_16x16x32_bf16 v[228:231], a[88:91], a[4:7], v[228:231]
 v_mfma_f32_16x16x32_bf16 v[232:235], a[88:91], a[8:11], v[232:235]
 v_mfma_f32_16x16x32_bf16 v[236:239], a[88:91], a[12:15], v[236:239]
 v_mfma_f32_16x16x32_bf16 v[240:243], a[92:95], a[0:3], v[240:243]
 v_mfma_f32_16x16x32_bf16 v[244:247], a[92:95], a[4:7], v[244:247]
 v_mfma_f32_16x16x32_bf16 v[248:251], a[92:95], a[8:11], v[248:251]
 v_mfma_f32_16x16x32_bf16 v[252:255], a[92:95], a[12:15], v[252:255]
 v_add_u32 v8, 8192, v1
 s_waitcnt vmcnt(8)
 s_waitcnt lgkmcnt(0)
 v_mfma_f32_16x16x32_bf16 v[128:131], a[96:99], a[16:19], v[128:131]
 buffer_load_dwordx4 a[0:3], v8, s[4:7], s24 offen
 v_mfma_f32_16x16x32_bf16 v[132:135], a[96:99], a[20:23], v[132:135]
 buffer_load_dwordx4 a[4:7], v8, s[4:7], s25 offen
 v_mfma_f32_16x16x32_bf16 v[136:139], a[96:99], a[24:27], v[136:139]
 buffer_load_dwordx4 a[8:11], v8, s[4:7], s26 offen
 v_mfma_f32_16x16x32_bf16 v[140:143], a[96:99], a[28:31], v[140:143]
 buffer_load_dwordx4 a[12:15], v8, s[4:7], s27 offen
 v_mfma_f32_16x16x32_bf16 v[144:147], a[100:103], a[16:19], v[144:147]
 ds_read_b128 a[64:67], v1 offset:6144
 v_mfma_f32_16x16x32_bf16 v[148:151], a[100:103], a[20:23], v[148:151]
 ds_read_b128 a[68:71], v1 offset:20480
 v_mfma_f32_16x16x32_bf16 v[152:155], a[100:103], a[24:27], v[152:155]
 ds_read_b128 a[72:75], v1 offset:34816
 v_mfma_f32_16x16x32_bf16 v[156:159], a[100:103], a[28:31], v[156:159]
 ds_read_b128 a[76:79], v1 offset:49152
 v_mfma_f32_16x16x32_bf16 v[160:163], a[104:107], a[16:19], v[160:163]
 ds_read_b128 a[80:83], v12 offset:6144
 v_mfma_f32_16x16x32_bf16 v[164:167], a[104:107], a[20:23], v[164:167]
 ds_read_b128 a[84:87], v12 offset:20480
 v_mfma_f32_16x16x32_bf16 v[168:171], a[104:107], a[24:27], v[168:171]
 ds_read_b128 a[88:91], v12 offset:34816
 v_mfma_f32_16x16x32_bf16 v[172:175], a[104:107], a[28:31], v[172:175]
 ds_read_b128 a[92:95], v12 offset:49152
 v_mfma_f32_16x16x32_bf16 v[176:179], a[108:111], a[16:19], v[176:179]
 v_mfma_f32_16x16x32_bf16 v[180:183], a[108:111], a[20:23], v[180:183]
 v_mfma_f32_16x16x32_bf16 v[184:187], a[108:111], a[24:27], v[184:187]
 v_mfma_f32_16x16x32_bf16 v[188:191], a[108:111], a[28:31], v[188:191]
 v_mfma_f32_16x16x32_bf16 v[192:195], a[112:115], a[16:19], v[192:195]
 v_mfma_f32_16x16x32_bf16 v[196:199], a[112:115], a[20:23], v[196:199]
 v_mfma_f32_16x16x32_bf16 v[200:203], a[112:115], a[24:27], v[200:203]
 v_mfma_f32_16x16x32_bf16 v[204:207], a[112:115], a[28:31], v[204:207]
 v_mfma_f32_16x16x32_bf16 v[208:211], a[116:119], a[16:19], v[208:211]
 v_mfma_f32_16x16x32_bf16 v[212:215], a[116:119], a[20:23], v[212:215]
 v_mfma_f32_16x16x32_bf16 v[216:219], a[116:119], a[24:27], v[216:219]
 v_mfma_f32_16x16x32_bf16 v[220:223], a[116:119], a[28:31], v[220:223]
 v_mfma_f32_16x16x32_bf16 v[224:227], a[120:123], a[16:19], v[224:227]
 v_mfma_f32_16x16x32_bf16 v[228:231], a[120:123], a[20:23], v[228:231]
 v_mfma_f32_16x16x32_bf16 v[232:235], a[120:123], a[24:27], v[232:235]
 v_mfma_f32_16x16x32_bf16 v[236:239], a[120:123], a[28:31], v[236:239]
 v_mfma_f32_16x16x32_bf16 v[240:243], a[124:127], a[16:19], v[240:243]
 v_mfma_f32_16x16x32_bf16 v[244:247], a[124:127], a[20:23], v[244:247]
 v_mfma_f32_16x16x32_bf16 v[248:251], a[124:127], a[24:27], v[248:251]
 v_mfma_f32_16x16x32_bf16 v[252:255], a[124:127], a[28:31], v[252:255]
 v_add_u32 v9, 9216, v1
 s_waitcnt vmcnt(8)
 s_waitcnt lgkmcnt(0)
 v_mfma_f32_16x16x32_bf16 v[128:131], a[64:67], a[32:35], v[128:131]
 buffer_load_dwordx4 a[16:19], v9, s[4:7], s24 offen
 v_mfma_f32_16x16x32_bf16 v[132:135], a[64:67], a[36:39], v[132:135]
 buffer_load_dwordx4 a[20:23], v9, s[4:7], s25 offen
 v_mfma_f32_16x16x32_bf16 v[136:139], a[64:67], a[40:43], v[136:139]
 buffer_load_dwordx4 a[24:27], v9, s[4:7], s26 offen
 v_mfma_f32_16x16x32_bf16 v[140:143], a[64:67], a[44:47], v[140:143]
 buffer_load_dwordx4 a[28:31], v9, s[4:7], s27 offen
 v_mfma_f32_16x16x32_bf16 v[144:147], a[68:71], a[32:35], v[144:147]
 ds_read_b128 a[96:99], v1 offset:7168
 v_mfma_f32_16x16x32_bf16 v[148:151], a[68:71], a[36:39], v[148:151]
 ds_read_b128 a[100:103], v1 offset:21504
 v_mfma_f32_16x16x32_bf16 v[152:155], a[68:71], a[40:43], v[152:155]
 ds_read_b128 a[104:107], v1 offset:35840
 v_mfma_f32_16x16x32_bf16 v[156:159], a[68:71], a[44:47], v[156:159]
 ds_read_b128 a[108:111], v1 offset:50176
 v_mfma_f32_16x16x32_bf16 v[160:163], a[72:75], a[32:35], v[160:163]
 ds_read_b128 a[112:115], v12 offset:7168
 v_mfma_f32_16x16x32_bf16 v[164:167], a[72:75], a[36:39], v[164:167]
 ds_read_b128 a[116:119], v12 offset:21504
 v_mfma_f32_16x16x32_bf16 v[168:171], a[72:75], a[40:43], v[168:171]
 ds_read_b128 a[120:123], v12 offset:35840
 v_mfma_f32_16x16x32_bf16 v[172:175], a[72:75], a[44:47], v[172:175]
 ds_read_b128 a[124:127], v12 offset:50176
 v_mfma_f32_16x16x32_bf16 v[176:179], a[76:79], a[32:35], v[176:179]
 v_mfma_f32_16x16x32_bf16 v[180:183], a[76:79], a[36:39], v[180:183]
 v_mfma_f32_16x16x32_bf16 v[184:187], a[76:79], a[40:43], v[184:187]
 v_mfma_f32_16x16x32_bf16 v[188:191], a[76:79], a[44:47], v[188:191]
 v_mfma_f32_16x16x32_bf16 v[192:195], a[80:83], a[32:35], v[192:195]
 v_mfma_f32_16x16x32_bf16 v[196:199], a[80:83], a[36:39], v[196:199]
 v_mfma_f32_16x16x32_bf16 v[200:203], a[80:83], a[40:43], v[200:203]
 v_mfma_f32_16x16x32_bf16 v[204:207], a[80:83], a[44:47], v[204:207]
 v_mfma_f32_16x16x32_bf16 v[208:211], a[84:87], a[32:35], v[208:211]
 v_mfma_f32_16x16x32_bf16 v[212:215], a[84:87], a[36:39], v[212:215]
 v_mfma_f32_16x16x32_bf16 v[216:219], a[84:87], a[40:43], v[216:219]
 v_mfma_f32_16x16x32_bf16 v[220:223], a[84:87], a[44:47], v[220:223]
 v_mfma_f32_16x16x32_bf16 v[224:227], a[88:91], a[32:35], v[224:227]
 v_mfma_f32_16x16x32_bf16 v[228:231], a[88:91], a[36:39], v[228:231]
 v_mfma_f32_16x16x32_bf16 v[232:235], a[88:91], a[40:43], v[232:235]
 v_mfma_f32_16x16x32_bf16 v[236:239], a[88:91], a[44:47], v[236:239]
 v_mfma_f32_16x16x32_bf16 v[240:243], a[92:95], a[32:35], v[240:243]
 v_mfma_f32_16x16x32_bf16 v[244:247], a[92:95], a[36:39], v[244:247]
 v_mfma_f32_16x16x32_bf16 v[248:251], a[92:95], a[40:43], v[248:251]
 v_mfma_f32_16x16x32_bf16 v[252:255], a[92:95], a[44:47], v[252:255]
 v_add_u32 v10, 10240, v1
 s_waitcnt vmcnt(8)
 s_waitcnt lgkmcnt(0)
 v_mfma_f32_16x16x32_bf16 v[128:131], a[96:99], a[48:51], v[128:131]
 buffer_load_dwordx4 a[32:35], v10, s[4:7], s24 offen
 v_mfma_f32_16x16x32_bf16 v[132:135], a[96:99], a[52:55], v[132:135]
 buffer_load_dwordx4 a[36:39], v10, s[4:7], s25 offen
 v_mfma_f32_16x16x32_bf16 v[136:139], a[96:99], a[56:59], v[136:139]
 buffer_load_dwordx4 a[40:43], v10, s[4:7], s26 offen
 v_mfma_f32_16x16x32_bf16 v[140:143], a[96:99], a[60:63], v[140:143]
 buffer_load_dwordx4 a[44:47], v10, s[4:7], s27 offen
 v_mfma_f32_16x16x32_bf16 v[144:147], a[100:103], a[48:51], v[144:147]
 ds_read_b128 a[64:67], v1 offset:8192
 v_mfma_f32_16x16x32_bf16 v[148:151], a[100:103], a[52:55], v[148:151]
 ds_read_b128 a[68:71], v1 offset:22528
 v_mfma_f32_16x16x32_bf16 v[152:155], a[100:103], a[56:59], v[152:155]
 ds_read_b128 a[72:75], v1 offset:36864
 v_mfma_f32_16x16x32_bf16 v[156:159], a[100:103], a[60:63], v[156:159]
 ds_read_b128 a[76:79], v1 offset:51200
 v_mfma_f32_16x16x32_bf16 v[160:163], a[104:107], a[48:51], v[160:163]
 ds_read_b128 a[80:83], v12 offset:8192
 v_mfma_f32_16x16x32_bf16 v[164:167], a[104:107], a[52:55], v[164:167]
 ds_read_b128 a[84:87], v12 offset:22528
 v_mfma_f32_16x16x32_bf16 v[168:171], a[104:107], a[56:59], v[168:171]
 ds_read_b128 a[88:91], v12 offset:36864
 v_mfma_f32_16x16x32_bf16 v[172:175], a[104:107], a[60:63], v[172:175]
 ds_read_b128 a[92:95], v12 offset:51200
 v_mfma_f32_16x16x32_bf16 v[176:179], a[108:111], a[48:51], v[176:179]
 v_mfma_f32_16x16x32_bf16 v[180:183], a[108:111], a[52:55], v[180:183]
 v_mfma_f32_16x16x32_bf16 v[184:187], a[108:111], a[56:59], v[184:187]
 v_mfma_f32_16x16x32_bf16 v[188:191], a[108:111], a[60:63], v[188:191]
 v_mfma_f32_16x16x32_bf16 v[192:195], a[112:115], a[48:51], v[192:195]
 v_mfma_f32_16x16x32_bf16 v[196:199], a[112:115], a[52:55], v[196:199]
 v_mfma_f32_16x16x32_bf16 v[200:203], a[112:115], a[56:59], v[200:203]
 v_mfma_f32_16x16x32_bf16 v[204:207], a[112:115], a[60:63], v[204:207]
 v_mfma_f32_16x16x32_bf16 v[208:211], a[116:119], a[48:51], v[208:211]
 v_mfma_f32_16x16x32_bf16 v[212:215], a[116:119], a[52:55], v[212:215]
 v_mfma_f32_16x16x32_bf16 v[216:219], a[116:119], a[56:59], v[216:219]
 v_mfma_f32_16x16x32_bf16 v[220:223], a[116:119], a[60:63], v[220:223]
 v_mfma_f32_16x16x32_bf16 v[224:227], a[120:123], a[48:51], v[224:227]
 v_mfma_f32_16x16x32_bf16 v[228:231], a[120:123], a[52:55], v[228:231]
 v_mfma_f32_16x16x32_bf16 v[232:235], a[120:123], a[56:59], v[232:235]
 v_mfma_f32_16x16x32_bf16 v[236:239], a[120:123], a[60:63], v[236:239]
 v_mfma_f32_16x16x32_bf16 v[240:243], a[124:127], a[48:51], v[240:243]
 v_mfma_f32_16x16x32_bf16 v[244:247], a[124:127], a[52:55], v[244:247]
 v_mfma_f32_16x16x32_bf16 v[248:251], a[124:127], a[56:59], v[248:251]
 v_mfma_f32_16x16x32_bf16 v[252:255], a[124:127], a[60:63], v[252:255]
 v_add_u32 v11, 11264, v1
 s_waitcnt vmcnt(8)
 s_waitcnt lgkmcnt(0)
 v_mfma_f32_16x16x32_bf16 v[128:131], a[64:67], a[0:3], v[128:131]
 buffer_load_dwordx4 a[48:51], v11, s[4:7], s24 offen
 v_mfma_f32_16x16x32_bf16 v[132:135], a[64:67], a[4:7], v[132:135]
 buffer_load_dwordx4 a[52:55], v11, s[4:7], s25 offen
 v_mfma_f32_16x16x32_bf16 v[136:139], a[64:67], a[8:11], v[136:139]
 buffer_load_dwordx4 a[56:59], v11, s[4:7], s26 offen
 v_mfma_f32_16x16x32_bf16 v[140:143], a[64:67], a[12:15], v[140:143]
 buffer_load_dwordx4 a[60:63], v11, s[4:7], s27 offen
 v_mfma_f32_16x16x32_bf16 v[144:147], a[68:71], a[0:3], v[144:147]
 ds_read_b128 a[96:99], v1 offset:9216
 v_mfma_f32_16x16x32_bf16 v[148:151], a[68:71], a[4:7], v[148:151]
 ds_read_b128 a[100:103], v1 offset:23552
 v_mfma_f32_16x16x32_bf16 v[152:155], a[68:71], a[8:11], v[152:155]
 ds_read_b128 a[104:107], v1 offset:37888
 v_mfma_f32_16x16x32_bf16 v[156:159], a[68:71], a[12:15], v[156:159]
 ds_read_b128 a[108:111], v1 offset:52224
 v_mfma_f32_16x16x32_bf16 v[160:163], a[72:75], a[0:3], v[160:163]
 ds_read_b128 a[112:115], v12 offset:9216
 v_mfma_f32_16x16x32_bf16 v[164:167], a[72:75], a[4:7], v[164:167]
 ds_read_b128 a[116:119], v12 offset:23552
 v_mfma_f32_16x16x32_bf16 v[168:171], a[72:75], a[8:11], v[168:171]
 ds_read_b128 a[120:123], v12 offset:37888
 v_mfma_f32_16x16x32_bf16 v[172:175], a[72:75], a[12:15], v[172:175]
 ds_read_b128 a[124:127], v12 offset:52224
 v_mfma_f32_16x16x32_bf16 v[176:179], a[76:79], a[0:3], v[176:179]
 v_mfma_f32_16x16x32_bf16 v[180:183], a[76:79], a[4:7], v[180:183]
 v_mfma_f32_16x16x32_bf16 v[184:187], a[76:79], a[8:11], v[184:187]
 v_mfma_f32_16x16x32_bf16 v[188:191], a[76:79], a[12:15], v[188:191]
 v_mfma_f32_16x16x32_bf16 v[192:195], a[80:83], a[0:3], v[192:195]
 v_mfma_f32_16x16x32_bf16 v[196:199], a[80:83], a[4:7], v[196:199]
 v_mfma_f32_16x16x32_bf16 v[200:203], a[80:83], a[8:11], v[200:203]
 v_mfma_f32_16x16x32_bf16 v[204:207], a[80:83], a[12:15], v[204:207]
 v_mfma_f32_16x16x32_bf16 v[208:211], a[84:87], a[0:3], v[208:211]
 v_mfma_f32_16x16x32_bf16 v[212:215], a[84:87], a[4:7], v[212:215]
 v_mfma_f32_16x16x32_bf16 v[216:219], a[84:87], a[8:11], v[216:219]
 v_mfma_f32_16x16x32_bf16 v[220:223], a[84:87], a[12:15], v[220:223]
 v_mfma_f32_16x16x32_bf16 v[224:227], a[88:91], a[0:3], v[224:227]
 v_mfma_f32_16x16x32_bf16 v[228:231], a[88:91], a[4:7], v[228:231]
 v_mfma_f32_16x16x32_bf16 v[232:235], a[88:91], a[8:11], v[232:235]
 v_mfma_f32_16x16x32_bf16 v[236:239], a[88:91], a[12:15], v[236:239]
 v_mfma_f32_16x16x32_bf16 v[240:243], a[92:95], a[0:3], v[240:243]
 v_mfma_f32_16x16x32_bf16 v[244:247], a[92:95], a[4:7], v[244:247]
 v_mfma_f32_16x16x32_bf16 v[248:251], a[92:95], a[8:11], v[248:251]
 v_mfma_f32_16x16x32_bf16 v[252:255], a[92:95], a[12:15], v[252:255]
 v_add_u32 v8, 12288, v1
 s_waitcnt vmcnt(8)
 s_waitcnt lgkmcnt(0)
 v_mfma_f32_16x16x32_bf16 v[128:131], a[96:99], a[16:19], v[128:131]
 buffer_load_dwordx4 a[0:3], v8, s[4:7], s24 offen
 v_mfma_f32_16x16x32_bf16 v[132:135], a[96:99], a[20:23], v[132:135]
 buffer_load_dwordx4 a[4:7], v8, s[4:7], s25 offen
 v_mfma_f32_16x16x32_bf16 v[136:139], a[96:99], a[24:27], v[136:139]
 buffer_load_dwordx4 a[8:11], v8, s[4:7], s26 offen
 v_mfma_f32_16x16x32_bf16 v[140:143], a[96:99], a[28:31], v[140:143]
 buffer_load_dwordx4 a[12:15], v8, s[4:7], s27 offen
 v_mfma_f32_16x16x32_bf16 v[144:147], a[100:103], a[16:19], v[144:147]
 ds_read_b128 a[64:67], v1 offset:10240
 v_mfma_f32_16x16x32_bf16 v[148:151], a[100:103], a[20:23], v[148:151]
 ds_read_b128 a[68:71], v1 offset:24576
 v_mfma_f32_16x16x32_bf16 v[152:155], a[100:103], a[24:27], v[152:155]
 ds_read_b128 a[72:75], v1 offset:38912
 v_mfma_f32_16x16x32_bf16 v[156:159], a[100:103], a[28:31], v[156:159]
 ds_read_b128 a[76:79], v1 offset:53248
 v_mfma_f32_16x16x32_bf16 v[160:163], a[104:107], a[16:19], v[160:163]
 ds_read_b128 a[80:83], v12 offset:10240
 v_mfma_f32_16x16x32_bf16 v[164:167], a[104:107], a[20:23], v[164:167]
 ds_read_b128 a[84:87], v12 offset:24576
 v_mfma_f32_16x16x32_bf16 v[168:171], a[104:107], a[24:27], v[168:171]
 ds_read_b128 a[88:91], v12 offset:38912
 v_mfma_f32_16x16x32_bf16 v[172:175], a[104:107], a[28:31], v[172:175]
 ds_read_b128 a[92:95], v12 offset:53248
 v_mfma_f32_16x16x32_bf16 v[176:179], a[108:111], a[16:19], v[176:179]
 v_mfma_f32_16x16x32_bf16 v[180:183], a[108:111], a[20:23], v[180:183]
 v_mfma_f32_16x16x32_bf16 v[184:187], a[108:111], a[24:27], v[184:187]
 v_mfma_f32_16x16x32_bf16 v[188:191], a[108:111], a[28:31], v[188:191]
 v_mfma_f32_16x16x32_bf16 v[192:195], a[112:115], a[16:19], v[192:195]
 v_mfma_f32_16x16x32_bf16 v[196:199], a[112:115], a[20:23], v[196:199]
 v_mfma_f32_16x16x32_bf16 v[200:203], a[112:115], a[24:27], v[200:203]
 v_mfma_f32_16x16x32_bf16 v[204:207], a[112:115], a[28:31], v[204:207]
 v_mfma_f32_16x16x32_bf16 v[208:211], a[116:119], a[16:19], v[208:211]
 v_mfma_f32_16x16x32_bf16 v[212:215], a[116:119], a[20:23], v[212:215]
 v_mfma_f32_16x16x32_bf16 v[216:219], a[116:119], a[24:27], v[216:219]
 v_mfma_f32_16x16x32_bf16 v[220:223], a[116:119], a[28:31], v[220:223]
 v_mfma_f32_16x16x32_bf16 v[224:227], a[120:123], a[16:19], v[224:227]
 v_mfma_f32_16x16x32_bf16 v[228:231], a[120:123], a[20:23], v[228:231]
 v_mfma_f32_16x16x32_bf16 v[232:235], a[120:123], a[24:27], v[232:235]
 v_mfma_f32_16x16x32_bf16 v[236:239], a[120:123], a[28:31], v[236:239]
 v_mfma_f32_16x16x32_bf16 v[240:243], a[124:127], a[16:19], v[240:243]
 v_mfma_f32_16x16x32_bf16 v[244:247], a[124:127], a[20:23], v[244:247]
 v_mfma_f32_16x16x32_bf16 v[248:251], a[124:127], a[24:27], v[248:251]
 v_mfma_f32_16x16x32_bf16 v[252:255], a[124:127], a[28:31], v[252:255]
 v_add_u32 v9, 13312, v1
 s_waitcnt vmcnt(8)
 s_waitcnt lgkmcnt(0)
 v_mfma_f32_16x16x32_bf16 v[128:131], a[64:67], a[32:35], v[128:131]
 buffer_load_dwordx4 a[16:19], v9, s[4:7], s24 offen
 v_mfma_f32_16x16x32_bf16 v[132:135], a[64:67], a[36:39], v[132:135]
 buffer_load_dwordx4 a[20:23], v9, s[4:7], s25 offen
 v_mfma_f32_16x16x32_bf16 v[136:139], a[64:67], a[40:43], v[136:139]
 buffer_load_dwordx4 a[24:27], v9, s[4:7], s26 offen
 v_mfma_f32_16x16x32_bf16 v[140:143], a[64:67], a[44:47], v[140:143]
 buffer_load_dwordx4 a[28:31], v9, s[4:7], s27 offen
 v_mfma_f32_16x16x32_bf16 v[144:147], a[68:71], a[32:35], v[144:147]
 ds_read_b128 a[96:99], v1 offset:11264
 v_mfma_f32_16x16x32_bf16 v[148:151], a[68:71], a[36:39], v[148:151]
 ds_read_b128 a[100:103], v1 offset:25600
 v_mfma_f32_16x16x32_bf16 v[152:155], a[68:71], a[40:43], v[152:155]
 ds_read_b128 a[104:107], v1 offset:39936
 v_mfma_f32_16x16x32_bf16 v[156:159], a[68:71], a[44:47], v[156:159]
 ds_read_b128 a[108:111], v1 offset:54272
 v_mfma_f32_16x16x32_bf16 v[160:163], a[72:75], a[32:35], v[160:163]
 ds_read_b128 a[112:115], v12 offset:11264
 v_mfma_f32_16x16x32_bf16 v[164:167], a[72:75], a[36:39], v[164:167]
 ds_read_b128 a[116:119], v12 offset:25600
 v_mfma_f32_16x16x32_bf16 v[168:171], a[72:75], a[40:43], v[168:171]
 ds_read_b128 a[120:123], v12 offset:39936
 v_mfma_f32_16x16x32_bf16 v[172:175], a[72:75], a[44:47], v[172:175]
 ds_read_b128 a[124:127], v12 offset:54272
 v_mfma_f32_16x16x32_bf16 v[176:179], a[76:79], a[32:35], v[176:179]
 v_mfma_f32_16x16x32_bf16 v[180:183], a[76:79], a[36:39], v[180:183]
 v_mfma_f32_16x16x32_bf16 v[184:187], a[76:79], a[40:43], v[184:187]
 v_mfma_f32_16x16x32_bf16 v[188:191], a[76:79], a[44:47], v[188:191]
 v_mfma_f32_16x16x32_bf16 v[192:195], a[80:83], a[32:35], v[192:195]
 v_mfma_f32_16x16x32_bf16 v[196:199], a[80:83], a[36:39], v[196:199]
 v_mfma_f32_16x16x32_bf16 v[200:203], a[80:83], a[40:43], v[200:203]
 v_mfma_f32_16x16x32_bf16 v[204:207], a[80:83], a[44:47], v[204:207]
 v_mfma_f32_16x16x32_bf16 v[208:211], a[84:87], a[32:35], v[208:211]
 v_mfma_f32_16x16x32_bf16 v[212:215], a[84:87], a[36:39], v[212:215]
 v_mfma_f32_16x16x32_bf16 v[216:219], a[84:87], a[40:43], v[216:219]
 v_mfma_f32_16x16x32_bf16 v[220:223], a[84:87], a[44:47], v[220:223]
 v_mfma_f32_16x16x32_bf16 v[224:227], a[88:91], a[32:35], v[224:227]
 v_mfma_f32_16x16x32_bf16 v[228:231], a[88:91], a[36:39], v[228:231]
 v_mfma_f32_16x16x32_bf16 v[232:235], a[88:91], a[40:43], v[232:235]
 v_mfma_f32_16x16x32_bf16 v[236:239], a[88:91], a[44:47], v[236:239]
 v_mfma_f32_16x16x32_bf16 v[240:243], a[92:95], a[32:35], v[240:243]
 v_mfma_f32_16x16x32_bf16 v[244:247], a[92:95], a[36:39], v[244:247]
 v_mfma_f32_16x16x32_bf16 v[248:251], a[92:95], a[40:43], v[248:251]
 v_mfma_f32_16x16x32_bf16 v[252:255], a[92:95], a[44:47], v[252:255]
 s_waitcnt vmcnt(8)
 s_waitcnt lgkmcnt(0)
 v_mfma_f32_16x16x32_bf16 v[128:131], a[96:99], a[48:51], v[128:131]
 v_mfma_f32_16x16x32_bf16 v[132:135], a[96:99], a[52:55], v[132:135]
 v_mfma_f32_16x16x32_bf16 v[136:139], a[96:99], a[56:59], v[136:139]
 v_mfma_f32_16x16x32_bf16 v[140:143], a[96:99], a[60:63], v[140:143]
 v_mfma_f32_16x16x32_bf16 v[144:147], a[100:103], a[48:51], v[144:147]
 ds_read_b128 a[64:67], v1 offset:12288
 v_mfma_f32_16x16x32_bf16 v[148:151], a[100:103], a[52:55], v[148:151]
 ds_read_b128 a[68:71], v1 offset:26624
 v_mfma_f32_16x16x32_bf16 v[152:155], a[100:103], a[56:59], v[152:155]
 ds_read_b128 a[72:75], v1 offset:40960
 v_mfma_f32_16x16x32_bf16 v[156:159], a[100:103], a[60:63], v[156:159]
 ds_read_b128 a[76:79], v1 offset:55296
 v_mfma_f32_16x16x32_bf16 v[160:163], a[104:107], a[48:51], v[160:163]
 ds_read_b128 a[80:83], v12 offset:12288
 v_mfma_f32_16x16x32_bf16 v[164:167], a[104:107], a[52:55], v[164:167]
 ds_read_b128 a[84:87], v12 offset:26624
 v_mfma_f32_16x16x32_bf16 v[168:171], a[104:107], a[56:59], v[168:171]
 ds_read_b128 a[88:91], v12 offset:40960
 v_mfma_f32_16x16x32_bf16 v[172:175], a[104:107], a[60:63], v[172:175]
 ds_read_b128 a[92:95], v12 offset:55296
 v_mfma_f32_16x16x32_bf16 v[176:179], a[108:111], a[48:51], v[176:179]
 v_mfma_f32_16x16x32_bf16 v[180:183], a[108:111], a[52:55], v[180:183]
 v_mfma_f32_16x16x32_bf16 v[184:187], a[108:111], a[56:59], v[184:187]
 v_mfma_f32_16x16x32_bf16 v[188:191], a[108:111], a[60:63], v[188:191]
 v_mfma_f32_16x16x32_bf16 v[192:195], a[112:115], a[48:51], v[192:195]
 v_mfma_f32_16x16x32_bf16 v[196:199], a[112:115], a[52:55], v[196:199]
 v_mfma_f32_16x16x32_bf16 v[200:203], a[112:115], a[56:59], v[200:203]
 v_mfma_f32_16x16x32_bf16 v[204:207], a[112:115], a[60:63], v[204:207]
 v_mfma_f32_16x16x32_bf16 v[208:211], a[116:119], a[48:51], v[208:211]
 v_mfma_f32_16x16x32_bf16 v[212:215], a[116:119], a[52:55], v[212:215]
 v_mfma_f32_16x16x32_bf16 v[216:219], a[116:119], a[56:59], v[216:219]
 v_mfma_f32_16x16x32_bf16 v[220:223], a[116:119], a[60:63], v[220:223]
 v_mfma_f32_16x16x32_bf16 v[224:227], a[120:123], a[48:51], v[224:227]
 v_mfma_f32_16x16x32_bf16 v[228:231], a[120:123], a[52:55], v[228:231]
 v_mfma_f32_16x16x32_bf16 v[232:235], a[120:123], a[56:59], v[232:235]
 v_mfma_f32_16x16x32_bf16 v[236:239], a[120:123], a[60:63], v[236:239]
 v_mfma_f32_16x16x32_bf16 v[240:243], a[124:127], a[48:51], v[240:243]
 v_mfma_f32_16x16x32_bf16 v[244:247], a[124:127], a[52:55], v[244:247]
 v_mfma_f32_16x16x32_bf16 v[248:251], a[124:127], a[56:59], v[248:251]
 v_mfma_f32_16x16x32_bf16 v[252:255], a[124:127], a[60:63], v[252:255]
 s_waitcnt vmcnt(4)
 s_waitcnt lgkmcnt(0)
 v_mfma_f32_16x16x32_bf16 v[128:131], a[64:67], a[0:3], v[128:131]
 v_mfma_f32_16x16x32_bf16 v[132:135], a[64:67], a[4:7], v[132:135]
 v_mfma_f32_16x16x32_bf16 v[136:139], a[64:67], a[8:11], v[136:139]
 v_mfma_f32_16x16x32_bf16 v[140:143], a[64:67], a[12:15], v[140:143]
 v_mfma_f32_16x16x32_bf16 v[144:147], a[68:71], a[0:3], v[144:147]
 ds_read_b128 a[96:99], v1 offset:13312
 v_mfma_f32_16x16x32_bf16 v[148:151], a[68:71], a[4:7], v[148:151]
 ds_read_b128 a[100:103], v1 offset:27648
 v_mfma_f32_16x16x32_bf16 v[152:155], a[68:71], a[8:11], v[152:155]
 ds_read_b128 a[104:107], v1 offset:41984
 v_mfma_f32_16x16x32_bf16 v[156:159], a[68:71], a[12:15], v[156:159]
 ds_read_b128 a[108:111], v1 offset:56320
 v_mfma_f32_16x16x32_bf16 v[160:163], a[72:75], a[0:3], v[160:163]
 ds_read_b128 a[112:115], v12 offset:13312
 v_mfma_f32_16x16x32_bf16 v[164:167], a[72:75], a[4:7], v[164:167]
 ds_read_b128 a[116:119], v12 offset:27648
 v_mfma_f32_16x16x32_bf16 v[168:171], a[72:75], a[8:11], v[168:171]
 ds_read_b128 a[120:123], v12 offset:41984
 v_mfma_f32_16x16x32_bf16 v[172:175], a[72:75], a[12:15], v[172:175]
 ds_read_b128 a[124:127], v12 offset:56320
 v_mfma_f32_16x16x32_bf16 v[176:179], a[76:79], a[0:3], v[176:179]
 v_mfma_f32_16x16x32_bf16 v[180:183], a[76:79], a[4:7], v[180:183]
 v_mfma_f32_16x16x32_bf16 v[184:187], a[76:79], a[8:11], v[184:187]
 v_mfma_f32_16x16x32_bf16 v[188:191], a[76:79], a[12:15], v[188:191]
 v_mfma_f32_16x16x32_bf16 v[192:195], a[80:83], a[0:3], v[192:195]
 v_mfma_f32_16x16x32_bf16 v[196:199], a[80:83], a[4:7], v[196:199]
 v_mfma_f32_16x16x32_bf16 v[200:203], a[80:83], a[8:11], v[200:203]
 v_mfma_f32_16x16x32_bf16 v[204:207], a[80:83], a[12:15], v[204:207]
 v_mfma_f32_16x16x32_bf16 v[208:211], a[84:87], a[0:3], v[208:211]
 v_mfma_f32_16x16x32_bf16 v[212:215], a[84:87], a[4:7], v[212:215]
 v_mfma_f32_16x16x32_bf16 v[216:219], a[84:87], a[8:11], v[216:219]
 v_mfma_f32_16x16x32_bf16 v[220:223], a[84:87], a[12:15], v[220:223]
 v_mfma_f32_16x16x32_bf16 v[224:227], a[88:91], a[0:3], v[224:227]
 v_mfma_f32_16x16x32_bf16 v[228:231], a[88:91], a[4:7], v[228:231]
 v_mfma_f32_16x16x32_bf16 v[232:235], a[88:91], a[8:11], v[232:235]
 v_mfma_f32_16x16x32_bf16 v[236:239], a[88:91], a[12:15], v[236:239]
 v_mfma_f32_16x16x32_bf16 v[240:243], a[92:95], a[0:3], v[240:243]
 v_mfma_f32_16x16x32_bf16 v[244:247], a[92:95], a[4:7], v[244:247]
 v_mfma_f32_16x16x32_bf16 v[248:251], a[92:95], a[8:11], v[248:251]
 v_mfma_f32_16x16x32_bf16 v[252:255], a[92:95], a[12:15], v[252:255]
 s_waitcnt vmcnt(0)
 s_waitcnt lgkmcnt(0)
 v_mfma_f32_16x16x32_bf16 v[128:131], a[96:99], a[16:19], v[128:131]
 v_mfma_f32_16x16x32_bf16 v[132:135], a[96:99], a[20:23], v[132:135]
 v_mfma_f32_16x16x32_bf16 v[136:139], a[96:99], a[24:27], v[136:139]
 v_mfma_f32_16x16x32_bf16 v[140:143], a[96:99], a[28:31], v[140:143]
 v_mfma_f32_16x16x32_bf16 v[144:147], a[100:103], a[16:19], v[144:147]
 v_mfma_f32_16x16x32_bf16 v[148:151], a[100:103], a[20:23], v[148:151]
 v_mfma_f32_16x16x32_bf16 v[152:155], a[100:103], a[24:27], v[152:155]
 v_mfma_f32_16x16x32_bf16 v[156:159], a[100:103], a[28:31], v[156:159]
 v_mfma_f32_16x16x32_bf16 v[160:163], a[104:107], a[16:19], v[160:163]
 v_mfma_f32_16x16x32_bf16 v[164:167], a[104:107], a[20:23], v[164:167]
 v_mfma_f32_16x16x32_bf16 v[168:171], a[104:107], a[24:27], v[168:171]
 v_mfma_f32_16x16x32_bf16 v[172:175], a[104:107], a[28:31], v[172:175]
 v_mfma_f32_16x16x32_bf16 v[176:179], a[108:111], a[16:19], v[176:179]
 v_mfma_f32_16x16x32_bf16 v[180:183], a[108:111], a[20:23], v[180:183]
 v_mfma_f32_16x16x32_bf16 v[184:187], a[108:111], a[24:27], v[184:187]
 v_mfma_f32_16x16x32_bf16 v[188:191], a[108:111], a[28:31], v[188:191]
 v_mfma_f32_16x16x32_bf16 v[192:195], a[112:115], a[16:19], v[192:195]
 v_mfma_f32_16x16x32_bf16 v[196:199], a[112:115], a[20:23], v[196:199]
 v_mfma_f32_16x16x32_bf16 v[200:203], a[112:115], a[24:27], v[200:203]
 v_mfma_f32_16x16x32_bf16 v[204:207], a[112:115], a[28:31], v[204:207]
 v_mfma_f32_16x16x32_bf16 v[208:211], a[116:119], a[16:19], v[208:211]
 v_mfma_f32_16x16x32_bf16 v[212:215], a[116:119], a[20:23], v[212:215]
 v_mfma_f32_16x16x32_bf16 v[216:219], a[116:119], a[24:27], v[216:219]
 v_mfma_f32_16x16x32_bf16 v[220:223], a[116:119], a[28:31], v[220:223]
 v_mfma_f32_16x16x32_bf16 v[224:227], a[120:123], a[16:19], v[224:227]
 v_mfma_f32_16x16x32_bf16 v[228:231], a[120:123], a[20:23], v[228:231]
 v_mfma_f32_16x16x32_bf16 v[232:235], a[120:123], a[24:27], v[232:235]
 v_mfma_f32_16x16x32_bf16 v[236:239], a[120:123], a[28:31], v[236:239]
 v_mfma_f32_16x16x32_bf16 v[240:243], a[124:127], a[16:19], v[240:243]
 v_mfma_f32_16x16x32_bf16 v[244:247], a[124:127], a[20:23], v[244:247]
 v_mfma_f32_16x16x32_bf16 v[248:251], a[124:127], a[24:27], v[248:251]
 v_mfma_f32_16x16x32_bf16 v[252:255], a[124:127], a[28:31], v[252:255]
 s_nop 7
 s_mul_i32 s11, s21, 1792
 s_add_u32 s11, s11, s23
 s_lshl_b32 s32, s11, 10
 v_cvt_pk_bf16_f32 v16, v128, v129
 v_cvt_pk_bf16_f32 v17, v144, v145
 v_cvt_pk_bf16_f32 v18, v130, v131
 v_cvt_pk_bf16_f32 v19, v146, v147
 s_add_u32 s11, s32, 34603008
 buffer_store_dwordx4 v[16:19], v1, s[4:7], s11 offen sc1
 v_cvt_pk_bf16_f32 v20, v132, v133
 v_cvt_pk_bf16_f32 v21, v148, v149
 v_cvt_pk_bf16_f32 v22, v134, v135
 v_cvt_pk_bf16_f32 v23, v150, v151
 s_add_u32 s11, s32, 34604032
 buffer_store_dwordx4 v[20:23], v1, s[4:7], s11 offen sc1
 v_cvt_pk_bf16_f32 v24, v136, v137
 v_cvt_pk_bf16_f32 v25, v152, v153
 v_cvt_pk_bf16_f32 v26, v138, v139
 v_cvt_pk_bf16_f32 v27, v154, v155
 s_add_u32 s11, s32, 34605056
 buffer_store_dwordx4 v[24:27], v1, s[4:7], s11 offen sc1
 v_cvt_pk_bf16_f32 v28, v140, v141
 v_cvt_pk_bf16_f32 v29, v156, v157
 v_cvt_pk_bf16_f32 v30, v142, v143
 v_cvt_pk_bf16_f32 v31, v158, v159
 s_add_u32 s11, s32, 34606080
 buffer_store_dwordx4 v[28:31], v1, s[4:7], s11 offen sc1
 v_cvt_pk_bf16_f32 v16, v160, v161
 v_cvt_pk_bf16_f32 v17, v176, v177
 v_cvt_pk_bf16_f32 v18, v162, v163
 v_cvt_pk_bf16_f32 v19, v178, v179
 s_add_u32 s11, s32, 35061760
 buffer_store_dwordx4 v[16:19], v1, s[4:7], s11 offen sc1
 v_cvt_pk_bf16_f32 v20, v164, v165
 v_cvt_pk_bf16_f32 v21, v180, v181
 v_cvt_pk_bf16_f32 v22, v166, v167
 v_cvt_pk_bf16_f32 v23, v182, v183
 s_add_u32 s11, s32, 35062784
 buffer_store_dwordx4 v[20:23], v1, s[4:7], s11 offen sc1
 v_cvt_pk_bf16_f32 v24, v168, v169
 v_cvt_pk_bf16_f32 v25, v184, v185
 v_cvt_pk_bf16_f32 v26, v170, v171
 v_cvt_pk_bf16_f32 v27, v186, v187
 s_add_u32 s11, s32, 35063808
 buffer_store_dwordx4 v[24:27], v1, s[4:7], s11 offen sc1
 v_cvt_pk_bf16_f32 v28, v172, v173
 v_cvt_pk_bf16_f32 v29, v188, v189
 v_cvt_pk_bf16_f32 v30, v174, v175
 v_cvt_pk_bf16_f32 v31, v190, v191
 s_add_u32 s11, s32, 35064832
 buffer_store_dwordx4 v[28:31], v1, s[4:7], s11 offen sc1
 v_cvt_pk_bf16_f32 v16, v192, v193
 v_cvt_pk_bf16_f32 v17, v208, v209
 v_cvt_pk_bf16_f32 v18, v194, v195
 v_cvt_pk_bf16_f32 v19, v210, v211
 s_add_u32 s11, s32, 35520512
 buffer_store_dwordx4 v[16:19], v1, s[4:7], s11 offen sc1
 v_cvt_pk_bf16_f32 v20, v196, v197
 v_cvt_pk_bf16_f32 v21, v212, v213
 v_cvt_pk_bf16_f32 v22, v198, v199
 v_cvt_pk_bf16_f32 v23, v214, v215
 s_add_u32 s11, s32, 35521536
 buffer_store_dwordx4 v[20:23], v1, s[4:7], s11 offen sc1
 v_cvt_pk_bf16_f32 v24, v200, v201
 v_cvt_pk_bf16_f32 v25, v216, v217
 v_cvt_pk_bf16_f32 v26, v202, v203
 v_cvt_pk_bf16_f32 v27, v218, v219
 s_add_u32 s11, s32, 35522560
 buffer_store_dwordx4 v[24:27], v1, s[4:7], s11 offen sc1
 v_cvt_pk_bf16_f32 v28, v204, v205
 v_cvt_pk_bf16_f32 v29, v220, v221
 v_cvt_pk_bf16_f32 v30, v206, v207
 v_cvt_pk_bf16_f32 v31, v222, v223
 s_add_u32 s11, s32, 35523584
 buffer_store_dwordx4 v[28:31], v1, s[4:7], s11 offen sc1
 v_cvt_pk_bf16_f32 v16, v224, v225
 v_cvt_pk_bf16_f32 v17, v240, v241
 v_cvt_pk_bf16_f32 v18, v226, v227
 v_cvt_pk_bf16_f32 v19, v242, v243
 s_add_u32 s11, s32, 35979264
 buffer_store_dwordx4 v[16:19], v1, s[4:7], s11 offen sc1
 v_cvt_pk_bf16_f32 v20, v228, v229
 v_cvt_pk_bf16_f32 v21, v244, v245
 v_cvt_pk_bf16_f32 v22, v230, v231
 v_cvt_pk_bf16_f32 v23, v246, v247
 s_add_u32 s11, s32, 35980288
 buffer_store_dwordx4 v[20:23], v1, s[4:7], s11 offen sc1
 v_cvt_pk_bf16_f32 v24, v232, v233
 v_cvt_pk_bf16_f32 v25, v248, v249
 v_cvt_pk_bf16_f32 v26, v234, v235
 v_cvt_pk_bf16_f32 v27, v250, v251
 s_add_u32 s11, s32, 35981312
 buffer_store_dwordx4 v[24:27], v1, s[4:7], s11 offen sc1
 v_cvt_pk_bf16_f32 v28, v236, v237
 v_cvt_pk_bf16_f32 v29, v252, v253
 v_cvt_pk_bf16_f32 v30, v238, v239
 v_cvt_pk_bf16_f32 v31, v254, v255
 s_add_u32 s11, s32, 35982336
 buffer_store_dwordx4 v[28:31], v1, s[4:7], s11 offen sc1
 s_waitcnt vmcnt(0)
 s_barrier
 s_lshl_b32 s33, s21, 7
 s_add_u32 s33, s33, 18413568
 buffer_atomic_add v2, v3, s[4:7], s33 offen sc1
 s_branch K_loop
K_t:
 s_sub_u32 s12, s92, 56
 s_lshr_b32 s21, s12, 2
 s_and_b32 s11, s12, 3
 s_lshl_b32 s22, s75, 2
 s_add_u32 s22, s22, s11
 s_lshl_b32 s23, s22, 4
 s_lshl_b32 s11, s8, 2
 s_add_u32 s23, s23, s11
 s_mul_i32 s11, s23, 14336
 s_add_u32 s24, s11, 2097152
 s_add_u32 s25, s11, 2111488
 s_add_u32 s26, s11, 2125824
 s_add_u32 s27, s11, 2140160
 s_mul_i32 s11, s21, 114688
 s_mul_i32 s12, s8, 28672
 s_add_u32 s11, s11, s12
 s_add_u32 s11, s11, 0
 s_add_u32 s13, s12, 0
 s_mov_b32 m0, s13
 s_add_u32 s13, s11, 0
 buffer_load_dwordx4 v1, s[4:7], s13 offen offset:0 lds
 buffer_load_dwordx4 v1, s[4:7], s13 offen offset:1024 lds
 buffer_load_dwordx4 v1, s[4:7], s13 offen offset:2048 lds
 buffer_load_dwordx4 v1, s[4:7], s13 offen offset:3072 lds
 s_add_u32 s13, s12, 4096
 s_mov_b32 m0, s13
 s_add_u32 s13, s11, 4096
 buffer_load_dwordx4 v1, s[4:7], s13 offen offset:0 lds
 buffer_load_dwordx4 v1, s[4:7], s13 offen offset:1024 lds
 buffer_load_dwordx4 v1, s[4:7], s13 offen offset:2048 lds
 buffer_load_dwordx4 v1, s[4:7], s13 offen offset:3072 lds
 s_add_u32 s13, s12, 8192
 s_mov_b32 m0, s13
 s_add_u32 s13, s11, 8192
 buffer_load_dwordx4 v1, s[4:7], s13 offen offset:0 lds
 buffer_load_dwordx4 v1, s[4:7], s13 offen offset:1024 lds
 buffer_load_dwordx4 v1, s[4:7], s13 offen offset:2048 lds
 buffer_load_dwordx4 v1, s[4:7], s13 offen offset:3072 lds
 s_add_u32 s13, s12, 12288
 s_mov_b32 m0, s13
 s_add_u32 s13, s11, 12288
 buffer_load_dwordx4 v1, s[4:7], s13 offen offset:0 lds
 buffer_load_dwordx4 v1, s[4:7], s13 offen offset:1024 lds
 buffer_load_dwordx4 v1, s[4:7], s13 offen offset:2048 lds
 buffer_load_dwordx4 v1, s[4:7], s13 offen offset:3072 lds
 s_add_u32 s13, s12, 16384
 s_mov_b32 m0, s13
 s_add_u32 s13, s11, 16384
 buffer_load_dwordx4 v1, s[4:7], s13 offen offset:0 lds
 buffer_load_dwordx4 v1, s[4:7], s13 offen offset:1024 lds
 buffer_load_dwordx4 v1, s[4:7], s13 offen offset:2048 lds
 buffer_load_dwordx4 v1, s[4:7], s13 offen offset:3072 lds
 s_add_u32 s13, s12, 20480
 s_mov_b32 m0, s13
 s_add_u32 s13, s11, 20480
 buffer_load_dwordx4 v1, s[4:7], s13 offen offset:0 lds
 buffer_load_dwordx4 v1, s[4:7], s13 offen offset:1024 lds
 buffer_load_dwordx4 v1, s[4:7], s13 offen offset:2048 lds
 buffer_load_dwordx4 v1, s[4:7], s13 offen offset:3072 lds
 s_add_u32 s13, s12, 24576
 s_mov_b32 m0, s13
 s_add_u32 s13, s11, 24576
 buffer_load_dwordx4 v1, s[4:7], s13 offen offset:0 lds
 buffer_load_dwordx4 v1, s[4:7], s13 offen offset:1024 lds
 buffer_load_dwordx4 v1, s[4:7], s13 offen offset:2048 lds
 buffer_load_dwordx4 v1, s[4:7], s13 offen offset:3072 lds
 v_add_u32 v12, 57344, v1
 v_add_u32 v8, 0, v1
 v_add_u32 v9, 1024, v1
 v_add_u32 v10, 2048, v1
 buffer_load_dwordx4 a[0:3], v8, s[4:7], s24 offen
 buffer_load_dwordx4 a[4:7], v8, s[4:7], s25 offen
 buffer_load_dwordx4 a[8:11], v8, s[4:7], s26 offen
 buffer_load_dwordx4 a[12:15], v8, s[4:7], s27 offen
 buffer_load_dwordx4 a[16:19], v9, s[4:7], s24 offen
 buffer_load_dwordx4 a[20:23], v9, s[4:7], s25 offen
 buffer_load_dwordx4 a[24:27], v9, s[4:7], s26 offen
 buffer_load_dwordx4 a[28:31], v9, s[4:7], s27 offen
 buffer_load_dwordx4 a[32:35], v10, s[4:7], s24 offen
 buffer_load_dwordx4 a[36:39], v10, s[4:7], s25 offen
 buffer_load_dwordx4 a[40:43], v10, s[4:7], s26 offen
 buffer_load_dwordx4 a[44:47], v10, s[4:7], s27 offen
 s_waitcnt vmcnt(12)
 s_barrier
 ds_read_b128 a[64:67], v1 offset:0
 ds_read_b128 a[68:71], v1 offset:14336
 ds_read_b128 a[72:75], v1 offset:28672
 ds_read_b128 a[76:79], v1 offset:43008
 ds_read_b128 a[80:83], v12 offset:0
 ds_read_b128 a[84:87], v12 offset:14336
 ds_read_b128 a[88:91], v12 offset:28672
 ds_read_b128 a[92:95], v12 offset:43008
 v_add_u32 v11, 3072, v1
 s_waitcnt vmcnt(8)
 s_waitcnt lgkmcnt(0)
 v_mfma_f32_16x16x32_bf16 v[128:131], a[0:3], a[64:67], 0
 buffer_load_dwordx4 a[48:51], v11, s[4:7], s24 offen
 v_mfma_f32_16x16x32_bf16 v[132:135], a[4:7], a[64:67], 0
 buffer_load_dwordx4 a[52:55], v11, s[4:7], s25 offen
 v_mfma_f32_16x16x32_bf16 v[136:139], a[8:11], a[64:67], 0
 buffer_load_dwordx4 a[56:59], v11, s[4:7], s26 offen
 v_mfma_f32_16x16x32_bf16 v[140:143], a[12:15], a[64:67], 0
 buffer_load_dwordx4 a[60:63], v11, s[4:7], s27 offen
 v_mfma_f32_16x16x32_bf16 v[144:147], a[0:3], a[68:71], 0
 ds_read_b128 a[96:99], v1 offset:1024
 v_mfma_f32_16x16x32_bf16 v[148:151], a[4:7], a[68:71], 0
 ds_read_b128 a[100:103], v1 offset:15360
 v_mfma_f32_16x16x32_bf16 v[152:155], a[8:11], a[68:71], 0
 ds_read_b128 a[104:107], v1 offset:29696
 v_mfma_f32_16x16x32_bf16 v[156:159], a[12:15], a[68:71], 0
 ds_read_b128 a[108:111], v1 offset:44032
 v_mfma_f32_16x16x32_bf16 v[160:163], a[0:3], a[72:75], 0
 ds_read_b128 a[112:115], v12 offset:1024
 v_mfma_f32_16x16x32_bf16 v[164:167], a[4:7], a[72:75], 0
 ds_read_b128 a[116:119], v12 offset:15360
 v_mfma_f32_16x16x32_bf16 v[168:171], a[8:11], a[72:75], 0
 ds_read_b128 a[120:123], v12 offset:29696
 v_mfma_f32_16x16x32_bf16 v[172:175], a[12:15], a[72:75], 0
 ds_read_b128 a[124:127], v12 offset:44032
 v_mfma_f32_16x16x32_bf16 v[176:179], a[0:3], a[76:79], 0
 v_mfma_f32_16x16x32_bf16 v[180:183], a[4:7], a[76:79], 0
 v_mfma_f32_16x16x32_bf16 v[184:187], a[8:11], a[76:79], 0
 v_mfma_f32_16x16x32_bf16 v[188:191], a[12:15], a[76:79], 0
 v_mfma_f32_16x16x32_bf16 v[192:195], a[0:3], a[80:83], 0
 v_mfma_f32_16x16x32_bf16 v[196:199], a[4:7], a[80:83], 0
 v_mfma_f32_16x16x32_bf16 v[200:203], a[8:11], a[80:83], 0
 v_mfma_f32_16x16x32_bf16 v[204:207], a[12:15], a[80:83], 0
 v_mfma_f32_16x16x32_bf16 v[208:211], a[0:3], a[84:87], 0
 v_mfma_f32_16x16x32_bf16 v[212:215], a[4:7], a[84:87], 0
 v_mfma_f32_16x16x32_bf16 v[216:219], a[8:11], a[84:87], 0
 v_mfma_f32_16x16x32_bf16 v[220:223], a[12:15], a[84:87], 0
 v_mfma_f32_16x16x32_bf16 v[224:227], a[0:3], a[88:91], 0
 v_mfma_f32_16x16x32_bf16 v[228:231], a[4:7], a[88:91], 0
 v_mfma_f32_16x16x32_bf16 v[232:235], a[8:11], a[88:91], 0
 v_mfma_f32_16x16x32_bf16 v[236:239], a[12:15], a[88:91], 0
 v_mfma_f32_16x16x32_bf16 v[240:243], a[0:3], a[92:95], 0
 v_mfma_f32_16x16x32_bf16 v[244:247], a[4:7], a[92:95], 0
 v_mfma_f32_16x16x32_bf16 v[248:251], a[8:11], a[92:95], 0
 v_mfma_f32_16x16x32_bf16 v[252:255], a[12:15], a[92:95], 0
 v_add_u32 v8, 4096, v1
 s_waitcnt vmcnt(8)
 s_waitcnt lgkmcnt(0)
 v_mfma_f32_16x16x32_bf16 v[128:131], a[16:19], a[96:99], v[128:131]
 buffer_load_dwordx4 a[0:3], v8, s[4:7], s24 offen
 v_mfma_f32_16x16x32_bf16 v[132:135], a[20:23], a[96:99], v[132:135]
 buffer_load_dwordx4 a[4:7], v8, s[4:7], s25 offen
 v_mfma_f32_16x16x32_bf16 v[136:139], a[24:27], a[96:99], v[136:139]
 buffer_load_dwordx4 a[8:11], v8, s[4:7], s26 offen
 v_mfma_f32_16x16x32_bf16 v[140:143], a[28:31], a[96:99], v[140:143]
 buffer_load_dwordx4 a[12:15], v8, s[4:7], s27 offen
 v_mfma_f32_16x16x32_bf16 v[144:147], a[16:19], a[100:103], v[144:147]
 ds_read_b128 a[64:67], v1 offset:2048
 v_mfma_f32_16x16x32_bf16 v[148:151], a[20:23], a[100:103], v[148:151]
 ds_read_b128 a[68:71], v1 offset:16384
 v_mfma_f32_16x16x32_bf16 v[152:155], a[24:27], a[100:103], v[152:155]
 ds_read_b128 a[72:75], v1 offset:30720
 v_mfma_f32_16x16x32_bf16 v[156:159], a[28:31], a[100:103], v[156:159]
 ds_read_b128 a[76:79], v1 offset:45056
 v_mfma_f32_16x16x32_bf16 v[160:163], a[16:19], a[104:107], v[160:163]
 ds_read_b128 a[80:83], v12 offset:2048
 v_mfma_f32_16x16x32_bf16 v[164:167], a[20:23], a[104:107], v[164:167]
 ds_read_b128 a[84:87], v12 offset:16384
 v_mfma_f32_16x16x32_bf16 v[168:171], a[24:27], a[104:107], v[168:171]
 ds_read_b128 a[88:91], v12 offset:30720
 v_mfma_f32_16x16x32_bf16 v[172:175], a[28:31], a[104:107], v[172:175]
 ds_read_b128 a[92:95], v12 offset:45056
 v_mfma_f32_16x16x32_bf16 v[176:179], a[16:19], a[108:111], v[176:179]
 v_mfma_f32_16x16x32_bf16 v[180:183], a[20:23], a[108:111], v[180:183]
 v_mfma_f32_16x16x32_bf16 v[184:187], a[24:27], a[108:111], v[184:187]
 v_mfma_f32_16x16x32_bf16 v[188:191], a[28:31], a[108:111], v[188:191]
 v_mfma_f32_16x16x32_bf16 v[192:195], a[16:19], a[112:115], v[192:195]
 v_mfma_f32_16x16x32_bf16 v[196:199], a[20:23], a[112:115], v[196:199]
 v_mfma_f32_16x16x32_bf16 v[200:203], a[24:27], a[112:115], v[200:203]
 v_mfma_f32_16x16x32_bf16 v[204:207], a[28:31], a[112:115], v[204:207]
 v_mfma_f32_16x16x32_bf16 v[208:211], a[16:19], a[116:119], v[208:211]
 v_mfma_f32_16x16x32_bf16 v[212:215], a[20:23], a[116:119], v[212:215]
 v_mfma_f32_16x16x32_bf16 v[216:219], a[24:27], a[116:119], v[216:219]
 v_mfma_f32_16x16x32_bf16 v[220:223], a[28:31], a[116:119], v[220:223]
 v_mfma_f32_16x16x32_bf16 v[224:227], a[16:19], a[120:123], v[224:227]
 v_mfma_f32_16x16x32_bf16 v[228:231], a[20:23], a[120:123], v[228:231]
 v_mfma_f32_16x16x32_bf16 v[232:235], a[24:27], a[120:123], v[232:235]
 v_mfma_f32_16x16x32_bf16 v[236:239], a[28:31], a[120:123], v[236:239]
 v_mfma_f32_16x16x32_bf16 v[240:243], a[16:19], a[124:127], v[240:243]
 v_mfma_f32_16x16x32_bf16 v[244:247], a[20:23], a[124:127], v[244:247]
 v_mfma_f32_16x16x32_bf16 v[248:251], a[24:27], a[124:127], v[248:251]
 v_mfma_f32_16x16x32_bf16 v[252:255], a[28:31], a[124:127], v[252:255]
 v_add_u32 v9, 5120, v1
 s_waitcnt vmcnt(8)
 s_waitcnt lgkmcnt(0)
 v_mfma_f32_16x16x32_bf16 v[128:131], a[32:35], a[64:67], v[128:131]
 buffer_load_dwordx4 a[16:19], v9, s[4:7], s24 offen
 v_mfma_f32_16x16x32_bf16 v[132:135], a[36:39], a[64:67], v[132:135]
 buffer_load_dwordx4 a[20:23], v9, s[4:7], s25 offen
 v_mfma_f32_16x16x32_bf16 v[136:139], a[40:43], a[64:67], v[136:139]
 buffer_load_dwordx4 a[24:27], v9, s[4:7], s26 offen
 v_mfma_f32_16x16x32_bf16 v[140:143], a[44:47], a[64:67], v[140:143]
 buffer_load_dwordx4 a[28:31], v9, s[4:7], s27 offen
 v_mfma_f32_16x16x32_bf16 v[144:147], a[32:35], a[68:71], v[144:147]
 ds_read_b128 a[96:99], v1 offset:3072
 v_mfma_f32_16x16x32_bf16 v[148:151], a[36:39], a[68:71], v[148:151]
 ds_read_b128 a[100:103], v1 offset:17408
 v_mfma_f32_16x16x32_bf16 v[152:155], a[40:43], a[68:71], v[152:155]
 ds_read_b128 a[104:107], v1 offset:31744
 v_mfma_f32_16x16x32_bf16 v[156:159], a[44:47], a[68:71], v[156:159]
 ds_read_b128 a[108:111], v1 offset:46080
 v_mfma_f32_16x16x32_bf16 v[160:163], a[32:35], a[72:75], v[160:163]
 ds_read_b128 a[112:115], v12 offset:3072
 v_mfma_f32_16x16x32_bf16 v[164:167], a[36:39], a[72:75], v[164:167]
 ds_read_b128 a[116:119], v12 offset:17408
 v_mfma_f32_16x16x32_bf16 v[168:171], a[40:43], a[72:75], v[168:171]
 ds_read_b128 a[120:123], v12 offset:31744
 v_mfma_f32_16x16x32_bf16 v[172:175], a[44:47], a[72:75], v[172:175]
 ds_read_b128 a[124:127], v12 offset:46080
 v_mfma_f32_16x16x32_bf16 v[176:179], a[32:35], a[76:79], v[176:179]
 v_mfma_f32_16x16x32_bf16 v[180:183], a[36:39], a[76:79], v[180:183]
 v_mfma_f32_16x16x32_bf16 v[184:187], a[40:43], a[76:79], v[184:187]
 v_mfma_f32_16x16x32_bf16 v[188:191], a[44:47], a[76:79], v[188:191]
 v_mfma_f32_16x16x32_bf16 v[192:195], a[32:35], a[80:83], v[192:195]
 v_mfma_f32_16x16x32_bf16 v[196:199], a[36:39], a[80:83], v[196:199]
 v_mfma_f32_16x16x32_bf16 v[200:203], a[40:43], a[80:83], v[200:203]
 v_mfma_f32_16x16x32_bf16 v[204:207], a[44:47], a[80:83], v[204:207]
 v_mfma_f32_16x16x32_bf16 v[208:211], a[32:35], a[84:87], v[208:211]
 v_mfma_f32_16x16x32_bf16 v[212:215], a[36:39], a[84:87], v[212:215]
 v_mfma_f32_16x16x32_bf16 v[216:219], a[40:43], a[84:87], v[216:219]
 v_mfma_f32_16x16x32_bf16 v[220:223], a[44:47], a[84:87], v[220:223]
 v_mfma_f32_16x16x32_bf16 v[224:227], a[32:35], a[88:91], v[224:227]
 v_mfma_f32_16x16x32_bf16 v[228:231], a[36:39], a[88:91], v[228:231]
 v_mfma_f32_16x16x32_bf16 v[232:235], a[40:43], a[88:91], v[232:235]
 v_mfma_f32_16x16x32_bf16 v[236:239], a[44:47], a[88:91], v[236:239]
 v_mfma_f32_16x16x32_bf16 v[240:243], a[32:35], a[92:95], v[240:243]
 v_mfma_f32_16x16x32_bf16 v[244:247], a[36:39], a[92:95], v[244:247]
 v_mfma_f32_16x16x32_bf16 v[248:251], a[40:43], a[92:95], v[248:251]
 v_mfma_f32_16x16x32_bf16 v[252:255], a[44:47], a[92:95], v[252:255]
 v_add_u32 v10, 6144, v1
 s_waitcnt vmcnt(8)
 s_waitcnt lgkmcnt(0)
 v_mfma_f32_16x16x32_bf16 v[128:131], a[48:51], a[96:99], v[128:131]
 buffer_load_dwordx4 a[32:35], v10, s[4:7], s24 offen
 v_mfma_f32_16x16x32_bf16 v[132:135], a[52:55], a[96:99], v[132:135]
 buffer_load_dwordx4 a[36:39], v10, s[4:7], s25 offen
 v_mfma_f32_16x16x32_bf16 v[136:139], a[56:59], a[96:99], v[136:139]
 buffer_load_dwordx4 a[40:43], v10, s[4:7], s26 offen
 v_mfma_f32_16x16x32_bf16 v[140:143], a[60:63], a[96:99], v[140:143]
 buffer_load_dwordx4 a[44:47], v10, s[4:7], s27 offen
 v_mfma_f32_16x16x32_bf16 v[144:147], a[48:51], a[100:103], v[144:147]
 ds_read_b128 a[64:67], v1 offset:4096
 v_mfma_f32_16x16x32_bf16 v[148:151], a[52:55], a[100:103], v[148:151]
 ds_read_b128 a[68:71], v1 offset:18432
 v_mfma_f32_16x16x32_bf16 v[152:155], a[56:59], a[100:103], v[152:155]
 ds_read_b128 a[72:75], v1 offset:32768
 v_mfma_f32_16x16x32_bf16 v[156:159], a[60:63], a[100:103], v[156:159]
 ds_read_b128 a[76:79], v1 offset:47104
 v_mfma_f32_16x16x32_bf16 v[160:163], a[48:51], a[104:107], v[160:163]
 ds_read_b128 a[80:83], v12 offset:4096
 v_mfma_f32_16x16x32_bf16 v[164:167], a[52:55], a[104:107], v[164:167]
 ds_read_b128 a[84:87], v12 offset:18432
 v_mfma_f32_16x16x32_bf16 v[168:171], a[56:59], a[104:107], v[168:171]
 ds_read_b128 a[88:91], v12 offset:32768
 v_mfma_f32_16x16x32_bf16 v[172:175], a[60:63], a[104:107], v[172:175]
 ds_read_b128 a[92:95], v12 offset:47104
 v_mfma_f32_16x16x32_bf16 v[176:179], a[48:51], a[108:111], v[176:179]
 v_mfma_f32_16x16x32_bf16 v[180:183], a[52:55], a[108:111], v[180:183]
 v_mfma_f32_16x16x32_bf16 v[184:187], a[56:59], a[108:111], v[184:187]
 v_mfma_f32_16x16x32_bf16 v[188:191], a[60:63], a[108:111], v[188:191]
 v_mfma_f32_16x16x32_bf16 v[192:195], a[48:51], a[112:115], v[192:195]
 v_mfma_f32_16x16x32_bf16 v[196:199], a[52:55], a[112:115], v[196:199]
 v_mfma_f32_16x16x32_bf16 v[200:203], a[56:59], a[112:115], v[200:203]
 v_mfma_f32_16x16x32_bf16 v[204:207], a[60:63], a[112:115], v[204:207]
 v_mfma_f32_16x16x32_bf16 v[208:211], a[48:51], a[116:119], v[208:211]
 v_mfma_f32_16x16x32_bf16 v[212:215], a[52:55], a[116:119], v[212:215]
 v_mfma_f32_16x16x32_bf16 v[216:219], a[56:59], a[116:119], v[216:219]
 v_mfma_f32_16x16x32_bf16 v[220:223], a[60:63], a[116:119], v[220:223]
 v_mfma_f32_16x16x32_bf16 v[224:227], a[48:51], a[120:123], v[224:227]
 v_mfma_f32_16x16x32_bf16 v[228:231], a[52:55], a[120:123], v[228:231]
 v_mfma_f32_16x16x32_bf16 v[232:235], a[56:59], a[120:123], v[232:235]
 v_mfma_f32_16x16x32_bf16 v[236:239], a[60:63], a[120:123], v[236:239]
 v_mfma_f32_16x16x32_bf16 v[240:243], a[48:51], a[124:127], v[240:243]
 v_mfma_f32_16x16x32_bf16 v[244:247], a[52:55], a[124:127], v[244:247]
 v_mfma_f32_16x16x32_bf16 v[248:251], a[56:59], a[124:127], v[248:251]
 v_mfma_f32_16x16x32_bf16 v[252:255], a[60:63], a[124:127], v[252:255]
 v_add_u32 v11, 7168, v1
 s_waitcnt vmcnt(8)
 s_waitcnt lgkmcnt(0)
 v_mfma_f32_16x16x32_bf16 v[128:131], a[0:3], a[64:67], v[128:131]
 buffer_load_dwordx4 a[48:51], v11, s[4:7], s24 offen
 v_mfma_f32_16x16x32_bf16 v[132:135], a[4:7], a[64:67], v[132:135]
 buffer_load_dwordx4 a[52:55], v11, s[4:7], s25 offen
 v_mfma_f32_16x16x32_bf16 v[136:139], a[8:11], a[64:67], v[136:139]
 buffer_load_dwordx4 a[56:59], v11, s[4:7], s26 offen
 v_mfma_f32_16x16x32_bf16 v[140:143], a[12:15], a[64:67], v[140:143]
 buffer_load_dwordx4 a[60:63], v11, s[4:7], s27 offen
 v_mfma_f32_16x16x32_bf16 v[144:147], a[0:3], a[68:71], v[144:147]
 ds_read_b128 a[96:99], v1 offset:5120
 v_mfma_f32_16x16x32_bf16 v[148:151], a[4:7], a[68:71], v[148:151]
 ds_read_b128 a[100:103], v1 offset:19456
 v_mfma_f32_16x16x32_bf16 v[152:155], a[8:11], a[68:71], v[152:155]
 ds_read_b128 a[104:107], v1 offset:33792
 v_mfma_f32_16x16x32_bf16 v[156:159], a[12:15], a[68:71], v[156:159]
 ds_read_b128 a[108:111], v1 offset:48128
 v_mfma_f32_16x16x32_bf16 v[160:163], a[0:3], a[72:75], v[160:163]
 ds_read_b128 a[112:115], v12 offset:5120
 v_mfma_f32_16x16x32_bf16 v[164:167], a[4:7], a[72:75], v[164:167]
 ds_read_b128 a[116:119], v12 offset:19456
 v_mfma_f32_16x16x32_bf16 v[168:171], a[8:11], a[72:75], v[168:171]
 ds_read_b128 a[120:123], v12 offset:33792
 v_mfma_f32_16x16x32_bf16 v[172:175], a[12:15], a[72:75], v[172:175]
 ds_read_b128 a[124:127], v12 offset:48128
 v_mfma_f32_16x16x32_bf16 v[176:179], a[0:3], a[76:79], v[176:179]
 v_mfma_f32_16x16x32_bf16 v[180:183], a[4:7], a[76:79], v[180:183]
 v_mfma_f32_16x16x32_bf16 v[184:187], a[8:11], a[76:79], v[184:187]
 v_mfma_f32_16x16x32_bf16 v[188:191], a[12:15], a[76:79], v[188:191]
 v_mfma_f32_16x16x32_bf16 v[192:195], a[0:3], a[80:83], v[192:195]
 v_mfma_f32_16x16x32_bf16 v[196:199], a[4:7], a[80:83], v[196:199]
 v_mfma_f32_16x16x32_bf16 v[200:203], a[8:11], a[80:83], v[200:203]
 v_mfma_f32_16x16x32_bf16 v[204:207], a[12:15], a[80:83], v[204:207]
 v_mfma_f32_16x16x32_bf16 v[208:211], a[0:3], a[84:87], v[208:211]
 v_mfma_f32_16x16x32_bf16 v[212:215], a[4:7], a[84:87], v[212:215]
 v_mfma_f32_16x16x32_bf16 v[216:219], a[8:11], a[84:87], v[216:219]
 v_mfma_f32_16x16x32_bf16 v[220:223], a[12:15], a[84:87], v[220:223]
 v_mfma_f32_16x16x32_bf16 v[224:227], a[0:3], a[88:91], v[224:227]
 v_mfma_f32_16x16x32_bf16 v[228:231], a[4:7], a[88:91], v[228:231]
 v_mfma_f32_16x16x32_bf16 v[232:235], a[8:11], a[88:91], v[232:235]
 v_mfma_f32_16x16x32_bf16 v[236:239], a[12:15], a[88:91], v[236:239]
 v_mfma_f32_16x16x32_bf16 v[240:243], a[0:3], a[92:95], v[240:243]
 v_mfma_f32_16x16x32_bf16 v[244:247], a[4:7], a[92:95], v[244:247]
 v_mfma_f32_16x16x32_bf16 v[248:251], a[8:11], a[92:95], v[248:251]
 v_mfma_f32_16x16x32_bf16 v[252:255], a[12:15], a[92:95], v[252:255]
 v_add_u32 v8, 8192, v1
 s_waitcnt vmcnt(8)
 s_waitcnt lgkmcnt(0)
 v_mfma_f32_16x16x32_bf16 v[128:131], a[16:19], a[96:99], v[128:131]
 buffer_load_dwordx4 a[0:3], v8, s[4:7], s24 offen
 v_mfma_f32_16x16x32_bf16 v[132:135], a[20:23], a[96:99], v[132:135]
 buffer_load_dwordx4 a[4:7], v8, s[4:7], s25 offen
 v_mfma_f32_16x16x32_bf16 v[136:139], a[24:27], a[96:99], v[136:139]
 buffer_load_dwordx4 a[8:11], v8, s[4:7], s26 offen
 v_mfma_f32_16x16x32_bf16 v[140:143], a[28:31], a[96:99], v[140:143]
 buffer_load_dwordx4 a[12:15], v8, s[4:7], s27 offen
 v_mfma_f32_16x16x32_bf16 v[144:147], a[16:19], a[100:103], v[144:147]
 ds_read_b128 a[64:67], v1 offset:6144
 v_mfma_f32_16x16x32_bf16 v[148:151], a[20:23], a[100:103], v[148:151]
 ds_read_b128 a[68:71], v1 offset:20480
 v_mfma_f32_16x16x32_bf16 v[152:155], a[24:27], a[100:103], v[152:155]
 ds_read_b128 a[72:75], v1 offset:34816
 v_mfma_f32_16x16x32_bf16 v[156:159], a[28:31], a[100:103], v[156:159]
 ds_read_b128 a[76:79], v1 offset:49152
 v_mfma_f32_16x16x32_bf16 v[160:163], a[16:19], a[104:107], v[160:163]
 ds_read_b128 a[80:83], v12 offset:6144
 v_mfma_f32_16x16x32_bf16 v[164:167], a[20:23], a[104:107], v[164:167]
 ds_read_b128 a[84:87], v12 offset:20480
 v_mfma_f32_16x16x32_bf16 v[168:171], a[24:27], a[104:107], v[168:171]
 ds_read_b128 a[88:91], v12 offset:34816
 v_mfma_f32_16x16x32_bf16 v[172:175], a[28:31], a[104:107], v[172:175]
 ds_read_b128 a[92:95], v12 offset:49152
 v_mfma_f32_16x16x32_bf16 v[176:179], a[16:19], a[108:111], v[176:179]
 v_mfma_f32_16x16x32_bf16 v[180:183], a[20:23], a[108:111], v[180:183]
 v_mfma_f32_16x16x32_bf16 v[184:187], a[24:27], a[108:111], v[184:187]
 v_mfma_f32_16x16x32_bf16 v[188:191], a[28:31], a[108:111], v[188:191]
 v_mfma_f32_16x16x32_bf16 v[192:195], a[16:19], a[112:115], v[192:195]
 v_mfma_f32_16x16x32_bf16 v[196:199], a[20:23], a[112:115], v[196:199]
 v_mfma_f32_16x16x32_bf16 v[200:203], a[24:27], a[112:115], v[200:203]
 v_mfma_f32_16x16x32_bf16 v[204:207], a[28:31], a[112:115], v[204:207]
 v_mfma_f32_16x16x32_bf16 v[208:211], a[16:19], a[116:119], v[208:211]
 v_mfma_f32_16x16x32_bf16 v[212:215], a[20:23], a[116:119], v[212:215]
 v_mfma_f32_16x16x32_bf16 v[216:219], a[24:27], a[116:119], v[216:219]
 v_mfma_f32_16x16x32_bf16 v[220:223], a[28:31], a[116:119], v[220:223]
 v_mfma_f32_16x16x32_bf16 v[224:227], a[16:19], a[120:123], v[224:227]
 v_mfma_f32_16x16x32_bf16 v[228:231], a[20:23], a[120:123], v[228:231]
 v_mfma_f32_16x16x32_bf16 v[232:235], a[24:27], a[120:123], v[232:235]
 v_mfma_f32_16x16x32_bf16 v[236:239], a[28:31], a[120:123], v[236:239]
 v_mfma_f32_16x16x32_bf16 v[240:243], a[16:19], a[124:127], v[240:243]
 v_mfma_f32_16x16x32_bf16 v[244:247], a[20:23], a[124:127], v[244:247]
 v_mfma_f32_16x16x32_bf16 v[248:251], a[24:27], a[124:127], v[248:251]
 v_mfma_f32_16x16x32_bf16 v[252:255], a[28:31], a[124:127], v[252:255]
 v_add_u32 v9, 9216, v1
 s_waitcnt vmcnt(8)
 s_waitcnt lgkmcnt(0)
 v_mfma_f32_16x16x32_bf16 v[128:131], a[32:35], a[64:67], v[128:131]
 buffer_load_dwordx4 a[16:19], v9, s[4:7], s24 offen
 v_mfma_f32_16x16x32_bf16 v[132:135], a[36:39], a[64:67], v[132:135]
 buffer_load_dwordx4 a[20:23], v9, s[4:7], s25 offen
 v_mfma_f32_16x16x32_bf16 v[136:139], a[40:43], a[64:67], v[136:139]
 buffer_load_dwordx4 a[24:27], v9, s[4:7], s26 offen
 v_mfma_f32_16x16x32_bf16 v[140:143], a[44:47], a[64:67], v[140:143]
 buffer_load_dwordx4 a[28:31], v9, s[4:7], s27 offen
 v_mfma_f32_16x16x32_bf16 v[144:147], a[32:35], a[68:71], v[144:147]
 ds_read_b128 a[96:99], v1 offset:7168
 v_mfma_f32_16x16x32_bf16 v[148:151], a[36:39], a[68:71], v[148:151]
 ds_read_b128 a[100:103], v1 offset:21504
 v_mfma_f32_16x16x32_bf16 v[152:155], a[40:43], a[68:71], v[152:155]
 ds_read_b128 a[104:107], v1 offset:35840
 v_mfma_f32_16x16x32_bf16 v[156:159], a[44:47], a[68:71], v[156:159]
 ds_read_b128 a[108:111], v1 offset:50176
 v_mfma_f32_16x16x32_bf16 v[160:163], a[32:35], a[72:75], v[160:163]
 ds_read_b128 a[112:115], v12 offset:7168
 v_mfma_f32_16x16x32_bf16 v[164:167], a[36:39], a[72:75], v[164:167]
 ds_read_b128 a[116:119], v12 offset:21504
 v_mfma_f32_16x16x32_bf16 v[168:171], a[40:43], a[72:75], v[168:171]
 ds_read_b128 a[120:123], v12 offset:35840
 v_mfma_f32_16x16x32_bf16 v[172:175], a[44:47], a[72:75], v[172:175]
 ds_read_b128 a[124:127], v12 offset:50176
 v_mfma_f32_16x16x32_bf16 v[176:179], a[32:35], a[76:79], v[176:179]
 v_mfma_f32_16x16x32_bf16 v[180:183], a[36:39], a[76:79], v[180:183]
 v_mfma_f32_16x16x32_bf16 v[184:187], a[40:43], a[76:79], v[184:187]
 v_mfma_f32_16x16x32_bf16 v[188:191], a[44:47], a[76:79], v[188:191]
 v_mfma_f32_16x16x32_bf16 v[192:195], a[32:35], a[80:83], v[192:195]
 v_mfma_f32_16x16x32_bf16 v[196:199], a[36:39], a[80:83], v[196:199]
 v_mfma_f32_16x16x32_bf16 v[200:203], a[40:43], a[80:83], v[200:203]
 v_mfma_f32_16x16x32_bf16 v[204:207], a[44:47], a[80:83], v[204:207]
 v_mfma_f32_16x16x32_bf16 v[208:211], a[32:35], a[84:87], v[208:211]
 v_mfma_f32_16x16x32_bf16 v[212:215], a[36:39], a[84:87], v[212:215]
 v_mfma_f32_16x16x32_bf16 v[216:219], a[40:43], a[84:87], v[216:219]
 v_mfma_f32_16x16x32_bf16 v[220:223], a[44:47], a[84:87], v[220:223]
 v_mfma_f32_16x16x32_bf16 v[224:227], a[32:35], a[88:91], v[224:227]
 v_mfma_f32_16x16x32_bf16 v[228:231], a[36:39], a[88:91], v[228:231]
 v_mfma_f32_16x16x32_bf16 v[232:235], a[40:43], a[88:91], v[232:235]
 v_mfma_f32_16x16x32_bf16 v[236:239], a[44:47], a[88:91], v[236:239]
 v_mfma_f32_16x16x32_bf16 v[240:243], a[32:35], a[92:95], v[240:243]
 v_mfma_f32_16x16x32_bf16 v[244:247], a[36:39], a[92:95], v[244:247]
 v_mfma_f32_16x16x32_bf16 v[248:251], a[40:43], a[92:95], v[248:251]
 v_mfma_f32_16x16x32_bf16 v[252:255], a[44:47], a[92:95], v[252:255]
 v_add_u32 v10, 10240, v1
 s_waitcnt vmcnt(8)
 s_waitcnt lgkmcnt(0)
 v_mfma_f32_16x16x32_bf16 v[128:131], a[48:51], a[96:99], v[128:131]
 buffer_load_dwordx4 a[32:35], v10, s[4:7], s24 offen
 v_mfma_f32_16x16x32_bf16 v[132:135], a[52:55], a[96:99], v[132:135]
 buffer_load_dwordx4 a[36:39], v10, s[4:7], s25 offen
 v_mfma_f32_16x16x32_bf16 v[136:139], a[56:59], a[96:99], v[136:139]
 buffer_load_dwordx4 a[40:43], v10, s[4:7], s26 offen
 v_mfma_f32_16x16x32_bf16 v[140:143], a[60:63], a[96:99], v[140:143]
 buffer_load_dwordx4 a[44:47], v10, s[4:7], s27 offen
 v_mfma_f32_16x16x32_bf16 v[144:147], a[48:51], a[100:103], v[144:147]
 ds_read_b128 a[64:67], v1 offset:8192
 v_mfma_f32_16x16x32_bf16 v[148:151], a[52:55], a[100:103], v[148:151]
 ds_read_b128 a[68:71], v1 offset:22528
 v_mfma_f32_16x16x32_bf16 v[152:155], a[56:59], a[100:103], v[152:155]
 ds_read_b128 a[72:75], v1 offset:36864
 v_mfma_f32_16x16x32_bf16 v[156:159], a[60:63], a[100:103], v[156:159]
 ds_read_b128 a[76:79], v1 offset:51200
 v_mfma_f32_16x16x32_bf16 v[160:163], a[48:51], a[104:107], v[160:163]
 ds_read_b128 a[80:83], v12 offset:8192
 v_mfma_f32_16x16x32_bf16 v[164:167], a[52:55], a[104:107], v[164:167]
 ds_read_b128 a[84:87], v12 offset:22528
 v_mfma_f32_16x16x32_bf16 v[168:171], a[56:59], a[104:107], v[168:171]
 ds_read_b128 a[88:91], v12 offset:36864
 v_mfma_f32_16x16x32_bf16 v[172:175], a[60:63], a[104:107], v[172:175]
 ds_read_b128 a[92:95], v12 offset:51200
 v_mfma_f32_16x16x32_bf16 v[176:179], a[48:51], a[108:111], v[176:179]
 v_mfma_f32_16x16x32_bf16 v[180:183], a[52:55], a[108:111], v[180:183]
 v_mfma_f32_16x16x32_bf16 v[184:187], a[56:59], a[108:111], v[184:187]
 v_mfma_f32_16x16x32_bf16 v[188:191], a[60:63], a[108:111], v[188:191]
 v_mfma_f32_16x16x32_bf16 v[192:195], a[48:51], a[112:115], v[192:195]
 v_mfma_f32_16x16x32_bf16 v[196:199], a[52:55], a[112:115], v[196:199]
 v_mfma_f32_16x16x32_bf16 v[200:203], a[56:59], a[112:115], v[200:203]
 v_mfma_f32_16x16x32_bf16 v[204:207], a[60:63], a[112:115], v[204:207]
 v_mfma_f32_16x16x32_bf16 v[208:211], a[48:51], a[116:119], v[208:211]
 v_mfma_f32_16x16x32_bf16 v[212:215], a[52:55], a[116:119], v[212:215]
 v_mfma_f32_16x16x32_bf16 v[216:219], a[56:59], a[116:119], v[216:219]
 v_mfma_f32_16x16x32_bf16 v[220:223], a[60:63], a[116:119], v[220:223]
 v_mfma_f32_16x16x32_bf16 v[224:227], a[48:51], a[120:123], v[224:227]
 v_mfma_f32_16x16x32_bf16 v[228:231], a[52:55], a[120:123], v[228:231]
 v_mfma_f32_16x16x32_bf16 v[232:235], a[56:59], a[120:123], v[232:235]
 v_mfma_f32_16x16x32_bf16 v[236:239], a[60:63], a[120:123], v[236:239]
 v_mfma_f32_16x16x32_bf16 v[240:243], a[48:51], a[124:127], v[240:243]
 v_mfma_f32_16x16x32_bf16 v[244:247], a[52:55], a[124:127], v[244:247]
 v_mfma_f32_16x16x32_bf16 v[248:251], a[56:59], a[124:127], v[248:251]
 v_mfma_f32_16x16x32_bf16 v[252:255], a[60:63], a[124:127], v[252:255]
 v_add_u32 v11, 11264, v1
 s_waitcnt vmcnt(8)
 s_waitcnt lgkmcnt(0)
 v_mfma_f32_16x16x32_bf16 v[128:131], a[0:3], a[64:67], v[128:131]
 buffer_load_dwordx4 a[48:51], v11, s[4:7], s24 offen
 v_mfma_f32_16x16x32_bf16 v[132:135], a[4:7], a[64:67], v[132:135]
 buffer_load_dwordx4 a[52:55], v11, s[4:7], s25 offen
 v_mfma_f32_16x16x32_bf16 v[136:139], a[8:11], a[64:67], v[136:139]
 buffer_load_dwordx4 a[56:59], v11, s[4:7], s26 offen
 v_mfma_f32_16x16x32_bf16 v[140:143], a[12:15], a[64:67], v[140:143]
 buffer_load_dwordx4 a[60:63], v11, s[4:7], s27 offen
 v_mfma_f32_16x16x32_bf16 v[144:147], a[0:3], a[68:71], v[144:147]
 ds_read_b128 a[96:99], v1 offset:9216
 v_mfma_f32_16x16x32_bf16 v[148:151], a[4:7], a[68:71], v[148:151]
 ds_read_b128 a[100:103], v1 offset:23552
 v_mfma_f32_16x16x32_bf16 v[152:155], a[8:11], a[68:71], v[152:155]
 ds_read_b128 a[104:107], v1 offset:37888
 v_mfma_f32_16x16x32_bf16 v[156:159], a[12:15], a[68:71], v[156:159]
 ds_read_b128 a[108:111], v1 offset:52224
 v_mfma_f32_16x16x32_bf16 v[160:163], a[0:3], a[72:75], v[160:163]
 ds_read_b128 a[112:115], v12 offset:9216
 v_mfma_f32_16x16x32_bf16 v[164:167], a[4:7], a[72:75], v[164:167]
 ds_read_b128 a[116:119], v12 offset:23552
 v_mfma_f32_16x16x32_bf16 v[168:171], a[8:11], a[72:75], v[168:171]
 ds_read_b128 a[120:123], v12 offset:37888
 v_mfma_f32_16x16x32_bf16 v[172:175], a[12:15], a[72:75], v[172:175]
 ds_read_b128 a[124:127], v12 offset:52224
 v_mfma_f32_16x16x32_bf16 v[176:179], a[0:3], a[76:79], v[176:179]
 v_mfma_f32_16x16x32_bf16 v[180:183], a[4:7], a[76:79], v[180:183]
 v_mfma_f32_16x16x32_bf16 v[184:187], a[8:11], a[76:79], v[184:187]
 v_mfma_f32_16x16x32_bf16 v[188:191], a[12:15], a[76:79], v[188:191]
 v_mfma_f32_16x16x32_bf16 v[192:195], a[0:3], a[80:83], v[192:195]
 v_mfma_f32_16x16x32_bf16 v[196:199], a[4:7], a[80:83], v[196:199]
 v_mfma_f32_16x16x32_bf16 v[200:203], a[8:11], a[80:83], v[200:203]
 v_mfma_f32_16x16x32_bf16 v[204:207], a[12:15], a[80:83], v[204:207]
 v_mfma_f32_16x16x32_bf16 v[208:211], a[0:3], a[84:87], v[208:211]
 v_mfma_f32_16x16x32_bf16 v[212:215], a[4:7], a[84:87], v[212:215]
 v_mfma_f32_16x16x32_bf16 v[216:219], a[8:11], a[84:87], v[216:219]
 v_mfma_f32_16x16x32_bf16 v[220:223], a[12:15], a[84:87], v[220:223]
 v_mfma_f32_16x16x32_bf16 v[224:227], a[0:3], a[88:91], v[224:227]
 v_mfma_f32_16x16x32_bf16 v[228:231], a[4:7], a[88:91], v[228:231]
 v_mfma_f32_16x16x32_bf16 v[232:235], a[8:11], a[88:91], v[232:235]
 v_mfma_f32_16x16x32_bf16 v[236:239], a[12:15], a[88:91], v[236:239]
 v_mfma_f32_16x16x32_bf16 v[240:243], a[0:3], a[92:95], v[240:243]
 v_mfma_f32_16x16x32_bf16 v[244:247], a[4:7], a[92:95], v[244:247]
 v_mfma_f32_16x16x32_bf16 v[248:251], a[8:11], a[92:95], v[248:251]
 v_mfma_f32_16x16x32_bf16 v[252:255], a[12:15], a[92:95], v[252:255]
 v_add_u32 v8, 12288, v1
 s_waitcnt vmcnt(8)
 s_waitcnt lgkmcnt(0)
 v_mfma_f32_16x16x32_bf16 v[128:131], a[16:19], a[96:99], v[128:131]
 buffer_load_dwordx4 a[0:3], v8, s[4:7], s24 offen
 v_mfma_f32_16x16x32_bf16 v[132:135], a[20:23], a[96:99], v[132:135]
 buffer_load_dwordx4 a[4:7], v8, s[4:7], s25 offen
 v_mfma_f32_16x16x32_bf16 v[136:139], a[24:27], a[96:99], v[136:139]
 buffer_load_dwordx4 a[8:11], v8, s[4:7], s26 offen
 v_mfma_f32_16x16x32_bf16 v[140:143], a[28:31], a[96:99], v[140:143]
 buffer_load_dwordx4 a[12:15], v8, s[4:7], s27 offen
 v_mfma_f32_16x16x32_bf16 v[144:147], a[16:19], a[100:103], v[144:147]
 ds_read_b128 a[64:67], v1 offset:10240
 v_mfma_f32_16x16x32_bf16 v[148:151], a[20:23], a[100:103], v[148:151]
 ds_read_b128 a[68:71], v1 offset:24576
 v_mfma_f32_16x16x32_bf16 v[152:155], a[24:27], a[100:103], v[152:155]
 ds_read_b128 a[72:75], v1 offset:38912
 v_mfma_f32_16x16x32_bf16 v[156:159], a[28:31], a[100:103], v[156:159]
 ds_read_b128 a[76:79], v1 offset:53248
 v_mfma_f32_16x16x32_bf16 v[160:163], a[16:19], a[104:107], v[160:163]
 ds_read_b128 a[80:83], v12 offset:10240
 v_mfma_f32_16x16x32_bf16 v[164:167], a[20:23], a[104:107], v[164:167]
 ds_read_b128 a[84:87], v12 offset:24576
 v_mfma_f32_16x16x32_bf16 v[168:171], a[24:27], a[104:107], v[168:171]
 ds_read_b128 a[88:91], v12 offset:38912
 v_mfma_f32_16x16x32_bf16 v[172:175], a[28:31], a[104:107], v[172:175]
 ds_read_b128 a[92:95], v12 offset:53248
 v_mfma_f32_16x16x32_bf16 v[176:179], a[16:19], a[108:111], v[176:179]
 v_mfma_f32_16x16x32_bf16 v[180:183], a[20:23], a[108:111], v[180:183]
 v_mfma_f32_16x16x32_bf16 v[184:187], a[24:27], a[108:111], v[184:187]
 v_mfma_f32_16x16x32_bf16 v[188:191], a[28:31], a[108:111], v[188:191]
 v_mfma_f32_16x16x32_bf16 v[192:195], a[16:19], a[112:115], v[192:195]
 v_mfma_f32_16x16x32_bf16 v[196:199], a[20:23], a[112:115], v[196:199]
 v_mfma_f32_16x16x32_bf16 v[200:203], a[24:27], a[112:115], v[200:203]
 v_mfma_f32_16x16x32_bf16 v[204:207], a[28:31], a[112:115], v[204:207]
 v_mfma_f32_16x16x32_bf16 v[208:211], a[16:19], a[116:119], v[208:211]
 v_mfma_f32_16x16x32_bf16 v[212:215], a[20:23], a[116:119], v[212:215]
 v_mfma_f32_16x16x32_bf16 v[216:219], a[24:27], a[116:119], v[216:219]
 v_mfma_f32_16x16x32_bf16 v[220:223], a[28:31], a[116:119], v[220:223]
 v_mfma_f32_16x16x32_bf16 v[224:227], a[16:19], a[120:123], v[224:227]
 v_mfma_f32_16x16x32_bf16 v[228:231], a[20:23], a[120:123], v[228:231]
 v_mfma_f32_16x16x32_bf16 v[232:235], a[24:27], a[120:123], v[232:235]
 v_mfma_f32_16x16x32_bf16 v[236:239], a[28:31], a[120:123], v[236:239]
 v_mfma_f32_16x16x32_bf16 v[240:243], a[16:19], a[124:127], v[240:243]
 v_mfma_f32_16x16x32_bf16 v[244:247], a[20:23], a[124:127], v[244:247]
 v_mfma_f32_16x16x32_bf16 v[248:251], a[24:27], a[124:127], v[248:251]
 v_mfma_f32_16x16x32_bf16 v[252:255], a[28:31], a[124:127], v[252:255]
 v_add_u32 v9, 13312, v1
 s_waitcnt vmcnt(8)
 s_waitcnt lgkmcnt(0)
 v_mfma_f32_16x16x32_bf16 v[128:131], a[32:35], a[64:67], v[128:131]
 buffer_load_dwordx4 a[16:19], v9, s[4:7], s24 offen
 v_mfma_f32_16x16x32_bf16 v[132:135], a[36:39], a[64:67], v[132:135]
 buffer_load_dwordx4 a[20:23], v9, s[4:7], s25 offen
 v_mfma_f32_16x16x32_bf16 v[136:139], a[40:43], a[64:67], v[136:139]
 buffer_load_dwordx4 a[24:27], v9, s[4:7], s26 offen
 v_mfma_f32_16x16x32_bf16 v[140:143], a[44:47], a[64:67], v[140:143]
 buffer_load_dwordx4 a[28:31], v9, s[4:7], s27 offen
 v_mfma_f32_16x16x32_bf16 v[144:147], a[32:35], a[68:71], v[144:147]
 ds_read_b128 a[96:99], v1 offset:11264
 v_mfma_f32_16x16x32_bf16 v[148:151], a[36:39], a[68:71], v[148:151]
 ds_read_b128 a[100:103], v1 offset:25600
 v_mfma_f32_16x16x32_bf16 v[152:155], a[40:43], a[68:71], v[152:155]
 ds_read_b128 a[104:107], v1 offset:39936
 v_mfma_f32_16x16x32_bf16 v[156:159], a[44:47], a[68:71], v[156:159]
 ds_read_b128 a[108:111], v1 offset:54272
 v_mfma_f32_16x16x32_bf16 v[160:163], a[32:35], a[72:75], v[160:163]
 ds_read_b128 a[112:115], v12 offset:11264
 v_mfma_f32_16x16x32_bf16 v[164:167], a[36:39], a[72:75], v[164:167]
 ds_read_b128 a[116:119], v12 offset:25600
 v_mfma_f32_16x16x32_bf16 v[168:171], a[40:43], a[72:75], v[168:171]
 ds_read_b128 a[120:123], v12 offset:39936
 v_mfma_f32_16x16x32_bf16 v[172:175], a[44:47], a[72:75], v[172:175]
 ds_read_b128 a[124:127], v12 offset:54272
 v_mfma_f32_16x16x32_bf16 v[176:179], a[32:35], a[76:79], v[176:179]
 v_mfma_f32_16x16x32_bf16 v[180:183], a[36:39], a[76:79], v[180:183]
 v_mfma_f32_16x16x32_bf16 v[184:187], a[40:43], a[76:79], v[184:187]
 v_mfma_f32_16x16x32_bf16 v[188:191], a[44:47], a[76:79], v[188:191]
 v_mfma_f32_16x16x32_bf16 v[192:195], a[32:35], a[80:83], v[192:195]
 v_mfma_f32_16x16x32_bf16 v[196:199], a[36:39], a[80:83], v[196:199]
 v_mfma_f32_16x16x32_bf16 v[200:203], a[40:43], a[80:83], v[200:203]
 v_mfma_f32_16x16x32_bf16 v[204:207], a[44:47], a[80:83], v[204:207]
 v_mfma_f32_16x16x32_bf16 v[208:211], a[32:35], a[84:87], v[208:211]
 v_mfma_f32_16x16x32_bf16 v[212:215], a[36:39], a[84:87], v[212:215]
 v_mfma_f32_16x16x32_bf16 v[216:219], a[40:43], a[84:87], v[216:219]
 v_mfma_f32_16x16x32_bf16 v[220:223], a[44:47], a[84:87], v[220:223]
 v_mfma_f32_16x16x32_bf16 v[224:227], a[32:35], a[88:91], v[224:227]
 v_mfma_f32_16x16x32_bf16 v[228:231], a[36:39], a[88:91], v[228:231]
 v_mfma_f32_16x16x32_bf16 v[232:235], a[40:43], a[88:91], v[232:235]
 v_mfma_f32_16x16x32_bf16 v[236:239], a[44:47], a[88:91], v[236:239]
 v_mfma_f32_16x16x32_bf16 v[240:243], a[32:35], a[92:95], v[240:243]
 v_mfma_f32_16x16x32_bf16 v[244:247], a[36:39], a[92:95], v[244:247]
 v_mfma_f32_16x16x32_bf16 v[248:251], a[40:43], a[92:95], v[248:251]
 v_mfma_f32_16x16x32_bf16 v[252:255], a[44:47], a[92:95], v[252:255]
 s_waitcnt vmcnt(8)
 s_waitcnt lgkmcnt(0)
 v_mfma_f32_16x16x32_bf16 v[128:131], a[48:51], a[96:99], v[128:131]
 v_mfma_f32_16x16x32_bf16 v[132:135], a[52:55], a[96:99], v[132:135]
 v_mfma_f32_16x16x32_bf16 v[136:139], a[56:59], a[96:99], v[136:139]
 v_mfma_f32_16x16x32_bf16 v[140:143], a[60:63], a[96:99], v[140:143]
 v_mfma_f32_16x16x32_bf16 v[144:147], a[48:51], a[100:103], v[144:147]
 ds_read_b128 a[64:67], v1 offset:12288
 v_mfma_f32_16x16x32_bf16 v[148:151], a[52:55], a[100:103], v[148:151]
 ds_read_b128 a[68:71], v1 offset:26624
 v_mfma_f32_16x16x32_bf16 v[152:155], a[56:59], a[100:103], v[152:155]
 ds_read_b128 a[72:75], v1 offset:40960
 v_mfma_f32_16x16x32_bf16 v[156:159], a[60:63], a[100:103], v[156:159]
 ds_read_b128 a[76:79], v1 offset:55296
 v_mfma_f32_16x16x32_bf16 v[160:163], a[48:51], a[104:107], v[160:163]
 ds_read_b128 a[80:83], v12 offset:12288
 v_mfma_f32_16x16x32_bf16 v[164:167], a[52:55], a[104:107], v[164:167]
 ds_read_b128 a[84:87], v12 offset:26624
 v_mfma_f32_16x16x32_bf16 v[168:171], a[56:59], a[104:107], v[168:171]
 ds_read_b128 a[88:91], v12 offset:40960
 v_mfma_f32_16x16x32_bf16 v[172:175], a[60:63], a[104:107], v[172:175]
 ds_read_b128 a[92:95], v12 offset:55296
 v_mfma_f32_16x16x32_bf16 v[176:179], a[48:51], a[108:111], v[176:179]
 v_mfma_f32_16x16x32_bf16 v[180:183], a[52:55], a[108:111], v[180:183]
 v_mfma_f32_16x16x32_bf16 v[184:187], a[56:59], a[108:111], v[184:187]
 v_mfma_f32_16x16x32_bf16 v[188:191], a[60:63], a[108:111], v[188:191]
 v_mfma_f32_16x16x32_bf16 v[192:195], a[48:51], a[112:115], v[192:195]
 v_mfma_f32_16x16x32_bf16 v[196:199], a[52:55], a[112:115], v[196:199]
 v_mfma_f32_16x16x32_bf16 v[200:203], a[56:59], a[112:115], v[200:203]
 v_mfma_f32_16x16x32_bf16 v[204:207], a[60:63], a[112:115], v[204:207]
 v_mfma_f32_16x16x32_bf16 v[208:211], a[48:51], a[116:119], v[208:211]
 v_mfma_f32_16x16x32_bf16 v[212:215], a[52:55], a[116:119], v[212:215]
 v_mfma_f32_16x16x32_bf16 v[216:219], a[56:59], a[116:119], v[216:219]
 v_mfma_f32_16x16x32_bf16 v[220:223], a[60:63], a[116:119], v[220:223]
 v_mfma_f32_16x16x32_bf16 v[224:227], a[48:51], a[120:123], v[224:227]
 v_mfma_f32_16x16x32_bf16 v[228:231], a[52:55], a[120:123], v[228:231]
 v_mfma_f32_16x16x32_bf16 v[232:235], a[56:59], a[120:123], v[232:235]
 v_mfma_f32_16x16x32_bf16 v[236:239], a[60:63], a[120:123], v[236:239]
 v_mfma_f32_16x16x32_bf16 v[240:243], a[48:51], a[124:127], v[240:243]
 v_mfma_f32_16x16x32_bf16 v[244:247], a[52:55], a[124:127], v[244:247]
 v_mfma_f32_16x16x32_bf16 v[248:251], a[56:59], a[124:127], v[248:251]
 v_mfma_f32_16x16x32_bf16 v[252:255], a[60:63], a[124:127], v[252:255]
 s_waitcnt vmcnt(4)
 s_waitcnt lgkmcnt(0)
 v_mfma_f32_16x16x32_bf16 v[128:131], a[0:3], a[64:67], v[128:131]
 v_mfma_f32_16x16x32_bf16 v[132:135], a[4:7], a[64:67], v[132:135]
 v_mfma_f32_16x16x32_bf16 v[136:139], a[8:11], a[64:67], v[136:139]
 v_mfma_f32_16x16x32_bf16 v[140:143], a[12:15], a[64:67], v[140:143]
 v_mfma_f32_16x16x32_bf16 v[144:147], a[0:3], a[68:71], v[144:147]
 ds_read_b128 a[96:99], v1 offset:13312
 v_mfma_f32_16x16x32_bf16 v[148:151], a[4:7], a[68:71], v[148:151]
 ds_read_b128 a[100:103], v1 offset:27648
 v_mfma_f32_16x16x32_bf16 v[152:155], a[8:11], a[68:71], v[152:155]
 ds_read_b128 a[104:107], v1 offset:41984
 v_mfma_f32_16x16x32_bf16 v[156:159], a[12:15], a[68:71], v[156:159]
 ds_read_b128 a[108:111], v1 offset:56320
 v_mfma_f32_16x16x32_bf16 v[160:163], a[0:3], a[72:75], v[160:163]
 ds_read_b128 a[112:115], v12 offset:13312
 v_mfma_f32_16x16x32_bf16 v[164:167], a[4:7], a[72:75], v[164:167]
 ds_read_b128 a[116:119], v12 offset:27648
 v_mfma_f32_16x16x32_bf16 v[168:171], a[8:11], a[72:75], v[168:171]
 ds_read_b128 a[120:123], v12 offset:41984
 v_mfma_f32_16x16x32_bf16 v[172:175], a[12:15], a[72:75], v[172:175]
 ds_read_b128 a[124:127], v12 offset:56320
 v_mfma_f32_16x16x32_bf16 v[176:179], a[0:3], a[76:79], v[176:179]
 v_mfma_f32_16x16x32_bf16 v[180:183], a[4:7], a[76:79], v[180:183]
 v_mfma_f32_16x16x32_bf16 v[184:187], a[8:11], a[76:79], v[184:187]
 v_mfma_f32_16x16x32_bf16 v[188:191], a[12:15], a[76:79], v[188:191]
 v_mfma_f32_16x16x32_bf16 v[192:195], a[0:3], a[80:83], v[192:195]
 v_mfma_f32_16x16x32_bf16 v[196:199], a[4:7], a[80:83], v[196:199]
 v_mfma_f32_16x16x32_bf16 v[200:203], a[8:11], a[80:83], v[200:203]
 v_mfma_f32_16x16x32_bf16 v[204:207], a[12:15], a[80:83], v[204:207]
 v_mfma_f32_16x16x32_bf16 v[208:211], a[0:3], a[84:87], v[208:211]
 v_mfma_f32_16x16x32_bf16 v[212:215], a[4:7], a[84:87], v[212:215]
 v_mfma_f32_16x16x32_bf16 v[216:219], a[8:11], a[84:87], v[216:219]
 v_mfma_f32_16x16x32_bf16 v[220:223], a[12:15], a[84:87], v[220:223]
 v_mfma_f32_16x16x32_bf16 v[224:227], a[0:3], a[88:91], v[224:227]
 v_mfma_f32_16x16x32_bf16 v[228:231], a[4:7], a[88:91], v[228:231]
 v_mfma_f32_16x16x32_bf16 v[232:235], a[8:11], a[88:91], v[232:235]
 v_mfma_f32_16x16x32_bf16 v[236:239], a[12:15], a[88:91], v[236:239]
 v_mfma_f32_16x16x32_bf16 v[240:243], a[0:3], a[92:95], v[240:243]
 v_mfma_f32_16x16x32_bf16 v[244:247], a[4:7], a[92:95], v[244:247]
 v_mfma_f32_16x16x32_bf16 v[248:251], a[8:11], a[92:95], v[248:251]
 v_mfma_f32_16x16x32_bf16 v[252:255], a[12:15], a[92:95], v[252:255]
 s_waitcnt vmcnt(0)
 s_waitcnt lgkmcnt(0)
 v_mfma_f32_16x16x32_bf16 v[128:131], a[16:19], a[96:99], v[128:131]
 v_mfma_f32_16x16x32_bf16 v[132:135], a[20:23], a[96:99], v[132:135]
 v_mfma_f32_16x16x32_bf16 v[136:139], a[24:27], a[96:99], v[136:139]
 v_mfma_f32_16x16x32_bf16 v[140:143], a[28:31], a[96:99], v[140:143]
 v_mfma_f32_16x16x32_bf16 v[144:147], a[16:19], a[100:103], v[144:147]
 v_mfma_f32_16x16x32_bf16 v[148:151], a[20:23], a[100:103], v[148:151]
 v_mfma_f32_16x16x32_bf16 v[152:155], a[24:27], a[100:103], v[152:155]
 v_mfma_f32_16x16x32_bf16 v[156:159], a[28:31], a[100:103], v[156:159]
 v_mfma_f32_16x16x32_bf16 v[160:163], a[16:19], a[104:107], v[160:163]
 v_mfma_f32_16x16x32_bf16 v[164:167], a[20:23], a[104:107], v[164:167]
 v_mfma_f32_16x16x32_bf16 v[168:171], a[24:27], a[104:107], v[168:171]
 v_mfma_f32_16x16x32_bf16 v[172:175], a[28:31], a[104:107], v[172:175]
 v_mfma_f32_16x16x32_bf16 v[176:179], a[16:19], a[108:111], v[176:179]
 v_mfma_f32_16x16x32_bf16 v[180:183], a[20:23], a[108:111], v[180:183]
 v_mfma_f32_16x16x32_bf16 v[184:187], a[24:27], a[108:111], v[184:187]
 v_mfma_f32_16x16x32_bf16 v[188:191], a[28:31], a[108:111], v[188:191]
 v_mfma_f32_16x16x32_bf16 v[192:195], a[16:19], a[112:115], v[192:195]
 v_mfma_f32_16x16x32_bf16 v[196:199], a[20:23], a[112:115], v[196:199]
 v_mfma_f32_16x16x32_bf16 v[200:203], a[24:27], a[112:115], v[200:203]
 v_mfma_f32_16x16x32_bf16 v[204:207], a[28:31], a[112:115], v[204:207]
 v_mfma_f32_16x16x32_bf16 v[208:211], a[16:19], a[116:119], v[208:211]
 v_mfma_f32_16x16x32_bf16 v[212:215], a[20:23], a[116:119], v[212:215]
 v_mfma_f32_16x16x32_bf16 v[216:219], a[24:27], a[116:119], v[216:219]
 v_mfma_f32_16x16x32_bf16 v[220:223], a[28:31], a[116:119], v[220:223]
 v_mfma_f32_16x16x32_bf16 v[224:227], a[16:19], a[120:123], v[224:227]
 v_mfma_f32_16x16x32_bf16 v[228:231], a[20:23], a[120:123], v[228:231]
 v_mfma_f32_16x16x32_bf16 v[232:235], a[24:27], a[120:123], v[232:235]
 v_mfma_f32_16x16x32_bf16 v[236:239], a[28:31], a[120:123], v[236:239]
 v_mfma_f32_16x16x32_bf16 v[240:243], a[16:19], a[124:127], v[240:243]
 v_mfma_f32_16x16x32_bf16 v[244:247], a[20:23], a[124:127], v[244:247]
 v_mfma_f32_16x16x32_bf16 v[248:251], a[24:27], a[124:127], v[248:251]
 v_mfma_f32_16x16x32_bf16 v[252:255], a[28:31], a[124:127], v[252:255]
 s_nop 7
 s_mul_i32 s11, s21, 1792
 s_lshr_b32 s12, s23, 1
 s_add_u32 s11, s11, s12
 s_lshl_b32 s32, s11, 10
 v_cvt_pk_bf16_f32 v16, v128, v129
 v_cvt_pk_bf16_f32 v17, v132, v133
 v_cvt_pk_bf16_f32 v18, v130, v131
 v_cvt_pk_bf16_f32 v19, v134, v135
 s_add_u32 s11, s32, 63963136
 buffer_store_dwordx4 v[16:19], v1, s[4:7], s11 offen sc1
 v_cvt_pk_bf16_f32 v20, v136, v137
 v_cvt_pk_bf16_f32 v21, v140, v141
 v_cvt_pk_bf16_f32 v22, v138, v139
 v_cvt_pk_bf16_f32 v23, v142, v143
 s_add_u32 s11, s32, 63964160
 buffer_store_dwordx4 v[20:23], v1, s[4:7], s11 offen sc1
 v_cvt_pk_bf16_f32 v24, v144, v145
 v_cvt_pk_bf16_f32 v25, v148, v149
 v_cvt_pk_bf16_f32 v26, v146, v147
 v_cvt_pk_bf16_f32 v27, v150, v151
 s_add_u32 s11, s32, 64192512
 buffer_store_dwordx4 v[24:27], v1, s[4:7], s11 offen sc1
 v_cvt_pk_bf16_f32 v28, v152, v153
 v_cvt_pk_bf16_f32 v29, v156, v157
 v_cvt_pk_bf16_f32 v30, v154, v155
 v_cvt_pk_bf16_f32 v31, v158, v159
 s_add_u32 s11, s32, 64193536
 buffer_store_dwordx4 v[28:31], v1, s[4:7], s11 offen sc1
 v_cvt_pk_bf16_f32 v16, v160, v161
 v_cvt_pk_bf16_f32 v17, v164, v165
 v_cvt_pk_bf16_f32 v18, v162, v163
 v_cvt_pk_bf16_f32 v19, v166, v167
 s_add_u32 s11, s32, 64421888
 buffer_store_dwordx4 v[16:19], v1, s[4:7], s11 offen sc1
 v_cvt_pk_bf16_f32 v20, v168, v169
 v_cvt_pk_bf16_f32 v21, v172, v173
 v_cvt_pk_bf16_f32 v22, v170, v171
 v_cvt_pk_bf16_f32 v23, v174, v175
 s_add_u32 s11, s32, 64422912
 buffer_store_dwordx4 v[20:23], v1, s[4:7], s11 offen sc1
 v_cvt_pk_bf16_f32 v24, v176, v177
 v_cvt_pk_bf16_f32 v25, v180, v181
 v_cvt_pk_bf16_f32 v26, v178, v179
 v_cvt_pk_bf16_f32 v27, v182, v183
 s_add_u32 s11, s32, 64651264
 buffer_store_dwordx4 v[24:27], v1, s[4:7], s11 offen sc1
 v_cvt_pk_bf16_f32 v28, v184, v185
 v_cvt_pk_bf16_f32 v29, v188, v189
 v_cvt_pk_bf16_f32 v30, v186, v187
 v_cvt_pk_bf16_f32 v31, v190, v191
 s_add_u32 s11, s32, 64652288
 buffer_store_dwordx4 v[28:31], v1, s[4:7], s11 offen sc1
 v_cvt_pk_bf16_f32 v16, v192, v193
 v_cvt_pk_bf16_f32 v17, v196, v197
 v_cvt_pk_bf16_f32 v18, v194, v195
 v_cvt_pk_bf16_f32 v19, v198, v199
 s_add_u32 s11, s32, 64880640
 buffer_store_dwordx4 v[16:19], v1, s[4:7], s11 offen sc1
 v_cvt_pk_bf16_f32 v20, v200, v201
 v_cvt_pk_bf16_f32 v21, v204, v205
 v_cvt_pk_bf16_f32 v22, v202, v203
 v_cvt_pk_bf16_f32 v23, v206, v207
 s_add_u32 s11, s32, 64881664
 buffer_store_dwordx4 v[20:23], v1, s[4:7], s11 offen sc1
 v_cvt_pk_bf16_f32 v24, v208, v209
 v_cvt_pk_bf16_f32 v25, v212, v213
 v_cvt_pk_bf16_f32 v26, v210, v211
 v_cvt_pk_bf16_f32 v27, v214, v215
 s_add_u32 s11, s32, 65110016
 buffer_store_dwordx4 v[24:27], v1, s[4:7], s11 offen sc1
 v_cvt_pk_bf16_f32 v28, v216, v217
 v_cvt_pk_bf16_f32 v29, v220, v221
 v_cvt_pk_bf16_f32 v30, v218, v219
 v_cvt_pk_bf16_f32 v31, v222, v223
 s_add_u32 s11, s32, 65111040
 buffer_store_dwordx4 v[28:31], v1, s[4:7], s11 offen sc1
 v_cvt_pk_bf16_f32 v16, v224, v225
 v_cvt_pk_bf16_f32 v17, v228, v229
 v_cvt_pk_bf16_f32 v18, v226, v227
 v_cvt_pk_bf16_f32 v19, v230, v231
 s_add_u32 s11, s32, 65339392
 buffer_store_dwordx4 v[16:19], v1, s[4:7], s11 offen sc1
 v_cvt_pk_bf16_f32 v20, v232, v233
 v_cvt_pk_bf16_f32 v21, v236, v237
 v_cvt_pk_bf16_f32 v22, v234, v235
 v_cvt_pk_bf16_f32 v23, v238, v239
 s_add_u32 s11, s32, 65340416
 buffer_store_dwordx4 v[20:23], v1, s[4:7], s11 offen sc1
 v_cvt_pk_bf16_f32 v24, v240, v241
 v_cvt_pk_bf16_f32 v25, v244, v245
 v_cvt_pk_bf16_f32 v26, v242, v243
 v_cvt_pk_bf16_f32 v27, v246, v247
 s_add_u32 s11, s32, 65568768
 buffer_store_dwordx4 v[24:27], v1, s[4:7], s11 offen sc1
 v_cvt_pk_bf16_f32 v28, v248, v249
 v_cvt_pk_bf16_f32 v29, v252, v253
 v_cvt_pk_bf16_f32 v30, v250, v251
 v_cvt_pk_bf16_f32 v31, v254, v255
 s_add_u32 s11, s32, 65569792
 buffer_store_dwordx4 v[28:31], v1, s[4:7], s11 offen sc1
 s_waitcnt vmcnt(0)
 s_barrier
 s_lshl_b32 s33, s21, 7
 s_add_u32 s33, s33, 18415616
 buffer_atomic_add v2, v3, s[4:7], s33 offen sc1
 s_branch K_loop
K_fa:
 s_mov_b32 s23, 18423808
 s_cmp_lg_u32 s8, 0
 s_cbranch_scc1 L_wcr_73_ok
 s_mov_b32 s19, 0
 v_mov_b32 v5, 0
 s_mov_b64 exec, 1
L_wcr_73:
 buffer_load_dword v6, v5, s[4:7], s23 offen sc1
 s_waitcnt vmcnt(0)
 v_readfirstlane_b32 s11, v6
 s_cmp_ge_u32 s11, 56
 s_cbranch_scc1 L_wcr_73_got
 s_sleep 12
 s_add_u32 s19, s19, 1
 s_cmp_le_u32 s19, 8192
 s_cbranch_scc1 L_wcr_73
 s_branch K_failw
L_wcr_73_got:
 s_mov_b64 exec, -1
L_wcr_73_ok:
 s_barrier
 s_sub_u32 s11, s92, 120
 s_lshr_b32 s21, s11, 1
 s_and_b32 s11, s11, 1
 s_lshl_b32 s22, s75, 1
 s_add_u32 s22, s22, s11
 s_mul_i32 s11, s21, 114688
 s_mul_i32 s12, s8, 28672
 s_add_u32 s11, s11, s12
 s_add_u32 s11, s11, 0
 s_add_u32 s13, s12, 0
 s_mov_b32 m0, s13
 s_add_u32 s13, s11, 0
 buffer_load_dwordx4 v1, s[4:7], s13 offen offset:0 lds
 buffer_load_dwordx4 v1, s[4:7], s13 offen offset:1024 lds
 buffer_load_dwordx4 v1, s[4:7], s13 offen offset:2048 lds
 buffer_load_dwordx4 v1, s[4:7], s13 offen offset:3072 lds
 s_add_u32 s13, s12, 4096
 s_mov_b32 m0, s13
 s_add_u32 s13, s11, 4096
 buffer_load_dwordx4 v1, s[4:7], s13 offen offset:0 lds
 buffer_load_dwordx4 v1, s[4:7], s13 offen offset:1024 lds
 buffer_load_dwordx4 v1, s[4:7], s13 offen offset:2048 lds
 buffer_load_dwordx4 v1, s[4:7], s13 offen offset:3072 lds
 s_add_u32 s13, s12, 8192
 s_mov_b32 m0, s13
 s_add_u32 s13, s11, 8192
 buffer_load_dwordx4 v1, s[4:7], s13 offen offset:0 lds
 buffer_load_dwordx4 v1, s[4:7], s13 offen offset:1024 lds
 buffer_load_dwordx4 v1, s[4:7], s13 offen offset:2048 lds
 buffer_load_dwordx4 v1, s[4:7], s13 offen offset:3072 lds
 s_add_u32 s13, s12, 12288
 s_mov_b32 m0, s13
 s_add_u32 s13, s11, 12288
 buffer_load_dwordx4 v1, s[4:7], s13 offen offset:0 lds
 buffer_load_dwordx4 v1, s[4:7], s13 offen offset:1024 lds
 buffer_load_dwordx4 v1, s[4:7], s13 offen offset:2048 lds
 buffer_load_dwordx4 v1, s[4:7], s13 offen offset:3072 lds
 s_add_u32 s13, s12, 16384
 s_mov_b32 m0, s13
 s_add_u32 s13, s11, 16384
 buffer_load_dwordx4 v1, s[4:7], s13 offen offset:0 lds
 buffer_load_dwordx4 v1, s[4:7], s13 offen offset:1024 lds
 buffer_load_dwordx4 v1, s[4:7], s13 offen offset:2048 lds
 buffer_load_dwordx4 v1, s[4:7], s13 offen offset:3072 lds
 s_add_u32 s13, s12, 20480
 s_mov_b32 m0, s13
 s_add_u32 s13, s11, 20480
 buffer_load_dwordx4 v1, s[4:7], s13 offen offset:0 lds
 buffer_load_dwordx4 v1, s[4:7], s13 offen offset:1024 lds
 buffer_load_dwordx4 v1, s[4:7], s13 offen offset:2048 lds
 buffer_load_dwordx4 v1, s[4:7], s13 offen offset:3072 lds
 s_add_u32 s13, s12, 24576
 s_mov_b32 m0, s13
 s_add_u32 s13, s11, 24576
 buffer_load_dwordx4 v1, s[4:7], s13 offen offset:0 lds
 buffer_load_dwordx4 v1, s[4:7], s13 offen offset:1024 lds
 buffer_load_dwordx4 v1, s[4:7], s13 offen offset:2048 lds
 buffer_load_dwordx4 v1, s[4:7], s13 offen offset:3072 lds
 v_add_u32 v12, 57344, v1
 s_lshl_b32 s23, s22, 2
 s_add_u32 s23, s23, s8
 s_mul_i32 s11, s23, 57344
 s_add_u32 s24, s11, 104857600
 s_add_u32 s25, s11, 104871936
 s_add_u32 s26, s11, 104886272
 s_add_u32 s27, s11, 104900608
 v_add_u32 v8, 0, v1
 v_add_u32 v9, 1024, v1
 v_add_u32 v10, 2048, v1
 buffer_load_dwordx4 a[0:3], v8, s[4:7], s24 offen
 buffer_load_dwordx4 a[4:7], v8, s[4:7], s25 offen
 buffer_load_dwordx4 a[8:11], v8, s[4:7], s26 offen
 buffer_load_dwordx4 a[12:15], v8, s[4:7], s27 offen
 buffer_load_dwordx4 a[16:19], v9, s[4:7], s24 offen
 buffer_load_dwordx4 a[20:23], v9, s[4:7], s25 offen
 buffer_load_dwordx4 a[24:27], v9, s[4:7], s26 offen
 buffer_load_dwordx4 a[28:31], v9, s[4:7], s27 offen
 buffer_load_dwordx4 a[32:35], v10, s[4:7], s24 offen
 buffer_load_dwordx4 a[36:39], v10, s[4:7], s25 offen
 buffer_load_dwordx4 a[40:43], v10, s[4:7], s26 offen
 buffer_load_dwordx4 a[44:47], v10, s[4:7], s27 offen
 s_waitcnt vmcnt(12)
 s_barrier
 ds_read_b128 a[64:67], v1 offset:0
 ds_read_b128 a[68:71], v1 offset:14336
 ds_read_b128 a[72:75], v1 offset:28672
 ds_read_b128 a[76:79], v1 offset:43008
 ds_read_b128 a[80:83], v12 offset:0
 ds_read_b128 a[84:87], v12 offset:14336
 ds_read_b128 a[88:91], v12 offset:28672
 ds_read_b128 a[92:95], v12 offset:43008
 v_add_u32 v11, 3072, v1
 s_waitcnt vmcnt(8)
 s_waitcnt lgkmcnt(0)
 v_mfma_f32_16x16x32_bf16 v[128:131], a[0:3], a[64:67], 0
 buffer_load_dwordx4 a[48:51], v11, s[4:7], s24 offen
 v_mfma_f32_16x16x32_bf16 v[132:135], a[4:7], a[64:67], 0
 buffer_load_dwordx4 a[52:55], v11, s[4:7], s25 offen
 v_mfma_f32_16x16x32_bf16 v[136:139], a[8:11], a[64:67], 0
 buffer_load_dwordx4 a[56:59], v11, s[4:7], s26 offen
 v_mfma_f32_16x16x32_bf16 v[140:143], a[12:15], a[64:67], 0
 buffer_load_dwordx4 a[60:63], v11, s[4:7], s27 offen
 v_mfma_f32_16x16x32_bf16 v[144:147], a[0:3], a[68:71], 0
 ds_read_b128 a[96:99], v1 offset:1024
 v_mfma_f32_16x16x32_bf16 v[148:151], a[4:7], a[68:71], 0
 ds_read_b128 a[100:103], v1 offset:15360
 v_mfma_f32_16x16x32_bf16 v[152:155], a[8:11], a[68:71], 0
 ds_read_b128 a[104:107], v1 offset:29696
 v_mfma_f32_16x16x32_bf16 v[156:159], a[12:15], a[68:71], 0
 ds_read_b128 a[108:111], v1 offset:44032
 v_mfma_f32_16x16x32_bf16 v[160:163], a[0:3], a[72:75], 0
 ds_read_b128 a[112:115], v12 offset:1024
 v_mfma_f32_16x16x32_bf16 v[164:167], a[4:7], a[72:75], 0
 ds_read_b128 a[116:119], v12 offset:15360
 v_mfma_f32_16x16x32_bf16 v[168:171], a[8:11], a[72:75], 0
 ds_read_b128 a[120:123], v12 offset:29696
 v_mfma_f32_16x16x32_bf16 v[172:175], a[12:15], a[72:75], 0
 ds_read_b128 a[124:127], v12 offset:44032
 v_mfma_f32_16x16x32_bf16 v[176:179], a[0:3], a[76:79], 0
 v_mfma_f32_16x16x32_bf16 v[180:183], a[4:7], a[76:79], 0
 v_mfma_f32_16x16x32_bf16 v[184:187], a[8:11], a[76:79], 0
 v_mfma_f32_16x16x32_bf16 v[188:191], a[12:15], a[76:79], 0
 v_mfma_f32_16x16x32_bf16 v[192:195], a[0:3], a[80:83], 0
 v_mfma_f32_16x16x32_bf16 v[196:199], a[4:7], a[80:83], 0
 v_mfma_f32_16x16x32_bf16 v[200:203], a[8:11], a[80:83], 0
 v_mfma_f32_16x16x32_bf16 v[204:207], a[12:15], a[80:83], 0
 v_mfma_f32_16x16x32_bf16 v[208:211], a[0:3], a[84:87], 0
 v_mfma_f32_16x16x32_bf16 v[212:215], a[4:7], a[84:87], 0
 v_mfma_f32_16x16x32_bf16 v[216:219], a[8:11], a[84:87], 0
 v_mfma_f32_16x16x32_bf16 v[220:223], a[12:15], a[84:87], 0
 v_mfma_f32_16x16x32_bf16 v[224:227], a[0:3], a[88:91], 0
 v_mfma_f32_16x16x32_bf16 v[228:231], a[4:7], a[88:91], 0
 v_mfma_f32_16x16x32_bf16 v[232:235], a[8:11], a[88:91], 0
 v_mfma_f32_16x16x32_bf16 v[236:239], a[12:15], a[88:91], 0
 v_mfma_f32_16x16x32_bf16 v[240:243], a[0:3], a[92:95], 0
 v_mfma_f32_16x16x32_bf16 v[244:247], a[4:7], a[92:95], 0
 v_mfma_f32_16x16x32_bf16 v[248:251], a[8:11], a[92:95], 0
 v_mfma_f32_16x16x32_bf16 v[252:255], a[12:15], a[92:95], 0
 v_add_u32 v8, 4096, v1
 s_waitcnt vmcnt(8)
 s_waitcnt lgkmcnt(0)
 v_mfma_f32_16x16x32_bf16 v[128:131], a[16:19], a[96:99], v[128:131]
 buffer_load_dwordx4 a[0:3], v8, s[4:7], s24 offen
 v_mfma_f32_16x16x32_bf16 v[132:135], a[20:23], a[96:99], v[132:135]
 buffer_load_dwordx4 a[4:7], v8, s[4:7], s25 offen
 v_mfma_f32_16x16x32_bf16 v[136:139], a[24:27], a[96:99], v[136:139]
 buffer_load_dwordx4 a[8:11], v8, s[4:7], s26 offen
 v_mfma_f32_16x16x32_bf16 v[140:143], a[28:31], a[96:99], v[140:143]
 buffer_load_dwordx4 a[12:15], v8, s[4:7], s27 offen
 v_mfma_f32_16x16x32_bf16 v[144:147], a[16:19], a[100:103], v[144:147]
 ds_read_b128 a[64:67], v1 offset:2048
 v_mfma_f32_16x16x32_bf16 v[148:151], a[20:23], a[100:103], v[148:151]
 ds_read_b128 a[68:71], v1 offset:16384
 v_mfma_f32_16x16x32_bf16 v[152:155], a[24:27], a[100:103], v[152:155]
 ds_read_b128 a[72:75], v1 offset:30720
 v_mfma_f32_16x16x32_bf16 v[156:159], a[28:31], a[100:103], v[156:159]
 ds_read_b128 a[76:79], v1 offset:45056
 v_mfma_f32_16x16x32_bf16 v[160:163], a[16:19], a[104:107], v[160:163]
 ds_read_b128 a[80:83], v12 offset:2048
 v_mfma_f32_16x16x32_bf16 v[164:167], a[20:23], a[104:107], v[164:167]
 ds_read_b128 a[84:87], v12 offset:16384
 v_mfma_f32_16x16x32_bf16 v[168:171], a[24:27], a[104:107], v[168:171]
 ds_read_b128 a[88:91], v12 offset:30720
 v_mfma_f32_16x16x32_bf16 v[172:175], a[28:31], a[104:107], v[172:175]
 ds_read_b128 a[92:95], v12 offset:45056
 v_mfma_f32_16x16x32_bf16 v[176:179], a[16:19], a[108:111], v[176:179]
 v_mfma_f32_16x16x32_bf16 v[180:183], a[20:23], a[108:111], v[180:183]
 v_mfma_f32_16x16x32_bf16 v[184:187], a[24:27], a[108:111], v[184:187]
 v_mfma_f32_16x16x32_bf16 v[188:191], a[28:31], a[108:111], v[188:191]
 v_mfma_f32_16x16x32_bf16 v[192:195], a[16:19], a[112:115], v[192:195]
 v_mfma_f32_16x16x32_bf16 v[196:199], a[20:23], a[112:115], v[196:199]
 v_mfma_f32_16x16x32_bf16 v[200:203], a[24:27], a[112:115], v[200:203]
 v_mfma_f32_16x16x32_bf16 v[204:207], a[28:31], a[112:115], v[204:207]
 v_mfma_f32_16x16x32_bf16 v[208:211], a[16:19], a[116:119], v[208:211]
 v_mfma_f32_16x16x32_bf16 v[212:215], a[20:23], a[116:119], v[212:215]
 v_mfma_f32_16x16x32_bf16 v[216:219], a[24:27], a[116:119], v[216:219]
 v_mfma_f32_16x16x32_bf16 v[220:223], a[28:31], a[116:119], v[220:223]
 v_mfma_f32_16x16x32_bf16 v[224:227], a[16:19], a[120:123], v[224:227]
 v_mfma_f32_16x16x32_bf16 v[228:231], a[20:23], a[120:123], v[228:231]
 v_mfma_f32_16x16x32_bf16 v[232:235], a[24:27], a[120:123], v[232:235]
 v_mfma_f32_16x16x32_bf16 v[236:239], a[28:31], a[120:123], v[236:239]
 v_mfma_f32_16x16x32_bf16 v[240:243], a[16:19], a[124:127], v[240:243]
 v_mfma_f32_16x16x32_bf16 v[244:247], a[20:23], a[124:127], v[244:247]
 v_mfma_f32_16x16x32_bf16 v[248:251], a[24:27], a[124:127], v[248:251]
 v_mfma_f32_16x16x32_bf16 v[252:255], a[28:31], a[124:127], v[252:255]
 v_add_u32 v9, 5120, v1
 s_waitcnt vmcnt(8)
 s_waitcnt lgkmcnt(0)
 v_mfma_f32_16x16x32_bf16 v[128:131], a[32:35], a[64:67], v[128:131]
 buffer_load_dwordx4 a[16:19], v9, s[4:7], s24 offen
 v_mfma_f32_16x16x32_bf16 v[132:135], a[36:39], a[64:67], v[132:135]
 buffer_load_dwordx4 a[20:23], v9, s[4:7], s25 offen
 v_mfma_f32_16x16x32_bf16 v[136:139], a[40:43], a[64:67], v[136:139]
 buffer_load_dwordx4 a[24:27], v9, s[4:7], s26 offen
 v_mfma_f32_16x16x32_bf16 v[140:143], a[44:47], a[64:67], v[140:143]
 buffer_load_dwordx4 a[28:31], v9, s[4:7], s27 offen
 v_mfma_f32_16x16x32_bf16 v[144:147], a[32:35], a[68:71], v[144:147]
 ds_read_b128 a[96:99], v1 offset:3072
 v_mfma_f32_16x16x32_bf16 v[148:151], a[36:39], a[68:71], v[148:151]
 ds_read_b128 a[100:103], v1 offset:17408
 v_mfma_f32_16x16x32_bf16 v[152:155], a[40:43], a[68:71], v[152:155]
 ds_read_b128 a[104:107], v1 offset:31744
 v_mfma_f32_16x16x32_bf16 v[156:159], a[44:47], a[68:71], v[156:159]
 ds_read_b128 a[108:111], v1 offset:46080
 v_mfma_f32_16x16x32_bf16 v[160:163], a[32:35], a[72:75], v[160:163]
 ds_read_b128 a[112:115], v12 offset:3072
 v_mfma_f32_16x16x32_bf16 v[164:167], a[36:39], a[72:75], v[164:167]
 ds_read_b128 a[116:119], v12 offset:17408
 v_mfma_f32_16x16x32_bf16 v[168:171], a[40:43], a[72:75], v[168:171]
 ds_read_b128 a[120:123], v12 offset:31744
 v_mfma_f32_16x16x32_bf16 v[172:175], a[44:47], a[72:75], v[172:175]
 ds_read_b128 a[124:127], v12 offset:46080
 v_mfma_f32_16x16x32_bf16 v[176:179], a[32:35], a[76:79], v[176:179]
 v_mfma_f32_16x16x32_bf16 v[180:183], a[36:39], a[76:79], v[180:183]
 v_mfma_f32_16x16x32_bf16 v[184:187], a[40:43], a[76:79], v[184:187]
 v_mfma_f32_16x16x32_bf16 v[188:191], a[44:47], a[76:79], v[188:191]
 v_mfma_f32_16x16x32_bf16 v[192:195], a[32:35], a[80:83], v[192:195]
 v_mfma_f32_16x16x32_bf16 v[196:199], a[36:39], a[80:83], v[196:199]
 v_mfma_f32_16x16x32_bf16 v[200:203], a[40:43], a[80:83], v[200:203]
 v_mfma_f32_16x16x32_bf16 v[204:207], a[44:47], a[80:83], v[204:207]
 v_mfma_f32_16x16x32_bf16 v[208:211], a[32:35], a[84:87], v[208:211]
 v_mfma_f32_16x16x32_bf16 v[212:215], a[36:39], a[84:87], v[212:215]
 v_mfma_f32_16x16x32_bf16 v[216:219], a[40:43], a[84:87], v[216:219]
 v_mfma_f32_16x16x32_bf16 v[220:223], a[44:47], a[84:87], v[220:223]
 v_mfma_f32_16x16x32_bf16 v[224:227], a[32:35], a[88:91], v[224:227]
 v_mfma_f32_16x16x32_bf16 v[228:231], a[36:39], a[88:91], v[228:231]
 v_mfma_f32_16x16x32_bf16 v[232:235], a[40:43], a[88:91], v[232:235]
 v_mfma_f32_16x16x32_bf16 v[236:239], a[44:47], a[88:91], v[236:239]
 v_mfma_f32_16x16x32_bf16 v[240:243], a[32:35], a[92:95], v[240:243]
 v_mfma_f32_16x16x32_bf16 v[244:247], a[36:39], a[92:95], v[244:247]
 v_mfma_f32_16x16x32_bf16 v[248:251], a[40:43], a[92:95], v[248:251]
 v_mfma_f32_16x16x32_bf16 v[252:255], a[44:47], a[92:95], v[252:255]
 v_add_u32 v10, 6144, v1
 s_waitcnt vmcnt(8)
 s_waitcnt lgkmcnt(0)
 v_mfma_f32_16x16x32_bf16 v[128:131], a[48:51], a[96:99], v[128:131]
 buffer_load_dwordx4 a[32:35], v10, s[4:7], s24 offen
 v_mfma_f32_16x16x32_bf16 v[132:135], a[52:55], a[96:99], v[132:135]
 buffer_load_dwordx4 a[36:39], v10, s[4:7], s25 offen
 v_mfma_f32_16x16x32_bf16 v[136:139], a[56:59], a[96:99], v[136:139]
 buffer_load_dwordx4 a[40:43], v10, s[4:7], s26 offen
 v_mfma_f32_16x16x32_bf16 v[140:143], a[60:63], a[96:99], v[140:143]
 buffer_load_dwordx4 a[44:47], v10, s[4:7], s27 offen
 v_mfma_f32_16x16x32_bf16 v[144:147], a[48:51], a[100:103], v[144:147]
 ds_read_b128 a[64:67], v1 offset:4096
 v_mfma_f32_16x16x32_bf16 v[148:151], a[52:55], a[100:103], v[148:151]
 ds_read_b128 a[68:71], v1 offset:18432
 v_mfma_f32_16x16x32_bf16 v[152:155], a[56:59], a[100:103], v[152:155]
 ds_read_b128 a[72:75], v1 offset:32768
 v_mfma_f32_16x16x32_bf16 v[156:159], a[60:63], a[100:103], v[156:159]
 ds_read_b128 a[76:79], v1 offset:47104
 v_mfma_f32_16x16x32_bf16 v[160:163], a[48:51], a[104:107], v[160:163]
 ds_read_b128 a[80:83], v12 offset:4096
 v_mfma_f32_16x16x32_bf16 v[164:167], a[52:55], a[104:107], v[164:167]
 ds_read_b128 a[84:87], v12 offset:18432
 v_mfma_f32_16x16x32_bf16 v[168:171], a[56:59], a[104:107], v[168:171]
 ds_read_b128 a[88:91], v12 offset:32768
 v_mfma_f32_16x16x32_bf16 v[172:175], a[60:63], a[104:107], v[172:175]
 ds_read_b128 a[92:95], v12 offset:47104
 v_mfma_f32_16x16x32_bf16 v[176:179], a[48:51], a[108:111], v[176:179]
 v_mfma_f32_16x16x32_bf16 v[180:183], a[52:55], a[108:111], v[180:183]
 v_mfma_f32_16x16x32_bf16 v[184:187], a[56:59], a[108:111], v[184:187]
 v_mfma_f32_16x16x32_bf16 v[188:191], a[60:63], a[108:111], v[188:191]
 v_mfma_f32_16x16x32_bf16 v[192:195], a[48:51], a[112:115], v[192:195]
 v_mfma_f32_16x16x32_bf16 v[196:199], a[52:55], a[112:115], v[196:199]
 v_mfma_f32_16x16x32_bf16 v[200:203], a[56:59], a[112:115], v[200:203]
 v_mfma_f32_16x16x32_bf16 v[204:207], a[60:63], a[112:115], v[204:207]
 v_mfma_f32_16x16x32_bf16 v[208:211], a[48:51], a[116:119], v[208:211]
 v_mfma_f32_16x16x32_bf16 v[212:215], a[52:55], a[116:119], v[212:215]
 v_mfma_f32_16x16x32_bf16 v[216:219], a[56:59], a[116:119], v[216:219]
 v_mfma_f32_16x16x32_bf16 v[220:223], a[60:63], a[116:119], v[220:223]
 v_mfma_f32_16x16x32_bf16 v[224:227], a[48:51], a[120:123], v[224:227]
 v_mfma_f32_16x16x32_bf16 v[228:231], a[52:55], a[120:123], v[228:231]
 v_mfma_f32_16x16x32_bf16 v[232:235], a[56:59], a[120:123], v[232:235]
 v_mfma_f32_16x16x32_bf16 v[236:239], a[60:63], a[120:123], v[236:239]
 v_mfma_f32_16x16x32_bf16 v[240:243], a[48:51], a[124:127], v[240:243]
 v_mfma_f32_16x16x32_bf16 v[244:247], a[52:55], a[124:127], v[244:247]
 v_mfma_f32_16x16x32_bf16 v[248:251], a[56:59], a[124:127], v[248:251]
 v_mfma_f32_16x16x32_bf16 v[252:255], a[60:63], a[124:127], v[252:255]
 v_add_u32 v11, 7168, v1
 s_waitcnt vmcnt(8)
 s_waitcnt lgkmcnt(0)
 v_mfma_f32_16x16x32_bf16 v[128:131], a[0:3], a[64:67], v[128:131]
 buffer_load_dwordx4 a[48:51], v11, s[4:7], s24 offen
 v_mfma_f32_16x16x32_bf16 v[132:135], a[4:7], a[64:67], v[132:135]
 buffer_load_dwordx4 a[52:55], v11, s[4:7], s25 offen
 v_mfma_f32_16x16x32_bf16 v[136:139], a[8:11], a[64:67], v[136:139]
 buffer_load_dwordx4 a[56:59], v11, s[4:7], s26 offen
 v_mfma_f32_16x16x32_bf16 v[140:143], a[12:15], a[64:67], v[140:143]
 buffer_load_dwordx4 a[60:63], v11, s[4:7], s27 offen
 v_mfma_f32_16x16x32_bf16 v[144:147], a[0:3], a[68:71], v[144:147]
 ds_read_b128 a[96:99], v1 offset:5120
 v_mfma_f32_16x16x32_bf16 v[148:151], a[4:7], a[68:71], v[148:151]
 ds_read_b128 a[100:103], v1 offset:19456
 v_mfma_f32_16x16x32_bf16 v[152:155], a[8:11], a[68:71], v[152:155]
 ds_read_b128 a[104:107], v1 offset:33792
 v_mfma_f32_16x16x32_bf16 v[156:159], a[12:15], a[68:71], v[156:159]
 ds_read_b128 a[108:111], v1 offset:48128
 v_mfma_f32_16x16x32_bf16 v[160:163], a[0:3], a[72:75], v[160:163]
 ds_read_b128 a[112:115], v12 offset:5120
 v_mfma_f32_16x16x32_bf16 v[164:167], a[4:7], a[72:75], v[164:167]
 ds_read_b128 a[116:119], v12 offset:19456
 v_mfma_f32_16x16x32_bf16 v[168:171], a[8:11], a[72:75], v[168:171]
 ds_read_b128 a[120:123], v12 offset:33792
 v_mfma_f32_16x16x32_bf16 v[172:175], a[12:15], a[72:75], v[172:175]
 ds_read_b128 a[124:127], v12 offset:48128
 v_mfma_f32_16x16x32_bf16 v[176:179], a[0:3], a[76:79], v[176:179]
 v_mfma_f32_16x16x32_bf16 v[180:183], a[4:7], a[76:79], v[180:183]
 v_mfma_f32_16x16x32_bf16 v[184:187], a[8:11], a[76:79], v[184:187]
 v_mfma_f32_16x16x32_bf16 v[188:191], a[12:15], a[76:79], v[188:191]
 v_mfma_f32_16x16x32_bf16 v[192:195], a[0:3], a[80:83], v[192:195]
 v_mfma_f32_16x16x32_bf16 v[196:199], a[4:7], a[80:83], v[196:199]
 v_mfma_f32_16x16x32_bf16 v[200:203], a[8:11], a[80:83], v[200:203]
 v_mfma_f32_16x16x32_bf16 v[204:207], a[12:15], a[80:83], v[204:207]
 v_mfma_f32_16x16x32_bf16 v[208:211], a[0:3], a[84:87], v[208:211]
 v_mfma_f32_16x16x32_bf16 v[212:215], a[4:7], a[84:87], v[212:215]
 v_mfma_f32_16x16x32_bf16 v[216:219], a[8:11], a[84:87], v[216:219]
 v_mfma_f32_16x16x32_bf16 v[220:223], a[12:15], a[84:87], v[220:223]
 v_mfma_f32_16x16x32_bf16 v[224:227], a[0:3], a[88:91], v[224:227]
 v_mfma_f32_16x16x32_bf16 v[228:231], a[4:7], a[88:91], v[228:231]
 v_mfma_f32_16x16x32_bf16 v[232:235], a[8:11], a[88:91], v[232:235]
 v_mfma_f32_16x16x32_bf16 v[236:239], a[12:15], a[88:91], v[236:239]
 v_mfma_f32_16x16x32_bf16 v[240:243], a[0:3], a[92:95], v[240:243]
 v_mfma_f32_16x16x32_bf16 v[244:247], a[4:7], a[92:95], v[244:247]
 v_mfma_f32_16x16x32_bf16 v[248:251], a[8:11], a[92:95], v[248:251]
 v_mfma_f32_16x16x32_bf16 v[252:255], a[12:15], a[92:95], v[252:255]
 v_add_u32 v8, 8192, v1
 s_waitcnt vmcnt(8)
 s_waitcnt lgkmcnt(0)
 v_mfma_f32_16x16x32_bf16 v[128:131], a[16:19], a[96:99], v[128:131]
 buffer_load_dwordx4 a[0:3], v8, s[4:7], s24 offen
 v_mfma_f32_16x16x32_bf16 v[132:135], a[20:23], a[96:99], v[132:135]
 buffer_load_dwordx4 a[4:7], v8, s[4:7], s25 offen
 v_mfma_f32_16x16x32_bf16 v[136:139], a[24:27], a[96:99], v[136:139]
 buffer_load_dwordx4 a[8:11], v8, s[4:7], s26 offen
 v_mfma_f32_16x16x32_bf16 v[140:143], a[28:31], a[96:99], v[140:143]
 buffer_load_dwordx4 a[12:15], v8, s[4:7], s27 offen
 v_mfma_f32_16x16x32_bf16 v[144:147], a[16:19], a[100:103], v[144:147]
 ds_read_b128 a[64:67], v1 offset:6144
 v_mfma_f32_16x16x32_bf16 v[148:151], a[20:23], a[100:103], v[148:151]
 ds_read_b128 a[68:71], v1 offset:20480
 v_mfma_f32_16x16x32_bf16 v[152:155], a[24:27], a[100:103], v[152:155]
 ds_read_b128 a[72:75], v1 offset:34816
 v_mfma_f32_16x16x32_bf16 v[156:159], a[28:31], a[100:103], v[156:159]
 ds_read_b128 a[76:79], v1 offset:49152
 v_mfma_f32_16x16x32_bf16 v[160:163], a[16:19], a[104:107], v[160:163]
 ds_read_b128 a[80:83], v12 offset:6144
 v_mfma_f32_16x16x32_bf16 v[164:167], a[20:23], a[104:107], v[164:167]
 ds_read_b128 a[84:87], v12 offset:20480
 v_mfma_f32_16x16x32_bf16 v[168:171], a[24:27], a[104:107], v[168:171]
 ds_read_b128 a[88:91], v12 offset:34816
 v_mfma_f32_16x16x32_bf16 v[172:175], a[28:31], a[104:107], v[172:175]
 ds_read_b128 a[92:95], v12 offset:49152
 v_mfma_f32_16x16x32_bf16 v[176:179], a[16:19], a[108:111], v[176:179]
 v_mfma_f32_16x16x32_bf16 v[180:183], a[20:23], a[108:111], v[180:183]
 v_mfma_f32_16x16x32_bf16 v[184:187], a[24:27], a[108:111], v[184:187]
 v_mfma_f32_16x16x32_bf16 v[188:191], a[28:31], a[108:111], v[188:191]
 v_mfma_f32_16x16x32_bf16 v[192:195], a[16:19], a[112:115], v[192:195]
 v_mfma_f32_16x16x32_bf16 v[196:199], a[20:23], a[112:115], v[196:199]
 v_mfma_f32_16x16x32_bf16 v[200:203], a[24:27], a[112:115], v[200:203]
 v_mfma_f32_16x16x32_bf16 v[204:207], a[28:31], a[112:115], v[204:207]
 v_mfma_f32_16x16x32_bf16 v[208:211], a[16:19], a[116:119], v[208:211]
 v_mfma_f32_16x16x32_bf16 v[212:215], a[20:23], a[116:119], v[212:215]
 v_mfma_f32_16x16x32_bf16 v[216:219], a[24:27], a[116:119], v[216:219]
 v_mfma_f32_16x16x32_bf16 v[220:223], a[28:31], a[116:119], v[220:223]
 v_mfma_f32_16x16x32_bf16 v[224:227], a[16:19], a[120:123], v[224:227]
 v_mfma_f32_16x16x32_bf16 v[228:231], a[20:23], a[120:123], v[228:231]
 v_mfma_f32_16x16x32_bf16 v[232:235], a[24:27], a[120:123], v[232:235]
 v_mfma_f32_16x16x32_bf16 v[236:239], a[28:31], a[120:123], v[236:239]
 v_mfma_f32_16x16x32_bf16 v[240:243], a[16:19], a[124:127], v[240:243]
 v_mfma_f32_16x16x32_bf16 v[244:247], a[20:23], a[124:127], v[244:247]
 v_mfma_f32_16x16x32_bf16 v[248:251], a[24:27], a[124:127], v[248:251]
 v_mfma_f32_16x16x32_bf16 v[252:255], a[28:31], a[124:127], v[252:255]
 v_add_u32 v9, 9216, v1
 s_waitcnt vmcnt(8)
 s_waitcnt lgkmcnt(0)
 v_mfma_f32_16x16x32_bf16 v[128:131], a[32:35], a[64:67], v[128:131]
 buffer_load_dwordx4 a[16:19], v9, s[4:7], s24 offen
 v_mfma_f32_16x16x32_bf16 v[132:135], a[36:39], a[64:67], v[132:135]
 buffer_load_dwordx4 a[20:23], v9, s[4:7], s25 offen
 v_mfma_f32_16x16x32_bf16 v[136:139], a[40:43], a[64:67], v[136:139]
 buffer_load_dwordx4 a[24:27], v9, s[4:7], s26 offen
 v_mfma_f32_16x16x32_bf16 v[140:143], a[44:47], a[64:67], v[140:143]
 buffer_load_dwordx4 a[28:31], v9, s[4:7], s27 offen
 v_mfma_f32_16x16x32_bf16 v[144:147], a[32:35], a[68:71], v[144:147]
 ds_read_b128 a[96:99], v1 offset:7168
 v_mfma_f32_16x16x32_bf16 v[148:151], a[36:39], a[68:71], v[148:151]
 ds_read_b128 a[100:103], v1 offset:21504
 v_mfma_f32_16x16x32_bf16 v[152:155], a[40:43], a[68:71], v[152:155]
 ds_read_b128 a[104:107], v1 offset:35840
 v_mfma_f32_16x16x32_bf16 v[156:159], a[44:47], a[68:71], v[156:159]
 ds_read_b128 a[108:111], v1 offset:50176
 v_mfma_f32_16x16x32_bf16 v[160:163], a[32:35], a[72:75], v[160:163]
 ds_read_b128 a[112:115], v12 offset:7168
 v_mfma_f32_16x16x32_bf16 v[164:167], a[36:39], a[72:75], v[164:167]
 ds_read_b128 a[116:119], v12 offset:21504
 v_mfma_f32_16x16x32_bf16 v[168:171], a[40:43], a[72:75], v[168:171]
 ds_read_b128 a[120:123], v12 offset:35840
 v_mfma_f32_16x16x32_bf16 v[172:175], a[44:47], a[72:75], v[172:175]
 ds_read_b128 a[124:127], v12 offset:50176
 v_mfma_f32_16x16x32_bf16 v[176:179], a[32:35], a[76:79], v[176:179]
 v_mfma_f32_16x16x32_bf16 v[180:183], a[36:39], a[76:79], v[180:183]
 v_mfma_f32_16x16x32_bf16 v[184:187], a[40:43], a[76:79], v[184:187]
 v_mfma_f32_16x16x32_bf16 v[188:191], a[44:47], a[76:79], v[188:191]
 v_mfma_f32_16x16x32_bf16 v[192:195], a[32:35], a[80:83], v[192:195]
 v_mfma_f32_16x16x32_bf16 v[196:199], a[36:39], a[80:83], v[196:199]
 v_mfma_f32_16x16x32_bf16 v[200:203], a[40:43], a[80:83], v[200:203]
 v_mfma_f32_16x16x32_bf16 v[204:207], a[44:47], a[80:83], v[204:207]
 v_mfma_f32_16x16x32_bf16 v[208:211], a[32:35], a[84:87], v[208:211]
 v_mfma_f32_16x16x32_bf16 v[212:215], a[36:39], a[84:87], v[212:215]
 v_mfma_f32_16x16x32_bf16 v[216:219], a[40:43], a[84:87], v[216:219]
 v_mfma_f32_16x16x32_bf16 v[220:223], a[44:47], a[84:87], v[220:223]
 v_mfma_f32_16x16x32_bf16 v[224:227], a[32:35], a[88:91], v[224:227]
 v_mfma_f32_16x16x32_bf16 v[228:231], a[36:39], a[88:91], v[228:231]
 v_mfma_f32_16x16x32_bf16 v[232:235], a[40:43], a[88:91], v[232:235]
 v_mfma_f32_16x16x32_bf16 v[236:239], a[44:47], a[88:91], v[236:239]
 v_mfma_f32_16x16x32_bf16 v[240:243], a[32:35], a[92:95], v[240:243]
 v_mfma_f32_16x16x32_bf16 v[244:247], a[36:39], a[92:95], v[244:247]
 v_mfma_f32_16x16x32_bf16 v[248:251], a[40:43], a[92:95], v[248:251]
 v_mfma_f32_16x16x32_bf16 v[252:255], a[44:47], a[92:95], v[252:255]
 v_add_u32 v10, 10240, v1
 s_waitcnt vmcnt(8)
 s_waitcnt lgkmcnt(0)
 v_mfma_f32_16x16x32_bf16 v[128:131], a[48:51], a[96:99], v[128:131]
 buffer_load_dwordx4 a[32:35], v10, s[4:7], s24 offen
 v_mfma_f32_16x16x32_bf16 v[132:135], a[52:55], a[96:99], v[132:135]
 buffer_load_dwordx4 a[36:39], v10, s[4:7], s25 offen
 v_mfma_f32_16x16x32_bf16 v[136:139], a[56:59], a[96:99], v[136:139]
 buffer_load_dwordx4 a[40:43], v10, s[4:7], s26 offen
 v_mfma_f32_16x16x32_bf16 v[140:143], a[60:63], a[96:99], v[140:143]
 buffer_load_dwordx4 a[44:47], v10, s[4:7], s27 offen
 v_mfma_f32_16x16x32_bf16 v[144:147], a[48:51], a[100:103], v[144:147]
 ds_read_b128 a[64:67], v1 offset:8192
 v_mfma_f32_16x16x32_bf16 v[148:151], a[52:55], a[100:103], v[148:151]
 ds_read_b128 a[68:71], v1 offset:22528
 v_mfma_f32_16x16x32_bf16 v[152:155], a[56:59], a[100:103], v[152:155]
 ds_read_b128 a[72:75], v1 offset:36864
 v_mfma_f32_16x16x32_bf16 v[156:159], a[60:63], a[100:103], v[156:159]
 ds_read_b128 a[76:79], v1 offset:51200
 v_mfma_f32_16x16x32_bf16 v[160:163], a[48:51], a[104:107], v[160:163]
 ds_read_b128 a[80:83], v12 offset:8192
 v_mfma_f32_16x16x32_bf16 v[164:167], a[52:55], a[104:107], v[164:167]
 ds_read_b128 a[84:87], v12 offset:22528
 v_mfma_f32_16x16x32_bf16 v[168:171], a[56:59], a[104:107], v[168:171]
 ds_read_b128 a[88:91], v12 offset:36864
 v_mfma_f32_16x16x32_bf16 v[172:175], a[60:63], a[104:107], v[172:175]
 ds_read_b128 a[92:95], v12 offset:51200
 v_mfma_f32_16x16x32_bf16 v[176:179], a[48:51], a[108:111], v[176:179]
 v_mfma_f32_16x16x32_bf16 v[180:183], a[52:55], a[108:111], v[180:183]
 v_mfma_f32_16x16x32_bf16 v[184:187], a[56:59], a[108:111], v[184:187]
 v_mfma_f32_16x16x32_bf16 v[188:191], a[60:63], a[108:111], v[188:191]
 v_mfma_f32_16x16x32_bf16 v[192:195], a[48:51], a[112:115], v[192:195]
 v_mfma_f32_16x16x32_bf16 v[196:199], a[52:55], a[112:115], v[196:199]
 v_mfma_f32_16x16x32_bf16 v[200:203], a[56:59], a[112:115], v[200:203]
 v_mfma_f32_16x16x32_bf16 v[204:207], a[60:63], a[112:115], v[204:207]
 v_mfma_f32_16x16x32_bf16 v[208:211], a[48:51], a[116:119], v[208:211]
 v_mfma_f32_16x16x32_bf16 v[212:215], a[52:55], a[116:119], v[212:215]
 v_mfma_f32_16x16x32_bf16 v[216:219], a[56:59], a[116:119], v[216:219]
 v_mfma_f32_16x16x32_bf16 v[220:223], a[60:63], a[116:119], v[220:223]
 v_mfma_f32_16x16x32_bf16 v[224:227], a[48:51], a[120:123], v[224:227]
 v_mfma_f32_16x16x32_bf16 v[228:231], a[52:55], a[120:123], v[228:231]
 v_mfma_f32_16x16x32_bf16 v[232:235], a[56:59], a[120:123], v[232:235]
 v_mfma_f32_16x16x32_bf16 v[236:239], a[60:63], a[120:123], v[236:239]
 v_mfma_f32_16x16x32_bf16 v[240:243], a[48:51], a[124:127], v[240:243]
 v_mfma_f32_16x16x32_bf16 v[244:247], a[52:55], a[124:127], v[244:247]
 v_mfma_f32_16x16x32_bf16 v[248:251], a[56:59], a[124:127], v[248:251]
 v_mfma_f32_16x16x32_bf16 v[252:255], a[60:63], a[124:127], v[252:255]
 v_add_u32 v11, 11264, v1
 s_waitcnt vmcnt(8)
 s_waitcnt lgkmcnt(0)
 v_mfma_f32_16x16x32_bf16 v[128:131], a[0:3], a[64:67], v[128:131]
 buffer_load_dwordx4 a[48:51], v11, s[4:7], s24 offen
 v_mfma_f32_16x16x32_bf16 v[132:135], a[4:7], a[64:67], v[132:135]
 buffer_load_dwordx4 a[52:55], v11, s[4:7], s25 offen
 v_mfma_f32_16x16x32_bf16 v[136:139], a[8:11], a[64:67], v[136:139]
 buffer_load_dwordx4 a[56:59], v11, s[4:7], s26 offen
 v_mfma_f32_16x16x32_bf16 v[140:143], a[12:15], a[64:67], v[140:143]
 buffer_load_dwordx4 a[60:63], v11, s[4:7], s27 offen
 v_mfma_f32_16x16x32_bf16 v[144:147], a[0:3], a[68:71], v[144:147]
 ds_read_b128 a[96:99], v1 offset:9216
 v_mfma_f32_16x16x32_bf16 v[148:151], a[4:7], a[68:71], v[148:151]
 ds_read_b128 a[100:103], v1 offset:23552
 v_mfma_f32_16x16x32_bf16 v[152:155], a[8:11], a[68:71], v[152:155]
 ds_read_b128 a[104:107], v1 offset:37888
 v_mfma_f32_16x16x32_bf16 v[156:159], a[12:15], a[68:71], v[156:159]
 ds_read_b128 a[108:111], v1 offset:52224
 v_mfma_f32_16x16x32_bf16 v[160:163], a[0:3], a[72:75], v[160:163]
 ds_read_b128 a[112:115], v12 offset:9216
 v_mfma_f32_16x16x32_bf16 v[164:167], a[4:7], a[72:75], v[164:167]
 ds_read_b128 a[116:119], v12 offset:23552
 v_mfma_f32_16x16x32_bf16 v[168:171], a[8:11], a[72:75], v[168:171]
 ds_read_b128 a[120:123], v12 offset:37888
 v_mfma_f32_16x16x32_bf16 v[172:175], a[12:15], a[72:75], v[172:175]
 ds_read_b128 a[124:127], v12 offset:52224
 v_mfma_f32_16x16x32_bf16 v[176:179], a[0:3], a[76:79], v[176:179]
 v_mfma_f32_16x16x32_bf16 v[180:183], a[4:7], a[76:79], v[180:183]
 v_mfma_f32_16x16x32_bf16 v[184:187], a[8:11], a[76:79], v[184:187]
 v_mfma_f32_16x16x32_bf16 v[188:191], a[12:15], a[76:79], v[188:191]
 v_mfma_f32_16x16x32_bf16 v[192:195], a[0:3], a[80:83], v[192:195]
 v_mfma_f32_16x16x32_bf16 v[196:199], a[4:7], a[80:83], v[196:199]
 v_mfma_f32_16x16x32_bf16 v[200:203], a[8:11], a[80:83], v[200:203]
 v_mfma_f32_16x16x32_bf16 v[204:207], a[12:15], a[80:83], v[204:207]
 v_mfma_f32_16x16x32_bf16 v[208:211], a[0:3], a[84:87], v[208:211]
 v_mfma_f32_16x16x32_bf16 v[212:215], a[4:7], a[84:87], v[212:215]
 v_mfma_f32_16x16x32_bf16 v[216:219], a[8:11], a[84:87], v[216:219]
 v_mfma_f32_16x16x32_bf16 v[220:223], a[12:15], a[84:87], v[220:223]
 v_mfma_f32_16x16x32_bf16 v[224:227], a[0:3], a[88:91], v[224:227]
 v_mfma_f32_16x16x32_bf16 v[228:231], a[4:7], a[88:91], v[228:231]
 v_mfma_f32_16x16x32_bf16 v[232:235], a[8:11], a[88:91], v[232:235]
 v_mfma_f32_16x16x32_bf16 v[236:239], a[12:15], a[88:91], v[236:239]
 v_mfma_f32_16x16x32_bf16 v[240:243], a[0:3], a[92:95], v[240:243]
 v_mfma_f32_16x16x32_bf16 v[244:247], a[4:7], a[92:95], v[244:247]
 v_mfma_f32_16x16x32_bf16 v[248:251], a[8:11], a[92:95], v[248:251]
 v_mfma_f32_16x16x32_bf16 v[252:255], a[12:15], a[92:95], v[252:255]
 v_add_u32 v8, 12288, v1
 s_waitcnt vmcnt(8)
 s_waitcnt lgkmcnt(0)
 v_mfma_f32_16x16x32_bf16 v[128:131], a[16:19], a[96:99], v[128:131]
 buffer_load_dwordx4 a[0:3], v8, s[4:7], s24 offen
 v_mfma_f32_16x16x32_bf16 v[132:135], a[20:23], a[96:99], v[132:135]
 buffer_load_dwordx4 a[4:7], v8, s[4:7], s25 offen
 v_mfma_f32_16x16x32_bf16 v[136:139], a[24:27], a[96:99], v[136:139]
 buffer_load_dwordx4 a[8:11], v8, s[4:7], s26 offen
 v_mfma_f32_16x16x32_bf16 v[140:143], a[28:31], a[96:99], v[140:143]
 buffer_load_dwordx4 a[12:15], v8, s[4:7], s27 offen
 v_mfma_f32_16x16x32_bf16 v[144:147], a[16:19], a[100:103], v[144:147]
 ds_read_b128 a[64:67], v1 offset:10240
 v_mfma_f32_16x16x32_bf16 v[148:151], a[20:23], a[100:103], v[148:151]
 ds_read_b128 a[68:71], v1 offset:24576
 v_mfma_f32_16x16x32_bf16 v[152:155], a[24:27], a[100:103], v[152:155]
 ds_read_b128 a[72:75], v1 offset:38912
 v_mfma_f32_16x16x32_bf16 v[156:159], a[28:31], a[100:103], v[156:159]
 ds_read_b128 a[76:79], v1 offset:53248
 v_mfma_f32_16x16x32_bf16 v[160:163], a[16:19], a[104:107], v[160:163]
 ds_read_b128 a[80:83], v12 offset:10240
 v_mfma_f32_16x16x32_bf16 v[164:167], a[20:23], a[104:107], v[164:167]
 ds_read_b128 a[84:87], v12 offset:24576
 v_mfma_f32_16x16x32_bf16 v[168:171], a[24:27], a[104:107], v[168:171]
 ds_read_b128 a[88:91], v12 offset:38912
 v_mfma_f32_16x16x32_bf16 v[172:175], a[28:31], a[104:107], v[172:175]
 ds_read_b128 a[92:95], v12 offset:53248
 v_mfma_f32_16x16x32_bf16 v[176:179], a[16:19], a[108:111], v[176:179]
 v_mfma_f32_16x16x32_bf16 v[180:183], a[20:23], a[108:111], v[180:183]
 v_mfma_f32_16x16x32_bf16 v[184:187], a[24:27], a[108:111], v[184:187]
 v_mfma_f32_16x16x32_bf16 v[188:191], a[28:31], a[108:111], v[188:191]
 v_mfma_f32_16x16x32_bf16 v[192:195], a[16:19], a[112:115], v[192:195]
 v_mfma_f32_16x16x32_bf16 v[196:199], a[20:23], a[112:115], v[196:199]
 v_mfma_f32_16x16x32_bf16 v[200:203], a[24:27], a[112:115], v[200:203]
 v_mfma_f32_16x16x32_bf16 v[204:207], a[28:31], a[112:115], v[204:207]
 v_mfma_f32_16x16x32_bf16 v[208:211], a[16:19], a[116:119], v[208:211]
 v_mfma_f32_16x16x32_bf16 v[212:215], a[20:23], a[116:119], v[212:215]
 v_mfma_f32_16x16x32_bf16 v[216:219], a[24:27], a[116:119], v[216:219]
 v_mfma_f32_16x16x32_bf16 v[220:223], a[28:31], a[116:119], v[220:223]
 v_mfma_f32_16x16x32_bf16 v[224:227], a[16:19], a[120:123], v[224:227]
 v_mfma_f32_16x16x32_bf16 v[228:231], a[20:23], a[120:123], v[228:231]
 v_mfma_f32_16x16x32_bf16 v[232:235], a[24:27], a[120:123], v[232:235]
 v_mfma_f32_16x16x32_bf16 v[236:239], a[28:31], a[120:123], v[236:239]
 v_mfma_f32_16x16x32_bf16 v[240:243], a[16:19], a[124:127], v[240:243]
 v_mfma_f32_16x16x32_bf16 v[244:247], a[20:23], a[124:127], v[244:247]
 v_mfma_f32_16x16x32_bf16 v[248:251], a[24:27], a[124:127], v[248:251]
 v_mfma_f32_16x16x32_bf16 v[252:255], a[28:31], a[124:127], v[252:255]
 v_add_u32 v9, 13312, v1
 s_waitcnt vmcnt(8)
 s_waitcnt lgkmcnt(0)
 v_mfma_f32_16x16x32_bf16 v[128:131], a[32:35], a[64:67], v[128:131]
 buffer_load_dwordx4 a[16:19], v9, s[4:7], s24 offen
 v_mfma_f32_16x16x32_bf16 v[132:135], a[36:39], a[64:67], v[132:135]
 buffer_load_dwordx4 a[20:23], v9, s[4:7], s25 offen
 v_mfma_f32_16x16x32_bf16 v[136:139], a[40:43], a[64:67], v[136:139]
 buffer_load_dwordx4 a[24:27], v9, s[4:7], s26 offen
 v_mfma_f32_16x16x32_bf16 v[140:143], a[44:47], a[64:67], v[140:143]
 buffer_load_dwordx4 a[28:31], v9, s[4:7], s27 offen
 v_mfma_f32_16x16x32_bf16 v[144:147], a[32:35], a[68:71], v[144:147]
 ds_read_b128 a[96:99], v1 offset:11264
 v_mfma_f32_16x16x32_bf16 v[148:151], a[36:39], a[68:71], v[148:151]
 ds_read_b128 a[100:103], v1 offset:25600
 v_mfma_f32_16x16x32_bf16 v[152:155], a[40:43], a[68:71], v[152:155]
 ds_read_b128 a[104:107], v1 offset:39936
 v_mfma_f32_16x16x32_bf16 v[156:159], a[44:47], a[68:71], v[156:159]
 ds_read_b128 a[108:111], v1 offset:54272
 v_mfma_f32_16x16x32_bf16 v[160:163], a[32:35], a[72:75], v[160:163]
 ds_read_b128 a[112:115], v12 offset:11264
 v_mfma_f32_16x16x32_bf16 v[164:167], a[36:39], a[72:75], v[164:167]
 ds_read_b128 a[116:119], v12 offset:25600
 v_mfma_f32_16x16x32_bf16 v[168:171], a[40:43], a[72:75], v[168:171]
 ds_read_b128 a[120:123], v12 offset:39936
 v_mfma_f32_16x16x32_bf16 v[172:175], a[44:47], a[72:75], v[172:175]
 ds_read_b128 a[124:127], v12 offset:54272
 v_mfma_f32_16x16x32_bf16 v[176:179], a[32:35], a[76:79], v[176:179]
 v_mfma_f32_16x16x32_bf16 v[180:183], a[36:39], a[76:79], v[180:183]
 v_mfma_f32_16x16x32_bf16 v[184:187], a[40:43], a[76:79], v[184:187]
 v_mfma_f32_16x16x32_bf16 v[188:191], a[44:47], a[76:79], v[188:191]
 v_mfma_f32_16x16x32_bf16 v[192:195], a[32:35], a[80:83], v[192:195]
 v_mfma_f32_16x16x32_bf16 v[196:199], a[36:39], a[80:83], v[196:199]
 v_mfma_f32_16x16x32_bf16 v[200:203], a[40:43], a[80:83], v[200:203]
 v_mfma_f32_16x16x32_bf16 v[204:207], a[44:47], a[80:83], v[204:207]
 v_mfma_f32_16x16x32_bf16 v[208:211], a[32:35], a[84:87], v[208:211]
 v_mfma_f32_16x16x32_bf16 v[212:215], a[36:39], a[84:87], v[212:215]
 v_mfma_f32_16x16x32_bf16 v[216:219], a[40:43], a[84:87], v[216:219]
 v_mfma_f32_16x16x32_bf16 v[220:223], a[44:47], a[84:87], v[220:223]
 v_mfma_f32_16x16x32_bf16 v[224:227], a[32:35], a[88:91], v[224:227]
 v_mfma_f32_16x16x32_bf16 v[228:231], a[36:39], a[88:91], v[228:231]
 v_mfma_f32_16x16x32_bf16 v[232:235], a[40:43], a[88:91], v[232:235]
 v_mfma_f32_16x16x32_bf16 v[236:239], a[44:47], a[88:91], v[236:239]
 v_mfma_f32_16x16x32_bf16 v[240:243], a[32:35], a[92:95], v[240:243]
 v_mfma_f32_16x16x32_bf16 v[244:247], a[36:39], a[92:95], v[244:247]
 v_mfma_f32_16x16x32_bf16 v[248:251], a[40:43], a[92:95], v[248:251]
 v_mfma_f32_16x16x32_bf16 v[252:255], a[44:47], a[92:95], v[252:255]
 s_waitcnt vmcnt(8)
 s_waitcnt lgkmcnt(0)
 v_mfma_f32_16x16x32_bf16 v[128:131], a[48:51], a[96:99], v[128:131]
 v_mfma_f32_16x16x32_bf16 v[132:135], a[52:55], a[96:99], v[132:135]
 v_mfma_f32_16x16x32_bf16 v[136:139], a[56:59], a[96:99], v[136:139]
 v_mfma_f32_16x16x32_bf16 v[140:143], a[60:63], a[96:99], v[140:143]
 v_mfma_f32_16x16x32_bf16 v[144:147], a[48:51], a[100:103], v[144:147]
 ds_read_b128 a[64:67], v1 offset:12288
 v_mfma_f32_16x16x32_bf16 v[148:151], a[52:55], a[100:103], v[148:151]
 ds_read_b128 a[68:71], v1 offset:26624
 v_mfma_f32_16x16x32_bf16 v[152:155], a[56:59], a[100:103], v[152:155]
 ds_read_b128 a[72:75], v1 offset:40960
 v_mfma_f32_16x16x32_bf16 v[156:159], a[60:63], a[100:103], v[156:159]
 ds_read_b128 a[76:79], v1 offset:55296
 v_mfma_f32_16x16x32_bf16 v[160:163], a[48:51], a[104:107], v[160:163]
 ds_read_b128 a[80:83], v12 offset:12288
 v_mfma_f32_16x16x32_bf16 v[164:167], a[52:55], a[104:107], v[164:167]
 ds_read_b128 a[84:87], v12 offset:26624
 v_mfma_f32_16x16x32_bf16 v[168:171], a[56:59], a[104:107], v[168:171]
 ds_read_b128 a[88:91], v12 offset:40960
 v_mfma_f32_16x16x32_bf16 v[172:175], a[60:63], a[104:107], v[172:175]
 ds_read_b128 a[92:95], v12 offset:55296
 v_mfma_f32_16x16x32_bf16 v[176:179], a[48:51], a[108:111], v[176:179]
 v_mfma_f32_16x16x32_bf16 v[180:183], a[52:55], a[108:111], v[180:183]
 v_mfma_f32_16x16x32_bf16 v[184:187], a[56:59], a[108:111], v[184:187]
 v_mfma_f32_16x16x32_bf16 v[188:191], a[60:63], a[108:111], v[188:191]
 v_mfma_f32_16x16x32_bf16 v[192:195], a[48:51], a[112:115], v[192:195]
 v_mfma_f32_16x16x32_bf16 v[196:199], a[52:55], a[112:115], v[196:199]
 v_mfma_f32_16x16x32_bf16 v[200:203], a[56:59], a[112:115], v[200:203]
 v_mfma_f32_16x16x32_bf16 v[204:207], a[60:63], a[112:115], v[204:207]
 v_mfma_f32_16x16x32_bf16 v[208:211], a[48:51], a[116:119], v[208:211]
 v_mfma_f32_16x16x32_bf16 v[212:215], a[52:55], a[116:119], v[212:215]
 v_mfma_f32_16x16x32_bf16 v[216:219], a[56:59], a[116:119], v[216:219]
 v_mfma_f32_16x16x32_bf16 v[220:223], a[60:63], a[116:119], v[220:223]
 v_mfma_f32_16x16x32_bf16 v[224:227], a[48:51], a[120:123], v[224:227]
 v_mfma_f32_16x16x32_bf16 v[228:231], a[52:55], a[120:123], v[228:231]
 v_mfma_f32_16x16x32_bf16 v[232:235], a[56:59], a[120:123], v[232:235]
 v_mfma_f32_16x16x32_bf16 v[236:239], a[60:63], a[120:123], v[236:239]
 v_mfma_f32_16x16x32_bf16 v[240:243], a[48:51], a[124:127], v[240:243]
 v_mfma_f32_16x16x32_bf16 v[244:247], a[52:55], a[124:127], v[244:247]
 v_mfma_f32_16x16x32_bf16 v[248:251], a[56:59], a[124:127], v[248:251]
 v_mfma_f32_16x16x32_bf16 v[252:255], a[60:63], a[124:127], v[252:255]
 s_waitcnt vmcnt(4)
 s_waitcnt lgkmcnt(0)
 v_mfma_f32_16x16x32_bf16 v[128:131], a[0:3], a[64:67], v[128:131]
 v_mfma_f32_16x16x32_bf16 v[132:135], a[4:7], a[64:67], v[132:135]
 v_mfma_f32_16x16x32_bf16 v[136:139], a[8:11], a[64:67], v[136:139]
 v_mfma_f32_16x16x32_bf16 v[140:143], a[12:15], a[64:67], v[140:143]
 v_mfma_f32_16x16x32_bf16 v[144:147], a[0:3], a[68:71], v[144:147]
 ds_read_b128 a[96:99], v1 offset:13312
 v_mfma_f32_16x16x32_bf16 v[148:151], a[4:7], a[68:71], v[148:151]
 ds_read_b128 a[100:103], v1 offset:27648
 v_mfma_f32_16x16x32_bf16 v[152:155], a[8:11], a[68:71], v[152:155]
 ds_read_b128 a[104:107], v1 offset:41984
 v_mfma_f32_16x16x32_bf16 v[156:159], a[12:15], a[68:71], v[156:159]
 ds_read_b128 a[108:111], v1 offset:56320
 v_mfma_f32_16x16x32_bf16 v[160:163], a[0:3], a[72:75], v[160:163]
 ds_read_b128 a[112:115], v12 offset:13312
 v_mfma_f32_16x16x32_bf16 v[164:167], a[4:7], a[72:75], v[164:167]
 ds_read_b128 a[116:119], v12 offset:27648
 v_mfma_f32_16x16x32_bf16 v[168:171], a[8:11], a[72:75], v[168:171]
 ds_read_b128 a[120:123], v12 offset:41984
 v_mfma_f32_16x16x32_bf16 v[172:175], a[12:15], a[72:75], v[172:175]
 ds_read_b128 a[124:127], v12 offset:56320
 v_mfma_f32_16x16x32_bf16 v[176:179], a[0:3], a[76:79], v[176:179]
 v_mfma_f32_16x16x32_bf16 v[180:183], a[4:7], a[76:79], v[180:183]
 v_mfma_f32_16x16x32_bf16 v[184:187], a[8:11], a[76:79], v[184:187]
 v_mfma_f32_16x16x32_bf16 v[188:191], a[12:15], a[76:79], v[188:191]
 v_mfma_f32_16x16x32_bf16 v[192:195], a[0:3], a[80:83], v[192:195]
 v_mfma_f32_16x16x32_bf16 v[196:199], a[4:7], a[80:83], v[196:199]
 v_mfma_f32_16x16x32_bf16 v[200:203], a[8:11], a[80:83], v[200:203]
 v_mfma_f32_16x16x32_bf16 v[204:207], a[12:15], a[80:83], v[204:207]
 v_mfma_f32_16x16x32_bf16 v[208:211], a[0:3], a[84:87], v[208:211]
 v_mfma_f32_16x16x32_bf16 v[212:215], a[4:7], a[84:87], v[212:215]
 v_mfma_f32_16x16x32_bf16 v[216:219], a[8:11], a[84:87], v[216:219]
 v_mfma_f32_16x16x32_bf16 v[220:223], a[12:15], a[84:87], v[220:223]
 v_mfma_f32_16x16x32_bf16 v[224:227], a[0:3], a[88:91], v[224:227]
 v_mfma_f32_16x16x32_bf16 v[228:231], a[4:7], a[88:91], v[228:231]
 v_mfma_f32_16x16x32_bf16 v[232:235], a[8:11], a[88:91], v[232:235]
 v_mfma_f32_16x16x32_bf16 v[236:239], a[12:15], a[88:91], v[236:239]
 v_mfma_f32_16x16x32_bf16 v[240:243], a[0:3], a[92:95], v[240:243]
 v_mfma_f32_16x16x32_bf16 v[244:247], a[4:7], a[92:95], v[244:247]
 v_mfma_f32_16x16x32_bf16 v[248:251], a[8:11], a[92:95], v[248:251]
 v_mfma_f32_16x16x32_bf16 v[252:255], a[12:15], a[92:95], v[252:255]
 s_waitcnt vmcnt(0)
 s_waitcnt lgkmcnt(0)
 v_mfma_f32_16x16x32_bf16 v[128:131], a[16:19], a[96:99], v[128:131]
 v_mfma_f32_16x16x32_bf16 v[132:135], a[20:23], a[96:99], v[132:135]
 v_mfma_f32_16x16x32_bf16 v[136:139], a[24:27], a[96:99], v[136:139]
 v_mfma_f32_16x16x32_bf16 v[140:143], a[28:31], a[96:99], v[140:143]
 v_mfma_f32_16x16x32_bf16 v[144:147], a[16:19], a[100:103], v[144:147]
 v_mfma_f32_16x16x32_bf16 v[148:151], a[20:23], a[100:103], v[148:151]
 v_mfma_f32_16x16x32_bf16 v[152:155], a[24:27], a[100:103], v[152:155]
 v_mfma_f32_16x16x32_bf16 v[156:159], a[28:31], a[100:103], v[156:159]
 v_mfma_f32_16x16x32_bf16 v[160:163], a[16:19], a[104:107], v[160:163]
 v_mfma_f32_16x16x32_bf16 v[164:167], a[20:23], a[104:107], v[164:167]
 v_mfma_f32_16x16x32_bf16 v[168:171], a[24:27], a[104:107], v[168:171]
 v_mfma_f32_16x16x32_bf16 v[172:175], a[28:31], a[104:107], v[172:175]
 v_mfma_f32_16x16x32_bf16 v[176:179], a[16:19], a[108:111], v[176:179]
 v_mfma_f32_16x16x32_bf16 v[180:183], a[20:23], a[108:111], v[180:183]
 v_mfma_f32_16x16x32_bf16 v[184:187], a[24:27], a[108:111], v[184:187]
 v_mfma_f32_16x16x32_bf16 v[188:191], a[28:31], a[108:111], v[188:191]
 v_mfma_f32_16x16x32_bf16 v[192:195], a[16:19], a[112:115], v[192:195]
 v_mfma_f32_16x16x32_bf16 v[196:199], a[20:23], a[112:115], v[196:199]
 v_mfma_f32_16x16x32_bf16 v[200:203], a[24:27], a[112:115], v[200:203]
 v_mfma_f32_16x16x32_bf16 v[204:207], a[28:31], a[112:115], v[204:207]
 v_mfma_f32_16x16x32_bf16 v[208:211], a[16:19], a[116:119], v[208:211]
 v_mfma_f32_16x16x32_bf16 v[212:215], a[20:23], a[116:119], v[212:215]
 v_mfma_f32_16x16x32_bf16 v[216:219], a[24:27], a[116:119], v[216:219]
 v_mfma_f32_16x16x32_bf16 v[220:223], a[28:31], a[116:119], v[220:223]
 v_mfma_f32_16x16x32_bf16 v[224:227], a[16:19], a[120:123], v[224:227]
 v_mfma_f32_16x16x32_bf16 v[228:231], a[20:23], a[120:123], v[228:231]
 v_mfma_f32_16x16x32_bf16 v[232:235], a[24:27], a[120:123], v[232:235]
 v_mfma_f32_16x16x32_bf16 v[236:239], a[28:31], a[120:123], v[236:239]
 v_mfma_f32_16x16x32_bf16 v[240:243], a[16:19], a[124:127], v[240:243]
 v_mfma_f32_16x16x32_bf16 v[244:247], a[20:23], a[124:127], v[244:247]
 v_mfma_f32_16x16x32_bf16 v[248:251], a[24:27], a[124:127], v[248:251]
 v_mfma_f32_16x16x32_bf16 v[252:255], a[28:31], a[124:127], v[252:255]
 s_nop 7
 s_mul_i32 s11, s21, 448
 s_add_u32 s11, s11, s23
 s_lshl_b32 s32, s11, 10
 v_max_f32 v128, 0, v128
 v_max_f32 v129, 0, v129
 v_max_f32 v130, 0, v130
 v_max_f32 v131, 0, v131
 v_max_f32 v132, 0, v132
 v_max_f32 v133, 0, v133
 v_max_f32 v134, 0, v134
 v_max_f32 v135, 0, v135
 v_pk_mul_f32 v[128:129], v[128:129], v[136:137]
 v_pk_mul_f32 v[130:131], v[130:131], v[138:139]
 v_pk_mul_f32 v[132:133], v[132:133], v[140:141]
 v_pk_mul_f32 v[134:135], v[134:135], v[142:143]
 v_cvt_pk_bf16_f32 v16, v128, v129
 v_cvt_pk_bf16_f32 v17, v132, v133
 v_cvt_pk_bf16_f32 v18, v130, v131
 v_cvt_pk_bf16_f32 v19, v134, v135
 s_add_u32 s11, s32, 93323264
 buffer_store_dwordx4 v[16:19], v1, s[4:7], s11 offen sc1
 v_max_f32 v144, 0, v144
 v_max_f32 v145, 0, v145
 v_max_f32 v146, 0, v146
 v_max_f32 v147, 0, v147
 v_max_f32 v148, 0, v148
 v_max_f32 v149, 0, v149
 v_max_f32 v150, 0, v150
 v_max_f32 v151, 0, v151
 v_pk_mul_f32 v[144:145], v[144:145], v[152:153]
 v_pk_mul_f32 v[146:147], v[146:147], v[154:155]
 v_pk_mul_f32 v[148:149], v[148:149], v[156:157]
 v_pk_mul_f32 v[150:151], v[150:151], v[158:159]
 v_cvt_pk_bf16_f32 v20, v144, v145
 v_cvt_pk_bf16_f32 v21, v148, v149
 v_cvt_pk_bf16_f32 v22, v146, v147
 v_cvt_pk_bf16_f32 v23, v150, v151
 s_add_u32 s11, s32, 93380608
 buffer_store_dwordx4 v[20:23], v1, s[4:7], s11 offen sc1
 v_max_f32 v160, 0, v160
 v_max_f32 v161, 0, v161
 v_max_f32 v162, 0, v162
 v_max_f32 v163, 0, v163
 v_max_f32 v164, 0, v164
 v_max_f32 v165, 0, v165
 v_max_f32 v166, 0, v166
 v_max_f32 v167, 0, v167
 v_pk_mul_f32 v[160:161], v[160:161], v[168:169]
 v_pk_mul_f32 v[162:163], v[162:163], v[170:171]
 v_pk_mul_f32 v[164:165], v[164:165], v[172:173]
 v_pk_mul_f32 v[166:167], v[166:167], v[174:175]
 v_cvt_pk_bf16_f32 v24, v160, v161
 v_cvt_pk_bf16_f32 v25, v164, v165
 v_cvt_pk_bf16_f32 v26, v162, v163
 v_cvt_pk_bf16_f32 v27, v166, v167
 s_add_u32 s11, s32, 93437952
 buffer_store_dwordx4 v[24:27], v1, s[4:7], s11 offen sc1
 v_max_f32 v176, 0, v176
 v_max_f32 v177, 0, v177
 v_max_f32 v178, 0, v178
 v_max_f32 v179, 0, v179
 v_max_f32 v180, 0, v180
 v_max_f32 v181, 0, v181
 v_max_f32 v182, 0, v182
 v_max_f32 v183, 0, v183
 v_pk_mul_f32 v[176:177], v[176:177], v[184:185]
 v_pk_mul_f32 v[178:179], v[178:179], v[186:187]
 v_pk_mul_f32 v[180:181], v[180:181], v[188:189]
 v_pk_mul_f32 v[182:183], v[182:183], v[190:191]
 v_cvt_pk_bf16_f32 v28, v176, v177
 v_cvt_pk_bf16_f32 v29, v180, v181
 v_cvt_pk_bf16_f32 v30, v178, v179
 v_cvt_pk_bf16_f32 v31, v182, v183
 s_add_u32 s11, s32, 93495296
 buffer_store_dwordx4 v[28:31], v1, s[4:7], s11 offen sc1
 v_max_f32 v192, 0, v192
 v_max_f32 v193, 0, v193
 v_max_f32 v194, 0, v194
 v_max_f32 v195, 0, v195
 v_max_f32 v196, 0, v196
 v_max_f32 v197, 0, v197
 v_max_f32 v198, 0, v198
 v_max_f32 v199, 0, v199
 v_pk_mul_f32 v[192:193], v[192:193], v[200:201]
 v_pk_mul_f32 v[194:195], v[194:195], v[202:203]
 v_pk_mul_f32 v[196:197], v[196:197], v[204:205]
 v_pk_mul_f32 v[198:199], v[198:199], v[206:207]
 v_cvt_pk_bf16_f32 v16, v192, v193
 v_cvt_pk_bf16_f32 v17, v196, v197
 v_cvt_pk_bf16_f32 v18, v194, v195
 v_cvt_pk_bf16_f32 v19, v198, v199
 s_add_u32 s11, s32, 93552640
 buffer_store_dwordx4 v[16:19], v1, s[4:7], s11 offen sc1
 v_max_f32 v208, 0, v208
 v_max_f32 v209, 0, v209
 v_max_f32 v210, 0, v210
 v_max_f32 v211, 0, v211
 v_max_f32 v212, 0, v212
 v_max_f32 v213, 0, v213
 v_max_f32 v214, 0, v214
 v_max_f32 v215, 0, v215
 v_pk_mul_f32 v[208:209], v[208:209], v[216:217]
 v_pk_mul_f32 v[210:211], v[210:211], v[218:219]
 v_pk_mul_f32 v[212:213], v[212:213], v[220:221]
 v_pk_mul_f32 v[214:215], v[214:215], v[222:223]
 v_cvt_pk_bf16_f32 v20, v208, v209
 v_cvt_pk_bf16_f32 v21, v212, v213
 v_cvt_pk_bf16_f32 v22, v210, v211
 v_cvt_pk_bf16_f32 v23, v214, v215
 s_add_u32 s11, s32, 93609984
 buffer_store_dwordx4 v[20:23], v1, s[4:7], s11 offen sc1
 v_max_f32 v224, 0, v224
 v_max_f32 v225, 0, v225
 v_max_f32 v226, 0, v226
 v_max_f32 v227, 0, v227
 v_max_f32 v228, 0, v228
 v_max_f32 v229, 0, v229
 v_max_f32 v230, 0, v230
 v_max_f32 v231, 0, v231
 v_pk_mul_f32 v[224:225], v[224:225], v[232:233]
 v_pk_mul_f32 v[226:227], v[226:227], v[234:235]
 v_pk_mul_f32 v[228:229], v[228:229], v[236:237]
 v_pk_mul_f32 v[230:231], v[230:231], v[238:239]
 v_cvt_pk_bf16_f32 v24, v224, v225
 v_cvt_pk_bf16_f32 v25, v228, v229
 v_cvt_pk_bf16_f32 v26, v226, v227
 v_cvt_pk_bf16_f32 v27, v230, v231
 s_add_u32 s11, s32, 93667328
 buffer_store_dwordx4 v[24:27], v1, s[4:7], s11 offen sc1
 v_max_f32 v240, 0, v240
 v_max_f32 v241, 0, v241
 v_max_f32 v242, 0, v242
 v_max_f32 v243, 0, v243
 v_max_f32 v244, 0, v244
 v_max_f32 v245, 0, v245
 v_max_f32 v246, 0, v246
 v_max_f32 v247, 0, v247
 v_pk_mul_f32 v[240:241], v[240:241], v[248:249]
 v_pk_mul_f32 v[242:243], v[242:243], v[250:251]
 v_pk_mul_f32 v[244:245], v[244:245], v[252:253]
 v_pk_mul_f32 v[246:247], v[246:247], v[254:255]
 v_cvt_pk_bf16_f32 v28, v240, v241
 v_cvt_pk_bf16_f32 v29, v244, v245
 v_cvt_pk_bf16_f32 v30, v242, v243
 v_cvt_pk_bf16_f32 v31, v246, v247
 s_add_u32 s11, s32, 93724672
 buffer_store_dwordx4 v[28:31], v1, s[4:7], s11 offen sc1
 s_waitcnt vmcnt(0)
 s_barrier
 s_lshl_b32 s33, s21, 7
 s_add_u32 s33, s33, 18417664
 buffer_atomic_add v2, v3, s[4:7], s33 offen sc1
 s_branch K_loop
K_q2:
 s_cmp_lg_u32 s8, 0
 s_cbranch_scc1 K_at_74
 s_mov_b64 exec, 1
 v_mov_b32 v5, 16
 v_mov_b32 v8, 1
 buffer_atomic_add v8, v5, s[80:83], 0 offen sc0 sc1
 s_waitcnt vmcnt(0)
 s_mov_b64 exec, -1
K_at_74:
 s_cmp_lg_u32 s8, 0
 s_cbranch_scc1 K_bc_75
 v_lshlrev_b32 v5, 2, v0
 v_add_u32 v5, 163776, v5
 s_mov_b64 exec, 1
 ds_write_b32 v5, v8
 s_waitcnt lgkmcnt(0)
 s_mov_b64 exec, -1
K_bc_75:
 s_barrier
 v_and_b32 v5, 7, v0
 v_lshlrev_b32 v5, 2, v5
 v_add_u32 v5, 163776, v5
 ds_read_b32 v6, v5
 v_mov_b32 v5, 163808
 ds_read_b32 v7, v5
 s_waitcnt lgkmcnt(0)
 v_cmp_ne_u32 vcc, 0, v7
 s_cbranch_vccnz K_done
 s_barrier
 v_readfirstlane_b32 s92, v6
 s_cmp_ge_u32 s92, 544
 s_cbranch_scc1 K_done
 s_cmp_ge_u32 s92, 32
 s_cbranch_scc1 K_fin
 s_mov_b32 s20, s92
 s_lshr_b32 s11, s20, 1
 s_lshl_b32 s11, s11, 7
 s_add_u32 s21, s11, 18417664
 s_cmp_lg_u32 s8, 0
 s_cbranch_scc1 L_wch_76_ok
 s_mov_b32 s19, 0
 v_mov_b32 v5, 0
 s_mov_b64 exec, 1
L_wch_76:
 buffer_load_dword v6, v5, s[4:7], s21 offen sc1
 s_waitcnt vmcnt(0)
 v_readfirstlane_b32 s11, v6
 s_cmp_ge_u32 s11, 14
 s_cbranch_scc1 L_wch_76_got
 s_sleep 12
 s_add_u32 s19, s19, 1
 s_cmp_le_u32 s19, 8192
 s_cbranch_scc1 L_wch_76
 s_branch K_failw
L_wch_76_got:
 s_mov_b64 exec, -1
L_wch_76_ok:
 s_barrier
 s_mul_i32 s11, s8, 401408
 s_add_u32 s24, s11, 109051904
 s_add_u32 s25, s11, 109109248
 s_add_u32 s26, s11, 109166592
 s_add_u32 s27, s11, 109223936
 s_add_u32 s28, s11, 109281280
 s_add_u32 s29, s11, 109338624
 s_add_u32 s30, s11, 109395968
 s_mul_i32 s11, s20, 229376
 s_add_u32 s32, s11, 93323264
 s_add_u32 s33, s11, 93380608
 s_add_u32 s34, s11, 93437952
 s_add_u32 s35, s11, 93495296
 v_mov_b32 v8, v1
 buffer_load_dwordx4 a[0:3], v8, s[4:7], s24 offen
 buffer_load_dwordx4 a[4:7], v8, s[4:7], s25 offen
 buffer_load_dwordx4 a[8:11], v8, s[4:7], s26 offen
 buffer_load_dwordx4 a[12:15], v8, s[4:7], s27 offen
 buffer_load_dwordx4 a[16:19], v8, s[4:7], s28 offen
 buffer_load_dwordx4 a[20:23], v8, s[4:7], s29 offen
 buffer_load_dwordx4 a[24:27], v8, s[4:7], s30 offen
 buffer_load_dwordx4 a[28:31], v8, s[4:7], s32 offen sc1
 buffer_load_dwordx4 a[32:35], v8, s[4:7], s33 offen sc1
 buffer_load_dwordx4 a[36:39], v8, s[4:7], s34 offen sc1
 buffer_load_dwordx4 a[40:43], v8, s[4:7], s35 offen sc1
 v_add_u32 v8, 1024, v8
 buffer_load_dwordx4 a[44:47], v8, s[4:7], s24 offen
 buffer_load_dwordx4 a[48:51], v8, s[4:7], s25 offen
 buffer_load_dwordx4 a[52:55], v8, s[4:7], s26 offen
 buffer_load_dwordx4 a[56:59], v8, s[4:7], s27 offen
 buffer_load_dwordx4 a[60:63], v8, s[4:7], s28 offen
 buffer_load_dwordx4 a[64:67], v8, s[4:7], s29 offen
 buffer_load_dwordx4 a[68:71], v8, s[4:7], s30 offen
 buffer_load_dwordx4 a[72:75], v8, s[4:7], s32 offen sc1
 buffer_load_dwordx4 a[76:79], v8, s[4:7], s33 offen sc1
 buffer_load_dwordx4 a[80:83], v8, s[4:7], s34 offen sc1
 buffer_load_dwordx4 a[84:87], v8, s[4:7], s35 offen sc1
 v_add_u32 v8, 1024, v8
 buffer_load_dwordx4 a[88:91], v8, s[4:7], s24 offen
 buffer_load_dwordx4 a[92:95], v8, s[4:7], s25 offen
 buffer_load_dwordx4 a[96:99], v8, s[4:7], s26 offen
 buffer_load_dwordx4 a[100:103], v8, s[4:7], s27 offen
 buffer_load_dwordx4 a[104:107], v8, s[4:7], s28 offen
 buffer_load_dwordx4 a[108:111], v8, s[4:7], s29 offen
 buffer_load_dwordx4 a[112:115], v8, s[4:7], s30 offen
 buffer_load_dwordx4 a[116:119], v8, s[4:7], s32 offen sc1
 buffer_load_dwordx4 a[120:123], v8, s[4:7], s33 offen sc1
 buffer_load_dwordx4 a[124:127], v8, s[4:7], s34 offen sc1
 buffer_load_dwordx4 a[128:131], v8, s[4:7], s35 offen sc1
 v_add_u32 v8, 1024, v8
 buffer_load_dwordx4 a[132:135], v8, s[4:7], s24 offen
 buffer_load_dwordx4 a[136:139], v8, s[4:7], s25 offen
 buffer_load_dwordx4 a[140:143], v8, s[4:7], s26 offen
 buffer_load_dwordx4 a[144:147], v8, s[4:7], s27 offen
 buffer_load_dwordx4 a[148:151], v8, s[4:7], s28 offen
 buffer_load_dwordx4 a[152:155], v8, s[4:7], s29 offen
 buffer_load_dwordx4 a[156:159], v8, s[4:7], s30 offen
 buffer_load_dwordx4 a[160:163], v8, s[4:7], s32 offen sc1
 buffer_load_dwordx4 a[164:167], v8, s[4:7], s33 offen sc1
 buffer_load_dwordx4 a[168:171], v8, s[4:7], s34 offen sc1
 buffer_load_dwordx4 a[172:175], v8, s[4:7], s35 offen sc1
 v_add_u32 v8, 1024, v8
 s_waitcnt vmcnt(33)
 v_mfma_f32_16x16x32_bf16 v[128:131], a[0:3], a[28:31], 0
 v_mfma_f32_16x16x32_bf16 v[132:135], a[4:7], a[28:31], 0
 v_mfma_f32_16x16x32_bf16 v[136:139], a[8:11], a[28:31], 0
 v_mfma_f32_16x16x32_bf16 v[140:143], a[12:15], a[28:31], 0
 v_mfma_f32_16x16x32_bf16 v[144:147], a[16:19], a[28:31], 0
 v_mfma_f32_16x16x32_bf16 v[148:151], a[20:23], a[28:31], 0
 v_mfma_f32_16x16x32_bf16 v[152:155], a[24:27], a[28:31], 0
 v_mfma_f32_16x16x32_bf16 v[156:159], a[0:3], a[32:35], 0
 v_mfma_f32_16x16x32_bf16 v[160:163], a[4:7], a[32:35], 0
 v_mfma_f32_16x16x32_bf16 v[164:167], a[8:11], a[32:35], 0
 v_mfma_f32_16x16x32_bf16 v[168:171], a[12:15], a[32:35], 0
 v_mfma_f32_16x16x32_bf16 v[172:175], a[16:19], a[32:35], 0
 v_mfma_f32_16x16x32_bf16 v[176:179], a[20:23], a[32:35], 0
 v_mfma_f32_16x16x32_bf16 v[180:183], a[24:27], a[32:35], 0
 v_mfma_f32_16x16x32_bf16 v[184:187], a[0:3], a[36:39], 0
 v_mfma_f32_16x16x32_bf16 v[188:191], a[4:7], a[36:39], 0
 v_mfma_f32_16x16x32_bf16 v[192:195], a[8:11], a[36:39], 0
 v_mfma_f32_16x16x32_bf16 v[196:199], a[12:15], a[36:39], 0
 v_mfma_f32_16x16x32_bf16 v[200:203], a[16:19], a[36:39], 0
 v_mfma_f32_16x16x32_bf16 v[204:207], a[20:23], a[36:39], 0
 v_mfma_f32_16x16x32_bf16 v[208:211], a[24:27], a[36:39], 0
 v_mfma_f32_16x16x32_bf16 v[212:215], a[0:3], a[40:43], 0
 v_mfma_f32_16x16x32_bf16 v[216:219], a[4:7], a[40:43], 0
 v_mfma_f32_16x16x32_bf16 v[220:223], a[8:11], a[40:43], 0
 v_mfma_f32_16x16x32_bf16 v[224:227], a[12:15], a[40:43], 0
 v_mfma_f32_16x16x32_bf16 v[228:231], a[16:19], a[40:43], 0
 v_mfma_f32_16x16x32_bf16 v[232:235], a[20:23], a[40:43], 0
 v_mfma_f32_16x16x32_bf16 v[236:239], a[24:27], a[40:43], 0
 s_mov_b32 s36, 0
L_fb_77:
 buffer_load_dwordx4 a[0:3], v8, s[4:7], s24 offen
 buffer_load_dwordx4 a[4:7], v8, s[4:7], s25 offen
 buffer_load_dwordx4 a[8:11], v8, s[4:7], s26 offen
 buffer_load_dwordx4 a[12:15], v8, s[4:7], s27 offen
 buffer_load_dwordx4 a[16:19], v8, s[4:7], s28 offen
 buffer_load_dwordx4 a[20:23], v8, s[4:7], s29 offen
 buffer_load_dwordx4 a[24:27], v8, s[4:7], s30 offen
 buffer_load_dwordx4 a[28:31], v8, s[4:7], s32 offen sc1
 buffer_load_dwordx4 a[32:35], v8, s[4:7], s33 offen sc1
 buffer_load_dwordx4 a[36:39], v8, s[4:7], s34 offen sc1
 buffer_load_dwordx4 a[40:43], v8, s[4:7], s35 offen sc1
 v_add_u32 v8, 1024, v8
 s_waitcnt vmcnt(33)
 v_mfma_f32_16x16x32_bf16 v[128:131], a[44:47], a[72:75], v[128:131]
 v_mfma_f32_16x16x32_bf16 v[132:135], a[48:51], a[72:75], v[132:135]
 v_mfma_f32_16x16x32_bf16 v[136:139], a[52:55], a[72:75], v[136:139]
 v_mfma_f32_16x16x32_bf16 v[140:143], a[56:59], a[72:75], v[140:143]
 v_mfma_f32_16x16x32_bf16 v[144:147], a[60:63], a[72:75], v[144:147]
 v_mfma_f32_16x16x32_bf16 v[148:151], a[64:67], a[72:75], v[148:151]
 v_mfma_f32_16x16x32_bf16 v[152:155], a[68:71], a[72:75], v[152:155]
 v_mfma_f32_16x16x32_bf16 v[156:159], a[44:47], a[76:79], v[156:159]
 v_mfma_f32_16x16x32_bf16 v[160:163], a[48:51], a[76:79], v[160:163]
 v_mfma_f32_16x16x32_bf16 v[164:167], a[52:55], a[76:79], v[164:167]
 v_mfma_f32_16x16x32_bf16 v[168:171], a[56:59], a[76:79], v[168:171]
 v_mfma_f32_16x16x32_bf16 v[172:175], a[60:63], a[76:79], v[172:175]
 v_mfma_f32_16x16x32_bf16 v[176:179], a[64:67], a[76:79], v[176:179]
 v_mfma_f32_16x16x32_bf16 v[180:183], a[68:71], a[76:79], v[180:183]
 v_mfma_f32_16x16x32_bf16 v[184:187], a[44:47], a[80:83], v[184:187]
 v_mfma_f32_16x16x32_bf16 v[188:191], a[48:51], a[80:83], v[188:191]
 v_mfma_f32_16x16x32_bf16 v[192:195], a[52:55], a[80:83], v[192:195]
 v_mfma_f32_16x16x32_bf16 v[196:199], a[56:59], a[80:83], v[196:199]
 v_mfma_f32_16x16x32_bf16 v[200:203], a[60:63], a[80:83], v[200:203]
 v_mfma_f32_16x16x32_bf16 v[204:207], a[64:67], a[80:83], v[204:207]
 v_mfma_f32_16x16x32_bf16 v[208:211], a[68:71], a[80:83], v[208:211]
 v_mfma_f32_16x16x32_bf16 v[212:215], a[44:47], a[84:87], v[212:215]
 v_mfma_f32_16x16x32_bf16 v[216:219], a[48:51], a[84:87], v[216:219]
 v_mfma_f32_16x16x32_bf16 v[220:223], a[52:55], a[84:87], v[220:223]
 v_mfma_f32_16x16x32_bf16 v[224:227], a[56:59], a[84:87], v[224:227]
 v_mfma_f32_16x16x32_bf16 v[228:231], a[60:63], a[84:87], v[228:231]
 v_mfma_f32_16x16x32_bf16 v[232:235], a[64:67], a[84:87], v[232:235]
 v_mfma_f32_16x16x32_bf16 v[236:239], a[68:71], a[84:87], v[236:239]
 buffer_load_dwordx4 a[44:47], v8, s[4:7], s24 offen
 buffer_load_dwordx4 a[48:51], v8, s[4:7], s25 offen
 buffer_load_dwordx4 a[52:55], v8, s[4:7], s26 offen
 buffer_load_dwordx4 a[56:59], v8, s[4:7], s27 offen
 buffer_load_dwordx4 a[60:63], v8, s[4:7], s28 offen
 buffer_load_dwordx4 a[64:67], v8, s[4:7], s29 offen
 buffer_load_dwordx4 a[68:71], v8, s[4:7], s30 offen
 buffer_load_dwordx4 a[72:75], v8, s[4:7], s32 offen sc1
 buffer_load_dwordx4 a[76:79], v8, s[4:7], s33 offen sc1
 buffer_load_dwordx4 a[80:83], v8, s[4:7], s34 offen sc1
 buffer_load_dwordx4 a[84:87], v8, s[4:7], s35 offen sc1
 v_add_u32 v8, 1024, v8
 s_waitcnt vmcnt(33)
 v_mfma_f32_16x16x32_bf16 v[128:131], a[88:91], a[116:119], v[128:131]
 v_mfma_f32_16x16x32_bf16 v[132:135], a[92:95], a[116:119], v[132:135]
 v_mfma_f32_16x16x32_bf16 v[136:139], a[96:99], a[116:119], v[136:139]
 v_mfma_f32_16x16x32_bf16 v[140:143], a[100:103], a[116:119], v[140:143]
 v_mfma_f32_16x16x32_bf16 v[144:147], a[104:107], a[116:119], v[144:147]
 v_mfma_f32_16x16x32_bf16 v[148:151], a[108:111], a[116:119], v[148:151]
 v_mfma_f32_16x16x32_bf16 v[152:155], a[112:115], a[116:119], v[152:155]
 v_mfma_f32_16x16x32_bf16 v[156:159], a[88:91], a[120:123], v[156:159]
 v_mfma_f32_16x16x32_bf16 v[160:163], a[92:95], a[120:123], v[160:163]
 v_mfma_f32_16x16x32_bf16 v[164:167], a[96:99], a[120:123], v[164:167]
 v_mfma_f32_16x16x32_bf16 v[168:171], a[100:103], a[120:123], v[168:171]
 v_mfma_f32_16x16x32_bf16 v[172:175], a[104:107], a[120:123], v[172:175]
 v_mfma_f32_16x16x32_bf16 v[176:179], a[108:111], a[120:123], v[176:179]
 v_mfma_f32_16x16x32_bf16 v[180:183], a[112:115], a[120:123], v[180:183]
 v_mfma_f32_16x16x32_bf16 v[184:187], a[88:91], a[124:127], v[184:187]
 v_mfma_f32_16x16x32_bf16 v[188:191], a[92:95], a[124:127], v[188:191]
 v_mfma_f32_16x16x32_bf16 v[192:195], a[96:99], a[124:127], v[192:195]
 v_mfma_f32_16x16x32_bf16 v[196:199], a[100:103], a[124:127], v[196:199]
 v_mfma_f32_16x16x32_bf16 v[200:203], a[104:107], a[124:127], v[200:203]
 v_mfma_f32_16x16x32_bf16 v[204:207], a[108:111], a[124:127], v[204:207]
 v_mfma_f32_16x16x32_bf16 v[208:211], a[112:115], a[124:127], v[208:211]
 v_mfma_f32_16x16x32_bf16 v[212:215], a[88:91], a[128:131], v[212:215]
 v_mfma_f32_16x16x32_bf16 v[216:219], a[92:95], a[128:131], v[216:219]
 v_mfma_f32_16x16x32_bf16 v[220:223], a[96:99], a[128:131], v[220:223]
 v_mfma_f32_16x16x32_bf16 v[224:227], a[100:103], a[128:131], v[224:227]
 v_mfma_f32_16x16x32_bf16 v[228:231], a[104:107], a[128:131], v[228:231]
 v_mfma_f32_16x16x32_bf16 v[232:235], a[108:111], a[128:131], v[232:235]
 v_mfma_f32_16x16x32_bf16 v[236:239], a[112:115], a[128:131], v[236:239]
 buffer_load_dwordx4 a[88:91], v8, s[4:7], s24 offen
 buffer_load_dwordx4 a[92:95], v8, s[4:7], s25 offen
 buffer_load_dwordx4 a[96:99], v8, s[4:7], s26 offen
 buffer_load_dwordx4 a[100:103], v8, s[4:7], s27 offen
 buffer_load_dwordx4 a[104:107], v8, s[4:7], s28 offen
 buffer_load_dwordx4 a[108:111], v8, s[4:7], s29 offen
 buffer_load_dwordx4 a[112:115], v8, s[4:7], s30 offen
 buffer_load_dwordx4 a[116:119], v8, s[4:7], s32 offen sc1
 buffer_load_dwordx4 a[120:123], v8, s[4:7], s33 offen sc1
 buffer_load_dwordx4 a[124:127], v8, s[4:7], s34 offen sc1
 buffer_load_dwordx4 a[128:131], v8, s[4:7], s35 offen sc1
 v_add_u32 v8, 1024, v8
 s_waitcnt vmcnt(33)
 v_mfma_f32_16x16x32_bf16 v[128:131], a[132:135], a[160:163], v[128:131]
 v_mfma_f32_16x16x32_bf16 v[132:135], a[136:139], a[160:163], v[132:135]
 v_mfma_f32_16x16x32_bf16 v[136:139], a[140:143], a[160:163], v[136:139]
 v_mfma_f32_16x16x32_bf16 v[140:143], a[144:147], a[160:163], v[140:143]
 v_mfma_f32_16x16x32_bf16 v[144:147], a[148:151], a[160:163], v[144:147]
 v_mfma_f32_16x16x32_bf16 v[148:151], a[152:155], a[160:163], v[148:151]
 v_mfma_f32_16x16x32_bf16 v[152:155], a[156:159], a[160:163], v[152:155]
 v_mfma_f32_16x16x32_bf16 v[156:159], a[132:135], a[164:167], v[156:159]
 v_mfma_f32_16x16x32_bf16 v[160:163], a[136:139], a[164:167], v[160:163]
 v_mfma_f32_16x16x32_bf16 v[164:167], a[140:143], a[164:167], v[164:167]
 v_mfma_f32_16x16x32_bf16 v[168:171], a[144:147], a[164:167], v[168:171]
 v_mfma_f32_16x16x32_bf16 v[172:175], a[148:151], a[164:167], v[172:175]
 v_mfma_f32_16x16x32_bf16 v[176:179], a[152:155], a[164:167], v[176:179]
 v_mfma_f32_16x16x32_bf16 v[180:183], a[156:159], a[164:167], v[180:183]
 v_mfma_f32_16x16x32_bf16 v[184:187], a[132:135], a[168:171], v[184:187]
 v_mfma_f32_16x16x32_bf16 v[188:191], a[136:139], a[168:171], v[188:191]
 v_mfma_f32_16x16x32_bf16 v[192:195], a[140:143], a[168:171], v[192:195]
 v_mfma_f32_16x16x32_bf16 v[196:199], a[144:147], a[168:171], v[196:199]
 v_mfma_f32_16x16x32_bf16 v[200:203], a[148:151], a[168:171], v[200:203]
 v_mfma_f32_16x16x32_bf16 v[204:207], a[152:155], a[168:171], v[204:207]
 v_mfma_f32_16x16x32_bf16 v[208:211], a[156:159], a[168:171], v[208:211]
 v_mfma_f32_16x16x32_bf16 v[212:215], a[132:135], a[172:175], v[212:215]
 v_mfma_f32_16x16x32_bf16 v[216:219], a[136:139], a[172:175], v[216:219]
 v_mfma_f32_16x16x32_bf16 v[220:223], a[140:143], a[172:175], v[220:223]
 v_mfma_f32_16x16x32_bf16 v[224:227], a[144:147], a[172:175], v[224:227]
 v_mfma_f32_16x16x32_bf16 v[228:231], a[148:151], a[172:175], v[228:231]
 v_mfma_f32_16x16x32_bf16 v[232:235], a[152:155], a[172:175], v[232:235]
 v_mfma_f32_16x16x32_bf16 v[236:239], a[156:159], a[172:175], v[236:239]
 buffer_load_dwordx4 a[132:135], v8, s[4:7], s24 offen
 buffer_load_dwordx4 a[136:139], v8, s[4:7], s25 offen
 buffer_load_dwordx4 a[140:143], v8, s[4:7], s26 offen
 buffer_load_dwordx4 a[144:147], v8, s[4:7], s27 offen
 buffer_load_dwordx4 a[148:151], v8, s[4:7], s28 offen
 buffer_load_dwordx4 a[152:155], v8, s[4:7], s29 offen
 buffer_load_dwordx4 a[156:159], v8, s[4:7], s30 offen
 buffer_load_dwordx4 a[160:163], v8, s[4:7], s32 offen sc1
 buffer_load_dwordx4 a[164:167], v8, s[4:7], s33 offen sc1
 buffer_load_dwordx4 a[168:171], v8, s[4:7], s34 offen sc1
 buffer_load_dwordx4 a[172:175], v8, s[4:7], s35 offen sc1
 v_add_u32 v8, 1024, v8
 s_waitcnt vmcnt(33)
 v_mfma_f32_16x16x32_bf16 v[128:131], a[0:3], a[28:31], v[128:131]
 v_mfma_f32_16x16x32_bf16 v[132:135], a[4:7], a[28:31], v[132:135]
 v_mfma_f32_16x16x32_bf16 v[136:139], a[8:11], a[28:31], v[136:139]
 v_mfma_f32_16x16x32_bf16 v[140:143], a[12:15], a[28:31], v[140:143]
 v_mfma_f32_16x16x32_bf16 v[144:147], a[16:19], a[28:31], v[144:147]
 v_mfma_f32_16x16x32_bf16 v[148:151], a[20:23], a[28:31], v[148:151]
 v_mfma_f32_16x16x32_bf16 v[152:155], a[24:27], a[28:31], v[152:155]
 v_mfma_f32_16x16x32_bf16 v[156:159], a[0:3], a[32:35], v[156:159]
 v_mfma_f32_16x16x32_bf16 v[160:163], a[4:7], a[32:35], v[160:163]
 v_mfma_f32_16x16x32_bf16 v[164:167], a[8:11], a[32:35], v[164:167]
 v_mfma_f32_16x16x32_bf16 v[168:171], a[12:15], a[32:35], v[168:171]
 v_mfma_f32_16x16x32_bf16 v[172:175], a[16:19], a[32:35], v[172:175]
 v_mfma_f32_16x16x32_bf16 v[176:179], a[20:23], a[32:35], v[176:179]
 v_mfma_f32_16x16x32_bf16 v[180:183], a[24:27], a[32:35], v[180:183]
 v_mfma_f32_16x16x32_bf16 v[184:187], a[0:3], a[36:39], v[184:187]
 v_mfma_f32_16x16x32_bf16 v[188:191], a[4:7], a[36:39], v[188:191]
 v_mfma_f32_16x16x32_bf16 v[192:195], a[8:11], a[36:39], v[192:195]
 v_mfma_f32_16x16x32_bf16 v[196:199], a[12:15], a[36:39], v[196:199]
 v_mfma_f32_16x16x32_bf16 v[200:203], a[16:19], a[36:39], v[200:203]
 v_mfma_f32_16x16x32_bf16 v[204:207], a[20:23], a[36:39], v[204:207]
 v_mfma_f32_16x16x32_bf16 v[208:211], a[24:27], a[36:39], v[208:211]
 v_mfma_f32_16x16x32_bf16 v[212:215], a[0:3], a[40:43], v[212:215]
 v_mfma_f32_16x16x32_bf16 v[216:219], a[4:7], a[40:43], v[216:219]
 v_mfma_f32_16x16x32_bf16 v[220:223], a[8:11], a[40:43], v[220:223]
 v_mfma_f32_16x16x32_bf16 v[224:227], a[12:15], a[40:43], v[224:227]
 v_mfma_f32_16x16x32_bf16 v[228:231], a[16:19], a[40:43], v[228:231]
 v_mfma_f32_16x16x32_bf16 v[232:235], a[20:23], a[40:43], v[232:235]
 v_mfma_f32_16x16x32_bf16 v[236:239], a[24:27], a[40:43], v[236:239]
 s_add_u32 s36, s36, 1
 s_cmp_lt_u32 s36, 13
 s_cbranch_scc1 L_fb_77
 s_waitcnt vmcnt(22)
 v_mfma_f32_16x16x32_bf16 v[128:131], a[44:47], a[72:75], v[128:131]
 v_mfma_f32_16x16x32_bf16 v[132:135], a[48:51], a[72:75], v[132:135]
 v_mfma_f32_16x16x32_bf16 v[136:139], a[52:55], a[72:75], v[136:139]
 v_mfma_f32_16x16x32_bf16 v[140:143], a[56:59], a[72:75], v[140:143]
 v_mfma_f32_16x16x32_bf16 v[144:147], a[60:63], a[72:75], v[144:147]
 v_mfma_f32_16x16x32_bf16 v[148:151], a[64:67], a[72:75], v[148:151]
 v_mfma_f32_16x16x32_bf16 v[152:155], a[68:71], a[72:75], v[152:155]
 v_mfma_f32_16x16x32_bf16 v[156:159], a[44:47], a[76:79], v[156:159]
 v_mfma_f32_16x16x32_bf16 v[160:163], a[48:51], a[76:79], v[160:163]
 v_mfma_f32_16x16x32_bf16 v[164:167], a[52:55], a[76:79], v[164:167]
 v_mfma_f32_16x16x32_bf16 v[168:171], a[56:59], a[76:79], v[168:171]
 v_mfma_f32_16x16x32_bf16 v[172:175], a[60:63], a[76:79], v[172:175]
 v_mfma_f32_16x16x32_bf16 v[176:179], a[64:67], a[76:79], v[176:179]
 v_mfma_f32_16x16x32_bf16 v[180:183], a[68:71], a[76:79], v[180:183]
 v_mfma_f32_16x16x32_bf16 v[184:187], a[44:47], a[80:83], v[184:187]
 v_mfma_f32_16x16x32_bf16 v[188:191], a[48:51], a[80:83], v[188:191]
 v_mfma_f32_16x16x32_bf16 v[192:195], a[52:55], a[80:83], v[192:195]
 v_mfma_f32_16x16x32_bf16 v[196:199], a[56:59], a[80:83], v[196:199]
 v_mfma_f32_16x16x32_bf16 v[200:203], a[60:63], a[80:83], v[200:203]
 v_mfma_f32_16x16x32_bf16 v[204:207], a[64:67], a[80:83], v[204:207]
 v_mfma_f32_16x16x32_bf16 v[208:211], a[68:71], a[80:83], v[208:211]
 v_mfma_f32_16x16x32_bf16 v[212:215], a[44:47], a[84:87], v[212:215]
 v_mfma_f32_16x16x32_bf16 v[216:219], a[48:51], a[84:87], v[216:219]
 v_mfma_f32_16x16x32_bf16 v[220:223], a[52:55], a[84:87], v[220:223]
 v_mfma_f32_16x16x32_bf16 v[224:227], a[56:59], a[84:87], v[224:227]
 v_mfma_f32_16x16x32_bf16 v[228:231], a[60:63], a[84:87], v[228:231]
 v_mfma_f32_16x16x32_bf16 v[232:235], a[64:67], a[84:87], v[232:235]
 v_mfma_f32_16x16x32_bf16 v[236:239], a[68:71], a[84:87], v[236:239]
 s_waitcnt vmcnt(11)
 v_mfma_f32_16x16x32_bf16 v[128:131], a[88:91], a[116:119], v[128:131]
 v_mfma_f32_16x16x32_bf16 v[132:135], a[92:95], a[116:119], v[132:135]
 v_mfma_f32_16x16x32_bf16 v[136:139], a[96:99], a[116:119], v[136:139]
 v_mfma_f32_16x16x32_bf16 v[140:143], a[100:103], a[116:119], v[140:143]
 v_mfma_f32_16x16x32_bf16 v[144:147], a[104:107], a[116:119], v[144:147]
 v_mfma_f32_16x16x32_bf16 v[148:151], a[108:111], a[116:119], v[148:151]
 v_mfma_f32_16x16x32_bf16 v[152:155], a[112:115], a[116:119], v[152:155]
 v_mfma_f32_16x16x32_bf16 v[156:159], a[88:91], a[120:123], v[156:159]
 v_mfma_f32_16x16x32_bf16 v[160:163], a[92:95], a[120:123], v[160:163]
 v_mfma_f32_16x16x32_bf16 v[164:167], a[96:99], a[120:123], v[164:167]
 v_mfma_f32_16x16x32_bf16 v[168:171], a[100:103], a[120:123], v[168:171]
 v_mfma_f32_16x16x32_bf16 v[172:175], a[104:107], a[120:123], v[172:175]
 v_mfma_f32_16x16x32_bf16 v[176:179], a[108:111], a[120:123], v[176:179]
 v_mfma_f32_16x16x32_bf16 v[180:183], a[112:115], a[120:123], v[180:183]
 v_mfma_f32_16x16x32_bf16 v[184:187], a[88:91], a[124:127], v[184:187]
 v_mfma_f32_16x16x32_bf16 v[188:191], a[92:95], a[124:127], v[188:191]
 v_mfma_f32_16x16x32_bf16 v[192:195], a[96:99], a[124:127], v[192:195]
 v_mfma_f32_16x16x32_bf16 v[196:199], a[100:103], a[124:127], v[196:199]
 v_mfma_f32_16x16x32_bf16 v[200:203], a[104:107], a[124:127], v[200:203]
 v_mfma_f32_16x16x32_bf16 v[204:207], a[108:111], a[124:127], v[204:207]
 v_mfma_f32_16x16x32_bf16 v[208:211], a[112:115], a[124:127], v[208:211]
 v_mfma_f32_16x16x32_bf16 v[212:215], a[88:91], a[128:131], v[212:215]
 v_mfma_f32_16x16x32_bf16 v[216:219], a[92:95], a[128:131], v[216:219]
 v_mfma_f32_16x16x32_bf16 v[220:223], a[96:99], a[128:131], v[220:223]
 v_mfma_f32_16x16x32_bf16 v[224:227], a[100:103], a[128:131], v[224:227]
 v_mfma_f32_16x16x32_bf16 v[228:231], a[104:107], a[128:131], v[228:231]
 v_mfma_f32_16x16x32_bf16 v[232:235], a[108:111], a[128:131], v[232:235]
 v_mfma_f32_16x16x32_bf16 v[236:239], a[112:115], a[128:131], v[236:239]
 s_waitcnt vmcnt(0)
 v_mfma_f32_16x16x32_bf16 v[128:131], a[132:135], a[160:163], v[128:131]
 v_mfma_f32_16x16x32_bf16 v[132:135], a[136:139], a[160:163], v[132:135]
 v_mfma_f32_16x16x32_bf16 v[136:139], a[140:143], a[160:163], v[136:139]
 v_mfma_f32_16x16x32_bf16 v[140:143], a[144:147], a[160:163], v[140:143]
 v_mfma_f32_16x16x32_bf16 v[144:147], a[148:151], a[160:163], v[144:147]
 v_mfma_f32_16x16x32_bf16 v[148:151], a[152:155], a[160:163], v[148:151]
 v_mfma_f32_16x16x32_bf16 v[152:155], a[156:159], a[160:163], v[152:155]
 v_mfma_f32_16x16x32_bf16 v[156:159], a[132:135], a[164:167], v[156:159]
 v_mfma_f32_16x16x32_bf16 v[160:163], a[136:139], a[164:167], v[160:163]
 v_mfma_f32_16x16x32_bf16 v[164:167], a[140:143], a[164:167], v[164:167]
 v_mfma_f32_16x16x32_bf16 v[168:171], a[144:147], a[164:167], v[168:171]
 v_mfma_f32_16x16x32_bf16 v[172:175], a[148:151], a[164:167], v[172:175]
 v_mfma_f32_16x16x32_bf16 v[176:179], a[152:155], a[164:167], v[176:179]
 v_mfma_f32_16x16x32_bf16 v[180:183], a[156:159], a[164:167], v[180:183]
 v_mfma_f32_16x16x32_bf16 v[184:187], a[132:135], a[168:171], v[184:187]
 v_mfma_f32_16x16x32_bf16 v[188:191], a[136:139], a[168:171], v[188:191]
 v_mfma_f32_16x16x32_bf16 v[192:195], a[140:143], a[168:171], v[192:195]
 v_mfma_f32_16x16x32_bf16 v[196:199], a[144:147], a[168:171], v[196:199]
 v_mfma_f32_16x16x32_bf16 v[200:203], a[148:151], a[168:171], v[200:203]
 v_mfma_f32_16x16x32_bf16 v[204:207], a[152:155], a[168:171], v[204:207]
 v_mfma_f32_16x16x32_bf16 v[208:211], a[156:159], a[168:171], v[208:211]
 v_mfma_f32_16x16x32_bf16 v[212:215], a[132:135], a[172:175], v[212:215]
 v_mfma_f32_16x16x32_bf16 v[216:219], a[136:139], a[172:175], v[216:219]
 v_mfma_f32_16x16x32_bf16 v[220:223], a[140:143], a[172:175], v[220:223]
 v_mfma_f32_16x16x32_bf16 v[224:227], a[144:147], a[172:175], v[224:227]
 v_mfma_f32_16x16x32_bf16 v[228:231], a[148:151], a[172:175], v[228:231]
 v_mfma_f32_16x16x32_bf16 v[232:235], a[152:155], a[172:175], v[232:235]
 v_mfma_f32_16x16x32_bf16 v[236:239], a[156:159], a[172:175], v[236:239]
 s_nop 7
 s_mul_i32 s11, s20, 57344
 s_mul_i32 s12, s8, 3584
 s_add_u32 s37, s11, s12
 v_lshlrev_b32 v9, 3, v0
 v_mov_b32 v10, 0xbfb8aa3b
 v_mul_f32 v16, v10, v128
 v_mul_f32 v17, v10, v129
 v_mul_f32 v18, v10, v130
 v_mul_f32 v19, v10, v131
 v_exp_f32 v16, v16
 v_exp_f32 v17, v17
 v_exp_f32 v18, v18
 v_exp_f32 v19, v19
 s_nop 0
 v_add_f32 v16, 1.0, v16
 v_add_f32 v17, 1.0, v17
 v_add_f32 v18, 1.0, v18
 v_add_f32 v19, 1.0, v19
 v_rcp_f32 v16, v16
 v_rcp_f32 v17, v17
 v_rcp_f32 v18, v18
 v_rcp_f32 v19, v19
 s_nop 0
 v_mul_f32 v16, v16, v128
 v_mul_f32 v17, v17, v129
 v_mul_f32 v18, v18, v130
 v_mul_f32 v19, v19, v131
 v_cvt_pk_bf16_f32 v20, v16, v17
 v_cvt_pk_bf16_f32 v21, v18, v19
 s_add_u32 s11, s37, 100663296
 buffer_store_dwordx2 v[20:21], v9, s[4:7], s11 offen sc1
 v_mul_f32 v24, v10, v132
 v_mul_f32 v25, v10, v133
 v_mul_f32 v26, v10, v134
 v_mul_f32 v27, v10, v135
 v_exp_f32 v24, v24
 v_exp_f32 v25, v25
 v_exp_f32 v26, v26
 v_exp_f32 v27, v27
 s_nop 0
 v_add_f32 v24, 1.0, v24
 v_add_f32 v25, 1.0, v25
 v_add_f32 v26, 1.0, v26
 v_add_f32 v27, 1.0, v27
 v_rcp_f32 v24, v24
 v_rcp_f32 v25, v25
 v_rcp_f32 v26, v26
 v_rcp_f32 v27, v27
 s_nop 0
 v_mul_f32 v24, v24, v132
 v_mul_f32 v25, v25, v133
 v_mul_f32 v26, v26, v134
 v_mul_f32 v27, v27, v135
 v_cvt_pk_bf16_f32 v28, v24, v25
 v_cvt_pk_bf16_f32 v29, v26, v27
 s_add_u32 s11, s37, 100663808
 buffer_store_dwordx2 v[28:29], v9, s[4:7], s11 offen sc1
 v_mul_f32 v16, v10, v136
 v_mul_f32 v17, v10, v137
 v_mul_f32 v18, v10, v138
 v_mul_f32 v19, v10, v139
 v_exp_f32 v16, v16
 v_exp_f32 v17, v17
 v_exp_f32 v18, v18
 v_exp_f32 v19, v19
 s_nop 0
 v_add_f32 v16, 1.0, v16
 v_add_f32 v17, 1.0, v17
 v_add_f32 v18, 1.0, v18
 v_add_f32 v19, 1.0, v19
 v_rcp_f32 v16, v16
 v_rcp_f32 v17, v17
 v_rcp_f32 v18, v18
 v_rcp_f32 v19, v19
 s_nop 0
 v_mul_f32 v16, v16, v136
 v_mul_f32 v17, v17, v137
 v_mul_f32 v18, v18, v138
 v_mul_f32 v19, v19, v139
 v_cvt_pk_bf16_f32 v20, v16, v17
 v_cvt_pk_bf16_f32 v21, v18, v19
 s_add_u32 s11, s37, 100664320
 buffer_store_dwordx2 v[20:21], v9, s[4:7], s11 offen sc1
 v_mul_f32 v24, v10, v140
 v_mul_f32 v25, v10, v141
 v_mul_f32 v26, v10, v142
 v_mul_f32 v27, v10, v143
 v_exp_f32 v24, v24
 v_exp_f32 v25, v25
 v_exp_f32 v26, v26
 v_exp_f32 v27, v27
 s_nop 0
 v_add_f32 v24, 1.0, v24
 v_add_f32 v25, 1.0, v25
 v_add_f32 v26, 1.0, v26
 v_add_f32 v27, 1.0, v27
 v_rcp_f32 v24, v24
 v_rcp_f32 v25, v25
 v_rcp_f32 v26, v26
 v_rcp_f32 v27, v27
 s_nop 0
 v_mul_f32 v24, v24, v140
 v_mul_f32 v25, v25, v141
 v_mul_f32 v26, v26, v142
 v_mul_f32 v27, v27, v143
 v_cvt_pk_bf16_f32 v28, v24, v25
 v_cvt_pk_bf16_f32 v29, v26, v27
 s_add_u32 s11, s37, 100664832
 buffer_store_dwordx2 v[28:29], v9, s[4:7], s11 offen sc1
 v_mul_f32 v16, v10, v144
 v_mul_f32 v17, v10, v145
 v_mul_f32 v18, v10, v146
 v_mul_f32 v19, v10, v147
 v_exp_f32 v16, v16
 v_exp_f32 v17, v17
 v_exp_f32 v18, v18
 v_exp_f32 v19, v19
 s_nop 0
 v_add_f32 v16, 1.0, v16
 v_add_f32 v17, 1.0, v17
 v_add_f32 v18, 1.0, v18
 v_add_f32 v19, 1.0, v19
 v_rcp_f32 v16, v16
 v_rcp_f32 v17, v17
 v_rcp_f32 v18, v18
 v_rcp_f32 v19, v19
 s_nop 0
 v_mul_f32 v16, v16, v144
 v_mul_f32 v17, v17, v145
 v_mul_f32 v18, v18, v146
 v_mul_f32 v19, v19, v147
 v_cvt_pk_bf16_f32 v20, v16, v17
 v_cvt_pk_bf16_f32 v21, v18, v19
 s_add_u32 s11, s37, 100665344
 buffer_store_dwordx2 v[20:21], v9, s[4:7], s11 offen sc1
 v_mul_f32 v24, v10, v148
 v_mul_f32 v25, v10, v149
 v_mul_f32 v26, v10, v150
 v_mul_f32 v27, v10, v151
 v_exp_f32 v24, v24
 v_exp_f32 v25, v25
 v_exp_f32 v26, v26
 v_exp_f32 v27, v27
 s_nop 0
 v_add_f32 v24, 1.0, v24
 v_add_f32 v25, 1.0, v25
 v_add_f32 v26, 1.0, v26
 v_add_f32 v27, 1.0, v27
 v_rcp_f32 v24, v24
 v_rcp_f32 v25, v25
 v_rcp_f32 v26, v26
 v_rcp_f32 v27, v27
 s_nop 0
 v_mul_f32 v24, v24, v148
 v_mul_f32 v25, v25, v149
 v_mul_f32 v26, v26, v150
 v_mul_f32 v27, v27, v151
 v_cvt_pk_bf16_f32 v28, v24, v25
 v_cvt_pk_bf16_f32 v29, v26, v27
 s_add_u32 s11, s37, 100665856
 buffer_store_dwordx2 v[28:29], v9, s[4:7], s11 offen sc1
 v_mul_f32 v16, v10, v152
 v_mul_f32 v17, v10, v153
 v_mul_f32 v18, v10, v154
 v_mul_f32 v19, v10, v155
 v_exp_f32 v16, v16
 v_exp_f32 v17, v17
 v_exp_f32 v18, v18
 v_exp_f32 v19, v19
 s_nop 0
 v_add_f32 v16, 1.0, v16
 v_add_f32 v17, 1.0, v17
 v_add_f32 v18, 1.0, v18
 v_add_f32 v19, 1.0, v19
 v_rcp_f32 v16, v16
 v_rcp_f32 v17, v17
 v_rcp_f32 v18, v18
 v_rcp_f32 v19, v19
 s_nop 0
 v_mul_f32 v16, v16, v152
 v_mul_f32 v17, v17, v153
 v_mul_f32 v18, v18, v154
 v_mul_f32 v19, v19, v155
 v_cvt_pk_bf16_f32 v20, v16, v17
 v_cvt_pk_bf16_f32 v21, v18, v19
 s_add_u32 s11, s37, 100666368
 buffer_store_dwordx2 v[20:21], v9, s[4:7], s11 offen sc1
 v_mul_f32 v24, v10, v156
 v_mul_f32 v25, v10, v157
 v_mul_f32 v26, v10, v158
 v_mul_f32 v27, v10, v159
 v_exp_f32 v24, v24
 v_exp_f32 v25, v25
 v_exp_f32 v26, v26
 v_exp_f32 v27, v27
 s_nop 0
 v_add_f32 v24, 1.0, v24
 v_add_f32 v25, 1.0, v25
 v_add_f32 v26, 1.0, v26
 v_add_f32 v27, 1.0, v27
 v_rcp_f32 v24, v24
 v_rcp_f32 v25, v25
 v_rcp_f32 v26, v26
 v_rcp_f32 v27, v27
 s_nop 0
 v_mul_f32 v24, v24, v156
 v_mul_f32 v25, v25, v157
 v_mul_f32 v26, v26, v158
 v_mul_f32 v27, v27, v159
 v_cvt_pk_bf16_f32 v28, v24, v25
 v_cvt_pk_bf16_f32 v29, v26, v27
 s_add_u32 s11, s37, 100677632
 buffer_store_dwordx2 v[28:29], v9, s[4:7], s11 offen sc1
 v_mul_f32 v16, v10, v160
 v_mul_f32 v17, v10, v161
 v_mul_f32 v18, v10, v162
 v_mul_f32 v19, v10, v163
 v_exp_f32 v16, v16
 v_exp_f32 v17, v17
 v_exp_f32 v18, v18
 v_exp_f32 v19, v19
 s_nop 0
 v_add_f32 v16, 1.0, v16
 v_add_f32 v17, 1.0, v17
 v_add_f32 v18, 1.0, v18
 v_add_f32 v19, 1.0, v19
 v_rcp_f32 v16, v16
 v_rcp_f32 v17, v17
 v_rcp_f32 v18, v18
 v_rcp_f32 v19, v19
 s_nop 0
 v_mul_f32 v16, v16, v160
 v_mul_f32 v17, v17, v161
 v_mul_f32 v18, v18, v162
 v_mul_f32 v19, v19, v163
 v_cvt_pk_bf16_f32 v20, v16, v17
 v_cvt_pk_bf16_f32 v21, v18, v19
 s_add_u32 s11, s37, 100678144
 buffer_store_dwordx2 v[20:21], v9, s[4:7], s11 offen sc1
 v_mul_f32 v24, v10, v164
 v_mul_f32 v25, v10, v165
 v_mul_f32 v26, v10, v166
 v_mul_f32 v27, v10, v167
 v_exp_f32 v24, v24
 v_exp_f32 v25, v25
 v_exp_f32 v26, v26
 v_exp_f32 v27, v27
 s_nop 0
 v_add_f32 v24, 1.0, v24
 v_add_f32 v25, 1.0, v25
 v_add_f32 v26, 1.0, v26
 v_add_f32 v27, 1.0, v27
 v_rcp_f32 v24, v24
 v_rcp_f32 v25, v25
 v_rcp_f32 v26, v26
 v_rcp_f32 v27, v27
 s_nop 0
 v_mul_f32 v24, v24, v164
 v_mul_f32 v25, v25, v165
 v_mul_f32 v26, v26, v166
 v_mul_f32 v27, v27, v167
 v_cvt_pk_bf16_f32 v28, v24, v25
 v_cvt_pk_bf16_f32 v29, v26, v27
 s_add_u32 s11, s37, 100678656
 buffer_store_dwordx2 v[28:29], v9, s[4:7], s11 offen sc1
 v_mul_f32 v16, v10, v168
 v_mul_f32 v17, v10, v169
 v_mul_f32 v18, v10, v170
 v_mul_f32 v19, v10, v171
 v_exp_f32 v16, v16
 v_exp_f32 v17, v17
 v_exp_f32 v18, v18
 v_exp_f32 v19, v19
 s_nop 0
 v_add_f32 v16, 1.0, v16
 v_add_f32 v17, 1.0, v17
 v_add_f32 v18, 1.0, v18
 v_add_f32 v19, 1.0, v19
 v_rcp_f32 v16, v16
 v_rcp_f32 v17, v17
 v_rcp_f32 v18, v18
 v_rcp_f32 v19, v19
 s_nop 0
 v_mul_f32 v16, v16, v168
 v_mul_f32 v17, v17, v169
 v_mul_f32 v18, v18, v170
 v_mul_f32 v19, v19, v171
 v_cvt_pk_bf16_f32 v20, v16, v17
 v_cvt_pk_bf16_f32 v21, v18, v19
 s_add_u32 s11, s37, 100679168
 buffer_store_dwordx2 v[20:21], v9, s[4:7], s11 offen sc1
 v_mul_f32 v24, v10, v172
 v_mul_f32 v25, v10, v173
 v_mul_f32 v26, v10, v174
 v_mul_f32 v27, v10, v175
 v_exp_f32 v24, v24
 v_exp_f32 v25, v25
 v_exp_f32 v26, v26
 v_exp_f32 v27, v27
 s_nop 0
 v_add_f32 v24, 1.0, v24
 v_add_f32 v25, 1.0, v25
 v_add_f32 v26, 1.0, v26
 v_add_f32 v27, 1.0, v27
 v_rcp_f32 v24, v24
 v_rcp_f32 v25, v25
 v_rcp_f32 v26, v26
 v_rcp_f32 v27, v27
 s_nop 0
 v_mul_f32 v24, v24, v172
 v_mul_f32 v25, v25, v173
 v_mul_f32 v26, v26, v174
 v_mul_f32 v27, v27, v175
 v_cvt_pk_bf16_f32 v28, v24, v25
 v_cvt_pk_bf16_f32 v29, v26, v27
 s_add_u32 s11, s37, 100679680
 buffer_store_dwordx2 v[28:29], v9, s[4:7], s11 offen sc1
 v_mul_f32 v16, v10, v176
 v_mul_f32 v17, v10, v177
 v_mul_f32 v18, v10, v178
 v_mul_f32 v19, v10, v179
 v_exp_f32 v16, v16
 v_exp_f32 v17, v17
 v_exp_f32 v18, v18
 v_exp_f32 v19, v19
 s_nop 0
 v_add_f32 v16, 1.0, v16
 v_add_f32 v17, 1.0, v17
 v_add_f32 v18, 1.0, v18
 v_add_f32 v19, 1.0, v19
 v_rcp_f32 v16, v16
 v_rcp_f32 v17, v17
 v_rcp_f32 v18, v18
 v_rcp_f32 v19, v19
 s_nop 0
 v_mul_f32 v16, v16, v176
 v_mul_f32 v17, v17, v177
 v_mul_f32 v18, v18, v178
 v_mul_f32 v19, v19, v179
 v_cvt_pk_bf16_f32 v20, v16, v17
 v_cvt_pk_bf16_f32 v21, v18, v19
 s_add_u32 s11, s37, 100680192
 buffer_store_dwordx2 v[20:21], v9, s[4:7], s11 offen sc1
 v_mul_f32 v24, v10, v180
 v_mul_f32 v25, v10, v181
 v_mul_f32 v26, v10, v182
 v_mul_f32 v27, v10, v183
 v_exp_f32 v24, v24
 v_exp_f32 v25, v25
 v_exp_f32 v26, v26
 v_exp_f32 v27, v27
 s_nop 0
 v_add_f32 v24, 1.0, v24
 v_add_f32 v25, 1.0, v25
 v_add_f32 v26, 1.0, v26
 v_add_f32 v27, 1.0, v27
 v_rcp_f32 v24, v24
 v_rcp_f32 v25, v25
 v_rcp_f32 v26, v26
 v_rcp_f32 v27, v27
 s_nop 0
 v_mul_f32 v24, v24, v180
 v_mul_f32 v25, v25, v181
 v_mul_f32 v26, v26, v182
 v_mul_f32 v27, v27, v183
 v_cvt_pk_bf16_f32 v28, v24, v25
 v_cvt_pk_bf16_f32 v29, v26, v27
 s_add_u32 s11, s37, 100680704
 buffer_store_dwordx2 v[28:29], v9, s[4:7], s11 offen sc1
 v_mul_f32 v16, v10, v184
 v_mul_f32 v17, v10, v185
 v_mul_f32 v18, v10, v186
 v_mul_f32 v19, v10, v187
 v_exp_f32 v16, v16
 v_exp_f32 v17, v17
 v_exp_f32 v18, v18
 v_exp_f32 v19, v19
 s_nop 0
 v_add_f32 v16, 1.0, v16
 v_add_f32 v17, 1.0, v17
 v_add_f32 v18, 1.0, v18
 v_add_f32 v19, 1.0, v19
 v_rcp_f32 v16, v16
 v_rcp_f32 v17, v17
 v_rcp_f32 v18, v18
 v_rcp_f32 v19, v19
 s_nop 0
 v_mul_f32 v16, v16, v184
 v_mul_f32 v17, v17, v185
 v_mul_f32 v18, v18, v186
 v_mul_f32 v19, v19, v187
 v_cvt_pk_bf16_f32 v20, v16, v17
 v_cvt_pk_bf16_f32 v21, v18, v19
 s_add_u32 s11, s37, 100691968
 buffer_store_dwordx2 v[20:21], v9, s[4:7], s11 offen sc1
 v_mul_f32 v24, v10, v188
 v_mul_f32 v25, v10, v189
 v_mul_f32 v26, v10, v190
 v_mul_f32 v27, v10, v191
 v_exp_f32 v24, v24
 v_exp_f32 v25, v25
 v_exp_f32 v26, v26
 v_exp_f32 v27, v27
 s_nop 0
 v_add_f32 v24, 1.0, v24
 v_add_f32 v25, 1.0, v25
 v_add_f32 v26, 1.0, v26
 v_add_f32 v27, 1.0, v27
 v_rcp_f32 v24, v24
 v_rcp_f32 v25, v25
 v_rcp_f32 v26, v26
 v_rcp_f32 v27, v27
 s_nop 0
 v_mul_f32 v24, v24, v188
 v_mul_f32 v25, v25, v189
 v_mul_f32 v26, v26, v190
 v_mul_f32 v27, v27, v191
 v_cvt_pk_bf16_f32 v28, v24, v25
 v_cvt_pk_bf16_f32 v29, v26, v27
 s_add_u32 s11, s37, 100692480
 buffer_store_dwordx2 v[28:29], v9, s[4:7], s11 offen sc1
 v_mul_f32 v16, v10, v192
 v_mul_f32 v17, v10, v193
 v_mul_f32 v18, v10, v194
 v_mul_f32 v19, v10, v195
 v_exp_f32 v16, v16
 v_exp_f32 v17, v17
 v_exp_f32 v18, v18
 v_exp_f32 v19, v19
 s_nop 0
 v_add_f32 v16, 1.0, v16
 v_add_f32 v17, 1.0, v17
 v_add_f32 v18, 1.0, v18
 v_add_f32 v19, 1.0, v19
 v_rcp_f32 v16, v16
 v_rcp_f32 v17, v17
 v_rcp_f32 v18, v18
 v_rcp_f32 v19, v19
 s_nop 0
 v_mul_f32 v16, v16, v192
 v_mul_f32 v17, v17, v193
 v_mul_f32 v18, v18, v194
 v_mul_f32 v19, v19, v195
 v_cvt_pk_bf16_f32 v20, v16, v17
 v_cvt_pk_bf16_f32 v21, v18, v19
 s_add_u32 s11, s37, 100692992
 buffer_store_dwordx2 v[20:21], v9, s[4:7], s11 offen sc1
 v_mul_f32 v24, v10, v196
 v_mul_f32 v25, v10, v197
 v_mul_f32 v26, v10, v198
 v_mul_f32 v27, v10, v199
 v_exp_f32 v24, v24
 v_exp_f32 v25, v25
 v_exp_f32 v26, v26
 v_exp_f32 v27, v27
 s_nop 0
 v_add_f32 v24, 1.0, v24
 v_add_f32 v25, 1.0, v25
 v_add_f32 v26, 1.0, v26
 v_add_f32 v27, 1.0, v27
 v_rcp_f32 v24, v24
 v_rcp_f32 v25, v25
 v_rcp_f32 v26, v26
 v_rcp_f32 v27, v27
 s_nop 0
 v_mul_f32 v24, v24, v196
 v_mul_f32 v25, v25, v197
 v_mul_f32 v26, v26, v198
 v_mul_f32 v27, v27, v199
 v_cvt_pk_bf16_f32 v28, v24, v25
 v_cvt_pk_bf16_f32 v29, v26, v27
 s_add_u32 s11, s37, 100693504
 buffer_store_dwordx2 v[28:29], v9, s[4:7], s11 offen sc1
 v_mul_f32 v16, v10, v200
 v_mul_f32 v17, v10, v201
 v_mul_f32 v18, v10, v202
 v_mul_f32 v19, v10, v203
 v_exp_f32 v16, v16
 v_exp_f32 v17, v17
 v_exp_f32 v18, v18
 v_exp_f32 v19, v19
 s_nop 0
 v_add_f32 v16, 1.0, v16
 v_add_f32 v17, 1.0, v17
 v_add_f32 v18, 1.0, v18
 v_add_f32 v19, 1.0, v19
 v_rcp_f32 v16, v16
 v_rcp_f32 v17, v17
 v_rcp_f32 v18, v18
 v_rcp_f32 v19, v19
 s_nop 0
 v_mul_f32 v16, v16, v200
 v_mul_f32 v17, v17, v201
 v_mul_f32 v18, v18, v202
 v_mul_f32 v19, v19, v203
 v_cvt_pk_bf16_f32 v20, v16, v17
 v_cvt_pk_bf16_f32 v21, v18, v19
 s_add_u32 s11, s37, 100694016
 buffer_store_dwordx2 v[20:21], v9, s[4:7], s11 offen sc1
 v_mul_f32 v24, v10, v204
 v_mul_f32 v25, v10, v205
 v_mul_f32 v26, v10, v206
 v_mul_f32 v27, v10, v207
 v_exp_f32 v24, v24
 v_exp_f32 v25, v25
 v_exp_f32 v26, v26
 v_exp_f32 v27, v27
 s_nop 0
 v_add_f32 v24, 1.0, v24
 v_add_f32 v25, 1.0, v25
 v_add_f32 v26, 1.0, v26
 v_add_f32 v27, 1.0, v27
 v_rcp_f32 v24, v24
 v_rcp_f32 v25, v25
 v_rcp_f32 v26, v26
 v_rcp_f32 v27, v27
 s_nop 0
 v_mul_f32 v24, v24, v204
 v_mul_f32 v25, v25, v205
 v_mul_f32 v26, v26, v206
 v_mul_f32 v27, v27, v207
 v_cvt_pk_bf16_f32 v28, v24, v25
 v_cvt_pk_bf16_f32 v29, v26, v27
 s_add_u32 s11, s37, 100694528
 buffer_store_dwordx2 v[28:29], v9, s[4:7], s11 offen sc1
 v_mul_f32 v16, v10, v208
 v_mul_f32 v17, v10, v209
 v_mul_f32 v18, v10, v210
 v_mul_f32 v19, v10, v211
 v_exp_f32 v16, v16
 v_exp_f32 v17, v17
 v_exp_f32 v18, v18
 v_exp_f32 v19, v19
 s_nop 0
 v_add_f32 v16, 1.0, v16
 v_add_f32 v17, 1.0, v17
 v_add_f32 v18, 1.0, v18
 v_add_f32 v19, 1.0, v19
 v_rcp_f32 v16, v16
 v_rcp_f32 v17, v17
 v_rcp_f32 v18, v18
 v_rcp_f32 v19, v19
 s_nop 0
 v_mul_f32 v16, v16, v208
 v_mul_f32 v17, v17, v209
 v_mul_f32 v18, v18, v210
 v_mul_f32 v19, v19, v211
 v_cvt_pk_bf16_f32 v20, v16, v17
 v_cvt_pk_bf16_f32 v21, v18, v19
 s_add_u32 s11, s37, 100695040
 buffer_store_dwordx2 v[20:21], v9, s[4:7], s11 offen sc1
 v_mul_f32 v24, v10, v212
 v_mul_f32 v25, v10, v213
 v_mul_f32 v26, v10, v214
 v_mul_f32 v27, v10, v215
 v_exp_f32 v24, v24
 v_exp_f32 v25, v25
 v_exp_f32 v26, v26
 v_exp_f32 v27, v27
 s_nop 0
 v_add_f32 v24, 1.0, v24
 v_add_f32 v25, 1.0, v25
 v_add_f32 v26, 1.0, v26
 v_add_f32 v27, 1.0, v27
 v_rcp_f32 v24, v24
 v_rcp_f32 v25, v25
 v_rcp_f32 v26, v26
 v_rcp_f32 v27, v27
 s_nop 0
 v_mul_f32 v24, v24, v212
 v_mul_f32 v25, v25, v213
 v_mul_f32 v26, v26, v214
 v_mul_f32 v27, v27, v215
 v_cvt_pk_bf16_f32 v28, v24, v25
 v_cvt_pk_bf16_f32 v29, v26, v27
 s_add_u32 s11, s37, 100706304
 buffer_store_dwordx2 v[28:29], v9, s[4:7], s11 offen sc1
 v_mul_f32 v16, v10, v216
 v_mul_f32 v17, v10, v217
 v_mul_f32 v18, v10, v218
 v_mul_f32 v19, v10, v219
 v_exp_f32 v16, v16
 v_exp_f32 v17, v17
 v_exp_f32 v18, v18
 v_exp_f32 v19, v19
 s_nop 0
 v_add_f32 v16, 1.0, v16
 v_add_f32 v17, 1.0, v17
 v_add_f32 v18, 1.0, v18
 v_add_f32 v19, 1.0, v19
 v_rcp_f32 v16, v16
 v_rcp_f32 v17, v17
 v_rcp_f32 v18, v18
 v_rcp_f32 v19, v19
 s_nop 0
 v_mul_f32 v16, v16, v216
 v_mul_f32 v17, v17, v217
 v_mul_f32 v18, v18, v218
 v_mul_f32 v19, v19, v219
 v_cvt_pk_bf16_f32 v20, v16, v17
 v_cvt_pk_bf16_f32 v21, v18, v19
 s_add_u32 s11, s37, 100706816
 buffer_store_dwordx2 v[20:21], v9, s[4:7], s11 offen sc1
 v_mul_f32 v24, v10, v220
 v_mul_f32 v25, v10, v221
 v_mul_f32 v26, v10, v222
 v_mul_f32 v27, v10, v223
 v_exp_f32 v24, v24
 v_exp_f32 v25, v25
 v_exp_f32 v26, v26
 v_exp_f32 v27, v27
 s_nop 0
 v_add_f32 v24, 1.0, v24
 v_add_f32 v25, 1.0, v25
 v_add_f32 v26, 1.0, v26
 v_add_f32 v27, 1.0, v27
 v_rcp_f32 v24, v24
 v_rcp_f32 v25, v25
 v_rcp_f32 v26, v26
 v_rcp_f32 v27, v27
 s_nop 0
 v_mul_f32 v24, v24, v220
 v_mul_f32 v25, v25, v221
 v_mul_f32 v26, v26, v222
 v_mul_f32 v27, v27, v223
 v_cvt_pk_bf16_f32 v28, v24, v25
 v_cvt_pk_bf16_f32 v29, v26, v27
 s_add_u32 s11, s37, 100707328
 buffer_store_dwordx2 v[28:29], v9, s[4:7], s11 offen sc1
 v_mul_f32 v16, v10, v224
 v_mul_f32 v17, v10, v225
 v_mul_f32 v18, v10, v226
 v_mul_f32 v19, v10, v227
 v_exp_f32 v16, v16
 v_exp_f32 v17, v17
 v_exp_f32 v18, v18
 v_exp_f32 v19, v19
 s_nop 0
 v_add_f32 v16, 1.0, v16
 v_add_f32 v17, 1.0, v17
 v_add_f32 v18, 1.0, v18
 v_add_f32 v19, 1.0, v19
 v_rcp_f32 v16, v16
 v_rcp_f32 v17, v17
 v_rcp_f32 v18, v18
 v_rcp_f32 v19, v19
 s_nop 0
 v_mul_f32 v16, v16, v224
 v_mul_f32 v17, v17, v225
 v_mul_f32 v18, v18, v226
 v_mul_f32 v19, v19, v227
 v_cvt_pk_bf16_f32 v20, v16, v17
 v_cvt_pk_bf16_f32 v21, v18, v19
 s_add_u32 s11, s37, 100707840
 buffer_store_dwordx2 v[20:21], v9, s[4:7], s11 offen sc1
 v_mul_f32 v24, v10, v228
 v_mul_f32 v25, v10, v229
 v_mul_f32 v26, v10, v230
 v_mul_f32 v27, v10, v231
 v_exp_f32 v24, v24
 v_exp_f32 v25, v25
 v_exp_f32 v26, v26
 v_exp_f32 v27, v27
 s_nop 0
 v_add_f32 v24, 1.0, v24
 v_add_f32 v25, 1.0, v25
 v_add_f32 v26, 1.0, v26
 v_add_f32 v27, 1.0, v27
 v_rcp_f32 v24, v24
 v_rcp_f32 v25, v25
 v_rcp_f32 v26, v26
 v_rcp_f32 v27, v27
 s_nop 0
 v_mul_f32 v24, v24, v228
 v_mul_f32 v25, v25, v229
 v_mul_f32 v26, v26, v230
 v_mul_f32 v27, v27, v231
 v_cvt_pk_bf16_f32 v28, v24, v25
 v_cvt_pk_bf16_f32 v29, v26, v27
 s_add_u32 s11, s37, 100708352
 buffer_store_dwordx2 v[28:29], v9, s[4:7], s11 offen sc1
 v_mul_f32 v16, v10, v232
 v_mul_f32 v17, v10, v233
 v_mul_f32 v18, v10, v234
 v_mul_f32 v19, v10, v235
 v_exp_f32 v16, v16
 v_exp_f32 v17, v17
 v_exp_f32 v18, v18
 v_exp_f32 v19, v19
 s_nop 0
 v_add_f32 v16, 1.0, v16
 v_add_f32 v17, 1.0, v17
 v_add_f32 v18, 1.0, v18
 v_add_f32 v19, 1.0, v19
 v_rcp_f32 v16, v16
 v_rcp_f32 v17, v17
 v_rcp_f32 v18, v18
 v_rcp_f32 v19, v19
 s_nop 0
 v_mul_f32 v16, v16, v232
 v_mul_f32 v17, v17, v233
 v_mul_f32 v18, v18, v234
 v_mul_f32 v19, v19, v235
 v_cvt_pk_bf16_f32 v20, v16, v17
 v_cvt_pk_bf16_f32 v21, v18, v19
 s_add_u32 s11, s37, 100708864
 buffer_store_dwordx2 v[20:21], v9, s[4:7], s11 offen sc1
 v_mul_f32 v24, v10, v236
 v_mul_f32 v25, v10, v237
 v_mul_f32 v26, v10, v238
 v_mul_f32 v27, v10, v239
 v_exp_f32 v24, v24
 v_exp_f32 v25, v25
 v_exp_f32 v26, v26
 v_exp_f32 v27, v27
 s_nop 0
 v_add_f32 v24, 1.0, v24
 v_add_f32 v25, 1.0, v25
 v_add_f32 v26, 1.0, v26
 v_add_f32 v27, 1.0, v27
 v_rcp_f32 v24, v24
 v_rcp_f32 v25, v25
 v_rcp_f32 v26, v26
 v_rcp_f32 v27, v27
 s_nop 0
 v_mul_f32 v24, v24, v236
 v_mul_f32 v25, v25, v237
 v_mul_f32 v26, v26, v238
 v_mul_f32 v27, v27, v239
 v_cvt_pk_bf16_f32 v28, v24, v25
 v_cvt_pk_bf16_f32 v29, v26, v27
 s_add_u32 s11, s37, 100709376
 buffer_store_dwordx2 v[28:29], v9, s[4:7], s11 offen sc1
 s_waitcnt vmcnt(0)
 s_barrier
 s_lshl_b32 s33, s20, 7
 s_add_u32 s33, s33, 18419712
 buffer_atomic_add v2, v3, s[4:7], s33 offen sc1
 s_branch K_loop
K_fin:
 s_sub_u32 s11, s92, 32
 s_lshr_b32 s20, s11, 3
 s_and_b32 s21, s11, 3
 s_bitcmp1_b32 s11, 2
 s_cbranch_scc1 K_fv
 s_lshl_b32 s22, s21, 2
 s_add_u32 s22, s22, s8
 s_lshr_b32 s11, s20, 2
 s_lshl_b32 s11, s11, 7
 s_add_u32 s23, s11, 18415616
 s_mul_i32 s24, s20, 28672
 s_add_u32 s11, s24, 0
 buffer_load_dwordx4 a[112:115], v1, s[4:7], s11 offen offset:0
 buffer_load_dwordx4 a[116:119], v1, s[4:7], s11 offen offset:1024
 buffer_load_dwordx4 a[120:123], v1, s[4:7], s11 offen offset:2048
 buffer_load_dwordx4 a[124:127], v1, s[4:7], s11 offen offset:3072
 s_add_u32 s11, s24, 4096
 buffer_load_dwordx4 a[128:131], v1, s[4:7], s11 offen offset:0
 buffer_load_dwordx4 a[132:135], v1, s[4:7], s11 offen offset:1024
 buffer_load_dwordx4 a[136:139], v1, s[4:7], s11 offen offset:2048
 buffer_load_dwordx4 a[140:143], v1, s[4:7], s11 offen offset:3072
 s_add_u32 s11, s24, 8192
 buffer_load_dwordx4 a[144:147], v1, s[4:7], s11 offen offset:0
 buffer_load_dwordx4 a[148:151], v1, s[4:7], s11 offen offset:1024
 buffer_load_dwordx4 a[152:155], v1, s[4:7], s11 offen offset:2048
 buffer_load_dwordx4 a[156:159], v1, s[4:7], s11 offen offset:3072
 s_add_u32 s11, s24, 12288
 buffer_load_dwordx4 a[160:163], v1, s[4:7], s11 offen offset:0
 buffer_load_dwordx4 a[164:167], v1, s[4:7], s11 offen offset:1024
 s_add_u32 s11, s24, 14336
 buffer_load_dwordx4 a[168:171], v1, s[4:7], s11 offen offset:0
 buffer_load_dwordx4 a[172:175], v1, s[4:7], s11 offen offset:1024
 buffer_load_dwordx4 a[176:179], v1, s[4:7], s11 offen offset:2048
 buffer_load_dwordx4 a[180:183], v1, s[4:7], s11 offen offset:3072
 s_add_u32 s11, s24, 18432
 buffer_load_dwordx4 a[184:187], v1, s[4:7], s11 offen offset:0
 buffer_load_dwordx4 a[188:191], v1, s[4:7], s11 offen offset:1024
 buffer_load_dwordx4 a[192:195], v1, s[4:7], s11 offen offset:2048
 buffer_load_dwordx4 a[196:199], v1, s[4:7], s11 offen offset:3072
 s_add_u32 s11, s24, 22528
 buffer_load_dwordx4 a[200:203], v1, s[4:7], s11 offen offset:0
 buffer_load_dwordx4 a[204:207], v1, s[4:7], s11 offen offset:1024
 buffer_load_dwordx4 a[208:211], v1, s[4:7], s11 offen offset:2048
 buffer_load_dwordx4 a[212:215], v1, s[4:7], s11 offen offset:3072
 s_add_u32 s11, s24, 26624
 buffer_load_dwordx4 a[216:219], v1, s[4:7], s11 offen offset:0
 buffer_load_dwordx4 a[220:223], v1, s[4:7], s11 offen offset:1024
 s_cmp_lg_u32 s8, 0
 s_cbranch_scc1 L_wct_78_ok
 s_mov_b32 s19, 0
 v_mov_b32 v5, 0
 s_mov_b64 exec, 1
L_wct_78:
 buffer_load_dword v6, v5, s[4:7], s23 offen sc1
 s_waitcnt vmcnt(0)
 v_readfirstlane_b32 s11, v6
 s_cmp_ge_u32 s11, 28
 s_cbranch_scc1 L_wct_78_got
 s_sleep 12
 s_add_u32 s19, s19, 1
 s_cmp_le_u32 s19, 8192
 s_cbranch_scc1 L_wct_78
 s_branch K_failw
L_wct_78_got:
 s_mov_b64 exec, -1
L_wct_78_ok:
 s_barrier
 s_mul_i32 s11, s20, 448
 s_mul_i32 s12, s22, 14
 s_add_u32 s11, s11, s12
 s_lshl_b32 s25, s11, 10
 s_add_u32 s11, s25, 63963136
 buffer_load_dwordx4 a[0:3], v1, s[4:7], s11 offen offset:0 sc1
 buffer_load_dwordx4 a[4:7], v1, s[4:7], s11 offen offset:1024 sc1
 buffer_load_dwordx4 a[8:11], v1, s[4:7], s11 offen offset:2048 sc1
 buffer_load_dwordx4 a[12:15], v1, s[4:7], s11 offen offset:3072 sc1
 s_add_u32 s11, s25, 63967232
 buffer_load_dwordx4 a[16:19], v1, s[4:7], s11 offen offset:0 sc1
 buffer_load_dwordx4 a[20:23], v1, s[4:7], s11 offen offset:1024 sc1
 buffer_load_dwordx4 a[24:27], v1, s[4:7], s11 offen offset:2048 sc1
 buffer_load_dwordx4 a[28:31], v1, s[4:7], s11 offen offset:3072 sc1
 s_add_u32 s11, s25, 63971328
 buffer_load_dwordx4 a[32:35], v1, s[4:7], s11 offen offset:0 sc1
 buffer_load_dwordx4 a[36:39], v1, s[4:7], s11 offen offset:1024 sc1
 buffer_load_dwordx4 a[40:43], v1, s[4:7], s11 offen offset:2048 sc1
 buffer_load_dwordx4 a[44:47], v1, s[4:7], s11 offen offset:3072 sc1
 s_add_u32 s11, s25, 63975424
 buffer_load_dwordx4 a[48:51], v1, s[4:7], s11 offen offset:0 sc1
 buffer_load_dwordx4 a[52:55], v1, s[4:7], s11 offen offset:1024 sc1
 s_add_u32 s11, s25, 64192512
 buffer_load_dwordx4 a[56:59], v1, s[4:7], s11 offen offset:0 sc1
 buffer_load_dwordx4 a[60:63], v1, s[4:7], s11 offen offset:1024 sc1
 buffer_load_dwordx4 a[64:67], v1, s[4:7], s11 offen offset:2048 sc1
 buffer_load_dwordx4 a[68:71], v1, s[4:7], s11 offen offset:3072 sc1
 s_add_u32 s11, s25, 64196608
 buffer_load_dwordx4 a[72:75], v1, s[4:7], s11 offen offset:0 sc1
 buffer_load_dwordx4 a[76:79], v1, s[4:7], s11 offen offset:1024 sc1
 buffer_load_dwordx4 a[80:83], v1, s[4:7], s11 offen offset:2048 sc1
 buffer_load_dwordx4 a[84:87], v1, s[4:7], s11 offen offset:3072 sc1
 s_add_u32 s11, s25, 64200704
 buffer_load_dwordx4 a[88:91], v1, s[4:7], s11 offen offset:0 sc1
 buffer_load_dwordx4 a[92:95], v1, s[4:7], s11 offen offset:1024 sc1
 buffer_load_dwordx4 a[96:99], v1, s[4:7], s11 offen offset:2048 sc1
 buffer_load_dwordx4 a[100:103], v1, s[4:7], s11 offen offset:3072 sc1
 s_add_u32 s11, s25, 64204800
 buffer_load_dwordx4 a[104:107], v1, s[4:7], s11 offen offset:0 sc1
 buffer_load_dwordx4 a[108:111], v1, s[4:7], s11 offen offset:1024 sc1
 v_and_b32 v8, 15, v0
 v_lshrrev_b32 v9, 4, v0
 v_lshlrev_b32 v10, 2, v9
 v_add_u32 v11, 0, v10
 v_cmp_le_u32 s[40:41], v11, v8
 v_add_u32 v11, 1, v10
 v_cmp_le_u32 s[42:43], v11, v8
 v_add_u32 v11, 2, v10
 v_cmp_le_u32 s[44:45], v11, v8
 v_add_u32 v11, 3, v10
 v_cmp_le_u32 s[46:47], v11, v8
 v_cmp_gt_u32 vcc, 2, v9
 v_mov_b32 v12, 0xff800000
 s_nop 0
 v_cndmask_b32 v13, 0, 1.0, vcc
 v_and_b32 v14, 7, v0
 v_lshrrev_b32 v15, 5, v0
 v_lshl_add_u32 v14, v15, 4, v14
 v_lshlrev_b32 v14, 4, v14
 v_and_b32 v15, 1, v9
 v_lshl_add_u32 v14, v15, 3, v14
 s_waitcnt vmcnt(0)
 v_mfma_f32_16x16x32_bf16 v[16:19], a[112:115], a[0:3], 0
 v_mfma_f32_16x16x32_bf16 v[16:19], a[116:119], a[4:7], v[16:19]
 v_mfma_f32_16x16x32_bf16 v[16:19], a[120:123], a[8:11], v[16:19]
 v_mfma_f32_16x16x32_bf16 v[16:19], a[124:127], a[12:15], v[16:19]
 v_mfma_f32_16x16x32_bf16 v[16:19], a[128:131], a[16:19], v[16:19]
 v_mfma_f32_16x16x32_bf16 v[16:19], a[132:135], a[20:23], v[16:19]
 v_mfma_f32_16x16x32_bf16 v[16:19], a[136:139], a[24:27], v[16:19]
 v_mfma_f32_16x16x32_bf16 v[16:19], a[140:143], a[28:31], v[16:19]
 v_mfma_f32_16x16x32_bf16 v[16:19], a[144:147], a[32:35], v[16:19]
 v_mfma_f32_16x16x32_bf16 v[16:19], a[148:151], a[36:39], v[16:19]
 v_mfma_f32_16x16x32_bf16 v[16:19], a[152:155], a[40:43], v[16:19]
 v_mfma_f32_16x16x32_bf16 v[16:19], a[156:159], a[44:47], v[16:19]
 v_mfma_f32_16x16x32_bf16 v[16:19], a[160:163], a[48:51], v[16:19]
 v_mfma_f32_16x16x32_bf16 v[16:19], a[164:167], a[52:55], v[16:19]
 v_mfma_f32_16x16x32_bf16 v[20:23], a[112:115], a[56:59], 0
 v_mfma_f32_16x16x32_bf16 v[20:23], a[116:119], a[60:63], v[20:23]
 v_mfma_f32_16x16x32_bf16 v[20:23], a[120:123], a[64:67], v[20:23]
 v_mfma_f32_16x16x32_bf16 v[20:23], a[124:127], a[68:71], v[20:23]
 v_mfma_f32_16x16x32_bf16 v[20:23], a[128:131], a[72:75], v[20:23]
 v_mfma_f32_16x16x32_bf16 v[20:23], a[132:135], a[76:79], v[20:23]
 v_mfma_f32_16x16x32_bf16 v[20:23], a[136:139], a[80:83], v[20:23]
 v_mfma_f32_16x16x32_bf16 v[20:23], a[140:143], a[84:87], v[20:23]
 v_mfma_f32_16x16x32_bf16 v[20:23], a[144:147], a[88:91], v[20:23]
 v_mfma_f32_16x16x32_bf16 v[20:23], a[148:151], a[92:95], v[20:23]
 v_mfma_f32_16x16x32_bf16 v[20:23], a[152:155], a[96:99], v[20:23]
 v_mfma_f32_16x16x32_bf16 v[20:23], a[156:159], a[100:103], v[20:23]
 v_mfma_f32_16x16x32_bf16 v[20:23], a[160:163], a[104:107], v[20:23]
 v_mfma_f32_16x16x32_bf16 v[20:23], a[164:167], a[108:111], v[20:23]
 v_mfma_f32_16x16x32_bf16 v[24:27], a[168:171], a[56:59], 0
 v_mfma_f32_16x16x32_bf16 v[24:27], a[172:175], a[60:63], v[24:27]
 v_mfma_f32_16x16x32_bf16 v[24:27], a[176:179], a[64:67], v[24:27]
 v_mfma_f32_16x16x32_bf16 v[24:27], a[180:183], a[68:71], v[24:27]
 v_mfma_f32_16x16x32_bf16 v[24:27], a[184:187], a[72:75], v[24:27]
 v_mfma_f32_16x16x32_bf16 v[24:27], a[188:191], a[76:79], v[24:27]
 v_mfma_f32_16x16x32_bf16 v[24:27], a[192:195], a[80:83], v[24:27]
 v_mfma_f32_16x16x32_bf16 v[24:27], a[196:199], a[84:87], v[24:27]
 v_mfma_f32_16x16x32_bf16 v[24:27], a[200:203], a[88:91], v[24:27]
 v_mfma_f32_16x16x32_bf16 v[24:27], a[204:207], a[92:95], v[24:27]
 v_mfma_f32_16x16x32_bf16 v[24:27], a[208:211], a[96:99], v[24:27]
 v_mfma_f32_16x16x32_bf16 v[24:27], a[212:215], a[100:103], v[24:27]
 v_mfma_f32_16x16x32_bf16 v[24:27], a[216:219], a[104:107], v[24:27]
 v_mfma_f32_16x16x32_bf16 v[24:27], a[220:223], a[108:111], v[24:27]
 s_mul_i32 s26, s20, 7168
 s_add_u32 s26, s26, 17235968
 s_mov_b32 s27, 0
L_fs_get_79:
 s_cmp_lg_u32 s8, 0
 s_cbranch_scc1 L_fs_nof_80
 v_lshlrev_b32 v5, 7, v0
 s_mov_b32 exec_lo, 0xffffffff
 s_mov_b32 exec_hi, 0xffffff
 v_add_u32 v5, 124, v5
 s_mov_b32 s19, 0
L_plfs_81:
 buffer_load_dword v6, v5, s[4:7], s26 offen sc1
 s_waitcnt vmcnt(0)
 v_cmp_eq_u32 vcc, -1, v6
 s_cbranch_vccz L_plfs_81_ok
 s_sleep 2
 s_add_u32 s19, s19, 1
 s_cmp_le_u32 s19, 8192
 s_cbranch_scc1 L_plfs_81
 s_branch K_failw
L_plfs_81_ok:
 s_mov_b64 exec, -1
 s_mov_b32 m0, 0
 s_add_u32 s11, s26, 4096
 buffer_load_dwordx4 v1, s[4:7], s26 offen offset:0 sc1 lds
 buffer_load_dwordx4 v1, s[4:7], s26 offen offset:1024 sc1 lds
 buffer_load_dwordx4 v1, s[4:7], s26 offen offset:2048 sc1 lds
 buffer_load_dwordx4 v1, s[4:7], s26 offen offset:3072 sc1 lds
 s_mov_b32 m0, 4096
 s_nop 0
 buffer_load_dwordx4 v1, s[4:7], s11 offen offset:0 sc1 lds
 buffer_load_dwordx4 v1, s[4:7], s11 offen offset:1024 sc1 lds
 buffer_load_dwordx4 v1, s[4:7], s11 offen offset:2048 sc1 lds
 s_waitcnt vmcnt(0)
L_fs_nof_80:
 s_barrier
 ds_read2_b32 v[64:65], v14 offset0:0 offset1:32
 ds_read2_b32 v[66:67], v14 offset0:1 offset1:33
 ds_read2_b32 v[68:69], v14 offset0:128 offset1:160
 ds_read2_b32 v[70:71], v14 offset0:129 offset1:161
 v_add_u32 v14, 1024, v14
 ds_read2_b32 v[72:73], v14 offset0:0 offset1:32
 ds_read2_b32 v[74:75], v14 offset0:1 offset1:33
 ds_read2_b32 v[76:77], v14 offset0:128 offset1:160
 ds_read2_b32 v[78:79], v14 offset0:129 offset1:161
 v_add_u32 v14, 1024, v14
 ds_read2_b32 v[80:81], v14 offset0:0 offset1:32
 ds_read2_b32 v[82:83], v14 offset0:1 offset1:33
 ds_read2_b32 v[84:85], v14 offset0:128 offset1:160
 ds_read2_b32 v[86:87], v14 offset0:129 offset1:161
 v_add_u32 v14, 1024, v14
 ds_read2_b32 v[88:89], v14 offset0:0 offset1:32
 ds_read2_b32 v[90:91], v14 offset0:1 offset1:33
 ds_read2_b32 v[92:93], v14 offset0:128 offset1:160
 ds_read2_b32 v[94:95], v14 offset0:129 offset1:161
 v_add_u32 v14, 1024, v14
 ds_read2_b32 v[96:97], v14 offset0:0 offset1:32
 ds_read2_b32 v[98:99], v14 offset0:1 offset1:33
 ds_read2_b32 v[100:101], v14 offset0:128 offset1:160
 ds_read2_b32 v[102:103], v14 offset0:129 offset1:161
 v_add_u32 v14, 1024, v14
 ds_read2_b32 v[104:105], v14 offset0:0 offset1:32
 ds_read2_b32 v[106:107], v14 offset0:1 offset1:33
 ds_read2_b32 v[108:109], v14 offset0:128 offset1:160
 ds_read2_b32 v[110:111], v14 offset0:129 offset1:161
 v_add_u32 v14, 1024, v14
 ds_read2_b32 v[112:113], v14 offset0:0 offset1:32
 ds_read2_b32 v[114:115], v14 offset0:1 offset1:33
 ds_read2_b32 v[116:117], v14 offset0:128 offset1:160
 ds_read2_b32 v[118:119], v14 offset0:129 offset1:161
 v_subrev_u32 v14, 6144, v14
 s_waitcnt lgkmcnt(0)
 v_max3_u32 v5, v64, v65, v66
 v_max_u32 v5, v5, v67
 v_max3_u32 v5, v5, v68, v69
 v_max3_u32 v5, v5, v70, v71
 v_max3_u32 v5, v5, v72, v73
 v_max3_u32 v5, v5, v74, v75
 v_max3_u32 v5, v5, v76, v77
 v_max3_u32 v5, v5, v78, v79
 v_max3_u32 v5, v5, v80, v81
 v_max3_u32 v5, v5, v82, v83
 v_max3_u32 v5, v5, v84, v85
 v_max3_u32 v5, v5, v86, v87
 v_max3_u32 v5, v5, v88, v89
 v_max3_u32 v5, v5, v90, v91
 v_max3_u32 v5, v5, v92, v93
 v_max3_u32 v5, v5, v94, v95
 v_max3_u32 v5, v5, v96, v97
 v_max3_u32 v5, v5, v98, v99
 v_max3_u32 v5, v5, v100, v101
 v_max3_u32 v5, v5, v102, v103
 v_max3_u32 v5, v5, v104, v105
 v_max3_u32 v5, v5, v106, v107
 v_max3_u32 v5, v5, v108, v109
 v_max3_u32 v5, v5, v110, v111
 v_max3_u32 v5, v5, v112, v113
 v_max3_u32 v5, v5, v114, v115
 v_max3_u32 v5, v5, v116, v117
 v_max3_u32 v5, v5, v118, v119
 v_cmp_eq_u32 vcc, -1, v5
 s_cbranch_vccz L_fs_ok_82
 s_add_u32 s27, s27, 1
 s_cmp_gt_u32 s27, 8192
 s_cbranch_scc1 K_failw
 s_barrier
 s_branch L_fs_get_79
L_fs_ok_82:
 v_mfma_f32_16x16x32_bf16 v[28:31], v[64:67], a[0:3], 0
 v_mfma_f32_16x16x32_bf16 v[28:31], v[68:71], a[4:7], v[28:31]
 v_mfma_f32_16x16x32_bf16 v[28:31], v[72:75], a[8:11], v[28:31]
 v_mfma_f32_16x16x32_bf16 v[28:31], v[76:79], a[12:15], v[28:31]
 v_mfma_f32_16x16x32_bf16 v[28:31], v[80:83], a[16:19], v[28:31]
 v_mfma_f32_16x16x32_bf16 v[28:31], v[84:87], a[20:23], v[28:31]
 v_mfma_f32_16x16x32_bf16 v[28:31], v[88:91], a[24:27], v[28:31]
 v_mfma_f32_16x16x32_bf16 v[28:31], v[92:95], a[28:31], v[28:31]
 v_mfma_f32_16x16x32_bf16 v[28:31], v[96:99], a[32:35], v[28:31]
 v_mfma_f32_16x16x32_bf16 v[28:31], v[100:103], a[36:39], v[28:31]
 v_mfma_f32_16x16x32_bf16 v[28:31], v[104:107], a[40:43], v[28:31]
 v_mfma_f32_16x16x32_bf16 v[28:31], v[108:111], a[44:47], v[28:31]
 v_mfma_f32_16x16x32_bf16 v[28:31], v[112:115], a[48:51], v[28:31]
 v_mfma_f32_16x16x32_bf16 v[28:31], v[116:119], a[52:55], v[28:31]
 v_mfma_f32_16x16x32_bf16 v[32:35], v[64:67], a[56:59], 0
 v_mfma_f32_16x16x32_bf16 v[32:35], v[68:71], a[60:63], v[32:35]
 v_mfma_f32_16x16x32_bf16 v[32:35], v[72:75], a[64:67], v[32:35]
 v_mfma_f32_16x16x32_bf16 v[32:35], v[76:79], a[68:71], v[32:35]
 v_mfma_f32_16x16x32_bf16 v[32:35], v[80:83], a[72:75], v[32:35]
 v_mfma_f32_16x16x32_bf16 v[32:35], v[84:87], a[76:79], v[32:35]
 v_mfma_f32_16x16x32_bf16 v[32:35], v[88:91], a[80:83], v[32:35]
 v_mfma_f32_16x16x32_bf16 v[32:35], v[92:95], a[84:87], v[32:35]
 v_mfma_f32_16x16x32_bf16 v[32:35], v[96:99], a[88:91], v[32:35]
 v_mfma_f32_16x16x32_bf16 v[32:35], v[100:103], a[92:95], v[32:35]
 v_mfma_f32_16x16x32_bf16 v[32:35], v[104:107], a[96:99], v[32:35]
 v_mfma_f32_16x16x32_bf16 v[32:35], v[108:111], a[100:103], v[32:35]
 v_mfma_f32_16x16x32_bf16 v[32:35], v[112:115], a[104:107], v[32:35]
 v_mfma_f32_16x16x32_bf16 v[32:35], v[116:119], a[108:111], v[32:35]
 s_nop 7
 s_lshl_b32 s11, s20, 4
 s_add_u32 s11, s11, s22
 s_lshl_b32 s28, s11, 11
 s_lshl_b32 s11, s20, 3
 s_lshr_b32 s12, s22, 1
 s_add_u32 s11, s11, s12
 s_lshl_b32 s29, s11, 11
 s_and_b32 s11, s22, 1
 s_lshl_b32 s11, s11, 2
 s_add_u32 s29, s29, s11
 v_cndmask_b32 v16, v12, v16, s[40:41]
 v_cndmask_b32 v17, v12, v17, s[42:43]
 v_cndmask_b32 v18, v12, v18, s[44:45]
 v_cndmask_b32 v19, v12, v19, s[46:47]
 v_max3_f32 v36, v28, v29, v30
 v_max3_f32 v36, v36, v31, v16
 v_max3_f32 v36, v36, v17, v18
 v_max_f32 v36, v36, v19
 v_mov_b32 v37, v36
 s_nop 1
 v_permlane32_swap_b32 v36, v37
 v_max_f32 v36, v36, v37
 v_mov_b32 v37, v36
 s_nop 1
 v_permlane16_swap_b32 v36, v37
 v_max_f32 v36, v36, v37
 v_sub_f32 v28, v28, v36
 v_sub_f32 v29, v29, v36
 v_sub_f32 v30, v30, v36
 v_sub_f32 v31, v31, v36
 v_sub_f32 v16, v16, v36
 v_sub_f32 v17, v17, v36
 v_sub_f32 v18, v18, v36
 v_sub_f32 v19, v19, v36
 v_exp_f32 v28, v28
 v_exp_f32 v29, v29
 v_exp_f32 v30, v30
 v_exp_f32 v31, v31
 v_exp_f32 v16, v16
 v_exp_f32 v17, v17
 v_exp_f32 v18, v18
 v_exp_f32 v19, v19
 s_nop 0
 v_add_f32 v36, v28, v29
 v_add_f32 v37, v30, v31
 v_add_f32 v36, v36, v37
 v_mul_f32 v36, v36, v13
 v_add_f32 v36, v36, v16
 v_add_f32 v36, v36, v17
 v_add_f32 v36, v36, v18
 v_add_f32 v36, v36, v19
 v_mov_b32 v37, v36
 s_nop 1
 v_permlane32_swap_b32 v36, v37
 v_add_f32 v36, v36, v37
 v_mov_b32 v37, v36
 s_nop 1
 v_permlane16_swap_b32 v36, v37
 v_add_f32 v36, v36, v37
 v_rcp_f32 v36, v36
 s_nop 0
 v_mul_f32 v28, v28, v36
 v_mul_f32 v29, v29, v36
 v_mul_f32 v30, v30, v36
 v_mul_f32 v31, v31, v36
 v_mul_f32 v16, v16, v36
 v_mul_f32 v17, v17, v36
 v_mul_f32 v18, v18, v36
 v_mul_f32 v19, v19, v36
 v_cvt_pk_bf16_f32 v40, v16, v17
 v_cvt_pk_bf16_f32 v42, v18, v19
 v_mov_b32 v41, 0
 v_mov_b32 v43, 0
 v_cvt_pk_bf16_f32 v44, v28, v29
 v_cvt_pk_bf16_f32 v45, v30, v31
 s_add_u32 s11, s28, 111149056
 buffer_store_dwordx4 v[40:43], v1, s[4:7], s11 offen sc1
 s_add_u32 s11, s29, 113246208
 buffer_store_dword v44, v1, s[4:7], s11 offen sc1
 buffer_store_dword v45, v1, s[4:7], s11 offen offset:8 sc1
 v_cndmask_b32 v24, v12, v24, s[40:41]
 v_cndmask_b32 v25, v12, v25, s[42:43]
 v_cndmask_b32 v26, v12, v26, s[44:45]
 v_cndmask_b32 v27, v12, v27, s[46:47]
 v_max3_f32 v36, v32, v33, v34
 v_max3_f32 v36, v36, v35, v20
 v_max3_f32 v36, v36, v21, v22
 v_max3_f32 v36, v36, v23, v24
 v_max3_f32 v36, v36, v25, v26
 v_max_f32 v36, v36, v27
 v_mov_b32 v37, v36
 s_nop 1
 v_permlane32_swap_b32 v36, v37
 v_max_f32 v36, v36, v37
 v_mov_b32 v37, v36
 s_nop 1
 v_permlane16_swap_b32 v36, v37
 v_max_f32 v36, v36, v37
 v_sub_f32 v32, v32, v36
 v_sub_f32 v33, v33, v36
 v_sub_f32 v34, v34, v36
 v_sub_f32 v35, v35, v36
 v_sub_f32 v20, v20, v36
 v_sub_f32 v21, v21, v36
 v_sub_f32 v22, v22, v36
 v_sub_f32 v23, v23, v36
 v_sub_f32 v24, v24, v36
 v_sub_f32 v25, v25, v36
 v_sub_f32 v26, v26, v36
 v_sub_f32 v27, v27, v36
 v_exp_f32 v32, v32
 v_exp_f32 v33, v33
 v_exp_f32 v34, v34
 v_exp_f32 v35, v35
 v_exp_f32 v20, v20
 v_exp_f32 v21, v21
 v_exp_f32 v22, v22
 v_exp_f32 v23, v23
 v_exp_f32 v24, v24
 v_exp_f32 v25, v25
 v_exp_f32 v26, v26
 v_exp_f32 v27, v27
 s_nop 0
 v_add_f32 v36, v32, v33
 v_add_f32 v37, v34, v35
 v_add_f32 v36, v36, v37
 v_mul_f32 v36, v36, v13
 v_add_f32 v36, v36, v20
 v_add_f32 v36, v36, v21
 v_add_f32 v36, v36, v22
 v_add_f32 v36, v36, v23
 v_add_f32 v36, v36, v24
 v_add_f32 v36, v36, v25
 v_add_f32 v36, v36, v26
 v_add_f32 v36, v36, v27
 v_mov_b32 v37, v36
 s_nop 1
 v_permlane32_swap_b32 v36, v37
 v_add_f32 v36, v36, v37
 v_mov_b32 v37, v36
 s_nop 1
 v_permlane16_swap_b32 v36, v37
 v_add_f32 v36, v36, v37
 v_rcp_f32 v36, v36
 s_nop 0
 v_mul_f32 v32, v32, v36
 v_mul_f32 v33, v33, v36
 v_mul_f32 v34, v34, v36
 v_mul_f32 v35, v35, v36
 v_mul_f32 v20, v20, v36
 v_mul_f32 v21, v21, v36
 v_mul_f32 v22, v22, v36
 v_mul_f32 v23, v23, v36
 v_mul_f32 v24, v24, v36
 v_mul_f32 v25, v25, v36
 v_mul_f32 v26, v26, v36
 v_mul_f32 v27, v27, v36
 v_cvt_pk_bf16_f32 v48, v20, v21
 v_cvt_pk_bf16_f32 v50, v22, v23
 v_cvt_pk_bf16_f32 v49, v24, v25
 v_cvt_pk_bf16_f32 v51, v26, v27
 v_cvt_pk_bf16_f32 v52, v32, v33
 v_cvt_pk_bf16_f32 v53, v34, v35
 s_add_u32 s11, s28, 111150080
 buffer_store_dwordx4 v[48:51], v1, s[4:7], s11 offen sc1
 s_add_u32 s11, s29, 113247232
 buffer_store_dword v52, v1, s[4:7], s11 offen sc1
 buffer_store_dword v53, v1, s[4:7], s11 offen offset:8 sc1
 s_waitcnt vmcnt(0)
 s_barrier
 s_lshl_b32 s11, s20, 7
 s_add_u32 s33, s11, 18405376
 buffer_atomic_add v2, v3, s[4:7], s33 offen sc1
 s_branch K_loop
K_fv:
 s_lshr_b32 s11, s20, 2
 s_lshl_b32 s11, s11, 7
 s_add_u32 s23, s11, 18413568
 s_cmp_lg_u32 s8, 0
 s_cbranch_scc1 L_wcu_83_ok
 s_mov_b32 s19, 0
 v_mov_b32 v5, 0
 s_mov_b64 exec, 1
L_wcu_83:
 buffer_load_dword v6, v5, s[4:7], s23 offen sc1
 s_waitcnt vmcnt(0)
 v_readfirstlane_b32 s11, v6
 s_cmp_ge_u32 s11, 28
 s_cbranch_scc1 L_wcu_83_got
 s_sleep 12
 s_add_u32 s19, s19, 1
 s_cmp_le_u32 s19, 8192
 s_cbranch_scc1 L_wcu_83
 s_branch K_failw
L_wcu_83_got:
 s_mov_b64 exec, -1
L_wcu_83_ok:
 s_barrier
 s_mul_i32 s22, s21, 7
 s_lshl_b32 s11, s20, 4
 s_lshl_b32 s12, s8, 2
 s_add_u32 s11, s11, s12
 s_mul_i32 s11, s11, 28
 s_add_u32 s11, s11, s22
 s_lshl_b32 s24, s11, 10
 s_add_u32 s11, s24, 34603008
 buffer_load_dwordx4 a[0:3], v1, s[4:7], s11 offen offset:0 sc1
 buffer_load_dwordx4 a[4:7], v1, s[4:7], s11 offen offset:1024 sc1
 buffer_load_dwordx4 a[8:11], v1, s[4:7], s11 offen offset:2048 sc1
 buffer_load_dwordx4 a[12:15], v1, s[4:7], s11 offen offset:3072 sc1
 s_add_u32 s11, s24, 34607104
 buffer_load_dwordx4 a[16:19], v1, s[4:7], s11 offen offset:0 sc1
 buffer_load_dwordx4 a[20:23], v1, s[4:7], s11 offen offset:1024 sc1
 buffer_load_dwordx4 a[24:27], v1, s[4:7], s11 offen offset:2048 sc1
 s_add_u32 s11, s24, 34631680
 buffer_load_dwordx4 a[28:31], v1, s[4:7], s11 offen offset:0 sc1
 buffer_load_dwordx4 a[32:35], v1, s[4:7], s11 offen offset:1024 sc1
 buffer_load_dwordx4 a[36:39], v1, s[4:7], s11 offen offset:2048 sc1
 buffer_load_dwordx4 a[40:43], v1, s[4:7], s11 offen offset:3072 sc1
 s_add_u32 s11, s24, 34635776
 buffer_load_dwordx4 a[44:47], v1, s[4:7], s11 offen offset:0 sc1
 buffer_load_dwordx4 a[48:51], v1, s[4:7], s11 offen offset:1024 sc1
 buffer_load_dwordx4 a[52:55], v1, s[4:7], s11 offen offset:2048 sc1
 s_add_u32 s11, s24, 34660352
 buffer_load_dwordx4 a[56:59], v1, s[4:7], s11 offen offset:0 sc1
 buffer_load_dwordx4 a[60:63], v1, s[4:7], s11 offen offset:1024 sc1
 buffer_load_dwordx4 a[64:67], v1, s[4:7], s11 offen offset:2048 sc1
 buffer_load_dwordx4 a[68:71], v1, s[4:7], s11 offen offset:3072 sc1
 s_add_u32 s11, s24, 34664448
 buffer_load_dwordx4 a[72:75], v1, s[4:7], s11 offen offset:0 sc1
 buffer_load_dwordx4 a[76:79], v1, s[4:7], s11 offen offset:1024 sc1
 buffer_load_dwordx4 a[80:83], v1, s[4:7], s11 offen offset:2048 sc1
 s_add_u32 s11, s24, 34689024
 buffer_load_dwordx4 a[84:87], v1, s[4:7], s11 offen offset:0 sc1
 buffer_load_dwordx4 a[88:91], v1, s[4:7], s11 offen offset:1024 sc1
 buffer_load_dwordx4 a[92:95], v1, s[4:7], s11 offen offset:2048 sc1
 buffer_load_dwordx4 a[96:99], v1, s[4:7], s11 offen offset:3072 sc1
 s_add_u32 s11, s24, 34693120
 buffer_load_dwordx4 a[100:103], v1, s[4:7], s11 offen offset:0 sc1
 buffer_load_dwordx4 a[104:107], v1, s[4:7], s11 offen offset:1024 sc1
 buffer_load_dwordx4 a[108:111], v1, s[4:7], s11 offen offset:2048 sc1
 v_and_b32 v8, 15, v0
 v_lshrrev_b32 v9, 4, v0
 v_mul_u32_u24 v10, 896, v8
 v_lshl_add_u32 v10, v9, 3, v10
 v_lshlrev_b32 v11, 3, v0
 s_add_u32 s11, s8, 0
 s_min_u32 s11, s11, 13
 s_lshr_b32 s12, s11, 1
 s_and_b32 s13, s11, 1
 s_add_u32 s12, s12, s22
 s_lshl_b32 s40, s20, 1
 s_add_u32 s40, s40, s13
 s_mul_i32 s44, s40, 14336
 s_lshl_b32 s13, s12, 5
 s_add_u32 s44, s44, s13
 s_mul_i32 s40, s40, 28
 s_add_u32 s40, s40, s12
 s_lshl_b32 s40, s40, 9
 s_add_u32 s40, s40, 100663296
 buffer_load_dwordx2 v[16:17], v10, s[84:87], s44 offen
 s_add_u32 s11, s8, 4
 s_min_u32 s11, s11, 13
 s_lshr_b32 s12, s11, 1
 s_and_b32 s13, s11, 1
 s_add_u32 s12, s12, s22
 s_lshl_b32 s41, s20, 1
 s_add_u32 s41, s41, s13
 s_mul_i32 s45, s41, 14336
 s_lshl_b32 s13, s12, 5
 s_add_u32 s45, s45, s13
 s_mul_i32 s41, s41, 28
 s_add_u32 s41, s41, s12
 s_lshl_b32 s41, s41, 9
 s_add_u32 s41, s41, 100663296
 buffer_load_dwordx2 v[20:21], v10, s[84:87], s45 offen
 s_add_u32 s11, s8, 8
 s_min_u32 s11, s11, 13
 s_lshr_b32 s12, s11, 1
 s_and_b32 s13, s11, 1
 s_add_u32 s12, s12, s22
 s_lshl_b32 s42, s20, 1
 s_add_u32 s42, s42, s13
 s_mul_i32 s46, s42, 14336
 s_lshl_b32 s13, s12, 5
 s_add_u32 s46, s46, s13
 s_mul_i32 s42, s42, 28
 s_add_u32 s42, s42, s12
 s_lshl_b32 s42, s42, 9
 s_add_u32 s42, s42, 100663296
 buffer_load_dwordx2 v[24:25], v10, s[84:87], s46 offen
 s_add_u32 s11, s8, 12
 s_min_u32 s11, s11, 13
 s_lshr_b32 s12, s11, 1
 s_and_b32 s13, s11, 1
 s_add_u32 s12, s12, s22
 s_lshl_b32 s43, s20, 1
 s_add_u32 s43, s43, s13
 s_mul_i32 s47, s43, 14336
 s_lshl_b32 s13, s12, 5
 s_add_u32 s47, s47, s13
 s_mul_i32 s43, s43, 28
 s_add_u32 s43, s43, s12
 s_lshl_b32 s43, s43, 9
 s_add_u32 s43, s43, 100663296
 buffer_load_dwordx2 v[28:29], v10, s[84:87], s47 offen
 s_lshr_b32 s11, s20, 1
 s_lshl_b32 s11, s11, 7
 s_add_u32 s23, s11, 18419712
 s_cmp_lg_u32 s8, 0
 s_cbranch_scc1 L_wcg_84_ok
 s_mov_b32 s19, 0
 v_mov_b32 v5, 0
 s_mov_b64 exec, 1
L_wcg_84:
 buffer_load_dword v6, v5, s[4:7], s23 offen sc1
 s_waitcnt vmcnt(0)
 v_readfirstlane_b32 s11, v6
 s_cmp_ge_u32 s11, 1
 s_cbranch_scc1 L_wcg_84_got
 s_sleep 12
 s_add_u32 s19, s19, 1
 s_cmp_le_u32 s19, 8192
 s_cbranch_scc1 L_wcg_84
 s_branch K_failw
L_wcg_84_got:
 s_mov_b64 exec, -1
L_wcg_84_ok:
 s_barrier
 buffer_load_dwordx2 v[18:19], v11, s[4:7], s40 offen sc1
 buffer_load_dwordx2 v[22:23], v11, s[4:7], s41 offen sc1
 buffer_load_dwordx2 v[26:27], v11, s[4:7], s42 offen sc1
 buffer_load_dwordx2 v[30:31], v11, s[4:7], s43 offen sc1
 s_lshl_b32 s11, s20, 3
 s_lshl_b32 s12, s8, 1
 s_add_u32 s25, s11, s12
 s_lshl_b32 s11, s20, 7
 s_add_u32 s23, s11, 18405376
 s_cmp_lg_u32 s8, 0
 s_cbranch_scc1 L_wcp_85_ok
 s_mov_b32 s19, 0
 v_mov_b32 v5, 0
 s_mov_b64 exec, 1
L_wcp_85:
 buffer_load_dword v6, v5, s[4:7], s23 offen sc1
 s_waitcnt vmcnt(0)
 v_readfirstlane_b32 s11, v6
 s_cmp_ge_u32 s11, 4
 s_cbranch_scc1 L_wcp_85_got
 s_sleep 4
 s_add_u32 s19, s19, 1
 s_cmp_le_u32 s19, 8192
 s_cbranch_scc1 L_wcp_85
 s_branch K_failw
L_wcp_85_got:
 s_mov_b64 exec, -1
L_wcp_85_ok:
 s_barrier
 s_lshl_b32 s11, s20, 4
 s_lshl_b32 s12, s8, 2
 s_add_u32 s11, s11, s12
 s_lshl_b32 s27, s11, 11
 s_add_u32 s11, s27, 111149056
 buffer_load_dwordx4 a[168:171], v1, s[4:7], s11 offen offset:0 sc1
 buffer_load_dwordx4 a[172:175], v1, s[4:7], s11 offen offset:1024 sc1
 buffer_load_dwordx4 a[176:179], v1, s[4:7], s11 offen offset:2048 sc1
 buffer_load_dwordx4 a[180:183], v1, s[4:7], s11 offen offset:3072 sc1
 s_add_u32 s11, s27, 111153152
 buffer_load_dwordx4 a[184:187], v1, s[4:7], s11 offen offset:0 sc1
 buffer_load_dwordx4 a[188:191], v1, s[4:7], s11 offen offset:1024 sc1
 buffer_load_dwordx4 a[192:195], v1, s[4:7], s11 offen offset:2048 sc1
 buffer_load_dwordx4 a[196:199], v1, s[4:7], s11 offen offset:3072 sc1
 s_lshl_b32 s11, s25, 11
 s_add_u32 s11, s11, 113246208
 buffer_load_dwordx4 a[200:203], v1, s[4:7], s11 offen offset:0 sc1
 buffer_load_dwordx4 a[204:207], v1, s[4:7], s11 offen offset:1024 sc1
 buffer_load_dwordx4 a[208:211], v1, s[4:7], s11 offen offset:2048 sc1
 buffer_load_dwordx4 a[212:215], v1, s[4:7], s11 offen offset:3072 sc1
 s_lshl_b32 s11, s20, 7
 s_add_u32 s23, s11, 18397184
 s_cmp_lg_u32 s8, 0
 s_cbranch_scc1 L_wcy_86_ok
 s_mov_b32 s19, 0
 v_mov_b32 v5, 0
 s_mov_b64 exec, 1
L_wcy_86:
 buffer_load_dword v6, v5, s[4:7], s23 offen sc1
 s_waitcnt vmcnt(0)
 v_readfirstlane_b32 s11, v6
 s_cmp_ge_u32 s11, 14
 s_cbranch_scc1 L_wcy_86_got
 s_sleep 4
 s_add_u32 s19, s19, 1
 s_cmp_le_u32 s19, 8192
 s_cbranch_scc1 L_wcy_86
 s_branch K_failw
L_wcy_86_got:
 s_mov_b64 exec, -1
L_wcy_86_ok:
 s_barrier
 s_mul_i32 s11, s25, 28
 s_add_u32 s11, s11, s22
 s_lshl_b32 s26, s11, 10
 s_add_u32 s11, s26, 19136512
 buffer_load_dwordx4 a[112:115], v1, s[4:7], s11 offen offset:0 sc1
 buffer_load_dwordx4 a[116:119], v1, s[4:7], s11 offen offset:1024 sc1
 buffer_load_dwordx4 a[120:123], v1, s[4:7], s11 offen offset:2048 sc1
 buffer_load_dwordx4 a[124:127], v1, s[4:7], s11 offen offset:3072 sc1
 s_add_u32 s11, s26, 19140608
 buffer_load_dwordx4 a[128:131], v1, s[4:7], s11 offen offset:0 sc1
 buffer_load_dwordx4 a[132:135], v1, s[4:7], s11 offen offset:1024 sc1
 buffer_load_dwordx4 a[136:139], v1, s[4:7], s11 offen offset:2048 sc1
 s_add_u32 s11, s26, 19165184
 buffer_load_dwordx4 a[140:143], v1, s[4:7], s11 offen offset:0 sc1
 buffer_load_dwordx4 a[144:147], v1, s[4:7], s11 offen offset:1024 sc1
 buffer_load_dwordx4 a[148:151], v1, s[4:7], s11 offen offset:2048 sc1
 buffer_load_dwordx4 a[152:155], v1, s[4:7], s11 offen offset:3072 sc1
 s_add_u32 s11, s26, 19169280
 buffer_load_dwordx4 a[156:159], v1, s[4:7], s11 offen offset:0 sc1
 buffer_load_dwordx4 a[160:163], v1, s[4:7], s11 offen offset:1024 sc1
 buffer_load_dwordx4 a[164:167], v1, s[4:7], s11 offen offset:2048 sc1
 s_waitcnt vmcnt(14)
 v_mfma_f32_16x16x32_bf16 v[64:67], a[0:3], a[168:171], 0
 v_mfma_f32_16x16x32_bf16 v[68:71], a[0:3], a[172:175], 0
 v_mfma_f32_16x16x32_bf16 v[72:75], a[4:7], a[168:171], 0
 v_mfma_f32_16x16x32_bf16 v[76:79], a[4:7], a[172:175], 0
 v_mfma_f32_16x16x32_bf16 v[80:83], a[8:11], a[168:171], 0
 v_mfma_f32_16x16x32_bf16 v[84:87], a[8:11], a[172:175], 0
 v_mfma_f32_16x16x32_bf16 v[88:91], a[12:15], a[168:171], 0
 v_mfma_f32_16x16x32_bf16 v[92:95], a[12:15], a[172:175], 0
 v_mfma_f32_16x16x32_bf16 v[96:99], a[16:19], a[168:171], 0
 v_mfma_f32_16x16x32_bf16 v[100:103], a[16:19], a[172:175], 0
 v_mfma_f32_16x16x32_bf16 v[104:107], a[20:23], a[168:171], 0
 v_mfma_f32_16x16x32_bf16 v[108:111], a[20:23], a[172:175], 0
 v_mfma_f32_16x16x32_bf16 v[112:115], a[24:27], a[168:171], 0
 v_mfma_f32_16x16x32_bf16 v[116:119], a[24:27], a[172:175], 0
 v_mfma_f32_16x16x32_bf16 v[64:67], a[28:31], a[176:179], v[64:67]
 v_mfma_f32_16x16x32_bf16 v[68:71], a[28:31], a[180:183], v[68:71]
 v_mfma_f32_16x16x32_bf16 v[72:75], a[32:35], a[176:179], v[72:75]
 v_mfma_f32_16x16x32_bf16 v[76:79], a[32:35], a[180:183], v[76:79]
 v_mfma_f32_16x16x32_bf16 v[80:83], a[36:39], a[176:179], v[80:83]
 v_mfma_f32_16x16x32_bf16 v[84:87], a[36:39], a[180:183], v[84:87]
 v_mfma_f32_16x16x32_bf16 v[88:91], a[40:43], a[176:179], v[88:91]
 v_mfma_f32_16x16x32_bf16 v[92:95], a[40:43], a[180:183], v[92:95]
 v_mfma_f32_16x16x32_bf16 v[96:99], a[44:47], a[176:179], v[96:99]
 v_mfma_f32_16x16x32_bf16 v[100:103], a[44:47], a[180:183], v[100:103]
 v_mfma_f32_16x16x32_bf16 v[104:107], a[48:51], a[176:179], v[104:107]
 v_mfma_f32_16x16x32_bf16 v[108:111], a[48:51], a[180:183], v[108:111]
 v_mfma_f32_16x16x32_bf16 v[112:115], a[52:55], a[176:179], v[112:115]
 v_mfma_f32_16x16x32_bf16 v[116:119], a[52:55], a[180:183], v[116:119]
 v_mfma_f32_16x16x32_bf16 v[64:67], a[56:59], a[184:187], v[64:67]
 v_mfma_f32_16x16x32_bf16 v[68:71], a[56:59], a[188:191], v[68:71]
 v_mfma_f32_16x16x32_bf16 v[72:75], a[60:63], a[184:187], v[72:75]
 v_mfma_f32_16x16x32_bf16 v[76:79], a[60:63], a[188:191], v[76:79]
 v_mfma_f32_16x16x32_bf16 v[80:83], a[64:67], a[184:187], v[80:83]
 v_mfma_f32_16x16x32_bf16 v[84:87], a[64:67], a[188:191], v[84:87]
 v_mfma_f32_16x16x32_bf16 v[88:91], a[68:71], a[184:187], v[88:91]
 v_mfma_f32_16x16x32_bf16 v[92:95], a[68:71], a[188:191], v[92:95]
 v_mfma_f32_16x16x32_bf16 v[96:99], a[72:75], a[184:187], v[96:99]
 v_mfma_f32_16x16x32_bf16 v[100:103], a[72:75], a[188:191], v[100:103]
 v_mfma_f32_16x16x32_bf16 v[104:107], a[76:79], a[184:187], v[104:107]
 v_mfma_f32_16x16x32_bf16 v[108:111], a[76:79], a[188:191], v[108:111]
 v_mfma_f32_16x16x32_bf16 v[112:115], a[80:83], a[184:187], v[112:115]
 v_mfma_f32_16x16x32_bf16 v[116:119], a[80:83], a[188:191], v[116:119]
 v_mfma_f32_16x16x32_bf16 v[64:67], a[84:87], a[192:195], v[64:67]
 v_mfma_f32_16x16x32_bf16 v[68:71], a[84:87], a[196:199], v[68:71]
 v_mfma_f32_16x16x32_bf16 v[72:75], a[88:91], a[192:195], v[72:75]
 v_mfma_f32_16x16x32_bf16 v[76:79], a[88:91], a[196:199], v[76:79]
 v_mfma_f32_16x16x32_bf16 v[80:83], a[92:95], a[192:195], v[80:83]
 v_mfma_f32_16x16x32_bf16 v[84:87], a[92:95], a[196:199], v[84:87]
 v_mfma_f32_16x16x32_bf16 v[88:91], a[96:99], a[192:195], v[88:91]
 v_mfma_f32_16x16x32_bf16 v[92:95], a[96:99], a[196:199], v[92:95]
 v_mfma_f32_16x16x32_bf16 v[96:99], a[100:103], a[192:195], v[96:99]
 v_mfma_f32_16x16x32_bf16 v[100:103], a[100:103], a[196:199], v[100:103]
 v_mfma_f32_16x16x32_bf16 v[104:107], a[104:107], a[192:195], v[104:107]
 v_mfma_f32_16x16x32_bf16 v[108:111], a[104:107], a[196:199], v[108:111]
 v_mfma_f32_16x16x32_bf16 v[112:115], a[108:111], a[192:195], v[112:115]
 v_mfma_f32_16x16x32_bf16 v[116:119], a[108:111], a[196:199], v[116:119]
 s_waitcnt vmcnt(0)
 v_mfma_f32_16x16x32_bf16 v[64:67], a[112:115], a[200:203], v[64:67]
 v_mfma_f32_16x16x32_bf16 v[68:71], a[112:115], a[204:207], v[68:71]
 v_mfma_f32_16x16x32_bf16 v[72:75], a[116:119], a[200:203], v[72:75]
 v_mfma_f32_16x16x32_bf16 v[76:79], a[116:119], a[204:207], v[76:79]
 v_mfma_f32_16x16x32_bf16 v[80:83], a[120:123], a[200:203], v[80:83]
 v_mfma_f32_16x16x32_bf16 v[84:87], a[120:123], a[204:207], v[84:87]
 v_mfma_f32_16x16x32_bf16 v[88:91], a[124:127], a[200:203], v[88:91]
 v_mfma_f32_16x16x32_bf16 v[92:95], a[124:127], a[204:207], v[92:95]
 v_mfma_f32_16x16x32_bf16 v[96:99], a[128:131], a[200:203], v[96:99]
 v_mfma_f32_16x16x32_bf16 v[100:103], a[128:131], a[204:207], v[100:103]
 v_mfma_f32_16x16x32_bf16 v[104:107], a[132:135], a[200:203], v[104:107]
 v_mfma_f32_16x16x32_bf16 v[108:111], a[132:135], a[204:207], v[108:111]
 v_mfma_f32_16x16x32_bf16 v[112:115], a[136:139], a[200:203], v[112:115]
 v_mfma_f32_16x16x32_bf16 v[116:119], a[136:139], a[204:207], v[116:119]
 v_mfma_f32_16x16x32_bf16 v[64:67], a[140:143], a[208:211], v[64:67]
 v_mfma_f32_16x16x32_bf16 v[68:71], a[140:143], a[212:215], v[68:71]
 v_mfma_f32_16x16x32_bf16 v[72:75], a[144:147], a[208:211], v[72:75]
 v_mfma_f32_16x16x32_bf16 v[76:79], a[144:147], a[212:215], v[76:79]
 v_mfma_f32_16x16x32_bf16 v[80:83], a[148:151], a[208:211], v[80:83]
 v_mfma_f32_16x16x32_bf16 v[84:87], a[148:151], a[212:215], v[84:87]
 v_mfma_f32_16x16x32_bf16 v[88:91], a[152:155], a[208:211], v[88:91]
 v_mfma_f32_16x16x32_bf16 v[92:95], a[152:155], a[212:215], v[92:95]
 v_mfma_f32_16x16x32_bf16 v[96:99], a[156:159], a[208:211], v[96:99]
 v_mfma_f32_16x16x32_bf16 v[100:103], a[156:159], a[212:215], v[100:103]
 v_mfma_f32_16x16x32_bf16 v[104:107], a[160:163], a[208:211], v[104:107]
 v_mfma_f32_16x16x32_bf16 v[108:111], a[160:163], a[212:215], v[108:111]
 v_mfma_f32_16x16x32_bf16 v[112:115], a[164:167], a[208:211], v[112:115]
 v_mfma_f32_16x16x32_bf16 v[116:119], a[164:167], a[212:215], v[116:119]
 s_nop 7
 s_mul_i32 s11, s8, 14336
 v_add_u32 v12, s11, v1
 ds_write_b128 v12, v[64:67] offset:0
 ds_write_b128 v12, v[68:71] offset:1024
 ds_write_b128 v12, v[72:75] offset:2048
 ds_write_b128 v12, v[76:79] offset:3072
 ds_write_b128 v12, v[80:83] offset:4096
 ds_write_b128 v12, v[84:87] offset:5120
 ds_write_b128 v12, v[88:91] offset:6144
 ds_write_b128 v12, v[92:95] offset:7168
 ds_write_b128 v12, v[96:99] offset:8192
 ds_write_b128 v12, v[100:103] offset:9216
 ds_write_b128 v12, v[104:107] offset:10240
 ds_write_b128 v12, v[108:111] offset:11264
 ds_write_b128 v12, v[112:115] offset:12288
 ds_write_b128 v12, v[116:119] offset:13312
 s_waitcnt lgkmcnt(0)
 s_barrier
 s_lshl_b32 s11, s8, 10
 v_add_u32 v12, s11, v1
 v_add_u32 v13, 28672, v12
 ds_read_b128 v[40:43], v12 offset:0
 ds_read_b128 v[44:47], v12 offset:14336
 ds_read_b128 v[48:51], v13 offset:0
 ds_read_b128 v[52:55], v13 offset:14336
 s_waitcnt lgkmcnt(0)
 v_pk_add_f32 v[40:41], v[40:41], v[44:45]
 v_pk_add_f32 v[48:49], v[48:49], v[52:53]
 v_pk_add_f32 v[40:41], v[40:41], v[48:49]
 v_pk_add_f32 v[42:43], v[42:43], v[46:47]
 v_pk_add_f32 v[50:51], v[50:51], v[54:55]
 v_pk_add_f32 v[42:43], v[42:43], v[50:51]
 v_lshlrev_b32 v44, 16, v16
 v_and_b32 v45, 0xffff0000, v16
 v_lshlrev_b32 v48, 16, v18
 v_and_b32 v49, 0xffff0000, v18
 v_lshlrev_b32 v46, 16, v17
 v_and_b32 v47, 0xffff0000, v17
 v_lshlrev_b32 v50, 16, v19
 v_and_b32 v51, 0xffff0000, v19
 v_fma_f32 v40, v40, v48, v44
 v_fma_f32 v41, v41, v49, v45
 v_fma_f32 v42, v42, v50, v46
 v_fma_f32 v43, v43, v51, v47
 v_cvt_pk_bf16_f32 v52, v40, v41
 v_cvt_pk_bf16_f32 v53, v42, v43
 buffer_store_dwordx2 v[52:53], v10, s[88:91], s44 offen
L_fv_skip_87:
 ds_read_b128 v[40:43], v12 offset:4096
 ds_read_b128 v[44:47], v12 offset:18432
 ds_read_b128 v[48:51], v13 offset:4096
 ds_read_b128 v[52:55], v13 offset:18432
 s_waitcnt lgkmcnt(0)
 v_pk_add_f32 v[40:41], v[40:41], v[44:45]
 v_pk_add_f32 v[48:49], v[48:49], v[52:53]
 v_pk_add_f32 v[40:41], v[40:41], v[48:49]
 v_pk_add_f32 v[42:43], v[42:43], v[46:47]
 v_pk_add_f32 v[50:51], v[50:51], v[54:55]
 v_pk_add_f32 v[42:43], v[42:43], v[50:51]
 v_lshlrev_b32 v44, 16, v20
 v_and_b32 v45, 0xffff0000, v20
 v_lshlrev_b32 v48, 16, v22
 v_and_b32 v49, 0xffff0000, v22
 v_lshlrev_b32 v46, 16, v21
 v_and_b32 v47, 0xffff0000, v21
 v_lshlrev_b32 v50, 16, v23
 v_and_b32 v51, 0xffff0000, v23
 v_fma_f32 v40, v40, v48, v44
 v_fma_f32 v41, v41, v49, v45
 v_fma_f32 v42, v42, v50, v46
 v_fma_f32 v43, v43, v51, v47
 v_cvt_pk_bf16_f32 v52, v40, v41
 v_cvt_pk_bf16_f32 v53, v42, v43
 buffer_store_dwordx2 v[52:53], v10, s[88:91], s45 offen
L_fv_skip_88:
 ds_read_b128 v[40:43], v12 offset:8192
 ds_read_b128 v[44:47], v12 offset:22528
 ds_read_b128 v[48:51], v13 offset:8192
 ds_read_b128 v[52:55], v13 offset:22528
 s_waitcnt lgkmcnt(0)
 v_pk_add_f32 v[40:41], v[40:41], v[44:45]
 v_pk_add_f32 v[48:49], v[48:49], v[52:53]
 v_pk_add_f32 v[40:41], v[40:41], v[48:49]
 v_pk_add_f32 v[42:43], v[42:43], v[46:47]
 v_pk_add_f32 v[50:51], v[50:51], v[54:55]
 v_pk_add_f32 v[42:43], v[42:43], v[50:51]
 v_lshlrev_b32 v44, 16, v24
 v_and_b32 v45, 0xffff0000, v24
 v_lshlrev_b32 v48, 16, v26
 v_and_b32 v49, 0xffff0000, v26
 v_lshlrev_b32 v46, 16, v25
 v_and_b32 v47, 0xffff0000, v25
 v_lshlrev_b32 v50, 16, v27
 v_and_b32 v51, 0xffff0000, v27
 v_fma_f32 v40, v40, v48, v44
 v_fma_f32 v41, v41, v49, v45
 v_fma_f32 v42, v42, v50, v46
 v_fma_f32 v43, v43, v51, v47
 v_cvt_pk_bf16_f32 v52, v40, v41
 v_cvt_pk_bf16_f32 v53, v42, v43
 buffer_store_dwordx2 v[52:53], v10, s[88:91], s46 offen
L_fv_skip_89:
 s_cmp_ge_u32 s8, 2
 s_cbranch_scc1 L_fv_skip_90
 ds_read_b128 v[40:43], v12 offset:12288
 ds_read_b128 v[44:47], v12 offset:26624
 ds_read_b128 v[48:51], v13 offset:12288
 ds_read_b128 v[52:55], v13 offset:26624
 s_waitcnt lgkmcnt(0)
 v_pk_add_f32 v[40:41], v[40:41], v[44:45]
 v_pk_add_f32 v[48:49], v[48:49], v[52:53]
 v_pk_add_f32 v[40:41], v[40:41], v[48:49]
 v_pk_add_f32 v[42:43], v[42:43], v[46:47]
 v_pk_add_f32 v[50:51], v[50:51], v[54:55]
 v_pk_add_f32 v[42:43], v[42:43], v[50:51]
 v_lshlrev_b32 v44, 16, v28
 v_and_b32 v45, 0xffff0000, v28
 v_lshlrev_b32 v48, 16, v30
 v_and_b32 v49, 0xffff0000, v30
 v_lshlrev_b32 v46, 16, v29
 v_and_b32 v47, 0xffff0000, v29
 v_lshlrev_b32 v50, 16, v31
 v_and_b32 v51, 0xffff0000, v31
 v_fma_f32 v40, v40, v48, v44
 v_fma_f32 v41, v41, v49, v45
 v_fma_f32 v42, v42, v50, v46
 v_fma_f32 v43, v43, v51, v47
 v_cvt_pk_bf16_f32 v52, v40, v41
 v_cvt_pk_bf16_f32 v53, v42, v43
 buffer_store_dwordx2 v[52:53], v10, s[88:91], s47 offen
L_fv_skip_90:
 s_waitcnt vmcnt(0)
 s_barrier
 s_branch K_loop
K_failw:
 s_mov_b64 exec, -1
 v_mov_b32 v5, 163808
 v_mov_b32 v6, 1
 ds_write_b32 v5, v6
 s_waitcnt lgkmcnt(0)
K_fail:
 s_mov_b64 exec, -1
 v_mov_b32 v5, 32
 v_mov_b32 v6, 0xdead
 v_mov_b32 v7, s2
 v_mov_b32 v8, s92
 v_mov_b32 v9, s72
 buffer_store_dwordx4 v[6:9], v5, s[80:83], 0 offen
K_done:
 s_waitcnt vmcnt(0) lgkmcnt(0)
 s_waitcnt vmcnt(0)
K_exit:
 s_endpgm
.section .rodata,"a"
.p2align 6
.amdhsa_kernel rs_prep_kernel
  .amdhsa_next_free_vgpr 512
  .amdhsa_next_free_sgpr 102
  .amdhsa_accum_offset 256
  .amdhsa_group_segment_fixed_size 0
  .amdhsa_kernarg_size 112
  .amdhsa_user_sgpr_count 2
  .amdhsa_user_sgpr_kernarg_segment_ptr 1
  .amdhsa_system_sgpr_workgroup_id_x 1
.end_amdhsa_kernel
.p2align 6
.amdhsa_kernel recurrent_scan__memory_aug_recurrent_mem_tr__glu_gated_reglu__prompt_kernel
  .amdhsa_next_free_vgpr 512
  .amdhsa_next_free_sgpr 102
  .amdhsa_accum_offset 256
  .amdhsa_group_segment_fixed_size 0
  .amdhsa_kernarg_size 112
  .amdhsa_user_sgpr_count 2
  .amdhsa_user_sgpr_kernarg_segment_ptr 1
  .amdhsa_system_sgpr_workgroup_id_x 1
.end_amdhsa_kernel
```
